```python
import torch

def _softmax(x, axis=-1):
    return torch.softmax(x, dim=axis)

def _gelu(x):
    return torch.nn.functional.gelu(x, approximate='tanh')

def _silu(x):
    return torch.nn.functional.silu(x)

def _sigmoid(x):
    return torch.sigmoid(x)

def _layernorm(x, axis=-1, eps=1e-05):
    m = x.mean(dim=axis, keepdim=True)
    v = x.var(dim=axis, keepdim=True, unbiased=False)
    return (x - m) / torch.sqrt(v + eps)

def _scatter_add(tgt, idx, src, axis=0):
    return tgt.clone().index_add_(axis, idx, src)

def _segment_sum(src, seg, n):
    out = torch.zeros((n,) + src.shape[1:], dtype=src.dtype)
    return out.index_add_(0, seg, src)

def _pad(x, pw):
    flat = tuple((v for pair in reversed(pw) for v in pair))
    return torch.nn.functional.pad(x, flat)
kernel_name = 'interleave_layers__memory_aug_recurrent_mem_tr__sliding_local_dilated__prompt'

def setup_inputs():

    _w = lambda a: (lambda t: t.to(torch.bfloat16) if t.is_floating_point() else t)(torch.as_tensor(a))

    def _A_setup():
        B, S, Dm = (1, 2048, 640)
        H, Dh = (32, 192)
        M, seg = (8, 32)
        seg = min(seg, S)
        S = S // seg * seg
        return {'x': _w((lambda *s: torch.randn(*s, dtype=torch.bfloat16) * 0.05)(B, S, Dm)), 'mem0': _w((lambda *s: torch.randn(*s, dtype=torch.bfloat16) * 0.8)(B, M, Dm)), 'Wq': _w((lambda *s: torch.randn(*s, dtype=torch.bfloat16) * 1.6)(Dm, H, Dh) * Dm ** (-0.5)), 'Wk': _w((lambda *s: torch.randn(*s, dtype=torch.bfloat16) * 1.6)(Dm, H, Dh) * Dm ** (-0.5)), 'Wv': _w((lambda *s: torch.randn(*s, dtype=torch.bfloat16) * 0.8)(Dm, H, Dh) * Dm ** (-0.5)), 'Wo': _w((lambda *s: torch.randn(*s, dtype=torch.bfloat16) * 0.8)(H, Dh, Dm) * (H * Dh) ** (-0.5)), 'seg_len': seg}
    _A_in = _A_setup()

    def _B_setup():
        B, S, D = (1, 2048, 640)
        return {'x': _w((lambda *s: torch.randn(*s, dtype=torch.bfloat16) * 0.05)(B, S, D)), 'wqkv': _w((lambda *s: torch.randn(*s, dtype=torch.bfloat16) * 0.05)(D, 3 * D)), 'wo': _w((lambda *s: torch.randn(*s, dtype=torch.bfloat16) * 0.05)(D, D))}
    _B_in = _B_setup()
    return {'A_x': _A_in['x'], 'A_mem0': _A_in['mem0'], 'A_Wq': _A_in['Wq'], 'A_Wk': _A_in['Wk'], 'A_Wv': _A_in['Wv'], 'A_Wo': _A_in['Wo'], 'A_seg_len': _A_in['seg_len'], 'B_x': _B_in['x'], 'B_wqkv': _B_in['wqkv'], 'B_wo': _B_in['wo']}

def reference(A_x, A_mem0, A_Wq, A_Wk, A_Wv, A_Wo, A_seg_len, B_x, B_wqkv, B_wo):

    def _A_ref(x, mem0, Wq, Wk, Wv, Wo, seg_len):
        B, S, Dm = x.shape
        H, Dh = (Wq.shape[1], Wq.shape[2])
        M = mem0.shape[1]
        scale = Dh ** (-0.5)
        n_seg = S // seg_len
        L = M + seg_len
        idx = torch.arange(L)
        mask = (idx[:, None] < M) | (idx[:, None] >= idx[None, :])
        mem = mem0
        outs = []
        for s in range(n_seg):
            xs = x[:, s * seg_len:(s + 1) * seg_len, :].clone()
            h = torch.concatenate([mem, xs], axis=1)
            q = torch.einsum('btd,dhe->bhte', h, Wq)
            k = torch.einsum('btd,dhe->bhte', h, Wk)
            v = torch.einsum('btd,dhe->bhte', h, Wv)
            scores = torch.einsum('bhqe,bhke->bhqk', q, k) * scale
            scores = torch.where(mask[None, None], scores, -1000000000.0)
            p = _softmax(scores, axis=-1)
            o = torch.einsum('bhqk,bhke->bhqe', p, v)
            o = torch.einsum('bhte,hed->btd', o, Wo)
            mem = o[:, :M, :].clone()
            outs.append(o[:, M:, :])
        return torch.concatenate(outs, axis=1)

    def _B_ref(x, wqkv, wo):
        B, S, D = x.shape
        H = 32
        Dh = D // H
        W, dil = (8, 2)
        qkv = (lambda x, *d: x.permute(*d))((x @ wqkv).reshape(B, S, 3, H, Dh), 2, 0, 3, 1, 4)
        q, k, v = (qkv[0], qkv[1], qkv[2])
        scale = Dh ** (-0.5)
        pos = torch.arange(S)
        off = torch.arange(W) * dil
        idx = pos[:, None] - off[None, :]
        mask = idx >= 0
        idx_c = torch.where(mask, idx, 0).reshape(-1)
        kg = k[:, :, idx_c, :].reshape(B, H, S, W, Dh)
        vg = v[:, :, idx_c, :].reshape(B, H, S, W, Dh)
        logits = torch.einsum('bhsd,bhswd->bhsw', q, kg) * scale
        logits = torch.where(mask[None, None, :, :], logits, -1000000000.0)
        attn = _softmax(logits, axis=-1)
        o = torch.einsum('bhsw,bhswd->bhsd', attn, vg)
        return (lambda x, *d: x.permute(*d))(o, 0, 2, 1, 3).reshape(B, S, D) @ wo
    x = A_x
    x = x + _A_ref(_layernorm(x, axis=-1), A_mem0, A_Wq, A_Wk, A_Wv, A_Wo, A_seg_len)
    x = x + _B_ref(_layernorm(x, axis=-1), B_wqkv, B_wo)
    x = x + _A_ref(_layernorm(x, axis=-1), A_mem0, A_Wq, A_Wk, A_Wv, A_Wo, A_seg_len)
    x = x + _B_ref(_layernorm(x, axis=-1), B_wqkv, B_wo)
    return x
```

```asm
; @launch grid=(256,1,1) block=(256,1,1) lds=163840
.amdgcn_target "amdgcn-amd-amdhsa--gfx950"
.text
.globl interleave_layers__memory_aug_recurrent_mem_tr__sliding_local_dilated__prompt_kernel
.p2align 8
.type interleave_layers__memory_aug_recurrent_mem_tr__sliding_local_dilated__prompt_kernel,@function
interleave_layers__memory_aug_recurrent_mem_tr__sliding_local_dilated__prompt_kernel:
  s_cmp_ge_u32 s2, 256
  s_cbranch_scc1 L_end
  s_load_dwordx8 s[16:23], s[0:1], 0
  s_load_dwordx4 s[24:27], s[0:1], 32
  s_load_dwordx8 s[32:39], s[0:1], 64
  s_load_dwordx2 s[40:41], s[0:1], 96
  s_getreg_b32 s42, hwreg(HW_REG_XCC_ID)
  s_and_b32 s42, s42, 7
  s_lshl_b32 s42, s42, 2
  s_lshr_b32 s42, 0x53427160, s42
  s_and_b32 s42, s42, 7
  v_lshrrev_b32 v1, 6, v0
  s_nop 0
  v_readfirstlane_b32 s12, v1
  s_mov_b32 s14, 0
  s_mov_b32 s15, 0
  s_waitcnt lgkmcnt(0)
  s_mov_b32 s4, s40
  s_mov_b32 s5, s41
  s_mov_b32 s6, 268435456
  s_mov_b32 s7, 0x20000
  s_mov_b32 s8, s38
  s_mov_b32 s9, s39
  s_mov_b32 s10, 256
  s_mov_b32 s11, 0x20000
  v_mov_b32 v3, 40000
  s_cmp_lg_u32 s12, 0
  s_cbranch_scc1 L_tick_done
  s_mov_b64 exec, 1
  v_mov_b32 v8, 1
  s_mov_b32 s44, 0
  s_mul_i32 s43, s42, 65
  s_and_b32 s43, s43, 0xc4
  buffer_atomic_add v8, off, s[8:11], s43 sc0
  s_waitcnt vmcnt(0)
  v_readfirstlane_b32 s45, v8
  s_and_b32 s45, s45, 0xffff
  s_cmp_lt_u32 s45, 32
  s_cbranch_scc1 L_tick_got
L_tick_next:
  s_mov_b32 s42, s44
  s_add_u32 s44, s44, 1
  v_mov_b32 v8, 0x10001
  s_mul_i32 s43, s42, 65
  s_and_b32 s43, s43, 0xc4
  buffer_atomic_add v8, off, s[8:11], s43 sc0
  s_waitcnt vmcnt(0)
  v_readfirstlane_b32 s45, v8
  s_and_b32 s45, s45, 0xffff
  s_cmp_lt_u32 s45, 32
  s_cbranch_scc1 L_tick_got
  s_cmp_lt_u32 s44, 8
  s_cbranch_scc1 L_tick_next
  s_mov_b32 s42, 8
  s_mov_b32 s45, 0
L_tick_got:
  s_lshl_b32 s42, s42, 5
  s_add_u32 s42, s42, s45
  v_mov_b32 v8, s42
  ds_write_b32 v3, v8
  s_waitcnt lgkmcnt(0)
  s_mov_b64 exec, -1
L_tick_done:
  s_barrier
  ds_read_b32 v8, v3
  s_waitcnt lgkmcnt(0)
  v_readfirstlane_b32 s13, v8
  s_barrier
  v_and_b32 v0, 63, v0
  s_cmp_ge_u32 s13, 256
  s_cbranch_scc1 L_end
  s_mov_b32 s100, 0
  s_cmp_lt_u32 s13, 64
  s_cbranch_scc1 L_role_rec
  s_cmp_lt_u32 s13, 128
  s_cbranch_scc1 L_second
  s_cmp_lt_u32 s13, 128
  s_cbranch_scc1 L_idle
  s_sub_u32 s101, s13, 128
  s_cmp_lt_u32 s13, 140
  s_cbranch_scc1 L_role_qkv
  s_sub_u32 s101, s13, 140
  s_cmp_lt_u32 s13, 150
  s_cbranch_scc1 L_to_bq
  s_sub_u32 s101, s13, 150
  s_cmp_lt_u32 s13, 160
  s_cbranch_scc1 L_sets
  s_sub_u32 s101, s13, 148
  s_cmp_lt_u32 s13, 180
  s_cbranch_scc1 L_role_qkv
  s_sub_u32 s101, s13, 170
  s_cmp_lt_u32 s13, 182
  s_cbranch_scc1 L_to_bq
  s_sub_u32 s101, s13, 162
  s_cmp_lt_u32 s13, 192
  s_cbranch_scc1 L_sets
  s_sub_u32 s101, s13, 160
  s_cmp_lt_u32 s13, 212
  s_cbranch_scc1 L_role_qkv
  s_sub_u32 s101, s13, 200
  s_cmp_lt_u32 s13, 214
  s_cbranch_scc1 L_to_bq
  s_sub_u32 s101, s13, 204
  s_cmp_lt_u32 s13, 219
  s_cbranch_scc1 L_sets
  s_sub_u32 s101, s13, 189
  s_cmp_lt_u32 s13, 224
  s_cbranch_scc1 L_sets
  s_sub_u32 s101, s13, 172
  s_cmp_lt_u32 s13, 244
  s_cbranch_scc1 L_role_qkv
  s_sub_u32 s101, s13, 230
  s_cmp_lt_u32 s13, 246
  s_cbranch_scc1 L_to_bq
  s_sub_u32 s101, s13, 231
  s_cmp_lt_u32 s13, 251
  s_cbranch_scc1 L_sets
  s_sub_u32 s101, s13, 216
  s_cmp_lt_u32 s13, 256
  s_cbranch_scc1 L_sets
L_sets:
  s_sub_u32 s42, s101, 30
  s_cmp_lt_u32 s42, 5
  s_cbranch_scc1 L_nofill
  s_sub_u32 s42, s101, 5
  s_cmp_lt_u32 s101, 30
  s_cselect_b32 s42, s101, s42
  v_mov_b32 v4, -1
  v_mov_b32 v5, -1
  v_mov_b32 v6, -1
  v_mov_b32 v7, -1
  v_lshlrev_b32 v8, 4, v0
  s_mul_i32 s96, s42, 65536
  s_lshl_b32 s97, s12, 10
  s_add_u32 s96, s96, s97
  s_mov_b32 s97, 458752
  s_cmp_lt_u32 s42, 33
  s_cselect_b32 s97, 1280, s97
  s_add_u32 s96, s96, s97
  s_add_u32 s97, s96, 65536
L_fill_1:
  buffer_store_dwordx4 v[4:7], v8, s[4:7], s96 offen sc1
  s_add_u32 s96, s96, 4096
  s_cmp_lt_u32 s96, s97
  s_cbranch_scc1 L_fill_1
  s_waitcnt vmcnt(0)
  s_barrier
  s_cmp_lg_u32 s12, 0
  s_cbranch_scc1 L_sig_2
  s_mov_b64 exec, 1
  v_mov_b32 v8, 8
  v_mov_b32 v9, 1
  global_atomic_add v8, v9, s[38:39]
  s_mov_b64 exec, -1
L_sig_2:
L_nofill:
  s_cmp_lt_u32 s101, 25
  s_cbranch_scc1 L_role_leaf
  s_sub_u32 s101, s101, 25
  s_cmp_lt_u32 s101, 5
  s_cbranch_scc1 L_role_root
  s_cmp_lt_u32 s101, 10
  s_cbranch_scc1 L_role_ln0
  s_sub_u32 s101, s101, 10
  s_cmp_lt_u32 s101, 5
  s_cbranch_scc1 L_role_bo
  s_sub_u32 s101, s101, 5
L_idle:
L_end:
  s_endpgm
L_second:
  s_and_b32 s101, s13, 63
  s_mov_b32 s100, 1
  s_branch L_role_qkv
L_to_bq:
  s_cmp_lt_u32 s101, 8
  s_cbranch_scc1 L_role_bq
  s_add_u32 s101, s101, 56
  s_mov_b32 s100, 2
  s_branch L_role_qkv
L_helper_done:
  v_mbcnt_lo_u32_b32 v0, -1, 0
  v_mbcnt_hi_u32_b32 v0, -1, v0
  s_sub_u32 s101, s101, 56
  s_cmp_eq_u32 s100, 1
  s_cbranch_scc1 L_role_rec
  s_branch L_role_bq
L_role_ln0:
  v_and_b32 v6, 7, v0
  v_lshrrev_b32 v7, 3, v0
  v_mul_u32_u24 v12, 1280, v6
  v_lshl_add_u32 v12, v7, 4, v12
  v_lshlrev_b32 v13, 4, v6
  v_lshl_add_u32 v13, v7, 9, v13
  v_and_b32 v14, 15, v0
  v_lshlrev_b32 v14, 4, v14
  v_bfe_u32 v6, v0, 4, 1
  v_lshl_add_u32 v14, v6, 3, v14
  s_lshl_b32 s51, s12, 8
  v_mov_b32 v6, s51
  v_mov_b32 v15, 1024
  v_cmp_gt_u32 vcc, 32, v0
  s_nop 1
  v_cndmask_b32 v6, v15, v6, vcc
  v_add_u32 v14, v14, v6
  v_cmp_eq_u32 s[96:97], s12, v7
  s_sub_u32 s66, s101, 5
  s_mov_b32 s69, 0
  s_mul_i32 s51, s66, 256
  s_add_u32 s69, s69, s51
  s_cmp_eq_u32 s12, 0
  s_cselect_b32 s69, s69, 0x20000000
  s_mov_b32 s8, s16
  s_mov_b32 s9, s17
  s_mov_b32 s10, 2621440
  s_mov_b32 s11, 0x20000
  s_mov_b64 exec, 1
  v_mov_b32 v7, -1
  buffer_store_dword v7, off, s[4:7], s69 sc1
  buffer_store_dword v7, off, s[4:7], s69 offset:128 sc1
  s_mov_b64 exec, -1
  s_mov_b32 s67, 0
  s_mul_i32 s51, s66, 40960
  s_add_u32 s67, s67, s51
  s_mul_i32 s51, s12, 10240
  s_add_u32 s67, s67, s51
  buffer_load_dwordx4 v[16:19], v12, s[8:11], s67 offen offset:0
  buffer_load_dwordx4 v[20:23], v12, s[8:11], s67 offen offset:128
  buffer_load_dwordx4 v[24:27], v12, s[8:11], s67 offen offset:256
  buffer_load_dwordx4 v[28:31], v12, s[8:11], s67 offen offset:384
  buffer_load_dwordx4 v[32:35], v12, s[8:11], s67 offen offset:512
  buffer_load_dwordx4 v[36:39], v12, s[8:11], s67 offen offset:640
  buffer_load_dwordx4 v[40:43], v12, s[8:11], s67 offen offset:768
  buffer_load_dwordx4 v[44:47], v12, s[8:11], s67 offen offset:896
  buffer_load_dwordx4 v[48:51], v12, s[8:11], s67 offen offset:1024
  buffer_load_dwordx4 v[52:55], v12, s[8:11], s67 offen offset:1152
  s_waitcnt vmcnt(0)
  s_barrier
  s_cmp_lg_u32 s12, 0
  s_cbranch_scc1 L_sig_3
  s_mov_b64 exec, 1
  v_mov_b32 v6, 8
  v_mov_b32 v7, 1
  global_atomic_add v6, v7, s[38:39]
  s_mov_b64 exec, -1
L_sig_3:
L_ln0_top:
  s_mov_b32 s68, 3145728
  s_mul_i32 s51, s66, 45056
  s_add_u32 s68, s68, s51
  s_mul_i32 s51, s12, 128
  s_add_u32 s68, s68, s51
  buffer_store_dwordx4 v[16:19], v13, s[4:7], s68 offen offset:0 sc1
  s_add_u32 s68, s68, 4096
  buffer_store_dwordx4 v[20:23], v13, s[4:7], s68 offen offset:0 sc1
  s_add_u32 s68, s68, 4096
  buffer_store_dwordx4 v[24:27], v13, s[4:7], s68 offen offset:0 sc1
  s_add_u32 s68, s68, 4096
  buffer_store_dwordx4 v[28:31], v13, s[4:7], s68 offen offset:0 sc1
  s_add_u32 s68, s68, 4096
  buffer_store_dwordx4 v[32:35], v13, s[4:7], s68 offen offset:0 sc1
  s_add_u32 s68, s68, 4096
  buffer_store_dwordx4 v[36:39], v13, s[4:7], s68 offen offset:0 sc1
  s_add_u32 s68, s68, 4096
  buffer_store_dwordx4 v[40:43], v13, s[4:7], s68 offen offset:0 sc1
  s_add_u32 s68, s68, 4096
  buffer_store_dwordx4 v[44:47], v13, s[4:7], s68 offen offset:0 sc1
  s_add_u32 s68, s68, 4096
  buffer_store_dwordx4 v[48:51], v13, s[4:7], s68 offen offset:0 sc1
  s_add_u32 s68, s68, 4096
  buffer_store_dwordx4 v[52:55], v13, s[4:7], s68 offen offset:0 sc1
  s_add_u32 s68, s68, 4096
  s_add_u32 s66, s66, 5
  s_mov_b32 s67, 0
  s_mul_i32 s51, s66, 40960
  s_add_u32 s67, s67, s51
  s_mul_i32 s51, s12, 10240
  s_add_u32 s67, s67, s51
  buffer_load_dwordx4 v[56:59], v12, s[8:11], s67 offen offset:0
  buffer_load_dwordx4 v[60:63], v12, s[8:11], s67 offen offset:128
  buffer_load_dwordx4 v[64:67], v12, s[8:11], s67 offen offset:256
  buffer_load_dwordx4 v[68:71], v12, s[8:11], s67 offen offset:384
  buffer_load_dwordx4 v[72:75], v12, s[8:11], s67 offen offset:512
  buffer_load_dwordx4 v[76:79], v12, s[8:11], s67 offen offset:640
  buffer_load_dwordx4 v[80:83], v12, s[8:11], s67 offen offset:768
  buffer_load_dwordx4 v[84:87], v12, s[8:11], s67 offen offset:896
  buffer_load_dwordx4 v[88:91], v12, s[8:11], s67 offen offset:1024
  buffer_load_dwordx4 v[92:95], v12, s[8:11], s67 offen offset:1152
  v_lshlrev_b32 v96, 16, v16
  v_and_b32 v97, 0xffff0000, v16
  v_pk_mul_f32 v[102:103], v[96:97], v[96:97]
  v_mov_b32 v100, v96
  v_mov_b32 v101, v97
  v_lshlrev_b32 v96, 16, v17
  v_and_b32 v97, 0xffff0000, v17
  v_pk_add_f32 v[100:101], v[100:101], v[96:97]
  v_pk_fma_f32 v[102:103], v[96:97], v[96:97], v[102:103]
  v_lshlrev_b32 v96, 16, v18
  v_and_b32 v97, 0xffff0000, v18
  v_pk_add_f32 v[100:101], v[100:101], v[96:97]
  v_pk_fma_f32 v[102:103], v[96:97], v[96:97], v[102:103]
  v_lshlrev_b32 v96, 16, v19
  v_and_b32 v97, 0xffff0000, v19
  v_pk_add_f32 v[100:101], v[100:101], v[96:97]
  v_pk_fma_f32 v[102:103], v[96:97], v[96:97], v[102:103]
  v_lshlrev_b32 v96, 16, v20
  v_and_b32 v97, 0xffff0000, v20
  v_pk_add_f32 v[100:101], v[100:101], v[96:97]
  v_pk_fma_f32 v[102:103], v[96:97], v[96:97], v[102:103]
  v_lshlrev_b32 v96, 16, v21
  v_and_b32 v97, 0xffff0000, v21
  v_pk_add_f32 v[100:101], v[100:101], v[96:97]
  v_pk_fma_f32 v[102:103], v[96:97], v[96:97], v[102:103]
  v_lshlrev_b32 v96, 16, v22
  v_and_b32 v97, 0xffff0000, v22
  v_pk_add_f32 v[100:101], v[100:101], v[96:97]
  v_pk_fma_f32 v[102:103], v[96:97], v[96:97], v[102:103]
  v_lshlrev_b32 v96, 16, v23
  v_and_b32 v97, 0xffff0000, v23
  v_pk_add_f32 v[100:101], v[100:101], v[96:97]
  v_pk_fma_f32 v[102:103], v[96:97], v[96:97], v[102:103]
  v_lshlrev_b32 v96, 16, v24
  v_and_b32 v97, 0xffff0000, v24
  v_pk_add_f32 v[100:101], v[100:101], v[96:97]
  v_pk_fma_f32 v[102:103], v[96:97], v[96:97], v[102:103]
  v_lshlrev_b32 v96, 16, v25
  v_and_b32 v97, 0xffff0000, v25
  v_pk_add_f32 v[100:101], v[100:101], v[96:97]
  v_pk_fma_f32 v[102:103], v[96:97], v[96:97], v[102:103]
  v_lshlrev_b32 v96, 16, v26
  v_and_b32 v97, 0xffff0000, v26
  v_pk_add_f32 v[100:101], v[100:101], v[96:97]
  v_pk_fma_f32 v[102:103], v[96:97], v[96:97], v[102:103]
  v_lshlrev_b32 v96, 16, v27
  v_and_b32 v97, 0xffff0000, v27
  v_pk_add_f32 v[100:101], v[100:101], v[96:97]
  v_pk_fma_f32 v[102:103], v[96:97], v[96:97], v[102:103]
  v_lshlrev_b32 v96, 16, v28
  v_and_b32 v97, 0xffff0000, v28
  v_pk_add_f32 v[100:101], v[100:101], v[96:97]
  v_pk_fma_f32 v[102:103], v[96:97], v[96:97], v[102:103]
  v_lshlrev_b32 v96, 16, v29
  v_and_b32 v97, 0xffff0000, v29
  v_pk_add_f32 v[100:101], v[100:101], v[96:97]
  v_pk_fma_f32 v[102:103], v[96:97], v[96:97], v[102:103]
  v_lshlrev_b32 v96, 16, v30
  v_and_b32 v97, 0xffff0000, v30
  v_pk_add_f32 v[100:101], v[100:101], v[96:97]
  v_pk_fma_f32 v[102:103], v[96:97], v[96:97], v[102:103]
  v_lshlrev_b32 v96, 16, v31
  v_and_b32 v97, 0xffff0000, v31
  v_pk_add_f32 v[100:101], v[100:101], v[96:97]
  v_pk_fma_f32 v[102:103], v[96:97], v[96:97], v[102:103]
  v_lshlrev_b32 v96, 16, v32
  v_and_b32 v97, 0xffff0000, v32
  v_pk_add_f32 v[100:101], v[100:101], v[96:97]
  v_pk_fma_f32 v[102:103], v[96:97], v[96:97], v[102:103]
  v_lshlrev_b32 v96, 16, v33
  v_and_b32 v97, 0xffff0000, v33
  v_pk_add_f32 v[100:101], v[100:101], v[96:97]
  v_pk_fma_f32 v[102:103], v[96:97], v[96:97], v[102:103]
  v_lshlrev_b32 v96, 16, v34
  v_and_b32 v97, 0xffff0000, v34
  v_pk_add_f32 v[100:101], v[100:101], v[96:97]
  v_pk_fma_f32 v[102:103], v[96:97], v[96:97], v[102:103]
  v_lshlrev_b32 v96, 16, v35
  v_and_b32 v97, 0xffff0000, v35
  v_pk_add_f32 v[100:101], v[100:101], v[96:97]
  v_pk_fma_f32 v[102:103], v[96:97], v[96:97], v[102:103]
  v_lshlrev_b32 v96, 16, v36
  v_and_b32 v97, 0xffff0000, v36
  v_pk_add_f32 v[100:101], v[100:101], v[96:97]
  v_pk_fma_f32 v[102:103], v[96:97], v[96:97], v[102:103]
  v_lshlrev_b32 v96, 16, v37
  v_and_b32 v97, 0xffff0000, v37
  v_pk_add_f32 v[100:101], v[100:101], v[96:97]
  v_pk_fma_f32 v[102:103], v[96:97], v[96:97], v[102:103]
  v_lshlrev_b32 v96, 16, v38
  v_and_b32 v97, 0xffff0000, v38
  v_pk_add_f32 v[100:101], v[100:101], v[96:97]
  v_pk_fma_f32 v[102:103], v[96:97], v[96:97], v[102:103]
  v_lshlrev_b32 v96, 16, v39
  v_and_b32 v97, 0xffff0000, v39
  v_pk_add_f32 v[100:101], v[100:101], v[96:97]
  v_pk_fma_f32 v[102:103], v[96:97], v[96:97], v[102:103]
  v_lshlrev_b32 v96, 16, v40
  v_and_b32 v97, 0xffff0000, v40
  v_pk_add_f32 v[100:101], v[100:101], v[96:97]
  v_pk_fma_f32 v[102:103], v[96:97], v[96:97], v[102:103]
  v_lshlrev_b32 v96, 16, v41
  v_and_b32 v97, 0xffff0000, v41
  v_pk_add_f32 v[100:101], v[100:101], v[96:97]
  v_pk_fma_f32 v[102:103], v[96:97], v[96:97], v[102:103]
  v_lshlrev_b32 v96, 16, v42
  v_and_b32 v97, 0xffff0000, v42
  v_pk_add_f32 v[100:101], v[100:101], v[96:97]
  v_pk_fma_f32 v[102:103], v[96:97], v[96:97], v[102:103]
  v_lshlrev_b32 v96, 16, v43
  v_and_b32 v97, 0xffff0000, v43
  v_pk_add_f32 v[100:101], v[100:101], v[96:97]
  v_pk_fma_f32 v[102:103], v[96:97], v[96:97], v[102:103]
  v_lshlrev_b32 v96, 16, v44
  v_and_b32 v97, 0xffff0000, v44
  v_pk_add_f32 v[100:101], v[100:101], v[96:97]
  v_pk_fma_f32 v[102:103], v[96:97], v[96:97], v[102:103]
  v_lshlrev_b32 v96, 16, v45
  v_and_b32 v97, 0xffff0000, v45
  v_pk_add_f32 v[100:101], v[100:101], v[96:97]
  v_pk_fma_f32 v[102:103], v[96:97], v[96:97], v[102:103]
  v_lshlrev_b32 v96, 16, v46
  v_and_b32 v97, 0xffff0000, v46
  v_pk_add_f32 v[100:101], v[100:101], v[96:97]
  v_pk_fma_f32 v[102:103], v[96:97], v[96:97], v[102:103]
  v_lshlrev_b32 v96, 16, v47
  v_and_b32 v97, 0xffff0000, v47
  v_pk_add_f32 v[100:101], v[100:101], v[96:97]
  v_pk_fma_f32 v[102:103], v[96:97], v[96:97], v[102:103]
  v_lshlrev_b32 v96, 16, v48
  v_and_b32 v97, 0xffff0000, v48
  v_pk_add_f32 v[100:101], v[100:101], v[96:97]
  v_pk_fma_f32 v[102:103], v[96:97], v[96:97], v[102:103]
  v_lshlrev_b32 v96, 16, v49
  v_and_b32 v97, 0xffff0000, v49
  v_pk_add_f32 v[100:101], v[100:101], v[96:97]
  v_pk_fma_f32 v[102:103], v[96:97], v[96:97], v[102:103]
  v_lshlrev_b32 v96, 16, v50
  v_and_b32 v97, 0xffff0000, v50
  v_pk_add_f32 v[100:101], v[100:101], v[96:97]
  v_pk_fma_f32 v[102:103], v[96:97], v[96:97], v[102:103]
  v_lshlrev_b32 v96, 16, v51
  v_and_b32 v97, 0xffff0000, v51
  v_pk_add_f32 v[100:101], v[100:101], v[96:97]
  v_pk_fma_f32 v[102:103], v[96:97], v[96:97], v[102:103]
  v_lshlrev_b32 v96, 16, v52
  v_and_b32 v97, 0xffff0000, v52
  v_pk_add_f32 v[100:101], v[100:101], v[96:97]
  v_pk_fma_f32 v[102:103], v[96:97], v[96:97], v[102:103]
  v_lshlrev_b32 v96, 16, v53
  v_and_b32 v97, 0xffff0000, v53
  v_pk_add_f32 v[100:101], v[100:101], v[96:97]
  v_pk_fma_f32 v[102:103], v[96:97], v[96:97], v[102:103]
  v_lshlrev_b32 v96, 16, v54
  v_and_b32 v97, 0xffff0000, v54
  v_pk_add_f32 v[100:101], v[100:101], v[96:97]
  v_pk_fma_f32 v[102:103], v[96:97], v[96:97], v[102:103]
  v_lshlrev_b32 v96, 16, v55
  v_and_b32 v97, 0xffff0000, v55
  v_pk_add_f32 v[100:101], v[100:101], v[96:97]
  v_pk_fma_f32 v[102:103], v[96:97], v[96:97], v[102:103]
  v_add_f32 v100, v100, v101
  v_add_f32 v101, v102, v103
  s_nop 0
  v_add_f32_dpp v100, v100, v100 row_ror:8 row_mask:0xf bank_mask:0xf
  v_mov_b32 v7, v100
  s_nop 1
  v_permlane16_swap_b32 v100, v7
  v_add_f32 v100, v100, v7
  v_mov_b32 v7, v100
  s_nop 1
  v_permlane32_swap_b32 v100, v7
  v_add_f32 v100, v100, v7
  v_cndmask_b32 v100, 0, v100, s[96:97]
  v_add_f32_dpp v101, v101, v101 row_ror:8 row_mask:0xf bank_mask:0xf
  v_mov_b32 v7, v101
  s_nop 1
  v_permlane16_swap_b32 v101, v7
  v_add_f32 v101, v101, v7
  v_mov_b32 v7, v101
  s_nop 1
  v_permlane32_swap_b32 v101, v7
  v_add_f32 v101, v101, v7
  v_cndmask_b32 v101, 0, v101, s[96:97]
  s_lshl_b32 s51, s12, 7
  s_sub_u32 s68, s68, s51
  buffer_store_dwordx2 v[100:101], v14, s[4:7], s68 offen offset:0 sc1
  s_waitcnt vmcnt(0)
  s_barrier
  s_mov_b64 exec, 1
  v_mov_b32 v7, s66
  buffer_store_dword v7, off, s[4:7], s69 sc1
  buffer_store_dword v7, off, s[4:7], s69 offset:128
  s_mov_b64 exec, -1
  s_cmp_ge_u32 s66, 64
  s_cbranch_scc1 L_ln0_done
  s_mov_b32 s68, 3145728
  s_mul_i32 s51, s66, 45056
  s_add_u32 s68, s68, s51
  s_mul_i32 s51, s12, 128
  s_add_u32 s68, s68, s51
  buffer_store_dwordx4 v[56:59], v13, s[4:7], s68 offen offset:0 sc1
  s_add_u32 s68, s68, 4096
  buffer_store_dwordx4 v[60:63], v13, s[4:7], s68 offen offset:0 sc1
  s_add_u32 s68, s68, 4096
  buffer_store_dwordx4 v[64:67], v13, s[4:7], s68 offen offset:0 sc1
  s_add_u32 s68, s68, 4096
  buffer_store_dwordx4 v[68:71], v13, s[4:7], s68 offen offset:0 sc1
  s_add_u32 s68, s68, 4096
  buffer_store_dwordx4 v[72:75], v13, s[4:7], s68 offen offset:0 sc1
  s_add_u32 s68, s68, 4096
  buffer_store_dwordx4 v[76:79], v13, s[4:7], s68 offen offset:0 sc1
  s_add_u32 s68, s68, 4096
  buffer_store_dwordx4 v[80:83], v13, s[4:7], s68 offen offset:0 sc1
  s_add_u32 s68, s68, 4096
  buffer_store_dwordx4 v[84:87], v13, s[4:7], s68 offen offset:0 sc1
  s_add_u32 s68, s68, 4096
  buffer_store_dwordx4 v[88:91], v13, s[4:7], s68 offen offset:0 sc1
  s_add_u32 s68, s68, 4096
  buffer_store_dwordx4 v[92:95], v13, s[4:7], s68 offen offset:0 sc1
  s_add_u32 s68, s68, 4096
  s_add_u32 s66, s66, 5
  s_mov_b32 s67, 0
  s_mul_i32 s51, s66, 40960
  s_add_u32 s67, s67, s51
  s_mul_i32 s51, s12, 10240
  s_add_u32 s67, s67, s51
  buffer_load_dwordx4 v[16:19], v12, s[8:11], s67 offen offset:0
  buffer_load_dwordx4 v[20:23], v12, s[8:11], s67 offen offset:128
  buffer_load_dwordx4 v[24:27], v12, s[8:11], s67 offen offset:256
  buffer_load_dwordx4 v[28:31], v12, s[8:11], s67 offen offset:384
  buffer_load_dwordx4 v[32:35], v12, s[8:11], s67 offen offset:512
  buffer_load_dwordx4 v[36:39], v12, s[8:11], s67 offen offset:640
  buffer_load_dwordx4 v[40:43], v12, s[8:11], s67 offen offset:768
  buffer_load_dwordx4 v[44:47], v12, s[8:11], s67 offen offset:896
  buffer_load_dwordx4 v[48:51], v12, s[8:11], s67 offen offset:1024
  buffer_load_dwordx4 v[52:55], v12, s[8:11], s67 offen offset:1152
  v_lshlrev_b32 v96, 16, v56
  v_and_b32 v97, 0xffff0000, v56
  v_pk_mul_f32 v[102:103], v[96:97], v[96:97]
  v_mov_b32 v100, v96
  v_mov_b32 v101, v97
  v_lshlrev_b32 v96, 16, v57
  v_and_b32 v97, 0xffff0000, v57
  v_pk_add_f32 v[100:101], v[100:101], v[96:97]
  v_pk_fma_f32 v[102:103], v[96:97], v[96:97], v[102:103]
  v_lshlrev_b32 v96, 16, v58
  v_and_b32 v97, 0xffff0000, v58
  v_pk_add_f32 v[100:101], v[100:101], v[96:97]
  v_pk_fma_f32 v[102:103], v[96:97], v[96:97], v[102:103]
  v_lshlrev_b32 v96, 16, v59
  v_and_b32 v97, 0xffff0000, v59
  v_pk_add_f32 v[100:101], v[100:101], v[96:97]
  v_pk_fma_f32 v[102:103], v[96:97], v[96:97], v[102:103]
  v_lshlrev_b32 v96, 16, v60
  v_and_b32 v97, 0xffff0000, v60
  v_pk_add_f32 v[100:101], v[100:101], v[96:97]
  v_pk_fma_f32 v[102:103], v[96:97], v[96:97], v[102:103]
  v_lshlrev_b32 v96, 16, v61
  v_and_b32 v97, 0xffff0000, v61
  v_pk_add_f32 v[100:101], v[100:101], v[96:97]
  v_pk_fma_f32 v[102:103], v[96:97], v[96:97], v[102:103]
  v_lshlrev_b32 v96, 16, v62
  v_and_b32 v97, 0xffff0000, v62
  v_pk_add_f32 v[100:101], v[100:101], v[96:97]
  v_pk_fma_f32 v[102:103], v[96:97], v[96:97], v[102:103]
  v_lshlrev_b32 v96, 16, v63
  v_and_b32 v97, 0xffff0000, v63
  v_pk_add_f32 v[100:101], v[100:101], v[96:97]
  v_pk_fma_f32 v[102:103], v[96:97], v[96:97], v[102:103]
  v_lshlrev_b32 v96, 16, v64
  v_and_b32 v97, 0xffff0000, v64
  v_pk_add_f32 v[100:101], v[100:101], v[96:97]
  v_pk_fma_f32 v[102:103], v[96:97], v[96:97], v[102:103]
  v_lshlrev_b32 v96, 16, v65
  v_and_b32 v97, 0xffff0000, v65
  v_pk_add_f32 v[100:101], v[100:101], v[96:97]
  v_pk_fma_f32 v[102:103], v[96:97], v[96:97], v[102:103]
  v_lshlrev_b32 v96, 16, v66
  v_and_b32 v97, 0xffff0000, v66
  v_pk_add_f32 v[100:101], v[100:101], v[96:97]
  v_pk_fma_f32 v[102:103], v[96:97], v[96:97], v[102:103]
  v_lshlrev_b32 v96, 16, v67
  v_and_b32 v97, 0xffff0000, v67
  v_pk_add_f32 v[100:101], v[100:101], v[96:97]
  v_pk_fma_f32 v[102:103], v[96:97], v[96:97], v[102:103]
  v_lshlrev_b32 v96, 16, v68
  v_and_b32 v97, 0xffff0000, v68
  v_pk_add_f32 v[100:101], v[100:101], v[96:97]
  v_pk_fma_f32 v[102:103], v[96:97], v[96:97], v[102:103]
  v_lshlrev_b32 v96, 16, v69
  v_and_b32 v97, 0xffff0000, v69
  v_pk_add_f32 v[100:101], v[100:101], v[96:97]
  v_pk_fma_f32 v[102:103], v[96:97], v[96:97], v[102:103]
  v_lshlrev_b32 v96, 16, v70
  v_and_b32 v97, 0xffff0000, v70
  v_pk_add_f32 v[100:101], v[100:101], v[96:97]
  v_pk_fma_f32 v[102:103], v[96:97], v[96:97], v[102:103]
  v_lshlrev_b32 v96, 16, v71
  v_and_b32 v97, 0xffff0000, v71
  v_pk_add_f32 v[100:101], v[100:101], v[96:97]
  v_pk_fma_f32 v[102:103], v[96:97], v[96:97], v[102:103]
  v_lshlrev_b32 v96, 16, v72
  v_and_b32 v97, 0xffff0000, v72
  v_pk_add_f32 v[100:101], v[100:101], v[96:97]
  v_pk_fma_f32 v[102:103], v[96:97], v[96:97], v[102:103]
  v_lshlrev_b32 v96, 16, v73
  v_and_b32 v97, 0xffff0000, v73
  v_pk_add_f32 v[100:101], v[100:101], v[96:97]
  v_pk_fma_f32 v[102:103], v[96:97], v[96:97], v[102:103]
  v_lshlrev_b32 v96, 16, v74
  v_and_b32 v97, 0xffff0000, v74
  v_pk_add_f32 v[100:101], v[100:101], v[96:97]
  v_pk_fma_f32 v[102:103], v[96:97], v[96:97], v[102:103]
  v_lshlrev_b32 v96, 16, v75
  v_and_b32 v97, 0xffff0000, v75
  v_pk_add_f32 v[100:101], v[100:101], v[96:97]
  v_pk_fma_f32 v[102:103], v[96:97], v[96:97], v[102:103]
  v_lshlrev_b32 v96, 16, v76
  v_and_b32 v97, 0xffff0000, v76
  v_pk_add_f32 v[100:101], v[100:101], v[96:97]
  v_pk_fma_f32 v[102:103], v[96:97], v[96:97], v[102:103]
  v_lshlrev_b32 v96, 16, v77
  v_and_b32 v97, 0xffff0000, v77
  v_pk_add_f32 v[100:101], v[100:101], v[96:97]
  v_pk_fma_f32 v[102:103], v[96:97], v[96:97], v[102:103]
  v_lshlrev_b32 v96, 16, v78
  v_and_b32 v97, 0xffff0000, v78
  v_pk_add_f32 v[100:101], v[100:101], v[96:97]
  v_pk_fma_f32 v[102:103], v[96:97], v[96:97], v[102:103]
  v_lshlrev_b32 v96, 16, v79
  v_and_b32 v97, 0xffff0000, v79
  v_pk_add_f32 v[100:101], v[100:101], v[96:97]
  v_pk_fma_f32 v[102:103], v[96:97], v[96:97], v[102:103]
  v_lshlrev_b32 v96, 16, v80
  v_and_b32 v97, 0xffff0000, v80
  v_pk_add_f32 v[100:101], v[100:101], v[96:97]
  v_pk_fma_f32 v[102:103], v[96:97], v[96:97], v[102:103]
  v_lshlrev_b32 v96, 16, v81
  v_and_b32 v97, 0xffff0000, v81
  v_pk_add_f32 v[100:101], v[100:101], v[96:97]
  v_pk_fma_f32 v[102:103], v[96:97], v[96:97], v[102:103]
  v_lshlrev_b32 v96, 16, v82
  v_and_b32 v97, 0xffff0000, v82
  v_pk_add_f32 v[100:101], v[100:101], v[96:97]
  v_pk_fma_f32 v[102:103], v[96:97], v[96:97], v[102:103]
  v_lshlrev_b32 v96, 16, v83
  v_and_b32 v97, 0xffff0000, v83
  v_pk_add_f32 v[100:101], v[100:101], v[96:97]
  v_pk_fma_f32 v[102:103], v[96:97], v[96:97], v[102:103]
  v_lshlrev_b32 v96, 16, v84
  v_and_b32 v97, 0xffff0000, v84
  v_pk_add_f32 v[100:101], v[100:101], v[96:97]
  v_pk_fma_f32 v[102:103], v[96:97], v[96:97], v[102:103]
  v_lshlrev_b32 v96, 16, v85
  v_and_b32 v97, 0xffff0000, v85
  v_pk_add_f32 v[100:101], v[100:101], v[96:97]
  v_pk_fma_f32 v[102:103], v[96:97], v[96:97], v[102:103]
  v_lshlrev_b32 v96, 16, v86
  v_and_b32 v97, 0xffff0000, v86
  v_pk_add_f32 v[100:101], v[100:101], v[96:97]
  v_pk_fma_f32 v[102:103], v[96:97], v[96:97], v[102:103]
  v_lshlrev_b32 v96, 16, v87
  v_and_b32 v97, 0xffff0000, v87
  v_pk_add_f32 v[100:101], v[100:101], v[96:97]
  v_pk_fma_f32 v[102:103], v[96:97], v[96:97], v[102:103]
  v_lshlrev_b32 v96, 16, v88
  v_and_b32 v97, 0xffff0000, v88
  v_pk_add_f32 v[100:101], v[100:101], v[96:97]
  v_pk_fma_f32 v[102:103], v[96:97], v[96:97], v[102:103]
  v_lshlrev_b32 v96, 16, v89
  v_and_b32 v97, 0xffff0000, v89
  v_pk_add_f32 v[100:101], v[100:101], v[96:97]
  v_pk_fma_f32 v[102:103], v[96:97], v[96:97], v[102:103]
  v_lshlrev_b32 v96, 16, v90
  v_and_b32 v97, 0xffff0000, v90
  v_pk_add_f32 v[100:101], v[100:101], v[96:97]
  v_pk_fma_f32 v[102:103], v[96:97], v[96:97], v[102:103]
  v_lshlrev_b32 v96, 16, v91
  v_and_b32 v97, 0xffff0000, v91
  v_pk_add_f32 v[100:101], v[100:101], v[96:97]
  v_pk_fma_f32 v[102:103], v[96:97], v[96:97], v[102:103]
  v_lshlrev_b32 v96, 16, v92
  v_and_b32 v97, 0xffff0000, v92
  v_pk_add_f32 v[100:101], v[100:101], v[96:97]
  v_pk_fma_f32 v[102:103], v[96:97], v[96:97], v[102:103]
  v_lshlrev_b32 v96, 16, v93
  v_and_b32 v97, 0xffff0000, v93
  v_pk_add_f32 v[100:101], v[100:101], v[96:97]
  v_pk_fma_f32 v[102:103], v[96:97], v[96:97], v[102:103]
  v_lshlrev_b32 v96, 16, v94
  v_and_b32 v97, 0xffff0000, v94
  v_pk_add_f32 v[100:101], v[100:101], v[96:97]
  v_pk_fma_f32 v[102:103], v[96:97], v[96:97], v[102:103]
  v_lshlrev_b32 v96, 16, v95
  v_and_b32 v97, 0xffff0000, v95
  v_pk_add_f32 v[100:101], v[100:101], v[96:97]
  v_pk_fma_f32 v[102:103], v[96:97], v[96:97], v[102:103]
  v_add_f32 v100, v100, v101
  v_add_f32 v101, v102, v103
  s_nop 0
  v_add_f32_dpp v100, v100, v100 row_ror:8 row_mask:0xf bank_mask:0xf
  v_mov_b32 v7, v100
  s_nop 1
  v_permlane16_swap_b32 v100, v7
  v_add_f32 v100, v100, v7
  v_mov_b32 v7, v100
  s_nop 1
  v_permlane32_swap_b32 v100, v7
  v_add_f32 v100, v100, v7
  v_cndmask_b32 v100, 0, v100, s[96:97]
  v_add_f32_dpp v101, v101, v101 row_ror:8 row_mask:0xf bank_mask:0xf
  v_mov_b32 v7, v101
  s_nop 1
  v_permlane16_swap_b32 v101, v7
  v_add_f32 v101, v101, v7
  v_mov_b32 v7, v101
  s_nop 1
  v_permlane32_swap_b32 v101, v7
  v_add_f32 v101, v101, v7
  v_cndmask_b32 v101, 0, v101, s[96:97]
  s_lshl_b32 s51, s12, 7
  s_sub_u32 s68, s68, s51
  buffer_store_dwordx2 v[100:101], v14, s[4:7], s68 offen offset:0 sc1
  s_waitcnt vmcnt(0)
  s_barrier
  s_mov_b64 exec, 1
  v_mov_b32 v7, s66
  buffer_store_dword v7, off, s[4:7], s69 sc1
  buffer_store_dword v7, off, s[4:7], s69 offset:128
  s_mov_b64 exec, -1
  s_cmp_ge_u32 s66, 64
  s_cbranch_scc1 L_ln0_done
  s_branch L_ln0_top
L_ln0_done:
  s_branch L_role_root
L_role_root:
  s_cmp_lg_u32 s12, 0
  s_cbranch_scc1 L_hold_4
  v_mov_b32 v6, 8
L_rdy_6:
  global_load_dword v7, v6, s[38:39] sc1
  s_waitcnt vmcnt(0)
  v_readfirstlane_b32 s15, v7
  s_and_b32 s3, s15, 0xffff
  s_cmp_ge_u32 s3, 48
  s_cbranch_scc1 L_rdyd_7
  s_sleep 32
  s_add_u32 s14, s14, 1
  s_cmp_lt_u32 s14, 100000
  s_cbranch_scc1 L_rdy_6
L_rdyd_7:
L_hold_5:
  s_sleep 16
  buffer_load_dword v6, off, s[4:7], 0 offset:0 sc1
  s_add_u32 s14, s14, 1
  s_waitcnt vmcnt(0)
  v_readfirstlane_b32 s3, v6
  s_cmp_ge_u32 s14, 100000
  s_cbranch_scc1 L_hold_4
  s_cmp_lt_i32 s3, 10
  s_cbranch_scc1 L_hold_5
L_hold_4:
  s_barrier
  s_cmp_ge_u32 s101, 5
  s_cselect_b32 s45, 1, 0
  s_mul_i32 s51, s45, 5
  s_sub_u32 s66, s101, s51
  s_mov_b32 s68, 4800
  v_lshlrev_b32 v1, 4, v0
  v_lshrrev_b32 v84, 4, v0
  v_mul_u32_u24 v84, 1024, v84
  v_add_u32 v84, v84, v1
  s_mov_b32 s70, 0
  s_mul_i32 s51, s68, 1280
  s_add_u32 s70, s70, s51
  s_mul_i32 s51, s66, 256
  s_add_u32 s70, s70, s51
  v_mov_b32 v6, 0x3010200
  v_mov_b32 v7, 0x7050604
  v_and_b32 v85, 16, v0
  v_cmp_eq_u32 vcc, 0, v85
  s_nop 1
  v_cndmask_b32 v6, v7, v6, vcc
  v_and_b32 v7, 3, v0
  v_lshlrev_b32 v7, 3, v7
  v_bfe_u32 v6, v6, v7, 8
  v_lshrrev_b32 v7, 5, v0
  v_mul_u32_u24 v7, 8, v7
  v_bfe_u32 v85, v0, 2, 2
  v_add_u32 v85, v85, v7
  v_mul_u32_u24 v85, 256, v85
  v_lshl_add_u32 v85, v6, 3, v85
  s_lshl_b32 s51, s12, 6
  v_add_u32 v85, s51, v85
  s_mov_b32 s8, s26
  s_mov_b32 s9, s27
  s_mov_b32 s10, 7864320
  s_mov_b32 s11, 0x20000
  s_mul_i32 s51, s12, 20480
  s_add_u32 s70, s70, s51
  s_mul_i32 s52, s12, 4096
  s_add_u32 m0, s52, 0
  s_add_u32 s51, s70, 0
  buffer_load_dwordx4 v84, s[8:11], s51 offen  lds
  s_add_u32 m0, s52, 1024
  s_add_u32 s51, s70, 5120
  buffer_load_dwordx4 v84, s[8:11], s51 offen  lds
  s_add_u32 m0, s52, 2048
  s_add_u32 s51, s70, 10240
  buffer_load_dwordx4 v84, s[8:11], s51 offen  lds
  s_add_u32 m0, s52, 3072
  s_add_u32 s51, s70, 15360
  buffer_load_dwordx4 v84, s[8:11], s51 offen  lds
  s_add_u32 m0, s52, 16384
  s_add_u32 s51, s70, 81920
  buffer_load_dwordx4 v84, s[8:11], s51 offen  lds
  s_add_u32 m0, s52, 17408
  s_add_u32 s51, s70, 87040
  buffer_load_dwordx4 v84, s[8:11], s51 offen  lds
  s_add_u32 m0, s52, 18432
  s_add_u32 s51, s70, 92160
  buffer_load_dwordx4 v84, s[8:11], s51 offen  lds
  s_add_u32 m0, s52, 19456
  s_add_u32 s51, s70, 97280
  buffer_load_dwordx4 v84, s[8:11], s51 offen  lds
  s_add_u32 m0, s52, 32768
  s_add_u32 s51, s70, 163840
  buffer_load_dwordx4 v84, s[8:11], s51 offen  lds
  s_add_u32 m0, s52, 33792
  s_add_u32 s51, s70, 168960
  buffer_load_dwordx4 v84, s[8:11], s51 offen  lds
  s_add_u32 m0, s52, 34816
  s_add_u32 s51, s70, 174080
  buffer_load_dwordx4 v84, s[8:11], s51 offen  lds
  s_add_u32 m0, s52, 35840
  s_add_u32 s51, s70, 179200
  buffer_load_dwordx4 v84, s[8:11], s51 offen  lds
  s_add_u32 m0, s52, 49152
  s_add_u32 s51, s70, 245760
  buffer_load_dwordx4 v84, s[8:11], s51 offen  lds
  s_add_u32 m0, s52, 50176
  s_add_u32 s51, s70, 250880
  buffer_load_dwordx4 v84, s[8:11], s51 offen  lds
  s_add_u32 m0, s52, 51200
  s_add_u32 s51, s70, 256000
  buffer_load_dwordx4 v84, s[8:11], s51 offen  lds
  s_add_u32 m0, s52, 52224
  s_add_u32 s51, s70, 261120
  buffer_load_dwordx4 v84, s[8:11], s51 offen  lds
  s_add_u32 m0, s52, 65536
  s_add_u32 s51, s70, 327680
  buffer_load_dwordx4 v84, s[8:11], s51 offen  lds
  s_add_u32 m0, s52, 66560
  s_add_u32 s51, s70, 332800
  buffer_load_dwordx4 v84, s[8:11], s51 offen  lds
  s_add_u32 m0, s52, 67584
  s_add_u32 s51, s70, 337920
  buffer_load_dwordx4 v84, s[8:11], s51 offen  lds
  s_add_u32 m0, s52, 68608
  s_add_u32 s51, s70, 343040
  buffer_load_dwordx4 v84, s[8:11], s51 offen  lds
  s_add_u32 m0, s52, 81920
  s_add_u32 s51, s70, 409600
  buffer_load_dwordx4 v84, s[8:11], s51 offen  lds
  s_add_u32 m0, s52, 82944
  s_add_u32 s51, s70, 414720
  buffer_load_dwordx4 v84, s[8:11], s51 offen  lds
  s_add_u32 m0, s52, 83968
  s_add_u32 s51, s70, 419840
  buffer_load_dwordx4 v84, s[8:11], s51 offen  lds
  s_add_u32 m0, s52, 84992
  s_add_u32 s51, s70, 424960
  buffer_load_dwordx4 v84, s[8:11], s51 offen  lds
  s_add_u32 m0, s52, 98304
  s_add_u32 s51, s70, 491520
  buffer_load_dwordx4 v84, s[8:11], s51 offen  lds
  s_add_u32 m0, s52, 99328
  s_add_u32 s51, s70, 496640
  buffer_load_dwordx4 v84, s[8:11], s51 offen  lds
  s_add_u32 m0, s52, 100352
  s_add_u32 s51, s70, 501760
  buffer_load_dwordx4 v84, s[8:11], s51 offen  lds
  s_add_u32 m0, s52, 101376
  s_add_u32 s51, s70, 506880
  buffer_load_dwordx4 v84, s[8:11], s51 offen  lds
  s_add_u32 m0, s52, 114688
  s_add_u32 s51, s70, 573440
  buffer_load_dwordx4 v84, s[8:11], s51 offen  lds
  s_add_u32 m0, s52, 115712
  s_add_u32 s51, s70, 578560
  buffer_load_dwordx4 v84, s[8:11], s51 offen  lds
  s_add_u32 m0, s52, 116736
  s_add_u32 s51, s70, 583680
  buffer_load_dwordx4 v84, s[8:11], s51 offen  lds
  s_add_u32 m0, s52, 117760
  s_add_u32 s51, s70, 588800
  buffer_load_dwordx4 v84, s[8:11], s51 offen  lds
  s_waitcnt vmcnt(28) lgkmcnt(0)
  s_barrier
  s_add_u32 m0, s52, 131072
  s_add_u32 s51, s70, 655360
  buffer_load_dwordx4 v84, s[8:11], s51 offen  lds
  s_add_u32 m0, s52, 132096
  s_add_u32 s51, s70, 660480
  buffer_load_dwordx4 v84, s[8:11], s51 offen  lds
  s_add_u32 m0, s52, 133120
  s_add_u32 s51, s70, 665600
  buffer_load_dwordx4 v84, s[8:11], s51 offen  lds
  s_add_u32 m0, s52, 134144
  s_add_u32 s51, s70, 670720
  buffer_load_dwordx4 v84, s[8:11], s51 offen  lds
  v_add_u32 v87, 0, v85
  ds_read_b64_tr_b16 a[0:1], v87 offset:0
  ds_read_b64_tr_b16 a[2:3], v87 offset:1024
  ds_read_b64_tr_b16 a[4:5], v87 offset:4096
  ds_read_b64_tr_b16 a[6:7], v87 offset:5120
  ds_read_b64_tr_b16 a[8:9], v87 offset:8192
  ds_read_b64_tr_b16 a[10:11], v87 offset:9216
  ds_read_b64_tr_b16 a[12:13], v87 offset:12288
  ds_read_b64_tr_b16 a[14:15], v87 offset:13312
  s_waitcnt vmcnt(28) lgkmcnt(0)
  s_barrier
  s_add_u32 m0, s52, 0
  s_add_u32 s51, s70, 737280
  buffer_load_dwordx4 v84, s[8:11], s51 offen  lds
  s_add_u32 m0, s52, 1024
  s_add_u32 s51, s70, 742400
  buffer_load_dwordx4 v84, s[8:11], s51 offen  lds
  s_add_u32 m0, s52, 2048
  s_add_u32 s51, s70, 747520
  buffer_load_dwordx4 v84, s[8:11], s51 offen  lds
  s_add_u32 m0, s52, 3072
  s_add_u32 s51, s70, 752640
  buffer_load_dwordx4 v84, s[8:11], s51 offen  lds
  v_add_u32 v87, 16384, v85
  ds_read_b64_tr_b16 a[16:17], v87 offset:0
  ds_read_b64_tr_b16 a[18:19], v87 offset:1024
  ds_read_b64_tr_b16 a[20:21], v87 offset:4096
  ds_read_b64_tr_b16 a[22:23], v87 offset:5120
  ds_read_b64_tr_b16 a[24:25], v87 offset:8192
  ds_read_b64_tr_b16 a[26:27], v87 offset:9216
  ds_read_b64_tr_b16 a[28:29], v87 offset:12288
  ds_read_b64_tr_b16 a[30:31], v87 offset:13312
  s_waitcnt vmcnt(28) lgkmcnt(0)
  s_barrier
  s_add_u32 m0, s52, 16384
  s_add_u32 s51, s70, 819200
  buffer_load_dwordx4 v84, s[8:11], s51 offen  lds
  s_add_u32 m0, s52, 17408
  s_add_u32 s51, s70, 824320
  buffer_load_dwordx4 v84, s[8:11], s51 offen  lds
  s_add_u32 m0, s52, 18432
  s_add_u32 s51, s70, 829440
  buffer_load_dwordx4 v84, s[8:11], s51 offen  lds
  s_add_u32 m0, s52, 19456
  s_add_u32 s51, s70, 834560
  buffer_load_dwordx4 v84, s[8:11], s51 offen  lds
  v_add_u32 v87, 32768, v85
  ds_read_b64_tr_b16 a[32:33], v87 offset:0
  ds_read_b64_tr_b16 a[34:35], v87 offset:1024
  ds_read_b64_tr_b16 a[36:37], v87 offset:4096
  ds_read_b64_tr_b16 a[38:39], v87 offset:5120
  ds_read_b64_tr_b16 a[40:41], v87 offset:8192
  ds_read_b64_tr_b16 a[42:43], v87 offset:9216
  ds_read_b64_tr_b16 a[44:45], v87 offset:12288
  ds_read_b64_tr_b16 a[46:47], v87 offset:13312
  s_waitcnt vmcnt(28) lgkmcnt(0)
  s_barrier
  s_add_u32 m0, s52, 32768
  s_add_u32 s51, s70, 901120
  buffer_load_dwordx4 v84, s[8:11], s51 offen  lds
  s_add_u32 m0, s52, 33792
  s_add_u32 s51, s70, 906240
  buffer_load_dwordx4 v84, s[8:11], s51 offen  lds
  s_add_u32 m0, s52, 34816
  s_add_u32 s51, s70, 911360
  buffer_load_dwordx4 v84, s[8:11], s51 offen  lds
  s_add_u32 m0, s52, 35840
  s_add_u32 s51, s70, 916480
  buffer_load_dwordx4 v84, s[8:11], s51 offen  lds
  v_add_u32 v87, 49152, v85
  ds_read_b64_tr_b16 a[48:49], v87 offset:0
  ds_read_b64_tr_b16 a[50:51], v87 offset:1024
  ds_read_b64_tr_b16 a[52:53], v87 offset:4096
  ds_read_b64_tr_b16 a[54:55], v87 offset:5120
  ds_read_b64_tr_b16 a[56:57], v87 offset:8192
  ds_read_b64_tr_b16 a[58:59], v87 offset:9216
  ds_read_b64_tr_b16 a[60:61], v87 offset:12288
  ds_read_b64_tr_b16 a[62:63], v87 offset:13312
  s_waitcnt vmcnt(28) lgkmcnt(0)
  s_barrier
  s_add_u32 m0, s52, 49152
  s_add_u32 s51, s70, 983040
  buffer_load_dwordx4 v84, s[8:11], s51 offen  lds
  s_add_u32 m0, s52, 50176
  s_add_u32 s51, s70, 988160
  buffer_load_dwordx4 v84, s[8:11], s51 offen  lds
  s_add_u32 m0, s52, 51200
  s_add_u32 s51, s70, 993280
  buffer_load_dwordx4 v84, s[8:11], s51 offen  lds
  s_add_u32 m0, s52, 52224
  s_add_u32 s51, s70, 998400
  buffer_load_dwordx4 v84, s[8:11], s51 offen  lds
  v_add_u32 v87, 65536, v85
  ds_read_b64_tr_b16 a[64:65], v87 offset:0
  ds_read_b64_tr_b16 a[66:67], v87 offset:1024
  ds_read_b64_tr_b16 a[68:69], v87 offset:4096
  ds_read_b64_tr_b16 a[70:71], v87 offset:5120
  ds_read_b64_tr_b16 a[72:73], v87 offset:8192
  ds_read_b64_tr_b16 a[74:75], v87 offset:9216
  ds_read_b64_tr_b16 a[76:77], v87 offset:12288
  ds_read_b64_tr_b16 a[78:79], v87 offset:13312
  s_waitcnt vmcnt(28) lgkmcnt(0)
  s_barrier
  s_add_u32 m0, s52, 65536
  s_add_u32 s51, s70, 1064960
  buffer_load_dwordx4 v84, s[8:11], s51 offen  lds
  s_add_u32 m0, s52, 66560
  s_add_u32 s51, s70, 1070080
  buffer_load_dwordx4 v84, s[8:11], s51 offen  lds
  s_add_u32 m0, s52, 67584
  s_add_u32 s51, s70, 1075200
  buffer_load_dwordx4 v84, s[8:11], s51 offen  lds
  s_add_u32 m0, s52, 68608
  s_add_u32 s51, s70, 1080320
  buffer_load_dwordx4 v84, s[8:11], s51 offen  lds
  v_add_u32 v87, 81920, v85
  ds_read_b64_tr_b16 a[80:81], v87 offset:0
  ds_read_b64_tr_b16 a[82:83], v87 offset:1024
  ds_read_b64_tr_b16 a[84:85], v87 offset:4096
  ds_read_b64_tr_b16 a[86:87], v87 offset:5120
  ds_read_b64_tr_b16 a[88:89], v87 offset:8192
  ds_read_b64_tr_b16 a[90:91], v87 offset:9216
  ds_read_b64_tr_b16 a[92:93], v87 offset:12288
  ds_read_b64_tr_b16 a[94:95], v87 offset:13312
  s_waitcnt vmcnt(28) lgkmcnt(0)
  s_barrier
  s_add_u32 m0, s52, 81920
  s_add_u32 s51, s70, 1146880
  buffer_load_dwordx4 v84, s[8:11], s51 offen  lds
  s_add_u32 m0, s52, 82944
  s_add_u32 s51, s70, 1152000
  buffer_load_dwordx4 v84, s[8:11], s51 offen  lds
  s_add_u32 m0, s52, 83968
  s_add_u32 s51, s70, 1157120
  buffer_load_dwordx4 v84, s[8:11], s51 offen  lds
  s_add_u32 m0, s52, 84992
  s_add_u32 s51, s70, 1162240
  buffer_load_dwordx4 v84, s[8:11], s51 offen  lds
  v_add_u32 v87, 98304, v85
  ds_read_b64_tr_b16 a[96:97], v87 offset:0
  ds_read_b64_tr_b16 a[98:99], v87 offset:1024
  ds_read_b64_tr_b16 a[100:101], v87 offset:4096
  ds_read_b64_tr_b16 a[102:103], v87 offset:5120
  ds_read_b64_tr_b16 a[104:105], v87 offset:8192
  ds_read_b64_tr_b16 a[106:107], v87 offset:9216
  ds_read_b64_tr_b16 a[108:109], v87 offset:12288
  ds_read_b64_tr_b16 a[110:111], v87 offset:13312
  s_waitcnt vmcnt(28) lgkmcnt(0)
  s_barrier
  s_add_u32 m0, s52, 98304
  s_add_u32 s51, s70, 1228800
  buffer_load_dwordx4 v84, s[8:11], s51 offen  lds
  s_add_u32 m0, s52, 99328
  s_add_u32 s51, s70, 1233920
  buffer_load_dwordx4 v84, s[8:11], s51 offen  lds
  s_add_u32 m0, s52, 100352
  s_add_u32 s51, s70, 1239040
  buffer_load_dwordx4 v84, s[8:11], s51 offen  lds
  s_add_u32 m0, s52, 101376
  s_add_u32 s51, s70, 1244160
  buffer_load_dwordx4 v84, s[8:11], s51 offen  lds
  v_add_u32 v87, 114688, v85
  ds_read_b64_tr_b16 a[112:113], v87 offset:0
  ds_read_b64_tr_b16 a[114:115], v87 offset:1024
  ds_read_b64_tr_b16 a[116:117], v87 offset:4096
  ds_read_b64_tr_b16 a[118:119], v87 offset:5120
  ds_read_b64_tr_b16 a[120:121], v87 offset:8192
  ds_read_b64_tr_b16 a[122:123], v87 offset:9216
  ds_read_b64_tr_b16 a[124:125], v87 offset:12288
  ds_read_b64_tr_b16 a[126:127], v87 offset:13312
  s_waitcnt vmcnt(28) lgkmcnt(0)
  s_barrier
  s_add_u32 m0, s52, 114688
  s_add_u32 s51, s70, 1310720
  buffer_load_dwordx4 v84, s[8:11], s51 offen  lds
  s_add_u32 m0, s52, 115712
  s_add_u32 s51, s70, 1315840
  buffer_load_dwordx4 v84, s[8:11], s51 offen  lds
  s_add_u32 m0, s52, 116736
  s_add_u32 s51, s70, 1320960
  buffer_load_dwordx4 v84, s[8:11], s51 offen  lds
  s_add_u32 m0, s52, 117760
  s_add_u32 s51, s70, 1326080
  buffer_load_dwordx4 v84, s[8:11], s51 offen  lds
  v_add_u32 v87, 131072, v85
  ds_read_b64_tr_b16 a[128:129], v87 offset:0
  ds_read_b64_tr_b16 a[130:131], v87 offset:1024
  ds_read_b64_tr_b16 a[132:133], v87 offset:4096
  ds_read_b64_tr_b16 a[134:135], v87 offset:5120
  ds_read_b64_tr_b16 a[136:137], v87 offset:8192
  ds_read_b64_tr_b16 a[138:139], v87 offset:9216
  ds_read_b64_tr_b16 a[140:141], v87 offset:12288
  ds_read_b64_tr_b16 a[142:143], v87 offset:13312
  s_waitcnt vmcnt(28) lgkmcnt(0)
  s_barrier
  s_add_u32 m0, s52, 131072
  s_add_u32 s51, s70, 1392640
  buffer_load_dwordx4 v84, s[8:11], s51 offen  lds
  s_add_u32 m0, s52, 132096
  s_add_u32 s51, s70, 1397760
  buffer_load_dwordx4 v84, s[8:11], s51 offen  lds
  s_add_u32 m0, s52, 133120
  s_add_u32 s51, s70, 1402880
  buffer_load_dwordx4 v84, s[8:11], s51 offen  lds
  s_add_u32 m0, s52, 134144
  s_add_u32 s51, s70, 1408000
  buffer_load_dwordx4 v84, s[8:11], s51 offen  lds
  v_add_u32 v87, 0, v85
  ds_read_b64_tr_b16 a[144:145], v87 offset:0
  ds_read_b64_tr_b16 a[146:147], v87 offset:1024
  ds_read_b64_tr_b16 a[148:149], v87 offset:4096
  ds_read_b64_tr_b16 a[150:151], v87 offset:5120
  ds_read_b64_tr_b16 a[152:153], v87 offset:8192
  ds_read_b64_tr_b16 a[154:155], v87 offset:9216
  ds_read_b64_tr_b16 a[156:157], v87 offset:12288
  ds_read_b64_tr_b16 a[158:159], v87 offset:13312
  s_waitcnt vmcnt(28) lgkmcnt(0)
  s_barrier
  s_add_u32 m0, s52, 0
  s_add_u32 s51, s70, 1474560
  buffer_load_dwordx4 v84, s[8:11], s51 offen  lds
  s_add_u32 m0, s52, 1024
  s_add_u32 s51, s70, 1479680
  buffer_load_dwordx4 v84, s[8:11], s51 offen  lds
  s_add_u32 m0, s52, 2048
  s_add_u32 s51, s70, 1484800
  buffer_load_dwordx4 v84, s[8:11], s51 offen  lds
  s_add_u32 m0, s52, 3072
  s_add_u32 s51, s70, 1489920
  buffer_load_dwordx4 v84, s[8:11], s51 offen  lds
  v_add_u32 v87, 16384, v85
  ds_read_b64_tr_b16 a[160:161], v87 offset:0
  ds_read_b64_tr_b16 a[162:163], v87 offset:1024
  ds_read_b64_tr_b16 a[164:165], v87 offset:4096
  ds_read_b64_tr_b16 a[166:167], v87 offset:5120
  ds_read_b64_tr_b16 a[168:169], v87 offset:8192
  ds_read_b64_tr_b16 a[170:171], v87 offset:9216
  ds_read_b64_tr_b16 a[172:173], v87 offset:12288
  ds_read_b64_tr_b16 a[174:175], v87 offset:13312
  s_waitcnt vmcnt(28) lgkmcnt(0)
  s_barrier
  s_add_u32 m0, s52, 16384
  s_add_u32 s51, s70, 1556480
  buffer_load_dwordx4 v84, s[8:11], s51 offen  lds
  s_add_u32 m0, s52, 17408
  s_add_u32 s51, s70, 1561600
  buffer_load_dwordx4 v84, s[8:11], s51 offen  lds
  s_add_u32 m0, s52, 18432
  s_add_u32 s51, s70, 1566720
  buffer_load_dwordx4 v84, s[8:11], s51 offen  lds
  s_add_u32 m0, s52, 19456
  s_add_u32 s51, s70, 1571840
  buffer_load_dwordx4 v84, s[8:11], s51 offen  lds
  v_add_u32 v87, 32768, v85
  ds_read_b64_tr_b16 a[176:177], v87 offset:0
  ds_read_b64_tr_b16 a[178:179], v87 offset:1024
  ds_read_b64_tr_b16 a[180:181], v87 offset:4096
  ds_read_b64_tr_b16 a[182:183], v87 offset:5120
  ds_read_b64_tr_b16 a[184:185], v87 offset:8192
  ds_read_b64_tr_b16 a[186:187], v87 offset:9216
  ds_read_b64_tr_b16 a[188:189], v87 offset:12288
  ds_read_b64_tr_b16 a[190:191], v87 offset:13312
  s_waitcnt vmcnt(28) lgkmcnt(0)
  s_barrier
  s_add_u32 m0, s52, 32768
  s_add_u32 s51, s70, 1638400
  buffer_load_dwordx4 v84, s[8:11], s51 offen  lds
  s_add_u32 m0, s52, 33792
  s_add_u32 s51, s70, 1643520
  buffer_load_dwordx4 v84, s[8:11], s51 offen  lds
  s_add_u32 m0, s52, 34816
  s_add_u32 s51, s70, 1648640
  buffer_load_dwordx4 v84, s[8:11], s51 offen  lds
  s_add_u32 m0, s52, 35840
  s_add_u32 s51, s70, 1653760
  buffer_load_dwordx4 v84, s[8:11], s51 offen  lds
  v_add_u32 v87, 49152, v85
  ds_read_b64_tr_b16 a[192:193], v87 offset:0
  ds_read_b64_tr_b16 a[194:195], v87 offset:1024
  ds_read_b64_tr_b16 a[196:197], v87 offset:4096
  ds_read_b64_tr_b16 a[198:199], v87 offset:5120
  ds_read_b64_tr_b16 a[200:201], v87 offset:8192
  ds_read_b64_tr_b16 a[202:203], v87 offset:9216
  ds_read_b64_tr_b16 a[204:205], v87 offset:12288
  ds_read_b64_tr_b16 a[206:207], v87 offset:13312
  s_waitcnt vmcnt(28) lgkmcnt(0)
  s_barrier
  v_add_u32 v87, 65536, v85
  ds_read_b64_tr_b16 a[208:209], v87 offset:0
  ds_read_b64_tr_b16 a[210:211], v87 offset:1024
  ds_read_b64_tr_b16 a[212:213], v87 offset:4096
  ds_read_b64_tr_b16 a[214:215], v87 offset:5120
  ds_read_b64_tr_b16 a[216:217], v87 offset:8192
  ds_read_b64_tr_b16 a[218:219], v87 offset:9216
  ds_read_b64_tr_b16 a[220:221], v87 offset:12288
  ds_read_b64_tr_b16 a[222:223], v87 offset:13312
  s_waitcnt vmcnt(24) lgkmcnt(0)
  s_barrier
  v_add_u32 v87, 81920, v85
  ds_read_b64_tr_b16 a[224:225], v87 offset:0
  ds_read_b64_tr_b16 a[226:227], v87 offset:1024
  ds_read_b64_tr_b16 a[228:229], v87 offset:4096
  ds_read_b64_tr_b16 a[230:231], v87 offset:5120
  ds_read_b64_tr_b16 a[232:233], v87 offset:8192
  ds_read_b64_tr_b16 a[234:235], v87 offset:9216
  ds_read_b64_tr_b16 a[236:237], v87 offset:12288
  ds_read_b64_tr_b16 a[238:239], v87 offset:13312
  s_waitcnt vmcnt(20) lgkmcnt(0)
  s_barrier
  v_add_u32 v87, 98304, v85
  ds_read_b64_tr_b16 a[240:241], v87 offset:0
  ds_read_b64_tr_b16 a[242:243], v87 offset:1024
  ds_read_b64_tr_b16 a[244:245], v87 offset:4096
  ds_read_b64_tr_b16 a[246:247], v87 offset:5120
  ds_read_b64_tr_b16 a[248:249], v87 offset:8192
  ds_read_b64_tr_b16 a[250:251], v87 offset:9216
  ds_read_b64_tr_b16 a[252:253], v87 offset:12288
  ds_read_b64_tr_b16 a[254:255], v87 offset:13312
  s_waitcnt vmcnt(16) lgkmcnt(0)
  s_barrier
  v_add_u32 v87, 114688, v85
  ds_read_b64_tr_b16 v[176:177], v87 offset:0
  ds_read_b64_tr_b16 v[178:179], v87 offset:1024
  ds_read_b64_tr_b16 v[180:181], v87 offset:4096
  ds_read_b64_tr_b16 v[182:183], v87 offset:5120
  ds_read_b64_tr_b16 v[184:185], v87 offset:8192
  ds_read_b64_tr_b16 v[186:187], v87 offset:9216
  ds_read_b64_tr_b16 v[188:189], v87 offset:12288
  ds_read_b64_tr_b16 v[190:191], v87 offset:13312
  s_waitcnt vmcnt(12) lgkmcnt(0)
  s_barrier
  v_add_u32 v87, 131072, v85
  ds_read_b64_tr_b16 v[192:193], v87 offset:0
  ds_read_b64_tr_b16 v[194:195], v87 offset:1024
  ds_read_b64_tr_b16 v[196:197], v87 offset:4096
  ds_read_b64_tr_b16 v[198:199], v87 offset:5120
  ds_read_b64_tr_b16 v[200:201], v87 offset:8192
  ds_read_b64_tr_b16 v[202:203], v87 offset:9216
  ds_read_b64_tr_b16 v[204:205], v87 offset:12288
  ds_read_b64_tr_b16 v[206:207], v87 offset:13312
  s_waitcnt vmcnt(8) lgkmcnt(0)
  s_barrier
  s_lshr_b32 s3, s13, 5
  s_mul_i32 s3, s3, 65
  s_and_b32 s3, s3, 0xc4
  v_mov_b32 v5, s3
  v_writelane_b32 v5, 8, 0
  v_writelane_b32 v5, 12, 2
  global_load_dword v5, v5, s[38:39] sc1
  v_add_u32 v87, 0, v85
  ds_read_b64_tr_b16 v[208:209], v87 offset:0
  ds_read_b64_tr_b16 v[210:211], v87 offset:1024
  ds_read_b64_tr_b16 v[212:213], v87 offset:4096
  ds_read_b64_tr_b16 v[214:215], v87 offset:5120
  ds_read_b64_tr_b16 v[216:217], v87 offset:8192
  ds_read_b64_tr_b16 v[218:219], v87 offset:9216
  ds_read_b64_tr_b16 v[220:221], v87 offset:12288
  ds_read_b64_tr_b16 v[222:223], v87 offset:13312
  s_waitcnt vmcnt(4) lgkmcnt(0)
  s_barrier
  v_add_u32 v87, 16384, v85
  ds_read_b64_tr_b16 v[224:225], v87 offset:0
  ds_read_b64_tr_b16 v[226:227], v87 offset:1024
  ds_read_b64_tr_b16 v[228:229], v87 offset:4096
  ds_read_b64_tr_b16 v[230:231], v87 offset:5120
  ds_read_b64_tr_b16 v[232:233], v87 offset:8192
  ds_read_b64_tr_b16 v[234:235], v87 offset:9216
  ds_read_b64_tr_b16 v[236:237], v87 offset:12288
  ds_read_b64_tr_b16 v[238:239], v87 offset:13312
  s_waitcnt vmcnt(0) lgkmcnt(0)
  s_barrier
  v_add_u32 v87, 32768, v85
  ds_read_b64_tr_b16 v[240:241], v87 offset:0
  ds_read_b64_tr_b16 v[242:243], v87 offset:1024
  ds_read_b64_tr_b16 v[244:245], v87 offset:4096
  ds_read_b64_tr_b16 v[246:247], v87 offset:5120
  ds_read_b64_tr_b16 v[248:249], v87 offset:8192
  ds_read_b64_tr_b16 v[250:251], v87 offset:9216
  ds_read_b64_tr_b16 v[252:253], v87 offset:12288
  ds_read_b64_tr_b16 v[254:255], v87 offset:13312
  s_waitcnt lgkmcnt(0)
  v_readlane_b32 s92, v5, 0
  v_readlane_b32 s93, v5, 1
  v_readlane_b32 s2, v5, 2
  s_waitcnt lgkmcnt(0)
  s_barrier
  v_lshlrev_b32 v10, 3, v0
  v_mov_b32 v2, v1
  v_add_u32 v3, 0x10000, v1
  v_and_b32 v4, 31, v0
  v_min_u32 v4, 0, v4
  v_lshlrev_b32 v4, 8, v4
  s_mul_i32 s51, s68, 683
  s_lshr_b32 s51, s51, 17
  s_lshl_b32 s51, s51, 1
  s_add_u32 s52, s68, 1280
  s_mul_i32 s52, s52, 683
  s_lshr_b32 s52, s52, 17
  s_lshl_b32 s52, s52, 1
  s_add_u32 s52, s52, 1
  v_and_b32 v4, 31, v0
  v_add_u32 v4, s51, v4
  v_min_u32 v4, s52, v4
  v_lshlrev_b32 v4, 8, v4
  v_and_b32 v6, 1, v0
  v_lshlrev_b32 v6, 4, v6
  v_mov_b32 v7, 0x3f80
  v_lshlrev_b32 v7, v6, v7
  v_bfe_u32 v6, v0, 4, 1
  v_cmp_eq_u32 vcc, 0, v6
  s_nop 1
  v_cndmask_b32 v7, 0, v7, vcc
  v_bfe_u32 v6, v0, 2, 1
  v_lshrrev_b32 v84, 5, v0
  v_cmp_eq_u32 vcc, v6, v84
  s_nop 1
  v_cndmask_b32 v7, 0, v7, vcc
  v_bfe_u32 v6, v0, 3, 1
  v_bfe_u32 v84, v0, 1, 1
  v_lshl_add_u32 v6, v6, 1, v84
  v_cmp_eq_u32 vcc, 0, v6
  s_nop 1
  v_cndmask_b32 v84, 0, v7, vcc
  v_cmp_eq_u32 vcc, 1, v6
  s_nop 1
  v_cndmask_b32 v85, 0, v7, vcc
  v_cmp_eq_u32 vcc, 2, v6
  s_nop 1
  v_cndmask_b32 v86, 0, v7, vcc
  v_cmp_eq_u32 vcc, 3, v6
  s_nop 1
  v_cndmask_b32 v87, 0, v7, vcc
  v_and_b32 v6, 1, v0
  v_lshlrev_b32 v6, 4, v6
  v_mov_b32 v7, 0x3f80
  v_lshlrev_b32 v7, v6, v7
  v_bfe_u32 v6, v0, 4, 1
  v_cmp_eq_u32 vcc, 1, v6
  s_nop 1
  v_cndmask_b32 v7, 0, v7, vcc
  v_bfe_u32 v6, v0, 2, 1
  v_lshrrev_b32 v88, 5, v0
  v_cmp_eq_u32 vcc, v6, v88
  s_nop 1
  v_cndmask_b32 v7, 0, v7, vcc
  v_bfe_u32 v6, v0, 3, 1
  v_bfe_u32 v88, v0, 1, 1
  v_lshl_add_u32 v6, v6, 1, v88
  v_cmp_eq_u32 vcc, 0, v6
  s_nop 1
  v_cndmask_b32 v88, 0, v7, vcc
  v_cmp_eq_u32 vcc, 1, v6
  s_nop 1
  v_cndmask_b32 v89, 0, v7, vcc
  v_cmp_eq_u32 vcc, 2, v6
  s_nop 1
  v_cndmask_b32 v90, 0, v7, vcc
  v_cmp_eq_u32 vcc, 3, v6
  s_nop 1
  v_cndmask_b32 v91, 0, v7, vcc
  v_and_b32 v148, 0xf0, v1
  v_bfe_u32 v6, v0, 4, 1
  v_lshl_add_u32 v148, v6, 3, v148
  v_lshrrev_b32 v6, 5, v0
  v_lshl_add_u32 v148, v6, 8, v148
  s_lshl_b32 s51, s12, 9
  s_add_u32 s51, s51, 151552
  v_add_u32 v148, s51, v148
  v_lshlrev_b32 v150, 2, v0
  v_add_u32 v149, 151552, v150
  s_cmp_eq_u32 s12, 0
  s_cselect_b32 s51, 0, 0x20000000
  v_add_u32 v150, s51, v150
  s_mov_b32 s69, 0
  s_mul_i32 s51, s66, 4
  s_add_u32 s69, s69, s51
  s_add_u32 s69, s69, s12
  s_mov_b32 s53, 3145728
  s_mul_i32 s51, s45, 5767168
  s_add_u32 s53, s53, s51
  s_mul_i32 s51, s69, 2048
  s_add_u32 s53, s53, s51
  s_mov_b32 s54, 6070272
  s_mul_i32 s51, s45, 5767168
  s_add_u32 s54, s54, s51
  s_mul_i32 s51, s66, 256
  s_add_u32 s54, s54, s51
  s_mov_b32 s78, 93184
  s_mul_i32 s51, s45, 6400
  s_add_u32 s78, s78, s51
  s_mul_i32 s51, s66, 1280
  s_add_u32 s78, s78, s51
  s_mul_i32 s51, s45, 16384
  v_add_u32 v4, s51, v4
  v_and_b32 v6, 31, v0
  v_min_u32 v6, 4, v6
  v_lshlrev_b32 v6, 8, v6
  s_sub_u32 s51, s78, 60416
  v_add_u32 v6, s51, v6
  v_lshrrev_b32 v7, 5, v0
  v_cmp_eq_u32 vcc, s45, v7
  s_nop 1
  v_cndmask_b32 v4, v6, v4, vcc
  s_not_b64 s[76:77], vcc
  s_mov_b32 s15, s93
  s_and_b32 s3, s92, 0xffff
  s_cmp_lt_u32 s3, 48
  s_cbranch_scc1 L_rslow_8
  s_and_b32 s3, s15, 0xffff
  s_cmp_ge_u32 s3, 32
  s_cbranch_scc1 L_rfast_9
L_rslow_8:
  v_mov_b32 v6, 8
L_rdy_10:
  global_load_dword v7, v6, s[38:39] sc1
  s_waitcnt vmcnt(0)
  v_readfirstlane_b32 s15, v7
  s_and_b32 s3, s15, 0xffff
  s_cmp_ge_u32 s3, 48
  s_cbranch_scc1 L_rdyd_11
  s_sleep 8
  s_add_u32 s14, s14, 1
  s_cmp_lt_u32 s14, 100000
  s_cbranch_scc1 L_rdy_10
L_rdyd_11:
  v_mov_b32 v6, 12
  global_load_dword v6, v6, s[38:39] sc1
  s_waitcnt vmcnt(0)
  v_readfirstlane_b32 s2, v6
  s_lshr_b32 s15, s13, 5
  s_mul_i32 s3, s15, 65
  s_and_b32 s3, s3, 0xc4
  v_mov_b32 v6, s3
L_rdy_12:
  global_load_dword v7, v6, s[38:39] sc1
  s_waitcnt vmcnt(0)
  v_readfirstlane_b32 s15, v7
  s_and_b32 s3, s15, 0xffff
  s_cmp_ge_u32 s3, 32
  s_cbranch_scc1 L_rdyd_13
  s_sleep 8
  s_add_u32 s14, s14, 1
  s_cmp_lt_u32 s14, 100000
  s_cbranch_scc1 L_rdy_12
L_rdyd_13:
L_rfast_9:
  s_lshr_b32 s15, s15, 16
  s_and_b32 s2, s2, 3
  s_mul_i32 s2, s2, 0x2001
  s_xor_b32 s2, s2, 0x2000
  s_mov_b64 vcc, 0
  s_cmp_eq_u32 s101, 0
  s_cselect_b32 vcc_lo, 0x0, vcc_lo
  s_cselect_b32 vcc_hi, 0xfffffff0, vcc_hi
  s_cmp_eq_u32 s101, 1
  s_cselect_b32 vcc_lo, 0x0, vcc_lo
  s_cselect_b32 vcc_hi, 0xfffffff0, vcc_hi
  s_cmp_eq_u32 s101, 2
  s_cselect_b32 vcc_lo, 0x0, vcc_lo
  s_cselect_b32 vcc_hi, 0xfffffff0, vcc_hi
  s_cmp_eq_u32 s101, 3
  s_cselect_b32 vcc_lo, 0x0, vcc_lo
  s_cselect_b32 vcc_hi, 0xfffffff0, vcc_hi
  s_cmp_eq_u32 s101, 4
  s_cselect_b32 vcc_lo, 0x0, vcc_lo
  s_cselect_b32 vcc_hi, 0xfffffff0, vcc_hi
  s_cmp_eq_u32 s101, 5
  s_cselect_b32 vcc_lo, 0x4, vcc_lo
  s_cselect_b32 vcc_hi, 0x0, vcc_hi
  s_cmp_eq_u32 s101, 6
  s_cselect_b32 vcc_lo, 0x4, vcc_lo
  s_cselect_b32 vcc_hi, 0x0, vcc_hi
  s_cmp_eq_u32 s101, 7
  s_cselect_b32 vcc_lo, 0x4, vcc_lo
  s_cselect_b32 vcc_hi, 0x0, vcc_hi
  s_cmp_eq_u32 s101, 8
  s_cselect_b32 vcc_lo, 0x4, vcc_lo
  s_cselect_b32 vcc_hi, 0x0, vcc_hi
  s_cmp_eq_u32 s101, 9
  s_cselect_b32 vcc_lo, 0x4, vcc_lo
  s_cselect_b32 vcc_hi, 0x0, vcc_hi
  s_cmp_eq_u32 s15, 0
  s_cselect_b32 s51, 128, 0
  v_mov_b32 v6, s51
  v_cndmask_b32 v6, 0, v6, vcc
  v_add_u32 v4, v4, v6
  s_mov_b32 s68, 655360
  s_and_b32 s51, s2, 0x2000
  s_add_u32 s68, s68, s51
  v_add_u32 v3, 131072, v1
  v_lshlrev_b32 v171, 2, v0
  v_add_u32 v171, 155648, v171
  s_lshl_b32 s95, s12, 8
  s_add_u32 s95, s95, 155648
  v_or_b32 v0, s12, v0
  v_lshlrev_b32 v0, 24, v0
  v_min_u32 v0, 0x1000000, v0
  v_lshlrev_b32 v0, 4, v0
  s_lshl_b32 s63, s12, 10
  s_mov_b32 s50, s63
  s_mov_b32 s42, -2
  s_mov_b32 s62, 0
  s_mov_b32 s48, 60416
  s_cmp_eq_u32 s12, 0
  s_cselect_b32 s48, s48, 0x20000000
  s_mov_b32 s56, 65536
  s_mov_b32 s55, 65536
  s_mov_b32 s83, s45
  s_mov_b32 s80, 63
  s_add_u32 s84, s42, 2
  s_mov_b32 s85, 165675008
  s_mul_i32 s52, s84, 1048576
  s_add_u32 s85, s85, s52
  s_add_u32 s85, s85, s68
  s_add_u32 s85, s85, s63
  s_lshl_b32 s52, s83, 21
  s_add_u32 s52, s52, s85
  s_lshr_b32 s52, s52, 8
  s_and_b32 s52, s52, 0x2000
  s_xor_b32 s85, s85, s52
  s_mov_b32 s43, s45
  s_mov_b32 s44, s46
  s_mov_b32 s46, s84
  s_mov_b32 s45, s83
  s_mov_b32 s64, s85
  s_add_u32 s42, s42, 1
  s_add_u32 s84, s42, 2
  s_mov_b32 s85, 165675008
  s_mul_i32 s52, s84, 1048576
  s_add_u32 s85, s85, s52
  s_add_u32 s85, s85, s68
  s_add_u32 s85, s85, s63
  s_lshl_b32 s52, s83, 21
  s_add_u32 s52, s52, s85
  s_lshr_b32 s52, s52, 8
  s_and_b32 s52, s52, 0x2000
  s_xor_b32 s85, s85, s52
  s_mov_b32 s57, 0x20000000
  s_mov_b32 s58, 0x20000000
  s_mov_b32 s59, 0x20000000
  s_mov_b32 s60, 0x20000000
  s_mov_b32 s61, 0x20000000
  s_mov_b32 s47, s64
  s_mov_b32 s49, 0
  s_mov_b32 s94, 0
  s_mov_b32 s71, 0x3f803f80
  s_branch L_root_spin
L_root_top:
  s_waitcnt vmcnt(5)
  s_barrier
  ds_read_b128 v[12:15], v3 offset:0
  ds_read_b128 v[16:19], v3 offset:1024
  ds_read_b128 v[20:23], v3 offset:2048
  ds_read_b128 v[24:27], v3 offset:3072
  ds_read_b128 v[28:31], v3 offset:4096
  ds_read_b32 v5, v171
  v_cvt_pk_bf16_f32 v68, v36, v37
  v_cvt_pk_bf16_f32 v69, v38, v39
  v_cvt_pk_bf16_f32 v70, v40, v41
  v_cvt_pk_bf16_f32 v71, v42, v43
  v_cvt_pk_bf16_f32 v72, v44, v45
  v_cvt_pk_bf16_f32 v73, v46, v47
  v_cvt_pk_bf16_f32 v74, v48, v49
  v_cvt_pk_bf16_f32 v75, v50, v51
  v_dot2_f32_bf16 v78, v68, s71, 0
  v_dot2_f32_bf16 v79, v68, v68, 0
  v_dot2_f32_bf16 v78, v69, s71, v78
  v_dot2_f32_bf16 v79, v69, v69, v79
  v_dot2_f32_bf16 v78, v70, s71, v78
  v_dot2_f32_bf16 v79, v70, v70, v79
  v_dot2_f32_bf16 v78, v71, s71, v78
  v_dot2_f32_bf16 v79, v71, v71, v79
  v_dot2_f32_bf16 v78, v72, s71, v78
  v_dot2_f32_bf16 v79, v72, v72, v79
  v_dot2_f32_bf16 v78, v73, s71, v78
  v_dot2_f32_bf16 v79, v73, v73, v79
  v_dot2_f32_bf16 v78, v74, s71, v78
  v_dot2_f32_bf16 v79, v74, v74, v79
  v_dot2_f32_bf16 v78, v75, s71, v78
  v_dot2_f32_bf16 v79, v75, v75, v79
L_root_body:
  s_waitcnt lgkmcnt(5)
  v_mfma_f32_32x32x16_bf16 v[36:51], a[0:3], v[12:15], 0
  ds_read_b128 v[32:35], v3 offset:5120
  buffer_store_dwordx4 v[68:71], v1, s[4:7], s57 offen offset:0 sc1
  s_nop 0
  ds_write_b64 v148, v[78:79]
  s_waitcnt lgkmcnt(6)
  v_mfma_f32_32x32x16_bf16 v[36:51], a[4:7], v[16:19], v[36:51]
  ds_read_b128 v[12:15], v3 offset:6144
  s_mov_b32 s43, s45
  s_mov_b32 s44, s46
  s_mov_b32 s46, s84
  s_mov_b32 s45, s83
  s_waitcnt lgkmcnt(6)
  v_mfma_f32_32x32x16_bf16 v[36:51], a[8:11], v[20:23], v[36:51]
  ds_read_b128 v[16:19], v3 offset:7168
  buffer_store_dwordx4 v[72:75], v1, s[4:7], s57 offen offset:1024 sc1
  s_mov_b32 s64, s85
  s_add_u32 s42, s42, 1
  s_mov_b32 s74, 0
  s_waitcnt lgkmcnt(6)
  v_mfma_f32_32x32x16_bf16 v[36:51], a[12:15], v[24:27], v[36:51]
  ds_read_b128 v[20:23], v3 offset:8192
  s_waitcnt lgkmcnt(3)
  s_barrier
  ds_read2st64_b32 v[92:93], v149 offset0:0 offset1:1
  ds_read2st64_b32 v[94:95], v149 offset0:2 offset1:3
  v_mfma_f32_32x32x16_bf16 v[36:51], a[16:19], v[28:31], v[36:51]
  ds_read_b128 v[24:27], v3 offset:9216
  ds_read2st64_b32 v[96:97], v149 offset0:4 offset1:5
  ds_read2st64_b32 v[98:99], v149 offset0:6 offset1:7
  v_cmp_ge_i32 vcc, s46, v5
  v_mfma_f32_32x32x16_bf16 v[36:51], a[20:23], v[32:35], v[36:51]
  ds_read_b128 v[28:31], v3 offset:10240
  s_cmp_eq_u32 s45, 0
  s_cselect_b32 s51, vcc_lo, vcc_hi
  s_cmp_lg_u32 s51, 0
  s_cselect_b32 s49, 0, 1
  s_waitcnt lgkmcnt(8)
  v_mfma_f32_32x32x16_bf16 v[36:51], a[24:27], v[12:15], v[36:51]
  ds_read_b128 v[32:35], v3 offset:11264
  s_cmp_lt_u32 s42, s80
  s_cselect_b32 s49, s49, 0
  s_add_u32 s74, s74, s53
  s_mul_i32 s52, s44, 45056
  s_waitcnt lgkmcnt(8)
  v_mfma_f32_32x32x16_bf16 v[36:51], a[28:31], v[16:19], v[36:51]
  ds_read_b128 v[12:15], v3 offset:12288
  s_waitcnt lgkmcnt(3)
  v_add_f32 v92, v92, v93
  v_add_f32 v92, v92, v94
  v_add_f32 v92, v92, v95
  v_mfma_f32_32x32x16_bf16 v[36:51], a[32:35], v[20:23], v[36:51]
  ds_read_b128 v[16:19], v3 offset:13312
  v_add_f32 v92, v92, v96
  v_add_f32 v92, v92, v97
  v_add_f32 v92, v92, v98
  v_add_f32 v92, v92, v99
  v_mfma_f32_32x32x16_bf16 v[36:51], a[36:39], v[24:27], v[36:51]
  ds_read_b128 v[20:23], v3 offset:14336
  buffer_store_dword v92, v150, s[4:7], s58 offen offset:0 sc1
  s_cmp_lg_u32 s49, 0
  s_cselect_b32 s47, s64, 0x20000000
  s_xor_b32 s50, s50, s56
  s_waitcnt lgkmcnt(4)
  v_mfma_f32_32x32x16_bf16 v[36:51], a[40:43], v[28:31], v[36:51]
  ds_read_b128 v[24:27], v3 offset:15360
  s_xor_b32 s95, s95, 1024
  s_mov_b32 m0, s95
  v_xor_b32 v171, 1024, v171
  buffer_load_dword v4, s[4:7], s48 offen sc1 lds
  s_waitcnt lgkmcnt(4)
  v_mfma_f32_32x32x16_bf16 v[36:51], a[44:47], v[32:35], v[36:51]
  ds_read_b128 v[28:31], v3 offset:16384
  s_add_u32 s74, s74, s52
  buffer_load_dwordx4 v[132:135], v1, s[4:7], s74 offen offset:0 sc1
  s_waitcnt lgkmcnt(4)
  v_mfma_f32_32x32x16_bf16 v[36:51], a[48:51], v[12:15], v[36:51]
  ds_read_b128 v[32:35], v3 offset:17408
  s_waitcnt lgkmcnt(4)
  v_mfma_f32_32x32x16_bf16 v[36:51], a[52:55], v[16:19], v[36:51]
  ds_read_b128 v[12:15], v3 offset:18432
  buffer_load_dwordx4 v[136:139], v1, s[4:7], s74 offen offset:1024 sc1
  s_mov_b32 s75, 232783872
  s_mul_i32 s52, s43, 13107200
  s_add_u32 s75, s75, s52
  s_waitcnt lgkmcnt(4)
  v_mfma_f32_32x32x16_bf16 v[36:51], a[56:59], v[20:23], v[36:51]
  ds_read_b128 v[16:19], v3 offset:19456
  s_mul_i32 s52, s44, 204800
  s_add_u32 s75, s75, s52
  s_mul_i32 s52, s69, 2048
  s_add_u32 s75, s75, s52
  s_waitcnt lgkmcnt(4)
  v_mfma_f32_32x32x16_bf16 v[36:51], a[60:63], v[24:27], v[36:51]
  ds_read_b128 v[20:23], v2 offset:0
  s_add_u32 m0, s50, 0
  s_add_u32 s51, s47, 36864
  buffer_load_dwordx4 v1, s[4:7], s51 offen sc1 lds
  s_add_u32 s84, s42, 2
  s_waitcnt lgkmcnt(4)
  v_mfma_f32_32x32x16_bf16 v[36:51], a[64:67], v[28:31], v[36:51]
  ds_read_b128 v[24:27], v2 offset:1024
  s_mov_b32 s85, 165675008
  s_mul_i32 s52, s84, 1048576
  s_add_u32 s85, s85, s52
  s_add_u32 s85, s85, s68
  s_waitcnt lgkmcnt(4)
  v_mfma_f32_32x32x16_bf16 v[36:51], a[68:71], v[32:35], v[36:51]
  ds_read_b128 v[28:31], v2 offset:2048
  s_add_u32 m0, s50, 4096
  s_add_u32 s51, s47, 49152
  buffer_load_dwordx4 v1, s[4:7], s51 offen sc1 lds
  s_add_u32 s85, s85, s63
  s_waitcnt lgkmcnt(4)
  v_mfma_f32_32x32x16_bf16 v[36:51], a[72:75], v[12:15], v[36:51]
  ds_read_b128 v[32:35], v2 offset:3072
  s_lshl_b32 s52, s83, 21
  s_add_u32 s52, s52, s85
  s_lshr_b32 s52, s52, 8
  s_and_b32 s52, s52, 0x2000
  s_waitcnt lgkmcnt(4)
  v_mfma_f32_32x32x16_bf16 v[36:51], a[76:79], v[16:19], v[36:51]
  s_waitcnt vmcnt(8)
  s_barrier
  ds_read_b128 v[12:15], v2 offset:4096
  s_add_u32 m0, s50, 8192
  s_add_u32 s51, s47, 53248
  buffer_load_dwordx4 v1, s[4:7], s51 offen sc1 lds
  s_waitcnt lgkmcnt(4)
  v_mfma_f32_32x32x16_bf16 v[36:51], a[80:83], v[20:23], v[36:51]
  ds_read_b128 v[16:19], v2 offset:5120
  s_xor_b32 s85, s85, s52
  s_waitcnt lgkmcnt(4)
  v_mfma_f32_32x32x16_bf16 v[36:51], a[84:87], v[24:27], v[36:51]
  ds_read_b128 v[20:23], v2 offset:6144
  s_add_u32 m0, s63, 131072
  s_add_u32 s51, s47, 0
  buffer_load_dwordx4 v1, s[4:7], s51 offen sc1 lds
  s_waitcnt lgkmcnt(4)
  v_mfma_f32_32x32x16_bf16 v[36:51], a[88:91], v[28:31], v[36:51]
  ds_read_b128 v[24:27], v2 offset:7168
  s_waitcnt lgkmcnt(4)
  v_mfma_f32_32x32x16_bf16 v[36:51], a[92:95], v[32:35], v[36:51]
  ds_read_b128 v[28:31], v2 offset:8192
  s_add_u32 m0, s63, 135168
  s_add_u32 s51, s47, 4096
  buffer_load_dwordx4 v1, s[4:7], s51 offen sc1 lds
  s_waitcnt lgkmcnt(4)
  v_mfma_f32_32x32x16_bf16 v[36:51], a[96:99], v[12:15], v[36:51]
  ds_read_b128 v[32:35], v2 offset:9216
  s_waitcnt lgkmcnt(4)
  v_mfma_f32_32x32x16_bf16 v[36:51], a[100:103], v[16:19], v[36:51]
  ds_read_b128 v[12:15], v2 offset:10240
  s_add_u32 m0, s63, 139264
  s_add_u32 s51, s47, 16384
  buffer_load_dwordx4 v1, s[4:7], s51 offen sc1 lds
  s_waitcnt lgkmcnt(4)
  v_mfma_f32_32x32x16_bf16 v[36:51], a[104:107], v[20:23], v[36:51]
  ds_read_b128 v[16:19], v2 offset:11264
  s_waitcnt lgkmcnt(4)
  v_mfma_f32_32x32x16_bf16 v[36:51], a[108:111], v[24:27], v[36:51]
  ds_read_b128 v[20:23], v2 offset:12288
  s_add_u32 m0, s63, 143360
  s_add_u32 s51, s47, 20480
  buffer_load_dwordx4 v1, s[4:7], s51 offen sc1 lds
  s_waitcnt lgkmcnt(4)
  v_mfma_f32_32x32x16_bf16 v[36:51], a[112:115], v[28:31], v[36:51]
  ds_read_b128 v[24:27], v2 offset:13312
  s_waitcnt lgkmcnt(4)
  v_mfma_f32_32x32x16_bf16 v[36:51], a[116:119], v[32:35], v[36:51]
  ds_read_b128 v[28:31], v2 offset:14336
  s_add_u32 m0, s63, 147456
  s_add_u32 s51, s47, 32768
  buffer_load_dwordx4 v1, s[4:7], s51 offen sc1 lds
  s_waitcnt lgkmcnt(4)
  v_mfma_f32_32x32x16_bf16 v[36:51], a[120:123], v[12:15], v[36:51]
  ds_read_b128 v[32:35], v2 offset:15360
  s_waitcnt lgkmcnt(4)
  v_mfma_f32_32x32x16_bf16 v[36:51], a[124:127], v[16:19], v[36:51]
  ds_read_b128 v[12:15], v2 offset:16384
  s_add_u32 m0, s50, 12288
  s_add_u32 s51, s47, 65536
  buffer_load_dwordx4 v1, s[4:7], s51 offen sc1 lds
  s_waitcnt lgkmcnt(4)
  v_mfma_f32_32x32x16_bf16 v[36:51], a[128:131], v[20:23], v[36:51]
  ds_read_b128 v[16:19], v2 offset:17408
  s_waitcnt lgkmcnt(4)
  v_mfma_f32_32x32x16_bf16 v[36:51], a[132:135], v[24:27], v[36:51]
  ds_read_b128 v[20:23], v2 offset:18432
  s_add_u32 m0, s50, 16384
  s_add_u32 s51, s47, 69632
  buffer_load_dwordx4 v1, s[4:7], s51 offen sc1 lds
  s_waitcnt lgkmcnt(4)
  v_mfma_f32_32x32x16_bf16 v[36:51], a[136:139], v[28:31], v[36:51]
  ds_read_b128 v[24:27], v2 offset:19456
  s_waitcnt lgkmcnt(4)
  v_mfma_f32_32x32x16_bf16 v[36:51], a[140:143], v[32:35], v[36:51]
  ds_read_b128 v[28:31], v2 offset:20480
  s_add_u32 m0, s50, 20480
  s_add_u32 s51, s47, 81920
  buffer_load_dwordx4 v1, s[4:7], s51 offen sc1 lds
  s_waitcnt lgkmcnt(4)
  v_mfma_f32_32x32x16_bf16 v[36:51], a[144:147], v[12:15], v[36:51]
  ds_read_b128 v[32:35], v2 offset:21504
  s_waitcnt lgkmcnt(4)
  v_mfma_f32_32x32x16_bf16 v[36:51], a[148:151], v[16:19], v[36:51]
  ds_read_b128 v[12:15], v2 offset:22528
  s_add_u32 m0, s50, 24576
  s_add_u32 s51, s47, 86016
  buffer_load_dwordx4 v1, s[4:7], s51 offen sc1 lds
  s_waitcnt lgkmcnt(4)
  v_mfma_f32_32x32x16_bf16 v[36:51], a[152:155], v[20:23], v[36:51]
  ds_read_b128 v[16:19], v2 offset:23552
  s_waitcnt lgkmcnt(4)
  v_mfma_f32_32x32x16_bf16 v[36:51], a[156:159], v[24:27], v[36:51]
  ds_read_b128 v[20:23], v2 offset:24576
  s_add_u32 m0, s50, 28672
  s_add_u32 s51, s47, 98304
  buffer_load_dwordx4 v1, s[4:7], s51 offen sc1 lds
  s_waitcnt lgkmcnt(4)
  v_mfma_f32_32x32x16_bf16 v[36:51], a[160:163], v[28:31], v[36:51]
  ds_read_b128 v[24:27], v2 offset:25600
  s_waitcnt lgkmcnt(4)
  v_mfma_f32_32x32x16_bf16 v[36:51], a[164:167], v[32:35], v[36:51]
  ds_read_b128 v[28:31], v2 offset:26624
  s_add_u32 m0, s50, 32768
  s_add_u32 s51, s47, 102400
  buffer_load_dwordx4 v1, s[4:7], s51 offen sc1 lds
  s_waitcnt lgkmcnt(4)
  v_mfma_f32_32x32x16_bf16 v[36:51], a[168:171], v[12:15], v[36:51]
  ds_read_b128 v[32:35], v2 offset:27648
  s_waitcnt vmcnt(16)
  s_barrier
  v_mov_b32 v7, s62
  buffer_store_dword v7, v0, s[4:7], s61 offen offset:0 sc1
  buffer_store_dword v7, v0, s[4:7], s61 offen offset:128
  ds_read_b32 v5, v171
  s_waitcnt lgkmcnt(5)
  v_mfma_f32_32x32x16_bf16 v[36:51], a[172:175], v[16:19], v[36:51]
  ds_read_b128 v[12:15], v2 offset:28672
  s_add_u32 m0, s50, 36864
  s_add_u32 s51, s47, 114688
  buffer_load_dwordx4 v1, s[4:7], s51 offen sc1 lds
  s_add_u32 s57, s74, 2883584
  s_waitcnt lgkmcnt(5)
  v_mfma_f32_32x32x16_bf16 v[36:51], a[176:179], v[20:23], v[36:51]
  ds_read_b128 v[16:19], v2 offset:29696
  s_mov_b32 s58, 0
  s_add_u32 s58, s58, s54
  s_mul_i32 s52, s44, 45056
  s_add_u32 s58, s58, s52
  s_waitcnt lgkmcnt(5)
  v_mfma_f32_32x32x16_bf16 v[36:51], a[180:183], v[24:27], v[36:51]
  ds_read_b128 v[20:23], v2 offset:30720
  s_waitcnt lgkmcnt(3)
  v_cmp_ge_i32 vcc, s44, v5
  s_and_b64 vcc, vcc, s[76:77]
  s_cselect_b32 s78, 0x20000000, s75
  s_cselect_b32 s79, 0, 1
  v_mfma_f32_32x32x16_bf16 v[36:51], a[184:187], v[28:31], v[36:51]
  ds_read_b128 v[24:27], v2 offset:31744
  buffer_load_dwordx4 v[92:95], v1, s[4:7], s78 offen offset:0 sc1
  s_mov_b32 s61, 1280
  s_mul_i32 s52, s43, 2560
  s_add_u32 s61, s61, s52
  v_mfma_f32_32x32x16_bf16 v[36:51], a[188:191], v[32:35], v[36:51]
  ds_read_b128 v[28:31], v2 offset:32768
  s_mul_i32 s52, s66, 256
  s_add_u32 s61, s61, s52
  s_add_u32 s62, s44, 1
  s_waitcnt lgkmcnt(4)
  v_mfma_f32_32x32x16_bf16 v[36:51], a[192:195], v[12:15], v[36:51]
  ds_read_b128 v[32:35], v2 offset:33792
  buffer_load_dwordx4 v[96:99], v1, s[4:7], s78 offen offset:1024 sc1
  s_add_u32 s78, s78, 40960
  s_waitcnt lgkmcnt(4)
  v_mfma_f32_32x32x16_bf16 v[36:51], a[196:199], v[16:19], v[36:51]
  ds_read_b128 v[12:15], v2 offset:34816
  s_waitcnt lgkmcnt(4)
  v_mfma_f32_32x32x16_bf16 v[36:51], a[200:203], v[20:23], v[36:51]
  ds_read_b128 v[16:19], v2 offset:35840
  buffer_load_dwordx4 v[100:103], v1, s[4:7], s78 offen offset:0 sc1
  s_waitcnt lgkmcnt(4)
  v_mfma_f32_32x32x16_bf16 v[36:51], a[204:207], v[24:27], v[36:51]
  ds_read_b128 v[20:23], v2 offset:36864
  s_waitcnt lgkmcnt(4)
  v_mfma_f32_32x32x16_bf16 v[36:51], a[208:211], v[28:31], v[36:51]
  ds_read_b128 v[24:27], v2 offset:37888
  buffer_load_dwordx4 v[104:107], v1, s[4:7], s78 offen offset:1024 sc1
  s_add_u32 s78, s78, 40960
  s_waitcnt lgkmcnt(4)
  v_mfma_f32_32x32x16_bf16 v[36:51], a[212:215], v[32:35], v[36:51]
  ds_read_b128 v[28:31], v2 offset:38912
  s_waitcnt lgkmcnt(4)
  v_mfma_f32_32x32x16_bf16 v[36:51], a[216:219], v[12:15], v[36:51]
  ds_read_b128 v[32:35], v2 offset:39936
  buffer_load_dwordx4 v[108:111], v1, s[4:7], s78 offen offset:0 sc1
  s_waitcnt lgkmcnt(4)
  v_mfma_f32_32x32x16_bf16 v[36:51], a[220:223], v[16:19], v[36:51]
  ds_read_b128 v[12:15], v2 offset:40960
  s_waitcnt lgkmcnt(4)
  v_mfma_f32_32x32x16_bf16 v[36:51], a[224:227], v[20:23], v[36:51]
  ds_read_b128 v[16:19], v2 offset:41984
  buffer_load_dwordx4 v[112:115], v1, s[4:7], s78 offen offset:1024 sc1
  s_add_u32 s78, s78, 40960
  s_waitcnt lgkmcnt(4)
  v_mfma_f32_32x32x16_bf16 v[36:51], a[228:231], v[24:27], v[36:51]
  ds_read_b128 v[20:23], v2 offset:43008
  s_waitcnt lgkmcnt(4)
  v_mfma_f32_32x32x16_bf16 v[36:51], a[232:235], v[28:31], v[36:51]
  ds_read_b128 v[24:27], v2 offset:44032
  buffer_load_dwordx4 v[116:119], v1, s[4:7], s78 offen offset:0 sc1
  s_waitcnt lgkmcnt(4)
  v_mfma_f32_32x32x16_bf16 v[36:51], a[236:239], v[32:35], v[36:51]
  ds_read_b128 v[28:31], v2 offset:45056
  s_waitcnt lgkmcnt(4)
  v_mfma_f32_32x32x16_bf16 v[36:51], a[240:243], v[12:15], v[36:51]
  ds_read_b128 v[32:35], v2 offset:46080
  buffer_load_dwordx4 v[120:123], v1, s[4:7], s78 offen offset:1024 sc1
  s_add_u32 s78, s78, 40960
  s_waitcnt lgkmcnt(4)
  v_mfma_f32_32x32x16_bf16 v[36:51], a[244:247], v[16:19], v[36:51]
  ds_read_b128 v[12:15], v2 offset:47104
  s_waitcnt lgkmcnt(4)
  v_mfma_f32_32x32x16_bf16 v[36:51], a[248:251], v[20:23], v[36:51]
  ds_read_b128 v[16:19], v2 offset:48128
  buffer_load_dwordx4 v[124:127], v1, s[4:7], s78 offen offset:0 sc1
  s_waitcnt lgkmcnt(4)
  v_mfma_f32_32x32x16_bf16 v[36:51], a[252:255], v[24:27], v[36:51]
  ds_read_b128 v[20:23], v2 offset:49152
  s_waitcnt lgkmcnt(4)
  v_mfma_f32_32x32x16_bf16 v[36:51], v[176:179], v[28:31], v[36:51]
  ds_read_b128 v[24:27], v2 offset:50176
  buffer_load_dwordx4 v[128:131], v1, s[4:7], s78 offen offset:1024 sc1
  s_add_u32 s78, s78, 40960
  s_waitcnt lgkmcnt(4)
  v_mfma_f32_32x32x16_bf16 v[36:51], v[180:183], v[32:35], v[36:51]
  ds_read_b128 v[28:31], v2 offset:51200
  s_waitcnt lgkmcnt(4)
  v_mfma_f32_32x32x16_bf16 v[36:51], v[184:187], v[12:15], v[36:51]
  ds_read_b128 v[32:35], v2 offset:52224
  s_add_u32 m0, s50, 40960
  s_add_u32 s51, s47, 118784
  buffer_load_dwordx4 v1, s[4:7], s51 offen sc1 lds
  s_waitcnt lgkmcnt(4)
  v_mfma_f32_32x32x16_bf16 v[36:51], v[188:191], v[16:19], v[36:51]
  ds_read_b128 v[12:15], v2 offset:53248
  s_xor_b32 s95, s95, 1024
  s_mov_b32 m0, s95
  v_xor_b32 v171, 1024, v171
  buffer_load_dword v4, s[4:7], s48 offen sc1 lds
  s_waitcnt lgkmcnt(4)
  v_mfma_f32_32x32x16_bf16 v[36:51], v[192:195], v[20:23], v[36:51]
  ds_read_b128 v[16:19], v2 offset:54272
  s_add_u32 m0, s50, 45056
  s_add_u32 s51, s47, 131072
  buffer_load_dwordx4 v1, s[4:7], s51 offen sc1 lds
  s_waitcnt lgkmcnt(4)
  v_mfma_f32_32x32x16_bf16 v[36:51], v[196:199], v[24:27], v[36:51]
  ds_read_b128 v[20:23], v2 offset:55296
  s_waitcnt lgkmcnt(4)
  v_mfma_f32_32x32x16_bf16 v[36:51], v[200:203], v[28:31], v[36:51]
  ds_read_b128 v[24:27], v2 offset:56320
  s_add_u32 m0, s50, 49152
  s_add_u32 s51, s47, 135168
  buffer_load_dwordx4 v1, s[4:7], s51 offen sc1 lds
  s_waitcnt lgkmcnt(4)
  v_mfma_f32_32x32x16_bf16 v[36:51], v[204:207], v[32:35], v[36:51]
  ds_read_b128 v[28:31], v2 offset:57344
  s_waitcnt lgkmcnt(4)
  v_mfma_f32_32x32x16_bf16 v[36:51], v[208:211], v[12:15], v[36:51]
  ds_read_b128 v[32:35], v2 offset:58368
  s_add_u32 m0, s50, 53248
  s_add_u32 s51, s47, 147456
  buffer_load_dwordx4 v1, s[4:7], s51 offen sc1 lds
  s_waitcnt lgkmcnt(4)
  v_mfma_f32_32x32x16_bf16 v[36:51], v[212:215], v[16:19], v[36:51]
  ds_read_b128 v[12:15], v2 offset:59392
  s_waitcnt lgkmcnt(4)
  v_mfma_f32_32x32x16_bf16 v[36:51], v[216:219], v[20:23], v[36:51]
  ds_read_b128 v[16:19], v2 offset:60416
  s_add_u32 m0, s50, 57344
  s_add_u32 s51, s47, 151552
  buffer_load_dwordx4 v1, s[4:7], s51 offen sc1 lds
  s_waitcnt lgkmcnt(4)
  v_mfma_f32_32x32x16_bf16 v[36:51], v[220:223], v[24:27], v[36:51]
  ds_read_b128 v[20:23], v2 offset:61440
  s_waitcnt lgkmcnt(4)
  v_mfma_f32_32x32x16_bf16 v[36:51], v[224:227], v[28:31], v[36:51]
  ds_read_b128 v[24:27], v2 offset:62464
  s_add_u32 m0, s50, 61440
  s_add_u32 s51, s47, 163840
  buffer_load_dwordx4 v1, s[4:7], s51 offen sc1 lds
  s_waitcnt lgkmcnt(4)
  v_mfma_f32_32x32x16_bf16 v[36:51], v[228:231], v[32:35], v[36:51]
  ds_read_b128 v[28:31], v2 offset:63488
  s_cmp_lg_u32 s79, 0
  s_cbranch_scc1 L_look_14
  s_xor_b32 s95, s95, 1024
  s_mov_b32 m0, s95
  v_xor_b32 v171, 1024, v171
  buffer_load_dword v4, s[4:7], s48 offen sc1 lds
L_look_14:
  s_waitcnt lgkmcnt(4)
  v_mfma_f32_32x32x16_bf16 v[36:51], v[232:235], v[12:15], v[36:51]
  ds_read_b128 v[32:35], v2 offset:64512
  s_waitcnt lgkmcnt(4)
  v_mfma_f32_32x32x16_bf16 v[36:51], v[236:239], v[16:19], v[36:51]
  v_add_u32 v2, s55, v2
  s_sub_u32 s55, 0, s55
  s_waitcnt lgkmcnt(3)
  v_mfma_f32_32x32x16_bf16 v[36:51], v[240:243], v[20:23], v[36:51]
  s_waitcnt lgkmcnt(2)
  v_mfma_f32_32x32x16_bf16 v[36:51], v[244:247], v[24:27], v[36:51]
  s_waitcnt lgkmcnt(1)
  v_mfma_f32_32x32x16_bf16 v[36:51], v[248:251], v[28:31], v[36:51]
  s_waitcnt lgkmcnt(0)
  v_mfma_f32_32x32x16_bf16 v[36:51], v[252:255], v[32:35], v[36:51]
  s_waitcnt vmcnt(34)
  v_mfma_f32_32x32x16_bf16 v[36:51], v[84:87], v[132:135], v[36:51]
  s_cmp_eq_u32 s79, 0
  s_cbranch_scc1 L_fpslow_18
  v_mfma_f32_32x32x16_bf16 v[36:51], v[88:91], v[136:139], v[36:51]
  s_waitcnt vmcnt(16)
  v_mfma_f32_32x32x16_bf16 v[36:51], v[84:87], v[92:95], v[36:51]
  s_waitcnt vmcnt(15)
  v_mfma_f32_32x32x16_bf16 v[36:51], v[88:91], v[96:99], v[36:51]
  s_waitcnt vmcnt(14)
  v_mfma_f32_32x32x16_bf16 v[36:51], v[84:87], v[100:103], v[36:51]
  s_waitcnt vmcnt(13)
  v_mfma_f32_32x32x16_bf16 v[36:51], v[88:91], v[104:107], v[36:51]
  s_waitcnt vmcnt(12)
  v_mfma_f32_32x32x16_bf16 v[36:51], v[84:87], v[108:111], v[36:51]
  s_waitcnt vmcnt(11)
  v_mfma_f32_32x32x16_bf16 v[36:51], v[88:91], v[112:115], v[36:51]
  s_waitcnt vmcnt(10)
  v_mfma_f32_32x32x16_bf16 v[36:51], v[84:87], v[116:119], v[36:51]
  s_waitcnt vmcnt(9)
  v_mfma_f32_32x32x16_bf16 v[36:51], v[88:91], v[120:123], v[36:51]
  s_waitcnt vmcnt(8)
  v_mfma_f32_32x32x16_bf16 v[36:51], v[84:87], v[124:127], v[36:51]
  s_waitcnt vmcnt(7)
  v_mfma_f32_32x32x16_bf16 v[36:51], v[88:91], v[128:131], v[36:51]
L_fpsum_19:
  s_cmp_lg_u32 s49, 0
  s_nop 1
  s_cbranch_scc1 L_root_top
  s_xor_b32 s95, s95, 1024
  s_mov_b32 m0, s95
  v_xor_b32 v171, 1024, v171
  buffer_load_dword v4, s[4:7], s48 offen sc1 lds
  s_nop 5
  v_cvt_pk_bf16_f32 v68, v36, v37
  v_cvt_pk_bf16_f32 v69, v38, v39
  v_cvt_pk_bf16_f32 v70, v40, v41
  v_cvt_pk_bf16_f32 v71, v42, v43
  v_cvt_pk_bf16_f32 v72, v44, v45
  v_cvt_pk_bf16_f32 v73, v46, v47
  v_cvt_pk_bf16_f32 v74, v48, v49
  v_cvt_pk_bf16_f32 v75, v50, v51
  buffer_store_dwordx4 v[68:71], v1, s[4:7], s57 offen offset:0 sc1
  v_dot2_f32_bf16 v78, v68, s71, 0
  v_dot2_f32_bf16 v79, v68, v68, 0
  v_dot2_f32_bf16 v78, v69, s71, v78
  v_dot2_f32_bf16 v79, v69, v69, v79
  v_dot2_f32_bf16 v78, v70, s71, v78
  v_dot2_f32_bf16 v79, v70, v70, v79
  v_dot2_f32_bf16 v78, v71, s71, v78
  v_dot2_f32_bf16 v79, v71, v71, v79
  v_dot2_f32_bf16 v78, v72, s71, v78
  v_dot2_f32_bf16 v79, v72, v72, v79
  v_dot2_f32_bf16 v78, v73, s71, v78
  v_dot2_f32_bf16 v79, v73, v73, v79
  v_dot2_f32_bf16 v78, v74, s71, v78
  v_dot2_f32_bf16 v79, v74, v74, v79
  v_dot2_f32_bf16 v78, v75, s71, v78
  v_dot2_f32_bf16 v79, v75, v75, v79
  buffer_store_dwordx4 v[72:75], v1, s[4:7], s57 offen offset:1024 sc1
  s_nop 1
  ds_write_b64 v148, v[78:79]
  s_waitcnt lgkmcnt(0)
  s_barrier
  ds_read2st64_b32 v[92:93], v149 offset0:0 offset1:1
  ds_read2st64_b32 v[94:95], v149 offset0:2 offset1:3
  ds_read2st64_b32 v[96:97], v149 offset0:4 offset1:5
  ds_read2st64_b32 v[98:99], v149 offset0:6 offset1:7
  s_waitcnt lgkmcnt(0)
  v_add_f32 v92, v92, v93
  v_add_f32 v92, v92, v94
  v_add_f32 v92, v92, v95
  v_add_f32 v92, v92, v96
  v_add_f32 v92, v92, v97
  v_add_f32 v92, v92, v98
  v_add_f32 v92, v92, v99
  buffer_store_dword v92, v150, s[4:7], s58 offen offset:0 sc1
  s_mov_b32 s47, s64
  s_cmp_eq_u32 s42, s80
  s_cbranch_scc1 L_root_fin
  s_waitcnt vmcnt(3)
  s_barrier
  ds_read_b32 v5, v171
  s_waitcnt lgkmcnt(0)
  v_cmp_ge_i32 vcc, s46, v5
  s_cmp_eq_u32 s45, 0
  s_cselect_b32 s51, vcc_lo, vcc_hi
  s_cmp_lg_u32 s51, 0
  s_cbranch_scc1 L_root_drain
  s_add_u32 m0, s63, 131072
  s_add_u32 s51, s47, 0
  buffer_load_dwordx4 v1, s[4:7], s51 offen sc1 lds
  s_add_u32 m0, s63, 135168
  s_add_u32 s51, s47, 4096
  buffer_load_dwordx4 v1, s[4:7], s51 offen sc1 lds
  s_add_u32 m0, s63, 139264
  s_add_u32 s51, s47, 16384
  buffer_load_dwordx4 v1, s[4:7], s51 offen sc1 lds
  s_add_u32 m0, s63, 143360
  s_add_u32 s51, s47, 20480
  buffer_load_dwordx4 v1, s[4:7], s51 offen sc1 lds
  s_add_u32 m0, s63, 147456
  s_add_u32 s51, s47, 32768
  buffer_load_dwordx4 v1, s[4:7], s51 offen sc1 lds
  s_add_u32 m0, s50, 0
  s_add_u32 s51, s47, 36864
  buffer_load_dwordx4 v1, s[4:7], s51 offen sc1 lds
  s_add_u32 m0, s50, 4096
  s_add_u32 s51, s47, 49152
  buffer_load_dwordx4 v1, s[4:7], s51 offen sc1 lds
  s_add_u32 m0, s50, 8192
  s_add_u32 s51, s47, 53248
  buffer_load_dwordx4 v1, s[4:7], s51 offen sc1 lds
  s_add_u32 m0, s50, 12288
  s_add_u32 s51, s47, 65536
  buffer_load_dwordx4 v1, s[4:7], s51 offen sc1 lds
  s_add_u32 m0, s50, 16384
  s_add_u32 s51, s47, 69632
  buffer_load_dwordx4 v1, s[4:7], s51 offen sc1 lds
  s_add_u32 m0, s50, 20480
  s_add_u32 s51, s47, 81920
  buffer_load_dwordx4 v1, s[4:7], s51 offen sc1 lds
  s_add_u32 m0, s50, 24576
  s_add_u32 s51, s47, 86016
  buffer_load_dwordx4 v1, s[4:7], s51 offen sc1 lds
  s_add_u32 m0, s50, 28672
  s_add_u32 s51, s47, 98304
  buffer_load_dwordx4 v1, s[4:7], s51 offen sc1 lds
  s_add_u32 m0, s50, 32768
  s_add_u32 s51, s47, 102400
  buffer_load_dwordx4 v1, s[4:7], s51 offen sc1 lds
  s_add_u32 m0, s50, 36864
  s_add_u32 s51, s47, 114688
  buffer_load_dwordx4 v1, s[4:7], s51 offen sc1 lds
  s_add_u32 m0, s50, 40960
  s_add_u32 s51, s47, 118784
  buffer_load_dwordx4 v1, s[4:7], s51 offen sc1 lds
  s_add_u32 m0, s50, 45056
  s_add_u32 s51, s47, 131072
  buffer_load_dwordx4 v1, s[4:7], s51 offen sc1 lds
  s_add_u32 m0, s50, 49152
  s_add_u32 s51, s47, 135168
  buffer_load_dwordx4 v1, s[4:7], s51 offen sc1 lds
  s_add_u32 m0, s50, 53248
  s_add_u32 s51, s47, 147456
  buffer_load_dwordx4 v1, s[4:7], s51 offen sc1 lds
  s_add_u32 m0, s50, 57344
  s_add_u32 s51, s47, 151552
  buffer_load_dwordx4 v1, s[4:7], s51 offen sc1 lds
  s_add_u32 m0, s50, 61440
  s_add_u32 s51, s47, 163840
  buffer_load_dwordx4 v1, s[4:7], s51 offen sc1 lds
  s_waitcnt vmcnt(21)
  s_barrier
  v_mov_b32 v7, s62
  buffer_store_dword v7, v0, s[4:7], s61 offen offset:0 sc1
  buffer_store_dword v7, v0, s[4:7], s61 offen offset:128
  s_mov_b32 s57, 0x20000000
  s_mov_b32 s58, 0x20000000
  s_mov_b32 s59, 0x20000000
  s_mov_b32 s60, 0x20000000
  s_mov_b32 s61, 0x20000000
  s_waitcnt vmcnt(17)
  s_branch L_root_entry
L_root_drain:
  s_waitcnt vmcnt(0)
  s_barrier
  v_mov_b32 v7, s62
  buffer_store_dword v7, v0, s[4:7], s61 offen offset:0 sc1
  buffer_store_dword v7, v0, s[4:7], s61 offen offset:128
  s_mov_b32 s57, 0x20000000
  s_mov_b32 s58, 0x20000000
  s_mov_b32 s59, 0x20000000
  s_mov_b32 s60, 0x20000000
  s_mov_b32 s61, 0x20000000
L_root_spin:
  s_sleep 1
  s_xor_b32 s95, s95, 1024
  s_mov_b32 m0, s95
  v_xor_b32 v171, 1024, v171
  buffer_load_dword v4, s[4:7], s48 offen sc1 lds
  s_add_u32 s94, s94, 1
  s_cmp_lt_u32 s94, 100000
  s_cselect_b32 s52, s46, -2
  s_waitcnt vmcnt(0)
  s_barrier
  ds_read_b32 v5, v171
  s_waitcnt lgkmcnt(0)
  v_cmp_ge_i32 vcc, s52, v5
  s_cmp_eq_u32 s45, 0
  s_cselect_b32 s51, vcc_lo, vcc_hi
  s_cmp_lg_u32 s51, 0
  s_cbranch_scc1 L_root_spin
  s_add_u32 m0, s63, 131072
  s_add_u32 s51, s47, 0
  buffer_load_dwordx4 v1, s[4:7], s51 offen sc1 lds
  s_add_u32 m0, s63, 135168
  s_add_u32 s51, s47, 4096
  buffer_load_dwordx4 v1, s[4:7], s51 offen sc1 lds
  s_add_u32 m0, s63, 139264
  s_add_u32 s51, s47, 16384
  buffer_load_dwordx4 v1, s[4:7], s51 offen sc1 lds
  s_add_u32 m0, s63, 143360
  s_add_u32 s51, s47, 20480
  buffer_load_dwordx4 v1, s[4:7], s51 offen sc1 lds
  s_add_u32 m0, s63, 147456
  s_add_u32 s51, s47, 32768
  buffer_load_dwordx4 v1, s[4:7], s51 offen sc1 lds
  s_add_u32 m0, s50, 0
  s_add_u32 s51, s47, 36864
  buffer_load_dwordx4 v1, s[4:7], s51 offen sc1 lds
  s_add_u32 m0, s50, 4096
  s_add_u32 s51, s47, 49152
  buffer_load_dwordx4 v1, s[4:7], s51 offen sc1 lds
  s_add_u32 m0, s50, 8192
  s_add_u32 s51, s47, 53248
  buffer_load_dwordx4 v1, s[4:7], s51 offen sc1 lds
  s_add_u32 m0, s50, 12288
  s_add_u32 s51, s47, 65536
  buffer_load_dwordx4 v1, s[4:7], s51 offen sc1 lds
  s_add_u32 m0, s50, 16384
  s_add_u32 s51, s47, 69632
  buffer_load_dwordx4 v1, s[4:7], s51 offen sc1 lds
  s_add_u32 m0, s50, 20480
  s_add_u32 s51, s47, 81920
  buffer_load_dwordx4 v1, s[4:7], s51 offen sc1 lds
  s_add_u32 m0, s50, 24576
  s_add_u32 s51, s47, 86016
  buffer_load_dwordx4 v1, s[4:7], s51 offen sc1 lds
  s_add_u32 m0, s50, 28672
  s_add_u32 s51, s47, 98304
  buffer_load_dwordx4 v1, s[4:7], s51 offen sc1 lds
  s_add_u32 m0, s50, 32768
  s_add_u32 s51, s47, 102400
  buffer_load_dwordx4 v1, s[4:7], s51 offen sc1 lds
  s_add_u32 m0, s50, 36864
  s_add_u32 s51, s47, 114688
  buffer_load_dwordx4 v1, s[4:7], s51 offen sc1 lds
  s_add_u32 m0, s50, 40960
  s_add_u32 s51, s47, 118784
  buffer_load_dwordx4 v1, s[4:7], s51 offen sc1 lds
  s_add_u32 m0, s50, 45056
  s_add_u32 s51, s47, 131072
  buffer_load_dwordx4 v1, s[4:7], s51 offen sc1 lds
  s_add_u32 m0, s50, 49152
  s_add_u32 s51, s47, 135168
  buffer_load_dwordx4 v1, s[4:7], s51 offen sc1 lds
  s_add_u32 m0, s50, 53248
  s_add_u32 s51, s47, 147456
  buffer_load_dwordx4 v1, s[4:7], s51 offen sc1 lds
  s_add_u32 m0, s50, 57344
  s_add_u32 s51, s47, 151552
  buffer_load_dwordx4 v1, s[4:7], s51 offen sc1 lds
  s_add_u32 m0, s50, 61440
  s_add_u32 s51, s47, 163840
  buffer_load_dwordx4 v1, s[4:7], s51 offen sc1 lds
  s_waitcnt vmcnt(15)
  s_branch L_root_entry
L_root_fin:
  s_waitcnt vmcnt(0)
  s_barrier
  v_mov_b32 v7, s62
  buffer_store_dword v7, v0, s[4:7], s61 offen offset:0 sc1
  buffer_store_dword v7, v0, s[4:7], s61 offen offset:128
  s_endpgm
L_root_entry:
  s_barrier
  ds_read_b128 v[12:15], v3 offset:0
  ds_read_b128 v[16:19], v3 offset:1024
  ds_read_b128 v[20:23], v3 offset:2048
  ds_read_b128 v[24:27], v3 offset:3072
  ds_read_b128 v[28:31], v3 offset:4096
  ds_read_b32 v5, v171
  s_branch L_root_body
L_fpslow_18:
  v_mfma_f32_32x32x16_bf16 v[36:51], v[88:91], v[136:139], v[36:51]
L_fpchk_16:
  s_waitcnt vmcnt(0)
  s_barrier
  ds_read_b32 v5, v171
  s_waitcnt lgkmcnt(0)
  v_cmp_ge_i32 vcc, s44, v5
  s_and_b64 vcc, vcc, s[76:77]
  s_cbranch_vccnz L_fpagain_15
L_fpgo_17:
  buffer_load_dwordx4 v[92:95], v1, s[4:7], s75 offen offset:0 sc1
  buffer_load_dwordx4 v[96:99], v1, s[4:7], s75 offen offset:1024 sc1
  s_add_u32 s75, s75, 40960
  buffer_load_dwordx4 v[100:103], v1, s[4:7], s75 offen offset:0 sc1
  buffer_load_dwordx4 v[104:107], v1, s[4:7], s75 offen offset:1024 sc1
  s_add_u32 s75, s75, 40960
  buffer_load_dwordx4 v[108:111], v1, s[4:7], s75 offen offset:0 sc1
  buffer_load_dwordx4 v[112:115], v1, s[4:7], s75 offen offset:1024 sc1
  s_add_u32 s75, s75, 40960
  buffer_load_dwordx4 v[116:119], v1, s[4:7], s75 offen offset:0 sc1
  buffer_load_dwordx4 v[120:123], v1, s[4:7], s75 offen offset:1024 sc1
  s_add_u32 s75, s75, 40960
  buffer_load_dwordx4 v[124:127], v1, s[4:7], s75 offen offset:0 sc1
  buffer_load_dwordx4 v[128:131], v1, s[4:7], s75 offen offset:1024 sc1
  s_add_u32 s75, s75, 40960
  s_waitcnt vmcnt(9)
  v_mfma_f32_32x32x16_bf16 v[36:51], v[84:87], v[92:95], v[36:51]
  s_waitcnt vmcnt(8)
  v_mfma_f32_32x32x16_bf16 v[36:51], v[88:91], v[96:99], v[36:51]
  s_waitcnt vmcnt(7)
  v_mfma_f32_32x32x16_bf16 v[36:51], v[84:87], v[100:103], v[36:51]
  s_waitcnt vmcnt(6)
  v_mfma_f32_32x32x16_bf16 v[36:51], v[88:91], v[104:107], v[36:51]
  s_waitcnt vmcnt(5)
  v_mfma_f32_32x32x16_bf16 v[36:51], v[84:87], v[108:111], v[36:51]
  s_waitcnt vmcnt(4)
  v_mfma_f32_32x32x16_bf16 v[36:51], v[88:91], v[112:115], v[36:51]
  s_waitcnt vmcnt(3)
  v_mfma_f32_32x32x16_bf16 v[36:51], v[84:87], v[116:119], v[36:51]
  s_waitcnt vmcnt(2)
  v_mfma_f32_32x32x16_bf16 v[36:51], v[88:91], v[120:123], v[36:51]
  s_waitcnt vmcnt(1)
  v_mfma_f32_32x32x16_bf16 v[36:51], v[84:87], v[124:127], v[36:51]
  s_waitcnt vmcnt(0)
  v_mfma_f32_32x32x16_bf16 v[36:51], v[88:91], v[128:131], v[36:51]
  s_branch L_fpsum_19
L_fpagain_15:
  s_xor_b32 s95, s95, 1024
  s_mov_b32 m0, s95
  v_xor_b32 v171, 1024, v171
  buffer_load_dword v4, s[4:7], s48 offen sc1 lds
  s_add_u32 s94, s94, 1
  s_cmp_lt_u32 s94, 100000
  s_cbranch_scc1 L_fpchk_16
  s_branch L_fpgo_17
L_role_qkv:
  s_mul_i32 s66, s101, 43
  s_lshr_b32 s66, s66, 10
  s_mul_i32 s51, s66, 24
  s_sub_u32 s67, s101, s51
  s_lshl_b32 s70, s67, 9
  s_lshl_b32 s67, s67, 2
  s_add_u32 s67, s67, s12
  s_mul_i32 s68, s67, 171
  s_lshr_b32 s68, s68, 9
  s_mul_i32 s51, s68, 3
  s_sub_u32 s69, s67, s51
  v_lshlrev_b32 v1, 4, v0
  v_lshrrev_b32 v20, 5, v0
  v_mul_u32_u24 v20, 11776, v20
  v_add_u32 v20, v20, v1
  v_lshrrev_b32 v6, 4, v0
  v_bfe_u32 v25, v0, 2, 2
  v_lshl_add_u32 v25, v6, 3, v25
  v_mul_u32_u24 v25, 512, v25
  v_and_b32 v6, 3, v0
  s_cmp_eq_u32 s69, 2
  s_cselect_b32 s51, s66, 0
  s_cmp_eq_u32 s51, 2
  s_cselect_b32 s51, 3, 4
  s_cselect_b32 s52, 0, 0
  v_lshlrev_b32 v21, s51, v6
  v_add3_u32 v21, v21, s52, v25
  s_lshl_b32 s51, s12, 7
  s_add_u32 s51, s51, 0
  v_add_u32 v21, s51, v21
  s_cmp_eq_u32 s69, 2
  s_cselect_b32 s51, s66, 0
  s_cmp_eq_u32 s51, 2
  s_cselect_b32 s51, 3, 4
  s_cselect_b32 s52, 32, 8
  v_lshlrev_b32 v22, s51, v6
  v_add3_u32 v22, v22, s52, v25
  s_lshl_b32 s51, s12, 7
  s_add_u32 s51, s51, 0
  v_add_u32 v22, s51, v22
  s_cmp_eq_u32 s69, 0
  s_cselect_b32 s51, s66, 0
  s_cmp_eq_u32 s51, 2
  s_cselect_b32 s51, 3, 4
  s_cselect_b32 s52, 0, 0
  v_lshlrev_b32 v23, s51, v6
  v_add3_u32 v23, v23, s52, v25
  s_lshl_b32 s51, s12, 7
  s_add_u32 s51, s51, 64
  v_add_u32 v23, s51, v23
  s_cmp_eq_u32 s69, 0
  s_cselect_b32 s51, s66, 0
  s_cmp_eq_u32 s51, 2
  s_cselect_b32 s51, 3, 4
  s_cselect_b32 s52, 32, 8
  v_lshlrev_b32 v24, s51, v6
  v_add3_u32 v24, v24, s52, v25
  s_lshl_b32 s51, s12, 7
  s_add_u32 s51, s51, 64
  v_add_u32 v24, s51, v24
  s_cmp_eq_u32 s66, 1
  s_cselect_b32 s72, s22, s20
  s_cselect_b32 s73, s23, s21
  s_cmp_eq_u32 s66, 2
  s_cselect_b32 s72, s24, s72
  s_cselect_b32 s73, s25, s73
  v_mov_b32 v12, 0x3f803f80
  v_mov_b32 v13, 0x3f803f80
  v_mov_b32 v14, 0x3f803f80
  v_mov_b32 v15, 0x3f803f80
  s_mov_b32 s8, s72
  s_mov_b32 s9, s73
  s_mov_b32 s10, 7864320
  s_mov_b32 s11, 0x20000
  s_mul_i32 s51, s12, 98304
  s_add_u32 s70, s70, s51
  s_mul_i32 s52, s12, 4096
  s_add_u32 m0, s52, 0
  s_add_u32 s51, s70, 0
  buffer_load_dwordx4 v20, s[8:11], s51 offen  lds
  s_add_u32 m0, s52, 1024
  s_add_u32 s51, s70, 24576
  buffer_load_dwordx4 v20, s[8:11], s51 offen  lds
  s_add_u32 m0, s52, 2048
  s_add_u32 s51, s70, 49152
  buffer_load_dwordx4 v20, s[8:11], s51 offen  lds
  s_add_u32 m0, s52, 3072
  s_add_u32 s51, s70, 73728
  buffer_load_dwordx4 v20, s[8:11], s51 offen  lds
  s_add_u32 m0, s52, 16384
  s_add_u32 s51, s70, 393216
  buffer_load_dwordx4 v20, s[8:11], s51 offen  lds
  s_add_u32 m0, s52, 17408
  s_add_u32 s51, s70, 417792
  buffer_load_dwordx4 v20, s[8:11], s51 offen  lds
  s_add_u32 m0, s52, 18432
  s_add_u32 s51, s70, 442368
  buffer_load_dwordx4 v20, s[8:11], s51 offen  lds
  s_add_u32 m0, s52, 19456
  s_add_u32 s51, s70, 466944
  buffer_load_dwordx4 v20, s[8:11], s51 offen  lds
  s_add_u32 m0, s52, 32768
  s_add_u32 s51, s70, 786432
  buffer_load_dwordx4 v20, s[8:11], s51 offen  lds
  s_add_u32 m0, s52, 33792
  s_add_u32 s51, s70, 811008
  buffer_load_dwordx4 v20, s[8:11], s51 offen  lds
  s_add_u32 m0, s52, 34816
  s_add_u32 s51, s70, 835584
  buffer_load_dwordx4 v20, s[8:11], s51 offen  lds
  s_add_u32 m0, s52, 35840
  s_add_u32 s51, s70, 860160
  buffer_load_dwordx4 v20, s[8:11], s51 offen  lds
  s_add_u32 m0, s52, 49152
  s_add_u32 s51, s70, 1179648
  buffer_load_dwordx4 v20, s[8:11], s51 offen  lds
  s_add_u32 m0, s52, 50176
  s_add_u32 s51, s70, 1204224
  buffer_load_dwordx4 v20, s[8:11], s51 offen  lds
  s_add_u32 m0, s52, 51200
  s_add_u32 s51, s70, 1228800
  buffer_load_dwordx4 v20, s[8:11], s51 offen  lds
  s_add_u32 m0, s52, 52224
  s_add_u32 s51, s70, 1253376
  buffer_load_dwordx4 v20, s[8:11], s51 offen  lds
  s_add_u32 m0, s52, 65536
  s_add_u32 s51, s70, 1572864
  buffer_load_dwordx4 v20, s[8:11], s51 offen  lds
  s_add_u32 m0, s52, 66560
  s_add_u32 s51, s70, 1597440
  buffer_load_dwordx4 v20, s[8:11], s51 offen  lds
  s_add_u32 m0, s52, 67584
  s_add_u32 s51, s70, 1622016
  buffer_load_dwordx4 v20, s[8:11], s51 offen  lds
  s_add_u32 m0, s52, 68608
  s_add_u32 s51, s70, 1646592
  buffer_load_dwordx4 v20, s[8:11], s51 offen  lds
  s_add_u32 m0, s52, 81920
  s_add_u32 s51, s70, 1966080
  buffer_load_dwordx4 v20, s[8:11], s51 offen  lds
  s_add_u32 m0, s52, 82944
  s_add_u32 s51, s70, 1990656
  buffer_load_dwordx4 v20, s[8:11], s51 offen  lds
  s_add_u32 m0, s52, 83968
  s_add_u32 s51, s70, 2015232
  buffer_load_dwordx4 v20, s[8:11], s51 offen  lds
  s_add_u32 m0, s52, 84992
  s_add_u32 s51, s70, 2039808
  buffer_load_dwordx4 v20, s[8:11], s51 offen  lds
  s_add_u32 m0, s52, 98304
  s_add_u32 s51, s70, 2359296
  buffer_load_dwordx4 v20, s[8:11], s51 offen  lds
  s_add_u32 m0, s52, 99328
  s_add_u32 s51, s70, 2383872
  buffer_load_dwordx4 v20, s[8:11], s51 offen  lds
  s_add_u32 m0, s52, 100352
  s_add_u32 s51, s70, 2408448
  buffer_load_dwordx4 v20, s[8:11], s51 offen  lds
  s_add_u32 m0, s52, 101376
  s_add_u32 s51, s70, 2433024
  buffer_load_dwordx4 v20, s[8:11], s51 offen  lds
  s_add_u32 m0, s52, 114688
  s_add_u32 s51, s70, 2752512
  buffer_load_dwordx4 v20, s[8:11], s51 offen  lds
  s_add_u32 m0, s52, 115712
  s_add_u32 s51, s70, 2777088
  buffer_load_dwordx4 v20, s[8:11], s51 offen  lds
  s_add_u32 m0, s52, 116736
  s_add_u32 s51, s70, 2801664
  buffer_load_dwordx4 v20, s[8:11], s51 offen  lds
  s_add_u32 m0, s52, 117760
  s_add_u32 s51, s70, 2826240
  buffer_load_dwordx4 v20, s[8:11], s51 offen  lds
  s_waitcnt vmcnt(28) lgkmcnt(0)
  s_barrier
  s_add_u32 m0, s52, 131072
  s_add_u32 s51, s70, 3145728
  buffer_load_dwordx4 v20, s[8:11], s51 offen  lds
  s_add_u32 m0, s52, 132096
  s_add_u32 s51, s70, 3170304
  buffer_load_dwordx4 v20, s[8:11], s51 offen  lds
  s_add_u32 m0, s52, 133120
  s_add_u32 s51, s70, 3194880
  buffer_load_dwordx4 v20, s[8:11], s51 offen  lds
  s_add_u32 m0, s52, 134144
  s_add_u32 s51, s70, 3219456
  buffer_load_dwordx4 v20, s[8:11], s51 offen  lds
  v_add_u32 v26, 0, v21
  ds_read_b64_tr_b16 a[0:1], v26 offset:0
  ds_read_b64_tr_b16 a[2:3], v26 offset:2048
  v_add_u32 v27, 0, v22
  ds_read_b64_tr_b16 a[4:5], v27 offset:0
  ds_read_b64_tr_b16 a[6:7], v27 offset:2048
  v_add_u32 v28, 0, v23
  ds_read_b64_tr_b16 a[8:9], v28 offset:0
  ds_read_b64_tr_b16 a[10:11], v28 offset:2048
  v_add_u32 v29, 0, v24
  ds_read_b64_tr_b16 a[12:13], v29 offset:0
  ds_read_b64_tr_b16 a[14:15], v29 offset:2048
  s_waitcnt vmcnt(28) lgkmcnt(0)
  s_barrier
  s_add_u32 m0, s52, 0
  s_add_u32 s51, s70, 3538944
  buffer_load_dwordx4 v20, s[8:11], s51 offen  lds
  s_add_u32 m0, s52, 1024
  s_add_u32 s51, s70, 3563520
  buffer_load_dwordx4 v20, s[8:11], s51 offen  lds
  s_add_u32 m0, s52, 2048
  s_add_u32 s51, s70, 3588096
  buffer_load_dwordx4 v20, s[8:11], s51 offen  lds
  s_add_u32 m0, s52, 3072
  s_add_u32 s51, s70, 3612672
  buffer_load_dwordx4 v20, s[8:11], s51 offen  lds
  v_add_u32 v26, 16384, v21
  ds_read_b64_tr_b16 a[16:17], v26 offset:0
  ds_read_b64_tr_b16 a[18:19], v26 offset:2048
  v_add_u32 v27, 16384, v22
  ds_read_b64_tr_b16 a[20:21], v27 offset:0
  ds_read_b64_tr_b16 a[22:23], v27 offset:2048
  v_add_u32 v28, 16384, v23
  ds_read_b64_tr_b16 a[24:25], v28 offset:0
  ds_read_b64_tr_b16 a[26:27], v28 offset:2048
  v_add_u32 v29, 16384, v24
  ds_read_b64_tr_b16 a[28:29], v29 offset:0
  ds_read_b64_tr_b16 a[30:31], v29 offset:2048
  v_mfma_f32_16x16x32_bf16 v[108:111], a[0:3], v[12:15], 0
  v_mfma_f32_16x16x32_bf16 v[144:147], v[12:15], a[0:3], 0
  v_mfma_f32_16x16x32_bf16 v[112:115], a[4:7], v[12:15], 0
  v_mfma_f32_16x16x32_bf16 v[148:151], v[12:15], a[4:7], 0
  v_mfma_f32_16x16x32_bf16 v[116:119], a[8:11], v[12:15], 0
  v_mfma_f32_16x16x32_bf16 v[152:155], v[12:15], a[8:11], 0
  v_mfma_f32_16x16x32_bf16 v[120:123], a[12:15], v[12:15], 0
  v_mfma_f32_16x16x32_bf16 v[156:159], v[12:15], a[12:15], 0
  s_waitcnt vmcnt(28) lgkmcnt(0)
  s_barrier
  s_add_u32 m0, s52, 16384
  s_add_u32 s51, s70, 3932160
  buffer_load_dwordx4 v20, s[8:11], s51 offen  lds
  s_add_u32 m0, s52, 17408
  s_add_u32 s51, s70, 3956736
  buffer_load_dwordx4 v20, s[8:11], s51 offen  lds
  s_add_u32 m0, s52, 18432
  s_add_u32 s51, s70, 3981312
  buffer_load_dwordx4 v20, s[8:11], s51 offen  lds
  s_add_u32 m0, s52, 19456
  s_add_u32 s51, s70, 4005888
  buffer_load_dwordx4 v20, s[8:11], s51 offen  lds
  v_add_u32 v26, 32768, v21
  ds_read_b64_tr_b16 a[32:33], v26 offset:0
  ds_read_b64_tr_b16 a[34:35], v26 offset:2048
  v_add_u32 v27, 32768, v22
  ds_read_b64_tr_b16 a[36:37], v27 offset:0
  ds_read_b64_tr_b16 a[38:39], v27 offset:2048
  v_add_u32 v28, 32768, v23
  ds_read_b64_tr_b16 a[40:41], v28 offset:0
  ds_read_b64_tr_b16 a[42:43], v28 offset:2048
  v_add_u32 v29, 32768, v24
  ds_read_b64_tr_b16 a[44:45], v29 offset:0
  ds_read_b64_tr_b16 a[46:47], v29 offset:2048
  v_mfma_f32_16x16x32_bf16 v[108:111], a[16:19], v[12:15], v[108:111]
  v_mfma_f32_16x16x32_bf16 v[144:147], v[12:15], a[16:19], v[144:147]
  v_mfma_f32_16x16x32_bf16 v[112:115], a[20:23], v[12:15], v[112:115]
  v_mfma_f32_16x16x32_bf16 v[148:151], v[12:15], a[20:23], v[148:151]
  v_mfma_f32_16x16x32_bf16 v[116:119], a[24:27], v[12:15], v[116:119]
  v_mfma_f32_16x16x32_bf16 v[152:155], v[12:15], a[24:27], v[152:155]
  v_mfma_f32_16x16x32_bf16 v[120:123], a[28:31], v[12:15], v[120:123]
  v_mfma_f32_16x16x32_bf16 v[156:159], v[12:15], a[28:31], v[156:159]
  s_waitcnt vmcnt(28) lgkmcnt(0)
  s_barrier
  s_add_u32 m0, s52, 32768
  s_add_u32 s51, s70, 4325376
  buffer_load_dwordx4 v20, s[8:11], s51 offen  lds
  s_add_u32 m0, s52, 33792
  s_add_u32 s51, s70, 4349952
  buffer_load_dwordx4 v20, s[8:11], s51 offen  lds
  s_add_u32 m0, s52, 34816
  s_add_u32 s51, s70, 4374528
  buffer_load_dwordx4 v20, s[8:11], s51 offen  lds
  s_add_u32 m0, s52, 35840
  s_add_u32 s51, s70, 4399104
  buffer_load_dwordx4 v20, s[8:11], s51 offen  lds
  v_add_u32 v26, 49152, v21
  ds_read_b64_tr_b16 a[48:49], v26 offset:0
  ds_read_b64_tr_b16 a[50:51], v26 offset:2048
  v_add_u32 v27, 49152, v22
  ds_read_b64_tr_b16 a[52:53], v27 offset:0
  ds_read_b64_tr_b16 a[54:55], v27 offset:2048
  v_add_u32 v28, 49152, v23
  ds_read_b64_tr_b16 a[56:57], v28 offset:0
  ds_read_b64_tr_b16 a[58:59], v28 offset:2048
  v_add_u32 v29, 49152, v24
  ds_read_b64_tr_b16 a[60:61], v29 offset:0
  ds_read_b64_tr_b16 a[62:63], v29 offset:2048
  v_mfma_f32_16x16x32_bf16 v[108:111], a[32:35], v[12:15], v[108:111]
  v_mfma_f32_16x16x32_bf16 v[144:147], v[12:15], a[32:35], v[144:147]
  v_mfma_f32_16x16x32_bf16 v[112:115], a[36:39], v[12:15], v[112:115]
  v_mfma_f32_16x16x32_bf16 v[148:151], v[12:15], a[36:39], v[148:151]
  v_mfma_f32_16x16x32_bf16 v[116:119], a[40:43], v[12:15], v[116:119]
  v_mfma_f32_16x16x32_bf16 v[152:155], v[12:15], a[40:43], v[152:155]
  v_mfma_f32_16x16x32_bf16 v[120:123], a[44:47], v[12:15], v[120:123]
  v_mfma_f32_16x16x32_bf16 v[156:159], v[12:15], a[44:47], v[156:159]
  s_waitcnt vmcnt(28) lgkmcnt(0)
  s_barrier
  s_add_u32 m0, s52, 49152
  s_add_u32 s51, s70, 4718592
  buffer_load_dwordx4 v20, s[8:11], s51 offen  lds
  s_add_u32 m0, s52, 50176
  s_add_u32 s51, s70, 4743168
  buffer_load_dwordx4 v20, s[8:11], s51 offen  lds
  s_add_u32 m0, s52, 51200
  s_add_u32 s51, s70, 4767744
  buffer_load_dwordx4 v20, s[8:11], s51 offen  lds
  s_add_u32 m0, s52, 52224
  s_add_u32 s51, s70, 4792320
  buffer_load_dwordx4 v20, s[8:11], s51 offen  lds
  v_add_u32 v26, 65536, v21
  ds_read_b64_tr_b16 a[64:65], v26 offset:0
  ds_read_b64_tr_b16 a[66:67], v26 offset:2048
  v_add_u32 v27, 65536, v22
  ds_read_b64_tr_b16 a[68:69], v27 offset:0
  ds_read_b64_tr_b16 a[70:71], v27 offset:2048
  v_add_u32 v28, 65536, v23
  ds_read_b64_tr_b16 a[72:73], v28 offset:0
  ds_read_b64_tr_b16 a[74:75], v28 offset:2048
  v_add_u32 v29, 65536, v24
  ds_read_b64_tr_b16 a[76:77], v29 offset:0
  ds_read_b64_tr_b16 a[78:79], v29 offset:2048
  v_mfma_f32_16x16x32_bf16 v[108:111], a[48:51], v[12:15], v[108:111]
  v_mfma_f32_16x16x32_bf16 v[144:147], v[12:15], a[48:51], v[144:147]
  v_mfma_f32_16x16x32_bf16 v[112:115], a[52:55], v[12:15], v[112:115]
  v_mfma_f32_16x16x32_bf16 v[148:151], v[12:15], a[52:55], v[148:151]
  v_mfma_f32_16x16x32_bf16 v[116:119], a[56:59], v[12:15], v[116:119]
  v_mfma_f32_16x16x32_bf16 v[152:155], v[12:15], a[56:59], v[152:155]
  v_mfma_f32_16x16x32_bf16 v[120:123], a[60:63], v[12:15], v[120:123]
  v_mfma_f32_16x16x32_bf16 v[156:159], v[12:15], a[60:63], v[156:159]
  s_waitcnt vmcnt(28) lgkmcnt(0)
  s_barrier
  s_add_u32 m0, s52, 65536
  s_add_u32 s51, s70, 5111808
  buffer_load_dwordx4 v20, s[8:11], s51 offen  lds
  s_add_u32 m0, s52, 66560
  s_add_u32 s51, s70, 5136384
  buffer_load_dwordx4 v20, s[8:11], s51 offen  lds
  s_add_u32 m0, s52, 67584
  s_add_u32 s51, s70, 5160960
  buffer_load_dwordx4 v20, s[8:11], s51 offen  lds
  s_add_u32 m0, s52, 68608
  s_add_u32 s51, s70, 5185536
  buffer_load_dwordx4 v20, s[8:11], s51 offen  lds
  v_add_u32 v26, 81920, v21
  ds_read_b64_tr_b16 a[80:81], v26 offset:0
  ds_read_b64_tr_b16 a[82:83], v26 offset:2048
  v_add_u32 v27, 81920, v22
  ds_read_b64_tr_b16 a[84:85], v27 offset:0
  ds_read_b64_tr_b16 a[86:87], v27 offset:2048
  v_add_u32 v28, 81920, v23
  ds_read_b64_tr_b16 a[88:89], v28 offset:0
  ds_read_b64_tr_b16 a[90:91], v28 offset:2048
  v_add_u32 v29, 81920, v24
  ds_read_b64_tr_b16 a[92:93], v29 offset:0
  ds_read_b64_tr_b16 a[94:95], v29 offset:2048
  v_mfma_f32_16x16x32_bf16 v[108:111], a[64:67], v[12:15], v[108:111]
  v_mfma_f32_16x16x32_bf16 v[144:147], v[12:15], a[64:67], v[144:147]
  v_mfma_f32_16x16x32_bf16 v[112:115], a[68:71], v[12:15], v[112:115]
  v_mfma_f32_16x16x32_bf16 v[148:151], v[12:15], a[68:71], v[148:151]
  v_mfma_f32_16x16x32_bf16 v[116:119], a[72:75], v[12:15], v[116:119]
  v_mfma_f32_16x16x32_bf16 v[152:155], v[12:15], a[72:75], v[152:155]
  v_mfma_f32_16x16x32_bf16 v[120:123], a[76:79], v[12:15], v[120:123]
  v_mfma_f32_16x16x32_bf16 v[156:159], v[12:15], a[76:79], v[156:159]
  s_waitcnt vmcnt(28) lgkmcnt(0)
  s_barrier
  s_add_u32 m0, s52, 81920
  s_add_u32 s51, s70, 5505024
  buffer_load_dwordx4 v20, s[8:11], s51 offen  lds
  s_add_u32 m0, s52, 82944
  s_add_u32 s51, s70, 5529600
  buffer_load_dwordx4 v20, s[8:11], s51 offen  lds
  s_add_u32 m0, s52, 83968
  s_add_u32 s51, s70, 5554176
  buffer_load_dwordx4 v20, s[8:11], s51 offen  lds
  s_add_u32 m0, s52, 84992
  s_add_u32 s51, s70, 5578752
  buffer_load_dwordx4 v20, s[8:11], s51 offen  lds
  v_add_u32 v26, 98304, v21
  ds_read_b64_tr_b16 a[96:97], v26 offset:0
  ds_read_b64_tr_b16 a[98:99], v26 offset:2048
  v_add_u32 v27, 98304, v22
  ds_read_b64_tr_b16 a[100:101], v27 offset:0
  ds_read_b64_tr_b16 a[102:103], v27 offset:2048
  v_add_u32 v28, 98304, v23
  ds_read_b64_tr_b16 a[104:105], v28 offset:0
  ds_read_b64_tr_b16 a[106:107], v28 offset:2048
  v_add_u32 v29, 98304, v24
  ds_read_b64_tr_b16 a[108:109], v29 offset:0
  ds_read_b64_tr_b16 a[110:111], v29 offset:2048
  v_mfma_f32_16x16x32_bf16 v[108:111], a[80:83], v[12:15], v[108:111]
  v_mfma_f32_16x16x32_bf16 v[144:147], v[12:15], a[80:83], v[144:147]
  v_mfma_f32_16x16x32_bf16 v[112:115], a[84:87], v[12:15], v[112:115]
  v_mfma_f32_16x16x32_bf16 v[148:151], v[12:15], a[84:87], v[148:151]
  v_mfma_f32_16x16x32_bf16 v[116:119], a[88:91], v[12:15], v[116:119]
  v_mfma_f32_16x16x32_bf16 v[152:155], v[12:15], a[88:91], v[152:155]
  v_mfma_f32_16x16x32_bf16 v[120:123], a[92:95], v[12:15], v[120:123]
  v_mfma_f32_16x16x32_bf16 v[156:159], v[12:15], a[92:95], v[156:159]
  s_waitcnt vmcnt(28) lgkmcnt(0)
  s_barrier
  s_add_u32 m0, s52, 98304
  s_add_u32 s51, s70, 5898240
  buffer_load_dwordx4 v20, s[8:11], s51 offen  lds
  s_add_u32 m0, s52, 99328
  s_add_u32 s51, s70, 5922816
  buffer_load_dwordx4 v20, s[8:11], s51 offen  lds
  s_add_u32 m0, s52, 100352
  s_add_u32 s51, s70, 5947392
  buffer_load_dwordx4 v20, s[8:11], s51 offen  lds
  s_add_u32 m0, s52, 101376
  s_add_u32 s51, s70, 5971968
  buffer_load_dwordx4 v20, s[8:11], s51 offen  lds
  v_add_u32 v26, 114688, v21
  ds_read_b64_tr_b16 a[112:113], v26 offset:0
  ds_read_b64_tr_b16 a[114:115], v26 offset:2048
  v_add_u32 v27, 114688, v22
  ds_read_b64_tr_b16 a[116:117], v27 offset:0
  ds_read_b64_tr_b16 a[118:119], v27 offset:2048
  v_add_u32 v28, 114688, v23
  ds_read_b64_tr_b16 a[120:121], v28 offset:0
  ds_read_b64_tr_b16 a[122:123], v28 offset:2048
  v_add_u32 v29, 114688, v24
  ds_read_b64_tr_b16 a[124:125], v29 offset:0
  ds_read_b64_tr_b16 a[126:127], v29 offset:2048
  v_mfma_f32_16x16x32_bf16 v[108:111], a[96:99], v[12:15], v[108:111]
  v_mfma_f32_16x16x32_bf16 v[144:147], v[12:15], a[96:99], v[144:147]
  v_mfma_f32_16x16x32_bf16 v[112:115], a[100:103], v[12:15], v[112:115]
  v_mfma_f32_16x16x32_bf16 v[148:151], v[12:15], a[100:103], v[148:151]
  v_mfma_f32_16x16x32_bf16 v[116:119], a[104:107], v[12:15], v[116:119]
  v_mfma_f32_16x16x32_bf16 v[152:155], v[12:15], a[104:107], v[152:155]
  v_mfma_f32_16x16x32_bf16 v[120:123], a[108:111], v[12:15], v[120:123]
  v_mfma_f32_16x16x32_bf16 v[156:159], v[12:15], a[108:111], v[156:159]
  s_waitcnt vmcnt(28) lgkmcnt(0)
  s_barrier
  s_add_u32 m0, s52, 114688
  s_add_u32 s51, s70, 6291456
  buffer_load_dwordx4 v20, s[8:11], s51 offen  lds
  s_add_u32 m0, s52, 115712
  s_add_u32 s51, s70, 6316032
  buffer_load_dwordx4 v20, s[8:11], s51 offen  lds
  s_add_u32 m0, s52, 116736
  s_add_u32 s51, s70, 6340608
  buffer_load_dwordx4 v20, s[8:11], s51 offen  lds
  s_add_u32 m0, s52, 117760
  s_add_u32 s51, s70, 6365184
  buffer_load_dwordx4 v20, s[8:11], s51 offen  lds
  v_add_u32 v26, 131072, v21
  ds_read_b64_tr_b16 a[128:129], v26 offset:0
  ds_read_b64_tr_b16 a[130:131], v26 offset:2048
  v_add_u32 v27, 131072, v22
  ds_read_b64_tr_b16 a[132:133], v27 offset:0
  ds_read_b64_tr_b16 a[134:135], v27 offset:2048
  v_add_u32 v28, 131072, v23
  ds_read_b64_tr_b16 a[136:137], v28 offset:0
  ds_read_b64_tr_b16 a[138:139], v28 offset:2048
  v_add_u32 v29, 131072, v24
  ds_read_b64_tr_b16 a[140:141], v29 offset:0
  ds_read_b64_tr_b16 a[142:143], v29 offset:2048
  v_mfma_f32_16x16x32_bf16 v[108:111], a[112:115], v[12:15], v[108:111]
  v_mfma_f32_16x16x32_bf16 v[144:147], v[12:15], a[112:115], v[144:147]
  v_mfma_f32_16x16x32_bf16 v[112:115], a[116:119], v[12:15], v[112:115]
  v_mfma_f32_16x16x32_bf16 v[148:151], v[12:15], a[116:119], v[148:151]
  v_mfma_f32_16x16x32_bf16 v[116:119], a[120:123], v[12:15], v[116:119]
  v_mfma_f32_16x16x32_bf16 v[152:155], v[12:15], a[120:123], v[152:155]
  v_mfma_f32_16x16x32_bf16 v[120:123], a[124:127], v[12:15], v[120:123]
  v_mfma_f32_16x16x32_bf16 v[156:159], v[12:15], a[124:127], v[156:159]
  s_waitcnt vmcnt(28) lgkmcnt(0)
  s_barrier
  s_add_u32 m0, s52, 131072
  s_add_u32 s51, s70, 6684672
  buffer_load_dwordx4 v20, s[8:11], s51 offen  lds
  s_add_u32 m0, s52, 132096
  s_add_u32 s51, s70, 6709248
  buffer_load_dwordx4 v20, s[8:11], s51 offen  lds
  s_add_u32 m0, s52, 133120
  s_add_u32 s51, s70, 6733824
  buffer_load_dwordx4 v20, s[8:11], s51 offen  lds
  s_add_u32 m0, s52, 134144
  s_add_u32 s51, s70, 6758400
  buffer_load_dwordx4 v20, s[8:11], s51 offen  lds
  v_add_u32 v26, 0, v21
  ds_read_b64_tr_b16 a[144:145], v26 offset:0
  ds_read_b64_tr_b16 a[146:147], v26 offset:2048
  v_add_u32 v27, 0, v22
  ds_read_b64_tr_b16 a[148:149], v27 offset:0
  ds_read_b64_tr_b16 a[150:151], v27 offset:2048
  v_add_u32 v28, 0, v23
  ds_read_b64_tr_b16 a[152:153], v28 offset:0
  ds_read_b64_tr_b16 a[154:155], v28 offset:2048
  v_add_u32 v29, 0, v24
  ds_read_b64_tr_b16 a[156:157], v29 offset:0
  ds_read_b64_tr_b16 a[158:159], v29 offset:2048
  v_mfma_f32_16x16x32_bf16 v[108:111], a[128:131], v[12:15], v[108:111]
  v_mfma_f32_16x16x32_bf16 v[144:147], v[12:15], a[128:131], v[144:147]
  v_mfma_f32_16x16x32_bf16 v[112:115], a[132:135], v[12:15], v[112:115]
  v_mfma_f32_16x16x32_bf16 v[148:151], v[12:15], a[132:135], v[148:151]
  v_mfma_f32_16x16x32_bf16 v[116:119], a[136:139], v[12:15], v[116:119]
  v_mfma_f32_16x16x32_bf16 v[152:155], v[12:15], a[136:139], v[152:155]
  v_mfma_f32_16x16x32_bf16 v[120:123], a[140:143], v[12:15], v[120:123]
  v_mfma_f32_16x16x32_bf16 v[156:159], v[12:15], a[140:143], v[156:159]
  s_waitcnt vmcnt(28) lgkmcnt(0)
  s_barrier
  s_add_u32 m0, s52, 0
  s_add_u32 s51, s70, 7077888
  buffer_load_dwordx4 v20, s[8:11], s51 offen  lds
  s_add_u32 m0, s52, 1024
  s_add_u32 s51, s70, 7102464
  buffer_load_dwordx4 v20, s[8:11], s51 offen  lds
  s_add_u32 m0, s52, 2048
  s_add_u32 s51, s70, 7127040
  buffer_load_dwordx4 v20, s[8:11], s51 offen  lds
  s_add_u32 m0, s52, 3072
  s_add_u32 s51, s70, 7151616
  buffer_load_dwordx4 v20, s[8:11], s51 offen  lds
  v_add_u32 v26, 16384, v21
  ds_read_b64_tr_b16 a[160:161], v26 offset:0
  ds_read_b64_tr_b16 a[162:163], v26 offset:2048
  v_add_u32 v27, 16384, v22
  ds_read_b64_tr_b16 a[164:165], v27 offset:0
  ds_read_b64_tr_b16 a[166:167], v27 offset:2048
  v_add_u32 v28, 16384, v23
  ds_read_b64_tr_b16 a[168:169], v28 offset:0
  ds_read_b64_tr_b16 a[170:171], v28 offset:2048
  v_add_u32 v29, 16384, v24
  ds_read_b64_tr_b16 a[172:173], v29 offset:0
  ds_read_b64_tr_b16 a[174:175], v29 offset:2048
  v_mfma_f32_16x16x32_bf16 v[108:111], a[144:147], v[12:15], v[108:111]
  v_mfma_f32_16x16x32_bf16 v[144:147], v[12:15], a[144:147], v[144:147]
  v_mfma_f32_16x16x32_bf16 v[112:115], a[148:151], v[12:15], v[112:115]
  v_mfma_f32_16x16x32_bf16 v[148:151], v[12:15], a[148:151], v[148:151]
  v_mfma_f32_16x16x32_bf16 v[116:119], a[152:155], v[12:15], v[116:119]
  v_mfma_f32_16x16x32_bf16 v[152:155], v[12:15], a[152:155], v[152:155]
  v_mfma_f32_16x16x32_bf16 v[120:123], a[156:159], v[12:15], v[120:123]
  v_mfma_f32_16x16x32_bf16 v[156:159], v[12:15], a[156:159], v[156:159]
  s_waitcnt vmcnt(28) lgkmcnt(0)
  s_barrier
  s_add_u32 m0, s52, 16384
  s_add_u32 s51, s70, 7471104
  buffer_load_dwordx4 v20, s[8:11], s51 offen  lds
  s_add_u32 m0, s52, 17408
  s_add_u32 s51, s70, 7495680
  buffer_load_dwordx4 v20, s[8:11], s51 offen  lds
  s_add_u32 m0, s52, 18432
  s_add_u32 s51, s70, 7520256
  buffer_load_dwordx4 v20, s[8:11], s51 offen  lds
  s_add_u32 m0, s52, 19456
  s_add_u32 s51, s70, 7544832
  buffer_load_dwordx4 v20, s[8:11], s51 offen  lds
  v_add_u32 v26, 32768, v21
  ds_read_b64_tr_b16 a[176:177], v26 offset:0
  ds_read_b64_tr_b16 a[178:179], v26 offset:2048
  v_add_u32 v27, 32768, v22
  ds_read_b64_tr_b16 a[180:181], v27 offset:0
  ds_read_b64_tr_b16 a[182:183], v27 offset:2048
  v_add_u32 v28, 32768, v23
  ds_read_b64_tr_b16 a[184:185], v28 offset:0
  ds_read_b64_tr_b16 a[186:187], v28 offset:2048
  v_add_u32 v29, 32768, v24
  ds_read_b64_tr_b16 a[188:189], v29 offset:0
  ds_read_b64_tr_b16 a[190:191], v29 offset:2048
  v_mfma_f32_16x16x32_bf16 v[108:111], a[160:163], v[12:15], v[108:111]
  v_mfma_f32_16x16x32_bf16 v[144:147], v[12:15], a[160:163], v[144:147]
  v_mfma_f32_16x16x32_bf16 v[112:115], a[164:167], v[12:15], v[112:115]
  v_mfma_f32_16x16x32_bf16 v[148:151], v[12:15], a[164:167], v[148:151]
  v_mfma_f32_16x16x32_bf16 v[116:119], a[168:171], v[12:15], v[116:119]
  v_mfma_f32_16x16x32_bf16 v[152:155], v[12:15], a[168:171], v[152:155]
  v_mfma_f32_16x16x32_bf16 v[120:123], a[172:175], v[12:15], v[120:123]
  v_mfma_f32_16x16x32_bf16 v[156:159], v[12:15], a[172:175], v[156:159]
  s_waitcnt vmcnt(28) lgkmcnt(0)
  s_barrier
  v_add_u32 v26, 49152, v21
  ds_read_b64_tr_b16 a[192:193], v26 offset:0
  ds_read_b64_tr_b16 a[194:195], v26 offset:2048
  v_add_u32 v27, 49152, v22
  ds_read_b64_tr_b16 a[196:197], v27 offset:0
  ds_read_b64_tr_b16 a[198:199], v27 offset:2048
  v_add_u32 v28, 49152, v23
  ds_read_b64_tr_b16 a[200:201], v28 offset:0
  ds_read_b64_tr_b16 a[202:203], v28 offset:2048
  v_add_u32 v29, 49152, v24
  ds_read_b64_tr_b16 a[204:205], v29 offset:0
  ds_read_b64_tr_b16 a[206:207], v29 offset:2048
  v_mfma_f32_16x16x32_bf16 v[108:111], a[176:179], v[12:15], v[108:111]
  v_mfma_f32_16x16x32_bf16 v[144:147], v[12:15], a[176:179], v[144:147]
  v_mfma_f32_16x16x32_bf16 v[112:115], a[180:183], v[12:15], v[112:115]
  v_mfma_f32_16x16x32_bf16 v[148:151], v[12:15], a[180:183], v[148:151]
  v_mfma_f32_16x16x32_bf16 v[116:119], a[184:187], v[12:15], v[116:119]
  v_mfma_f32_16x16x32_bf16 v[152:155], v[12:15], a[184:187], v[152:155]
  v_mfma_f32_16x16x32_bf16 v[120:123], a[188:191], v[12:15], v[120:123]
  v_mfma_f32_16x16x32_bf16 v[156:159], v[12:15], a[188:191], v[156:159]
  s_waitcnt vmcnt(24) lgkmcnt(0)
  s_barrier
  v_add_u32 v26, 65536, v21
  ds_read_b64_tr_b16 a[208:209], v26 offset:0
  ds_read_b64_tr_b16 a[210:211], v26 offset:2048
  v_add_u32 v27, 65536, v22
  ds_read_b64_tr_b16 a[212:213], v27 offset:0
  ds_read_b64_tr_b16 a[214:215], v27 offset:2048
  v_add_u32 v28, 65536, v23
  ds_read_b64_tr_b16 a[216:217], v28 offset:0
  ds_read_b64_tr_b16 a[218:219], v28 offset:2048
  v_add_u32 v29, 65536, v24
  ds_read_b64_tr_b16 a[220:221], v29 offset:0
  ds_read_b64_tr_b16 a[222:223], v29 offset:2048
  v_mfma_f32_16x16x32_bf16 v[108:111], a[192:195], v[12:15], v[108:111]
  v_mfma_f32_16x16x32_bf16 v[144:147], v[12:15], a[192:195], v[144:147]
  v_mfma_f32_16x16x32_bf16 v[112:115], a[196:199], v[12:15], v[112:115]
  v_mfma_f32_16x16x32_bf16 v[148:151], v[12:15], a[196:199], v[148:151]
  v_mfma_f32_16x16x32_bf16 v[116:119], a[200:203], v[12:15], v[116:119]
  v_mfma_f32_16x16x32_bf16 v[152:155], v[12:15], a[200:203], v[152:155]
  v_mfma_f32_16x16x32_bf16 v[120:123], a[204:207], v[12:15], v[120:123]
  v_mfma_f32_16x16x32_bf16 v[156:159], v[12:15], a[204:207], v[156:159]
  s_waitcnt vmcnt(20) lgkmcnt(0)
  s_barrier
  v_add_u32 v26, 81920, v21
  ds_read_b64_tr_b16 a[224:225], v26 offset:0
  ds_read_b64_tr_b16 a[226:227], v26 offset:2048
  v_add_u32 v27, 81920, v22
  ds_read_b64_tr_b16 a[228:229], v27 offset:0
  ds_read_b64_tr_b16 a[230:231], v27 offset:2048
  v_add_u32 v28, 81920, v23
  ds_read_b64_tr_b16 a[232:233], v28 offset:0
  ds_read_b64_tr_b16 a[234:235], v28 offset:2048
  v_add_u32 v29, 81920, v24
  ds_read_b64_tr_b16 a[236:237], v29 offset:0
  ds_read_b64_tr_b16 a[238:239], v29 offset:2048
  v_mfma_f32_16x16x32_bf16 v[108:111], a[208:211], v[12:15], v[108:111]
  v_mfma_f32_16x16x32_bf16 v[144:147], v[12:15], a[208:211], v[144:147]
  v_mfma_f32_16x16x32_bf16 v[112:115], a[212:215], v[12:15], v[112:115]
  v_mfma_f32_16x16x32_bf16 v[148:151], v[12:15], a[212:215], v[148:151]
  v_mfma_f32_16x16x32_bf16 v[116:119], a[216:219], v[12:15], v[116:119]
  v_mfma_f32_16x16x32_bf16 v[152:155], v[12:15], a[216:219], v[152:155]
  v_mfma_f32_16x16x32_bf16 v[120:123], a[220:223], v[12:15], v[120:123]
  v_mfma_f32_16x16x32_bf16 v[156:159], v[12:15], a[220:223], v[156:159]
  s_waitcnt vmcnt(16) lgkmcnt(0)
  s_barrier
  v_add_u32 v26, 98304, v21
  ds_read_b64_tr_b16 a[240:241], v26 offset:0
  ds_read_b64_tr_b16 a[242:243], v26 offset:2048
  v_add_u32 v27, 98304, v22
  ds_read_b64_tr_b16 a[244:245], v27 offset:0
  ds_read_b64_tr_b16 a[246:247], v27 offset:2048
  v_add_u32 v28, 98304, v23
  ds_read_b64_tr_b16 a[248:249], v28 offset:0
  ds_read_b64_tr_b16 a[250:251], v28 offset:2048
  v_add_u32 v29, 98304, v24
  ds_read_b64_tr_b16 a[252:253], v29 offset:0
  ds_read_b64_tr_b16 a[254:255], v29 offset:2048
  v_mfma_f32_16x16x32_bf16 v[108:111], a[224:227], v[12:15], v[108:111]
  v_mfma_f32_16x16x32_bf16 v[144:147], v[12:15], a[224:227], v[144:147]
  v_mfma_f32_16x16x32_bf16 v[112:115], a[228:231], v[12:15], v[112:115]
  v_mfma_f32_16x16x32_bf16 v[148:151], v[12:15], a[228:231], v[148:151]
  v_mfma_f32_16x16x32_bf16 v[116:119], a[232:235], v[12:15], v[116:119]
  v_mfma_f32_16x16x32_bf16 v[152:155], v[12:15], a[232:235], v[152:155]
  v_mfma_f32_16x16x32_bf16 v[120:123], a[236:239], v[12:15], v[120:123]
  v_mfma_f32_16x16x32_bf16 v[156:159], v[12:15], a[236:239], v[156:159]
  s_waitcnt vmcnt(12) lgkmcnt(0)
  s_barrier
  v_add_u32 v26, 114688, v21
  ds_read_b64_tr_b16 v[192:193], v26 offset:0
  ds_read_b64_tr_b16 v[194:195], v26 offset:2048
  v_add_u32 v27, 114688, v22
  ds_read_b64_tr_b16 v[196:197], v27 offset:0
  ds_read_b64_tr_b16 v[198:199], v27 offset:2048
  v_add_u32 v28, 114688, v23
  ds_read_b64_tr_b16 v[200:201], v28 offset:0
  ds_read_b64_tr_b16 v[202:203], v28 offset:2048
  v_add_u32 v29, 114688, v24
  ds_read_b64_tr_b16 v[204:205], v29 offset:0
  ds_read_b64_tr_b16 v[206:207], v29 offset:2048
  v_mfma_f32_16x16x32_bf16 v[108:111], a[240:243], v[12:15], v[108:111]
  v_mfma_f32_16x16x32_bf16 v[144:147], v[12:15], a[240:243], v[144:147]
  v_mfma_f32_16x16x32_bf16 v[112:115], a[244:247], v[12:15], v[112:115]
  v_mfma_f32_16x16x32_bf16 v[148:151], v[12:15], a[244:247], v[148:151]
  v_mfma_f32_16x16x32_bf16 v[116:119], a[248:251], v[12:15], v[116:119]
  v_mfma_f32_16x16x32_bf16 v[152:155], v[12:15], a[248:251], v[152:155]
  v_mfma_f32_16x16x32_bf16 v[120:123], a[252:255], v[12:15], v[120:123]
  v_mfma_f32_16x16x32_bf16 v[156:159], v[12:15], a[252:255], v[156:159]
  s_waitcnt vmcnt(8) lgkmcnt(0)
  s_barrier
  s_lshr_b32 s3, s13, 5
  s_mul_i32 s3, s3, 65
  s_and_b32 s3, s3, 0xc4
  v_mov_b32 v5, s3
  v_writelane_b32 v5, 8, 0
  v_writelane_b32 v5, 12, 2
  global_load_dword v5, v5, s[38:39] sc1
  v_add_u32 v26, 131072, v21
  ds_read_b64_tr_b16 v[208:209], v26 offset:0
  ds_read_b64_tr_b16 v[210:211], v26 offset:2048
  v_add_u32 v27, 131072, v22
  ds_read_b64_tr_b16 v[212:213], v27 offset:0
  ds_read_b64_tr_b16 v[214:215], v27 offset:2048
  v_add_u32 v28, 131072, v23
  ds_read_b64_tr_b16 v[216:217], v28 offset:0
  ds_read_b64_tr_b16 v[218:219], v28 offset:2048
  v_add_u32 v29, 131072, v24
  ds_read_b64_tr_b16 v[220:221], v29 offset:0
  ds_read_b64_tr_b16 v[222:223], v29 offset:2048
  v_mfma_f32_16x16x32_bf16 v[108:111], v[192:195], v[12:15], v[108:111]
  v_mfma_f32_16x16x32_bf16 v[144:147], v[12:15], v[192:195], v[144:147]
  v_mfma_f32_16x16x32_bf16 v[112:115], v[196:199], v[12:15], v[112:115]
  v_mfma_f32_16x16x32_bf16 v[148:151], v[12:15], v[196:199], v[148:151]
  v_mfma_f32_16x16x32_bf16 v[116:119], v[200:203], v[12:15], v[116:119]
  v_mfma_f32_16x16x32_bf16 v[152:155], v[12:15], v[200:203], v[152:155]
  v_mfma_f32_16x16x32_bf16 v[120:123], v[204:207], v[12:15], v[120:123]
  v_mfma_f32_16x16x32_bf16 v[156:159], v[12:15], v[204:207], v[156:159]
  s_waitcnt vmcnt(4) lgkmcnt(0)
  s_barrier
  v_add_u32 v26, 0, v21
  ds_read_b64_tr_b16 v[224:225], v26 offset:0
  ds_read_b64_tr_b16 v[226:227], v26 offset:2048
  v_add_u32 v27, 0, v22
  ds_read_b64_tr_b16 v[228:229], v27 offset:0
  ds_read_b64_tr_b16 v[230:231], v27 offset:2048
  v_add_u32 v28, 0, v23
  ds_read_b64_tr_b16 v[232:233], v28 offset:0
  ds_read_b64_tr_b16 v[234:235], v28 offset:2048
  v_add_u32 v29, 0, v24
  ds_read_b64_tr_b16 v[236:237], v29 offset:0
  ds_read_b64_tr_b16 v[238:239], v29 offset:2048
  v_mfma_f32_16x16x32_bf16 v[108:111], v[208:211], v[12:15], v[108:111]
  v_mfma_f32_16x16x32_bf16 v[144:147], v[12:15], v[208:211], v[144:147]
  v_mfma_f32_16x16x32_bf16 v[112:115], v[212:215], v[12:15], v[112:115]
  v_mfma_f32_16x16x32_bf16 v[148:151], v[12:15], v[212:215], v[148:151]
  v_mfma_f32_16x16x32_bf16 v[116:119], v[216:219], v[12:15], v[116:119]
  v_mfma_f32_16x16x32_bf16 v[152:155], v[12:15], v[216:219], v[152:155]
  v_mfma_f32_16x16x32_bf16 v[120:123], v[220:223], v[12:15], v[120:123]
  v_mfma_f32_16x16x32_bf16 v[156:159], v[12:15], v[220:223], v[156:159]
  s_waitcnt vmcnt(0) lgkmcnt(0)
  s_barrier
  v_add_u32 v26, 16384, v21
  ds_read_b64_tr_b16 v[240:241], v26 offset:0
  ds_read_b64_tr_b16 v[242:243], v26 offset:2048
  v_add_u32 v27, 16384, v22
  ds_read_b64_tr_b16 v[244:245], v27 offset:0
  ds_read_b64_tr_b16 v[246:247], v27 offset:2048
  v_add_u32 v28, 16384, v23
  ds_read_b64_tr_b16 v[248:249], v28 offset:0
  ds_read_b64_tr_b16 v[250:251], v28 offset:2048
  v_add_u32 v29, 16384, v24
  ds_read_b64_tr_b16 v[252:253], v29 offset:0
  ds_read_b64_tr_b16 v[254:255], v29 offset:2048
  v_mfma_f32_16x16x32_bf16 v[108:111], v[224:227], v[12:15], v[108:111]
  v_mfma_f32_16x16x32_bf16 v[144:147], v[12:15], v[224:227], v[144:147]
  v_mfma_f32_16x16x32_bf16 v[112:115], v[228:231], v[12:15], v[112:115]
  v_mfma_f32_16x16x32_bf16 v[148:151], v[12:15], v[228:231], v[148:151]
  v_mfma_f32_16x16x32_bf16 v[116:119], v[232:235], v[12:15], v[116:119]
  v_mfma_f32_16x16x32_bf16 v[152:155], v[12:15], v[232:235], v[152:155]
  v_mfma_f32_16x16x32_bf16 v[120:123], v[236:239], v[12:15], v[120:123]
  v_mfma_f32_16x16x32_bf16 v[156:159], v[12:15], v[236:239], v[156:159]
  s_waitcnt lgkmcnt(0)
  v_mfma_f32_16x16x32_bf16 v[108:111], v[240:243], v[12:15], v[108:111]
  v_mfma_f32_16x16x32_bf16 v[144:147], v[12:15], v[240:243], v[144:147]
  v_mfma_f32_16x16x32_bf16 v[112:115], v[244:247], v[12:15], v[112:115]
  v_mfma_f32_16x16x32_bf16 v[148:151], v[12:15], v[244:247], v[148:151]
  v_mfma_f32_16x16x32_bf16 v[116:119], v[248:251], v[12:15], v[116:119]
  v_mfma_f32_16x16x32_bf16 v[152:155], v[12:15], v[248:251], v[152:155]
  v_mfma_f32_16x16x32_bf16 v[120:123], v[252:255], v[12:15], v[120:123]
  v_mfma_f32_16x16x32_bf16 v[156:159], v[12:15], v[252:255], v[156:159]
  v_readlane_b32 s92, v5, 0
  v_readlane_b32 s93, v5, 1
  v_readlane_b32 s2, v5, 2
  s_waitcnt lgkmcnt(0)
  s_barrier
  v_lshlrev_b32 v10, 3, v0
  v_mov_b32 v2, v1
  v_add_u32 v3, 0x10000, v1
  v_and_b32 v4, 31, v0
  v_min_u32 v4, 4, v4
  v_lshlrev_b32 v4, 8, v4
  v_and_b32 v9, 0xf0, v1
  v_lshrrev_b32 v6, 4, v0
  v_lshl_add_u32 v8, v6, 9, v9
  v_mov_b32 v2, v8
  v_add_u32 v3, 40960, v9
  s_mov_b32 s53, 7340032
  s_mul_i32 s51, s68, 36864
  s_add_u32 s53, s53, s51
  s_mul_i32 s51, s66, 12288
  s_add_u32 s53, s53, s51
  s_mul_i32 s51, s69, 4096
  s_add_u32 s53, s53, s51
  s_andn2_b32 s51, s53, 0x1fff
  s_add_u32 s53, s53, s51
  s_mov_b32 s54, 5120
  s_mul_i32 s51, s101, 256
  s_add_u32 s54, s54, s51
  v_lshrrev_b32 v6, 5, v0
  v_mul_u32_u24 v6, 2560, v6
  v_add_u32 v4, v4, v6
  s_cmp_eq_u32 s66, 2
  s_cbranch_scc1 L_qkv_v
  s_mov_b32 s15, s93
  s_and_b32 s3, s92, 0xffff
  s_cmp_lt_u32 s3, 48
  s_cbranch_scc1 L_rslow_20
  s_and_b32 s3, s15, 0xffff
  s_cmp_ge_u32 s3, 32
  s_cbranch_scc1 L_rfast_21
L_rslow_20:
  v_mov_b32 v6, 8
L_rdy_22:
  global_load_dword v7, v6, s[38:39] sc1
  s_waitcnt vmcnt(0)
  v_readfirstlane_b32 s15, v7
  s_and_b32 s3, s15, 0xffff
  s_cmp_ge_u32 s3, 48
  s_cbranch_scc1 L_rdyd_23
  s_sleep 8
  s_add_u32 s14, s14, 1
  s_cmp_lt_u32 s14, 100000
  s_cbranch_scc1 L_rdy_22
L_rdyd_23:
  v_mov_b32 v6, 12
  global_load_dword v6, v6, s[38:39] sc1
  s_waitcnt vmcnt(0)
  v_readfirstlane_b32 s2, v6
  s_lshr_b32 s15, s13, 5
  s_mul_i32 s3, s15, 65
  s_and_b32 s3, s3, 0xc4
  v_mov_b32 v6, s3
L_rdy_24:
  global_load_dword v7, v6, s[38:39] sc1
  s_waitcnt vmcnt(0)
  v_readfirstlane_b32 s15, v7
  s_and_b32 s3, s15, 0xffff
  s_cmp_ge_u32 s3, 32
  s_cbranch_scc1 L_rdyd_25
  s_sleep 8
  s_add_u32 s14, s14, 1
  s_cmp_lt_u32 s14, 100000
  s_cbranch_scc1 L_rdy_24
L_rdyd_25:
L_rfast_21:
  s_lshr_b32 s15, s15, 16
  s_and_b32 s2, s2, 3
  s_mul_i32 s2, s2, 0x2001
  s_xor_b32 s2, s2, 0x2000
  s_lshr_b32 s51, s13, 5
  s_mov_b64 vcc, 0
  s_cmp_eq_u32 s51, 6
  s_cselect_b32 vcc_lo, 0xffffffff, vcc_lo
  s_cselect_b32 vcc_hi, 0x0, vcc_hi
  s_cmp_eq_u32 s51, 7
  s_cselect_b32 vcc_lo, 0x0, vcc_lo
  s_cselect_b32 vcc_hi, 0xffffffff, vcc_hi
  s_cmp_eq_u32 s15, 0
  s_cselect_b32 s51, 128, 0
  v_mov_b32 v6, s51
  v_cndmask_b32 v6, 0, v6, vcc
  v_add_u32 v4, v4, v6
  s_and_b32 s51, s2, 0x2000
  s_add_u32 s53, s53, s51
  s_cmp_eq_u32 s66, 0
  s_cselect_b32 s51, 0x2000, 0
  s_xor_b32 s53, s53, s51
  s_lshl_b32 s51, s12, 6
  s_sub_u32 s51, 80, s51
  v_mov_b32 v9, 0x10000000
  v_cmp_gt_i32 vcc, s51, v0
  s_nop 1
  v_cndmask_b32 v9, v9, v1, vcc
  v_lshlrev_b32 v171, 2, v0
  v_add_u32 v171, 155648, v171
  s_lshl_b32 s95, s12, 8
  s_add_u32 s95, s95, 155648
  v_or_b32 v0, s12, v0
  v_lshlrev_b32 v0, 24, v0
  v_min_u32 v0, 0x1000000, v0
  v_lshlrev_b32 v0, 4, v0
  s_lshl_b32 s63, s12, 10
  s_mov_b32 s50, s63
  s_mov_b32 s42, -2
  s_mov_b32 s62, 0
  s_mov_b32 s48, 0
  s_cmp_eq_u32 s12, 0
  s_cselect_b32 s48, s48, 0x20000000
  s_mov_b32 s56, 45056
  s_mov_b32 s55, 45056
  s_mov_b32 s86, 0x6d400000
  s_mov_b32 s87, 0xdadb5b6b
  s_mov_b32 s88, 0xadb5b6b6
  s_mov_b32 s89, 0xfff6d
  s_mov_b64 s[90:91], 0
  s_mov_b32 s80, 115
  s_mov_b32 s81, 8
  s_mov_b32 s82, 20
  s_mov_b32 s43, 1
  s_mov_b32 s45, 1
  s_cmp_eq_u32 s100, 0
  s_cbranch_scc1 L_main_26
  s_mov_b64 s[86:87], 0
  s_mov_b32 s90, 8
  s_mov_b32 s80, 11
  s_mov_b32 s81, 20
  s_mov_b32 s82, 64
  s_add_u32 s54, s54, 36864
  s_mov_b32 s61, s54
  s_mov_b32 s62, 8
  s_barrier
  v_mov_b32 v7, s62
  buffer_store_dword v7, v0, s[4:7], s61 offen offset:0 sc1
L_main_26:
  s_cmp_eq_u32 s42, 62
  s_cselect_b64 s[86:87], s[88:89], s[86:87]
  s_and_b32 s83, s86, 1
  s_cselect_b32 s84, s91, s90
  s_lshr_b64 s[86:87], s[86:87], 1
  s_add_u32 s91, s91, s83
  s_xor_b32 s52, s83, 1
  s_add_u32 s90, s90, s52
  s_cmp_eq_u32 s90, 8
  s_cselect_b32 s90, 20, s90
  s_lshl_b32 s52, s43, 8
  s_add_u32 s52, s52, s62
  s_cmp_eq_u32 s52, s81
  s_cselect_b32 s62, s82, s62
  s_mov_b32 s85, 3145728
  s_mul_i32 s52, s83, 5767168
  s_add_u32 s85, s85, s52
  s_mul_i32 s52, s84, 45056
  s_add_u32 s85, s85, s52
  s_add_u32 s85, s85, s63
  s_mov_b32 s43, s45
  s_mov_b32 s44, s46
  s_mov_b32 s46, s84
  s_mov_b32 s45, s83
  s_mov_b32 s64, s85
  s_add_u32 s42, s42, 1
  s_cmp_eq_u32 s42, 62
  s_cselect_b64 s[86:87], s[88:89], s[86:87]
  s_and_b32 s83, s86, 1
  s_cselect_b32 s84, s91, s90
  s_lshr_b64 s[86:87], s[86:87], 1
  s_add_u32 s91, s91, s83
  s_xor_b32 s52, s83, 1
  s_add_u32 s90, s90, s52
  s_cmp_eq_u32 s90, 8
  s_cselect_b32 s90, 20, s90
  s_lshl_b32 s52, s43, 8
  s_add_u32 s52, s52, s62
  s_cmp_eq_u32 s52, s81
  s_cselect_b32 s62, s82, s62
  s_mov_b32 s85, 3145728
  s_mul_i32 s52, s83, 5767168
  s_add_u32 s85, s85, s52
  s_mul_i32 s52, s84, 45056
  s_add_u32 s85, s85, s52
  s_add_u32 s85, s85, s63
  s_mov_b32 s57, 0x20000000
  s_mov_b32 s58, 0x20000000
  s_mov_b32 s59, 0x20000000
  s_mov_b32 s60, 0x20000000
  s_mov_b32 s61, 0x20000000
  s_mov_b32 s47, s64
  s_mov_b32 s49, 0
  s_mov_b32 s94, 0
  s_branch L_qk_spin1
L_qk_body0:
  s_waitcnt lgkmcnt(2)
  v_mfma_f32_16x16x32_bf16 v[28:31], a[0:3], v[12:15], 0
  s_mov_b32 s43, s45
  ds_read_b128 v[24:27], v2 offset:2304
  ds_read_b32 v5, v171
  v_mfma_f32_16x16x32_bf16 v[32:35], a[4:7], v[12:15], 0
  s_mov_b32 s44, s46
  v_fmac_f32 v60, v124, v108
  v_fmac_f32 v61, v124, v109
  v_mfma_f32_16x16x32_bf16 v[36:39], a[8:11], v[12:15], 0
  s_mov_b32 s46, s84
  v_fmac_f32 v62, v124, v110
  v_fmac_f32 v63, v124, v111
  v_mfma_f32_16x16x32_bf16 v[40:43], a[12:15], v[12:15], 0
  s_waitcnt lgkmcnt(3)
  v_mul_f32 v60, v60, v125
  v_mul_f32 v61, v61, v125
  v_mfma_f32_16x16x32_bf16 v[44:47], a[0:3], v[16:19], 0
  s_mov_b32 s45, s83
  ds_read_b128 v[12:15], v2 offset:4096
  v_mul_f32 v62, v62, v125
  v_mfma_f32_16x16x32_bf16 v[48:51], a[4:7], v[16:19], 0
  s_mov_b32 s64, s85
  v_mul_f32 v63, v63, v125
  v_cvt_pk_bf16_f32 v92, v60, v61
  v_mfma_f32_16x16x32_bf16 v[52:55], a[8:11], v[16:19], 0
  s_add_u32 s42, s42, 1
  v_cvt_pk_bf16_f32 v93, v62, v63
  v_fmac_f32 v64, v124, v112
  v_mfma_f32_16x16x32_bf16 v[56:59], a[12:15], v[16:19], 0
  s_waitcnt lgkmcnt(3)
  v_fmac_f32 v65, v124, v113
  v_fmac_f32 v66, v124, v114
  v_mfma_f32_16x16x32_bf16 v[28:31], a[16:19], v[20:23], v[28:31]
  s_waitcnt lgkmcnt(1)
  ds_read_b128 v[16:19], v2 offset:4352
  v_fmac_f32 v67, v124, v115
  v_mfma_f32_16x16x32_bf16 v[32:35], a[20:23], v[20:23], v[32:35]
  v_mul_f32 v64, v64, v125
  v_mul_f32 v65, v65, v125
  v_mfma_f32_16x16x32_bf16 v[36:39], a[24:27], v[20:23], v[36:39]
  v_mul_f32 v66, v66, v125
  v_mul_f32 v67, v67, v125
  v_mfma_f32_16x16x32_bf16 v[40:43], a[28:31], v[20:23], v[40:43]
  v_cvt_pk_bf16_f32 v94, v64, v65
  v_cvt_pk_bf16_f32 v95, v66, v67
  v_mfma_f32_16x16x32_bf16 v[44:47], a[16:19], v[24:27], v[44:47]
  ds_read_b128 v[20:23], v2 offset:6144
  v_cmp_ge_i32 vcc, s46, v5
  v_mfma_f32_16x16x32_bf16 v[48:51], a[20:23], v[24:27], v[48:51]
  buffer_store_dwordx4 v[92:95], v8, s[4:7], s57 offen offset:0 sc1
  v_mfma_f32_16x16x32_bf16 v[52:55], a[24:27], v[24:27], v[52:55]
  v_fmac_f32 v76, v126, v108
  v_fmac_f32 v77, v126, v109
  v_mfma_f32_16x16x32_bf16 v[56:59], a[28:31], v[24:27], v[56:59]
  s_waitcnt lgkmcnt(2)
  v_fmac_f32 v78, v126, v110
  v_fmac_f32 v79, v126, v111
  v_mfma_f32_16x16x32_bf16 v[28:31], a[32:35], v[12:15], v[28:31]
  s_cmp_eq_u32 s45, 0
  ds_read_b128 v[24:27], v2 offset:6400
  v_mul_f32 v76, v76, v127
  v_mfma_f32_16x16x32_bf16 v[32:35], a[36:39], v[12:15], v[32:35]
  s_cselect_b32 s51, vcc_lo, vcc_hi
  v_mul_f32 v77, v77, v127
  v_mul_f32 v78, v78, v127
  v_mfma_f32_16x16x32_bf16 v[36:39], a[40:43], v[12:15], v[36:39]
  s_cmp_lg_u32 s51, 0
  v_mul_f32 v79, v79, v127
  v_cvt_pk_bf16_f32 v96, v76, v77
  v_mfma_f32_16x16x32_bf16 v[40:43], a[44:47], v[12:15], v[40:43]
  s_waitcnt lgkmcnt(2)
  v_cvt_pk_bf16_f32 v97, v78, v79
  v_fmac_f32 v80, v126, v112
  v_mfma_f32_16x16x32_bf16 v[44:47], a[32:35], v[16:19], v[44:47]
  s_cselect_b32 s49, 0, 1
  ds_read_b128 v[12:15], v2 offset:8192
  v_fmac_f32 v81, v126, v113
  v_mfma_f32_16x16x32_bf16 v[48:51], a[36:39], v[16:19], v[48:51]
  s_cmp_lt_u32 s42, s80
  v_fmac_f32 v82, v126, v114
  v_fmac_f32 v83, v126, v115
  v_mfma_f32_16x16x32_bf16 v[52:55], a[40:43], v[16:19], v[52:55]
  s_cselect_b32 s49, s49, 0
  v_mul_f32 v80, v80, v127
  v_mul_f32 v81, v81, v127
  v_mfma_f32_16x16x32_bf16 v[56:59], a[44:47], v[16:19], v[56:59]
  s_waitcnt lgkmcnt(2)
  v_mul_f32 v82, v82, v127
  v_mul_f32 v83, v83, v127
  v_mfma_f32_16x16x32_bf16 v[28:31], a[48:51], v[20:23], v[28:31]
  s_cmp_lg_u32 s49, 0
  ds_read_b128 v[16:19], v2 offset:8448
  v_cvt_pk_bf16_f32 v98, v80, v81
  v_mfma_f32_16x16x32_bf16 v[32:35], a[52:55], v[20:23], v[32:35]
  s_cselect_b32 s47, s64, 0x20000000
  s_xor_b32 s50, s50, s56
  v_cvt_pk_bf16_f32 v99, v82, v83
  v_mfma_f32_16x16x32_bf16 v[36:39], a[56:59], v[20:23], v[36:39]
  buffer_store_dwordx4 v[96:99], v8, s[4:7], s57 offen offset:256 sc1
  v_mfma_f32_16x16x32_bf16 v[40:43], a[60:63], v[20:23], v[40:43]
  s_waitcnt lgkmcnt(2)
  v_fmac_f32 v68, v124, v116
  v_fmac_f32 v69, v124, v117
  v_mfma_f32_16x16x32_bf16 v[44:47], a[48:51], v[24:27], v[44:47]
  ds_read_b128 v[20:23], v2 offset:10240
  v_fmac_f32 v70, v124, v118
  v_mfma_f32_16x16x32_bf16 v[48:51], a[52:55], v[24:27], v[48:51]
  v_fmac_f32 v71, v124, v119
  v_mul_f32 v68, v68, v125
  v_mfma_f32_16x16x32_bf16 v[52:55], a[56:59], v[24:27], v[52:55]
  v_mul_f32 v69, v69, v125
  v_mul_f32 v70, v70, v125
  v_mfma_f32_16x16x32_bf16 v[56:59], a[60:63], v[24:27], v[56:59]
  s_waitcnt lgkmcnt(2)
  v_mul_f32 v71, v71, v125
  v_cvt_pk_bf16_f32 v100, v68, v69
  v_mfma_f32_16x16x32_bf16 v[28:31], a[64:67], v[12:15], v[28:31]
  ds_read_b128 v[24:27], v2 offset:10496
  v_cvt_pk_bf16_f32 v101, v70, v71
  v_mfma_f32_16x16x32_bf16 v[32:35], a[68:71], v[12:15], v[32:35]
  v_fmac_f32 v72, v124, v120
  v_fmac_f32 v73, v124, v121
  v_mfma_f32_16x16x32_bf16 v[36:39], a[72:75], v[12:15], v[36:39]
  v_fmac_f32 v74, v124, v122
  v_fmac_f32 v75, v124, v123
  v_mfma_f32_16x16x32_bf16 v[40:43], a[76:79], v[12:15], v[40:43]
  s_waitcnt lgkmcnt(2)
  v_mul_f32 v72, v72, v125
  v_mul_f32 v73, v73, v125
  v_mfma_f32_16x16x32_bf16 v[44:47], a[64:67], v[16:19], v[44:47]
  ds_read_b128 v[12:15], v2 offset:12288
  v_mul_f32 v74, v74, v125
  v_mfma_f32_16x16x32_bf16 v[48:51], a[68:71], v[16:19], v[48:51]
  v_mul_f32 v75, v75, v125
  v_cvt_pk_bf16_f32 v102, v72, v73
  v_mfma_f32_16x16x32_bf16 v[52:55], a[72:75], v[16:19], v[52:55]
  v_cvt_pk_bf16_f32 v103, v74, v75
  v_mfma_f32_16x16x32_bf16 v[56:59], a[76:79], v[16:19], v[56:59]
  s_waitcnt lgkmcnt(2)
  buffer_store_dwordx4 v[100:103], v8, s[4:7], s57 offen offset:2048 sc1
  v_mfma_f32_16x16x32_bf16 v[28:31], a[80:83], v[20:23], v[28:31]
  ds_read_b128 v[16:19], v2 offset:12544
  v_fmac_f32 v84, v126, v116
  v_mfma_f32_16x16x32_bf16 v[32:35], a[84:87], v[20:23], v[32:35]
  v_fmac_f32 v85, v126, v117
  v_fmac_f32 v86, v126, v118
  v_mfma_f32_16x16x32_bf16 v[36:39], a[88:91], v[20:23], v[36:39]
  v_fmac_f32 v87, v126, v119
  v_mul_f32 v84, v84, v127
  v_mfma_f32_16x16x32_bf16 v[40:43], a[92:95], v[20:23], v[40:43]
  s_waitcnt lgkmcnt(2)
  v_mul_f32 v85, v85, v127
  v_mul_f32 v86, v86, v127
  v_mfma_f32_16x16x32_bf16 v[44:47], a[80:83], v[24:27], v[44:47]
  ds_read_b128 v[20:23], v2 offset:14336
  v_mul_f32 v87, v87, v127
  v_mfma_f32_16x16x32_bf16 v[48:51], a[84:87], v[24:27], v[48:51]
  v_cvt_pk_bf16_f32 v104, v84, v85
  v_cvt_pk_bf16_f32 v105, v86, v87
  v_mfma_f32_16x16x32_bf16 v[52:55], a[88:91], v[24:27], v[52:55]
  v_fmac_f32 v88, v126, v120
  v_fmac_f32 v89, v126, v121
  v_mfma_f32_16x16x32_bf16 v[56:59], a[92:95], v[24:27], v[56:59]
  s_waitcnt lgkmcnt(2)
  v_fmac_f32 v90, v126, v122
  v_fmac_f32 v91, v126, v123
  v_mfma_f32_16x16x32_bf16 v[28:31], a[96:99], v[12:15], v[28:31]
  ds_read_b128 v[24:27], v2 offset:14592
  v_mul_f32 v88, v88, v127
  v_mfma_f32_16x16x32_bf16 v[32:35], a[100:103], v[12:15], v[32:35]
  v_mul_f32 v89, v89, v127
  v_mul_f32 v90, v90, v127
  v_mfma_f32_16x16x32_bf16 v[36:39], a[104:107], v[12:15], v[36:39]
  v_mul_f32 v91, v91, v127
  v_cvt_pk_bf16_f32 v106, v88, v89
  v_mfma_f32_16x16x32_bf16 v[40:43], a[108:111], v[12:15], v[40:43]
  s_waitcnt lgkmcnt(2)
  v_cvt_pk_bf16_f32 v107, v90, v91
  v_mfma_f32_16x16x32_bf16 v[44:47], a[96:99], v[16:19], v[44:47]
  ds_read_b128 v[12:15], v2 offset:16384
  v_mfma_f32_16x16x32_bf16 v[48:51], a[100:103], v[16:19], v[48:51]
  buffer_store_dwordx4 v[104:107], v8, s[4:7], s57 offen offset:2304 sc1
  v_mfma_f32_16x16x32_bf16 v[52:55], a[104:107], v[16:19], v[52:55]
  v_mfma_f32_16x16x32_bf16 v[56:59], a[108:111], v[16:19], v[56:59]
  s_waitcnt lgkmcnt(2)
  s_add_u32 m0, s50, 0
  s_add_u32 s51, s47, 0
  v_mfma_f32_16x16x32_bf16 v[28:31], a[112:115], v[20:23], v[28:31]
  ds_read_b128 v[16:19], v2 offset:16640
  buffer_load_dwordx4 v1, s[4:7], s51 offen sc1 lds
  v_mfma_f32_16x16x32_bf16 v[32:35], a[116:119], v[20:23], v[32:35]
  s_add_u32 m0, s50, 4096
  s_add_u32 s51, s47, 4096
  v_mfma_f32_16x16x32_bf16 v[36:39], a[120:123], v[20:23], v[36:39]
  v_mfma_f32_16x16x32_bf16 v[40:43], a[124:127], v[20:23], v[40:43]
  s_waitcnt lgkmcnt(2)
  v_mfma_f32_16x16x32_bf16 v[44:47], a[112:115], v[24:27], v[44:47]
  ds_read_b128 v[20:23], v2 offset:18432
  v_mfma_f32_16x16x32_bf16 v[48:51], a[116:119], v[24:27], v[48:51]
  v_mfma_f32_16x16x32_bf16 v[52:55], a[120:123], v[24:27], v[52:55]
  buffer_load_dwordx4 v1, s[4:7], s51 offen sc1 lds
  v_mfma_f32_16x16x32_bf16 v[56:59], a[124:127], v[24:27], v[56:59]
  s_waitcnt lgkmcnt(2)
  s_add_u32 m0, s50, 8192
  s_add_u32 s51, s47, 8192
  v_mfma_f32_16x16x32_bf16 v[28:31], a[128:131], v[12:15], v[28:31]
  ds_read_b128 v[24:27], v2 offset:18688
  v_mfma_f32_16x16x32_bf16 v[32:35], a[132:135], v[12:15], v[32:35]
  v_mfma_f32_16x16x32_bf16 v[36:39], a[136:139], v[12:15], v[36:39]
  v_mfma_f32_16x16x32_bf16 v[40:43], a[140:143], v[12:15], v[40:43]
  s_waitcnt lgkmcnt(2)
  v_mfma_f32_16x16x32_bf16 v[44:47], a[128:131], v[16:19], v[44:47]
  ds_read_b128 v[12:15], v2 offset:20480
  buffer_load_dwordx4 v1, s[4:7], s51 offen sc1 lds
  v_mfma_f32_16x16x32_bf16 v[48:51], a[132:135], v[16:19], v[48:51]
  s_add_u32 m0, s50, 12288
  s_add_u32 s51, s47, 12288
  v_mfma_f32_16x16x32_bf16 v[52:55], a[136:139], v[16:19], v[52:55]
  v_mfma_f32_16x16x32_bf16 v[56:59], a[140:143], v[16:19], v[56:59]
  s_waitcnt lgkmcnt(2)
  v_mfma_f32_16x16x32_bf16 v[28:31], a[144:147], v[20:23], v[28:31]
  ds_read_b128 v[16:19], v2 offset:20736
  v_mfma_f32_16x16x32_bf16 v[32:35], a[148:151], v[20:23], v[32:35]
  v_mfma_f32_16x16x32_bf16 v[36:39], a[152:155], v[20:23], v[36:39]
  buffer_load_dwordx4 v1, s[4:7], s51 offen sc1 lds
  v_mfma_f32_16x16x32_bf16 v[40:43], a[156:159], v[20:23], v[40:43]
  s_waitcnt lgkmcnt(2)
  s_add_u32 m0, s50, 16384
  s_add_u32 s51, s47, 16384
  v_mfma_f32_16x16x32_bf16 v[44:47], a[144:147], v[24:27], v[44:47]
  ds_read_b128 v[20:23], v2 offset:22528
  v_mfma_f32_16x16x32_bf16 v[48:51], a[148:151], v[24:27], v[48:51]
  v_mfma_f32_16x16x32_bf16 v[52:55], a[152:155], v[24:27], v[52:55]
  v_mfma_f32_16x16x32_bf16 v[56:59], a[156:159], v[24:27], v[56:59]
  s_waitcnt lgkmcnt(2)
  v_mfma_f32_16x16x32_bf16 v[28:31], a[160:163], v[12:15], v[28:31]
  ds_read_b128 v[24:27], v2 offset:22784
  buffer_load_dwordx4 v1, s[4:7], s51 offen sc1 lds
  v_mfma_f32_16x16x32_bf16 v[32:35], a[164:167], v[12:15], v[32:35]
  s_add_u32 m0, s50, 20480
  s_add_u32 s51, s47, 20480
  v_mfma_f32_16x16x32_bf16 v[36:39], a[168:171], v[12:15], v[36:39]
  v_mfma_f32_16x16x32_bf16 v[40:43], a[172:175], v[12:15], v[40:43]
  s_waitcnt lgkmcnt(2)
  v_mfma_f32_16x16x32_bf16 v[44:47], a[160:163], v[16:19], v[44:47]
  ds_read_b128 v[12:15], v2 offset:24576
  v_mfma_f32_16x16x32_bf16 v[48:51], a[164:167], v[16:19], v[48:51]
  v_mfma_f32_16x16x32_bf16 v[52:55], a[168:171], v[16:19], v[52:55]
  buffer_load_dwordx4 v1, s[4:7], s51 offen sc1 lds
  v_mfma_f32_16x16x32_bf16 v[56:59], a[172:175], v[16:19], v[56:59]
  s_waitcnt lgkmcnt(2)
  s_add_u32 m0, s50, 24576
  s_add_u32 s51, s47, 24576
  v_mfma_f32_16x16x32_bf16 v[28:31], a[176:179], v[20:23], v[28:31]
  ds_read_b128 v[16:19], v2 offset:24832
  v_mfma_f32_16x16x32_bf16 v[32:35], a[180:183], v[20:23], v[32:35]
  v_mfma_f32_16x16x32_bf16 v[36:39], a[184:187], v[20:23], v[36:39]
  v_mfma_f32_16x16x32_bf16 v[40:43], a[188:191], v[20:23], v[40:43]
  s_waitcnt lgkmcnt(2)
  v_mfma_f32_16x16x32_bf16 v[44:47], a[176:179], v[24:27], v[44:47]
  ds_read_b128 v[20:23], v2 offset:26624
  buffer_load_dwordx4 v1, s[4:7], s51 offen sc1 lds
  v_mfma_f32_16x16x32_bf16 v[48:51], a[180:183], v[24:27], v[48:51]
  s_add_u32 m0, s50, 28672
  s_add_u32 s51, s47, 28672
  v_mfma_f32_16x16x32_bf16 v[52:55], a[184:187], v[24:27], v[52:55]
  v_mfma_f32_16x16x32_bf16 v[56:59], a[188:191], v[24:27], v[56:59]
  s_waitcnt lgkmcnt(2)
  v_mfma_f32_16x16x32_bf16 v[28:31], a[192:195], v[12:15], v[28:31]
  ds_read_b128 v[24:27], v2 offset:26880
  v_mfma_f32_16x16x32_bf16 v[32:35], a[196:199], v[12:15], v[32:35]
  v_mfma_f32_16x16x32_bf16 v[36:39], a[200:203], v[12:15], v[36:39]
  buffer_load_dwordx4 v1, s[4:7], s51 offen sc1 lds
  v_mfma_f32_16x16x32_bf16 v[40:43], a[204:207], v[12:15], v[40:43]
  s_waitcnt lgkmcnt(2)
  s_xor_b32 s95, s95, 1024
  s_mov_b32 m0, s95
  v_mfma_f32_16x16x32_bf16 v[44:47], a[192:195], v[16:19], v[44:47]
  s_waitcnt vmcnt(8)
  s_barrier
  ds_read_b128 v[12:15], v2 offset:28672
  v_mfma_f32_16x16x32_bf16 v[48:51], a[196:199], v[16:19], v[48:51]
  v_xor_b32 v171, 1024, v171
  v_mov_b32 v7, s62
  v_mfma_f32_16x16x32_bf16 v[52:55], a[200:203], v[16:19], v[52:55]
  buffer_load_dword v4, s[4:7], s48 offen sc1 lds
  ds_read_b128 v[124:127], v3 offset:0
  v_mfma_f32_16x16x32_bf16 v[56:59], a[204:207], v[16:19], v[56:59]
  s_waitcnt lgkmcnt(3)
  s_add_u32 m0, s50, 32768
  s_add_u32 s51, s47, 32768
  v_mfma_f32_16x16x32_bf16 v[28:31], a[208:211], v[20:23], v[28:31]
  ds_read_b128 v[16:19], v2 offset:28928
  buffer_load_dwordx4 v1, s[4:7], s51 offen sc1 lds
  v_mfma_f32_16x16x32_bf16 v[32:35], a[212:215], v[20:23], v[32:35]
  s_add_u32 m0, s50, 36864
  s_add_u32 s51, s47, 36864
  ds_read_b128 v[128:131], v3 offset:256
  v_mfma_f32_16x16x32_bf16 v[36:39], a[216:219], v[20:23], v[36:39]
  buffer_store_dword v7, v0, s[4:7], s61 offen offset:0 sc1
  v_mfma_f32_16x16x32_bf16 v[40:43], a[220:223], v[20:23], v[40:43]
  s_waitcnt lgkmcnt(4)
  s_mul_i32 s52, s44, 2359296
  s_add_u32 s57, s53, s52
  v_mfma_f32_16x16x32_bf16 v[44:47], a[208:211], v[24:27], v[44:47]
  s_lshl_b32 s52, s43, 21
  s_add_u32 s52, s52, s57
  ds_read_b128 v[20:23], v2 offset:30720
  v_mfma_f32_16x16x32_bf16 v[48:51], a[212:215], v[24:27], v[48:51]
  s_lshr_b32 s52, s52, 8
  s_and_b32 s52, s52, 0x2000
  s_xor_b32 s57, s57, s52
  v_mfma_f32_16x16x32_bf16 v[52:55], a[216:219], v[24:27], v[52:55]
  s_mov_b32 s61, 0
  s_add_u32 s61, s61, s54
  buffer_load_dwordx4 v1, s[4:7], s51 offen sc1 lds
  v_mfma_f32_16x16x32_bf16 v[56:59], a[220:223], v[24:27], v[56:59]
  s_waitcnt lgkmcnt(4)
  s_add_u32 m0, s50, 40960
  s_add_u32 s51, s47, 40960
  v_mfma_f32_16x16x32_bf16 v[28:31], a[224:227], v[12:15], v[28:31]
  s_mul_i32 s52, s43, 18432
  s_add_u32 s61, s61, s52
  ds_read_b128 v[24:27], v2 offset:30976
  v_mfma_f32_16x16x32_bf16 v[32:35], a[228:231], v[12:15], v[32:35]
  s_add_u32 s62, s44, 1
  ds_read_b128 v[132:135], v3 offset:512
  ds_read_b128 v[136:139], v3 offset:768
  v_mfma_f32_16x16x32_bf16 v[36:39], a[232:235], v[12:15], v[36:39]
  ds_read_b128 v[140:143], v3 offset:1024
  v_mfma_f32_16x16x32_bf16 v[40:43], a[236:239], v[12:15], v[40:43]
  s_waitcnt lgkmcnt(6)
  v_mfma_f32_16x16x32_bf16 v[44:47], a[224:227], v[16:19], v[44:47]
  ds_read_b128 v[12:15], v2 offset:32768
  buffer_load_dwordx4 v9, s[4:7], s51 offen sc1 lds
  v_mfma_f32_16x16x32_bf16 v[48:51], a[228:231], v[16:19], v[48:51]
  s_cmp_eq_u32 s42, 62
  s_cselect_b64 s[86:87], s[88:89], s[86:87]
  s_and_b32 s83, s86, 1
  v_mfma_f32_16x16x32_bf16 v[52:55], a[232:235], v[16:19], v[52:55]
  s_cselect_b32 s84, s91, s90
  s_lshr_b64 s[86:87], s[86:87], 1
  s_add_u32 s91, s91, s83
  v_mfma_f32_16x16x32_bf16 v[56:59], a[236:239], v[16:19], v[56:59]
  s_waitcnt lgkmcnt(5)
  s_xor_b32 s52, s83, 1
  s_add_u32 s90, s90, s52
  v_mfma_f32_16x16x32_bf16 v[28:31], a[240:243], v[20:23], v[28:31]
  s_cmp_eq_u32 s90, 8
  s_cselect_b32 s90, 20, s90
  ds_read_b128 v[16:19], v2 offset:33024
  v_mfma_f32_16x16x32_bf16 v[32:35], a[244:247], v[20:23], v[32:35]
  s_lshl_b32 s52, s43, 8
  s_add_u32 s52, s52, s62
  s_cmp_eq_u32 s52, s81
  v_mfma_f32_16x16x32_bf16 v[36:39], a[248:251], v[20:23], v[36:39]
  s_cselect_b32 s62, s82, s62
  s_mov_b32 s85, 3145728
  s_mul_i32 s52, s83, 5767168
  v_mfma_f32_16x16x32_bf16 v[40:43], a[252:255], v[20:23], v[40:43]
  s_waitcnt lgkmcnt(5)
  s_add_u32 s85, s85, s52
  s_mul_i32 s52, s84, 45056
  v_mfma_f32_16x16x32_bf16 v[44:47], a[240:243], v[24:27], v[44:47]
  s_add_u32 s85, s85, s52
  s_add_u32 s85, s85, s63
  ds_read_b128 v[20:23], v2 offset:34816
  v_mfma_f32_16x16x32_bf16 v[48:51], a[244:247], v[24:27], v[48:51]
  s_waitcnt lgkmcnt(3)
  v_add_f32 v124, v124, v128
  v_add_f32 v125, v125, v129
  v_mfma_f32_16x16x32_bf16 v[52:55], a[248:251], v[24:27], v[52:55]
  v_add_f32 v126, v126, v130
  v_add_f32 v127, v127, v131
  v_mfma_f32_16x16x32_bf16 v[56:59], a[252:255], v[24:27], v[56:59]
  s_waitcnt lgkmcnt(2)
  v_add_f32 v124, v124, v132
  v_add_f32 v125, v125, v133
  v_mfma_f32_16x16x32_bf16 v[28:31], v[192:195], v[12:15], v[28:31]
  ds_read_b128 v[24:27], v2 offset:35072
  v_add_f32 v126, v126, v134
  v_mfma_f32_16x16x32_bf16 v[32:35], v[196:199], v[12:15], v[32:35]
  v_add_f32 v127, v127, v135
  v_add_f32 v124, v124, v136
  v_mfma_f32_16x16x32_bf16 v[36:39], v[200:203], v[12:15], v[36:39]
  v_add_f32 v125, v125, v137
  v_add_f32 v126, v126, v138
  v_mfma_f32_16x16x32_bf16 v[40:43], v[204:207], v[12:15], v[40:43]
  s_waitcnt lgkmcnt(2)
  v_add_f32 v127, v127, v139
  v_add_f32 v124, v124, v140
  v_mfma_f32_16x16x32_bf16 v[44:47], v[192:195], v[16:19], v[44:47]
  ds_read_b128 v[12:15], v2 offset:36864
  v_add_f32 v125, v125, v141
  v_mfma_f32_16x16x32_bf16 v[48:51], v[196:199], v[16:19], v[48:51]
  v_add_f32 v126, v126, v142
  v_add_f32 v127, v127, v143
  v_mfma_f32_16x16x32_bf16 v[52:55], v[200:203], v[16:19], v[52:55]
  v_mul_f32 v124, 0xbacccccd, v124
  v_mul_f32 v125, 0x3acccccd, v125
  v_mfma_f32_16x16x32_bf16 v[56:59], v[204:207], v[16:19], v[56:59]
  s_waitcnt lgkmcnt(2)
  v_mul_f32 v126, 0xbacccccd, v126
  v_mul_f32 v127, 0x3acccccd, v127
  v_mfma_f32_16x16x32_bf16 v[28:31], v[208:211], v[20:23], v[28:31]
  ds_read_b128 v[16:19], v2 offset:37120
  v_fma_f32 v125, -v124, v124, v125
  v_mfma_f32_16x16x32_bf16 v[32:35], v[212:215], v[20:23], v[32:35]
  v_fma_f32 v127, -v126, v126, v127
  v_max_f32 v125, 0, v125
  v_mfma_f32_16x16x32_bf16 v[36:39], v[216:219], v[20:23], v[36:39]
  v_max_f32 v127, 0, v127
  v_add_f32 v125, 0x3727c5ac, v125
  v_mfma_f32_16x16x32_bf16 v[40:43], v[220:223], v[20:23], v[40:43]
  s_waitcnt lgkmcnt(2)
  v_add_f32 v127, 0x3727c5ac, v127
  v_mfma_f32_16x16x32_bf16 v[44:47], v[208:211], v[24:27], v[44:47]
  ds_read_b128 v[20:23], v2 offset:38912
  v_mfma_f32_16x16x32_bf16 v[48:51], v[212:215], v[24:27], v[48:51]
  v_rsq_f32 v125, v125
  v_mfma_f32_16x16x32_bf16 v[52:55], v[216:219], v[24:27], v[52:55]
  v_rsq_f32 v127, v127
  v_mfma_f32_16x16x32_bf16 v[56:59], v[220:223], v[24:27], v[56:59]
  s_waitcnt lgkmcnt(2)
  v_mfma_f32_16x16x32_bf16 v[28:31], v[224:227], v[12:15], v[28:31]
  ds_read_b128 v[24:27], v2 offset:39168
  v_mfma_f32_16x16x32_bf16 v[32:35], v[228:231], v[12:15], v[32:35]
  v_add_u32 v2, s55, v2
  v_add_u32 v3, s55, v3
  v_mfma_f32_16x16x32_bf16 v[36:39], v[232:235], v[12:15], v[36:39]
  s_sub_u32 s55, 0, s55
  v_mfma_f32_16x16x32_bf16 v[40:43], v[236:239], v[12:15], v[40:43]
  s_waitcnt lgkmcnt(2)
  v_mfma_f32_16x16x32_bf16 v[44:47], v[224:227], v[16:19], v[44:47]
  v_mfma_f32_16x16x32_bf16 v[48:51], v[228:231], v[16:19], v[48:51]
  v_mfma_f32_16x16x32_bf16 v[52:55], v[232:235], v[16:19], v[52:55]
  s_cmp_eq_u32 s49, 0
  s_cbranch_scc1 L_qk_slow0
  v_mfma_f32_16x16x32_bf16 v[56:59], v[236:239], v[16:19], v[56:59]
  s_waitcnt vmcnt(4) lgkmcnt(0)
  s_barrier
  ds_read_b128 v[12:15], v2 offset:0
  v_mfma_f32_16x16x32_bf16 v[28:31], v[240:243], v[20:23], v[28:31]
  ds_read_b128 v[16:19], v2 offset:256
  v_mfma_f32_16x16x32_bf16 v[32:35], v[244:247], v[20:23], v[32:35]
  v_mfma_f32_16x16x32_bf16 v[36:39], v[248:251], v[20:23], v[36:39]
  v_mfma_f32_16x16x32_bf16 v[40:43], v[252:255], v[20:23], v[40:43]
  ds_read_b128 v[20:23], v2 offset:2048
  v_mfma_f32_16x16x32_bf16 v[44:47], v[240:243], v[24:27], v[44:47]
  v_mfma_f32_16x16x32_bf16 v[48:51], v[244:247], v[24:27], v[48:51]
  v_mfma_f32_16x16x32_bf16 v[52:55], v[248:251], v[24:27], v[52:55]
  v_mfma_f32_16x16x32_bf16 v[56:59], v[252:255], v[24:27], v[56:59]
L_qk_body1:
  s_waitcnt lgkmcnt(2)
  v_mfma_f32_16x16x32_bf16 v[60:63], a[0:3], v[12:15], 0
  s_mov_b32 s43, s45
  ds_read_b128 v[24:27], v2 offset:2304
  ds_read_b32 v5, v171
  v_mfma_f32_16x16x32_bf16 v[64:67], a[4:7], v[12:15], 0
  s_mov_b32 s44, s46
  v_fmac_f32 v28, v124, v108
  v_fmac_f32 v29, v124, v109
  v_mfma_f32_16x16x32_bf16 v[68:71], a[8:11], v[12:15], 0
  s_mov_b32 s46, s84
  v_fmac_f32 v30, v124, v110
  v_fmac_f32 v31, v124, v111
  v_mfma_f32_16x16x32_bf16 v[72:75], a[12:15], v[12:15], 0
  s_waitcnt lgkmcnt(3)
  v_mul_f32 v28, v28, v125
  v_mul_f32 v29, v29, v125
  v_mfma_f32_16x16x32_bf16 v[76:79], a[0:3], v[16:19], 0
  s_mov_b32 s45, s83
  ds_read_b128 v[12:15], v2 offset:4096
  v_mul_f32 v30, v30, v125
  v_mfma_f32_16x16x32_bf16 v[80:83], a[4:7], v[16:19], 0
  s_mov_b32 s64, s85
  v_mul_f32 v31, v31, v125
  v_cvt_pk_bf16_f32 v92, v28, v29
  v_mfma_f32_16x16x32_bf16 v[84:87], a[8:11], v[16:19], 0
  s_add_u32 s42, s42, 1
  v_cvt_pk_bf16_f32 v93, v30, v31
  v_fmac_f32 v32, v124, v112
  v_mfma_f32_16x16x32_bf16 v[88:91], a[12:15], v[16:19], 0
  s_waitcnt lgkmcnt(3)
  v_fmac_f32 v33, v124, v113
  v_fmac_f32 v34, v124, v114
  v_mfma_f32_16x16x32_bf16 v[60:63], a[16:19], v[20:23], v[60:63]
  s_waitcnt lgkmcnt(1)
  ds_read_b128 v[16:19], v2 offset:4352
  v_fmac_f32 v35, v124, v115
  v_mfma_f32_16x16x32_bf16 v[64:67], a[20:23], v[20:23], v[64:67]
  v_mul_f32 v32, v32, v125
  v_mul_f32 v33, v33, v125
  v_mfma_f32_16x16x32_bf16 v[68:71], a[24:27], v[20:23], v[68:71]
  v_mul_f32 v34, v34, v125
  v_mul_f32 v35, v35, v125
  v_mfma_f32_16x16x32_bf16 v[72:75], a[28:31], v[20:23], v[72:75]
  v_cvt_pk_bf16_f32 v94, v32, v33
  v_cvt_pk_bf16_f32 v95, v34, v35
  v_mfma_f32_16x16x32_bf16 v[76:79], a[16:19], v[24:27], v[76:79]
  ds_read_b128 v[20:23], v2 offset:6144
  v_cmp_ge_i32 vcc, s46, v5
  v_mfma_f32_16x16x32_bf16 v[80:83], a[20:23], v[24:27], v[80:83]
  buffer_store_dwordx4 v[92:95], v8, s[4:7], s57 offen offset:0 sc1
  v_mfma_f32_16x16x32_bf16 v[84:87], a[24:27], v[24:27], v[84:87]
  v_fmac_f32 v44, v126, v108
  v_fmac_f32 v45, v126, v109
  v_mfma_f32_16x16x32_bf16 v[88:91], a[28:31], v[24:27], v[88:91]
  s_waitcnt lgkmcnt(2)
  v_fmac_f32 v46, v126, v110
  v_fmac_f32 v47, v126, v111
  v_mfma_f32_16x16x32_bf16 v[60:63], a[32:35], v[12:15], v[60:63]
  s_cmp_eq_u32 s45, 0
  ds_read_b128 v[24:27], v2 offset:6400
  v_mul_f32 v44, v44, v127
  v_mfma_f32_16x16x32_bf16 v[64:67], a[36:39], v[12:15], v[64:67]
  s_cselect_b32 s51, vcc_lo, vcc_hi
  v_mul_f32 v45, v45, v127
  v_mul_f32 v46, v46, v127
  v_mfma_f32_16x16x32_bf16 v[68:71], a[40:43], v[12:15], v[68:71]
  s_cmp_lg_u32 s51, 0
  v_mul_f32 v47, v47, v127
  v_cvt_pk_bf16_f32 v96, v44, v45
  v_mfma_f32_16x16x32_bf16 v[72:75], a[44:47], v[12:15], v[72:75]
  s_waitcnt lgkmcnt(2)
  v_cvt_pk_bf16_f32 v97, v46, v47
  v_fmac_f32 v48, v126, v112
  v_mfma_f32_16x16x32_bf16 v[76:79], a[32:35], v[16:19], v[76:79]
  s_cselect_b32 s49, 0, 1
  ds_read_b128 v[12:15], v2 offset:8192
  v_fmac_f32 v49, v126, v113
  v_mfma_f32_16x16x32_bf16 v[80:83], a[36:39], v[16:19], v[80:83]
  s_cmp_lt_u32 s42, s80
  v_fmac_f32 v50, v126, v114
  v_fmac_f32 v51, v126, v115
  v_mfma_f32_16x16x32_bf16 v[84:87], a[40:43], v[16:19], v[84:87]
  s_cselect_b32 s49, s49, 0
  v_mul_f32 v48, v48, v127
  v_mul_f32 v49, v49, v127
  v_mfma_f32_16x16x32_bf16 v[88:91], a[44:47], v[16:19], v[88:91]
  s_waitcnt lgkmcnt(2)
  v_mul_f32 v50, v50, v127
  v_mul_f32 v51, v51, v127
  v_mfma_f32_16x16x32_bf16 v[60:63], a[48:51], v[20:23], v[60:63]
  s_cmp_lg_u32 s49, 0
  ds_read_b128 v[16:19], v2 offset:8448
  v_cvt_pk_bf16_f32 v98, v48, v49
  v_mfma_f32_16x16x32_bf16 v[64:67], a[52:55], v[20:23], v[64:67]
  s_cselect_b32 s47, s64, 0x20000000
  s_xor_b32 s50, s50, s56
  v_cvt_pk_bf16_f32 v99, v50, v51
  v_mfma_f32_16x16x32_bf16 v[68:71], a[56:59], v[20:23], v[68:71]
  buffer_store_dwordx4 v[96:99], v8, s[4:7], s57 offen offset:256 sc1
  v_mfma_f32_16x16x32_bf16 v[72:75], a[60:63], v[20:23], v[72:75]
  s_waitcnt lgkmcnt(2)
  v_fmac_f32 v36, v124, v116
  v_fmac_f32 v37, v124, v117
  v_mfma_f32_16x16x32_bf16 v[76:79], a[48:51], v[24:27], v[76:79]
  ds_read_b128 v[20:23], v2 offset:10240
  v_fmac_f32 v38, v124, v118
  v_mfma_f32_16x16x32_bf16 v[80:83], a[52:55], v[24:27], v[80:83]
  v_fmac_f32 v39, v124, v119
  v_mul_f32 v36, v36, v125
  v_mfma_f32_16x16x32_bf16 v[84:87], a[56:59], v[24:27], v[84:87]
  v_mul_f32 v37, v37, v125
  v_mul_f32 v38, v38, v125
  v_mfma_f32_16x16x32_bf16 v[88:91], a[60:63], v[24:27], v[88:91]
  s_waitcnt lgkmcnt(2)
  v_mul_f32 v39, v39, v125
  v_cvt_pk_bf16_f32 v100, v36, v37
  v_mfma_f32_16x16x32_bf16 v[60:63], a[64:67], v[12:15], v[60:63]
  ds_read_b128 v[24:27], v2 offset:10496
  v_cvt_pk_bf16_f32 v101, v38, v39
  v_mfma_f32_16x16x32_bf16 v[64:67], a[68:71], v[12:15], v[64:67]
  v_fmac_f32 v40, v124, v120
  v_fmac_f32 v41, v124, v121
  v_mfma_f32_16x16x32_bf16 v[68:71], a[72:75], v[12:15], v[68:71]
  v_fmac_f32 v42, v124, v122
  v_fmac_f32 v43, v124, v123
  v_mfma_f32_16x16x32_bf16 v[72:75], a[76:79], v[12:15], v[72:75]
  s_waitcnt lgkmcnt(2)
  v_mul_f32 v40, v40, v125
  v_mul_f32 v41, v41, v125
  v_mfma_f32_16x16x32_bf16 v[76:79], a[64:67], v[16:19], v[76:79]
  ds_read_b128 v[12:15], v2 offset:12288
  v_mul_f32 v42, v42, v125
  v_mfma_f32_16x16x32_bf16 v[80:83], a[68:71], v[16:19], v[80:83]
  v_mul_f32 v43, v43, v125
  v_cvt_pk_bf16_f32 v102, v40, v41
  v_mfma_f32_16x16x32_bf16 v[84:87], a[72:75], v[16:19], v[84:87]
  v_cvt_pk_bf16_f32 v103, v42, v43
  v_mfma_f32_16x16x32_bf16 v[88:91], a[76:79], v[16:19], v[88:91]
  s_waitcnt lgkmcnt(2)
  buffer_store_dwordx4 v[100:103], v8, s[4:7], s57 offen offset:2048 sc1
  v_mfma_f32_16x16x32_bf16 v[60:63], a[80:83], v[20:23], v[60:63]
  ds_read_b128 v[16:19], v2 offset:12544
  v_fmac_f32 v52, v126, v116
  v_mfma_f32_16x16x32_bf16 v[64:67], a[84:87], v[20:23], v[64:67]
  v_fmac_f32 v53, v126, v117
  v_fmac_f32 v54, v126, v118
  v_mfma_f32_16x16x32_bf16 v[68:71], a[88:91], v[20:23], v[68:71]
  v_fmac_f32 v55, v126, v119
  v_mul_f32 v52, v52, v127
  v_mfma_f32_16x16x32_bf16 v[72:75], a[92:95], v[20:23], v[72:75]
  s_waitcnt lgkmcnt(2)
  v_mul_f32 v53, v53, v127
  v_mul_f32 v54, v54, v127
  v_mfma_f32_16x16x32_bf16 v[76:79], a[80:83], v[24:27], v[76:79]
  ds_read_b128 v[20:23], v2 offset:14336
  v_mul_f32 v55, v55, v127
  v_mfma_f32_16x16x32_bf16 v[80:83], a[84:87], v[24:27], v[80:83]
  v_cvt_pk_bf16_f32 v104, v52, v53
  v_cvt_pk_bf16_f32 v105, v54, v55
  v_mfma_f32_16x16x32_bf16 v[84:87], a[88:91], v[24:27], v[84:87]
  v_fmac_f32 v56, v126, v120
  v_fmac_f32 v57, v126, v121
  v_mfma_f32_16x16x32_bf16 v[88:91], a[92:95], v[24:27], v[88:91]
  s_waitcnt lgkmcnt(2)
  v_fmac_f32 v58, v126, v122
  v_fmac_f32 v59, v126, v123
  v_mfma_f32_16x16x32_bf16 v[60:63], a[96:99], v[12:15], v[60:63]
  ds_read_b128 v[24:27], v2 offset:14592
  v_mul_f32 v56, v56, v127
  v_mfma_f32_16x16x32_bf16 v[64:67], a[100:103], v[12:15], v[64:67]
  v_mul_f32 v57, v57, v127
  v_mul_f32 v58, v58, v127
  v_mfma_f32_16x16x32_bf16 v[68:71], a[104:107], v[12:15], v[68:71]
  v_mul_f32 v59, v59, v127
  v_cvt_pk_bf16_f32 v106, v56, v57
  v_mfma_f32_16x16x32_bf16 v[72:75], a[108:111], v[12:15], v[72:75]
  s_waitcnt lgkmcnt(2)
  v_cvt_pk_bf16_f32 v107, v58, v59
  v_mfma_f32_16x16x32_bf16 v[76:79], a[96:99], v[16:19], v[76:79]
  ds_read_b128 v[12:15], v2 offset:16384
  v_mfma_f32_16x16x32_bf16 v[80:83], a[100:103], v[16:19], v[80:83]
  buffer_store_dwordx4 v[104:107], v8, s[4:7], s57 offen offset:2304 sc1
  v_mfma_f32_16x16x32_bf16 v[84:87], a[104:107], v[16:19], v[84:87]
  v_mfma_f32_16x16x32_bf16 v[88:91], a[108:111], v[16:19], v[88:91]
  s_waitcnt lgkmcnt(2)
  s_add_u32 m0, s50, 0
  s_add_u32 s51, s47, 0
  v_mfma_f32_16x16x32_bf16 v[60:63], a[112:115], v[20:23], v[60:63]
  ds_read_b128 v[16:19], v2 offset:16640
  buffer_load_dwordx4 v1, s[4:7], s51 offen sc1 lds
  v_mfma_f32_16x16x32_bf16 v[64:67], a[116:119], v[20:23], v[64:67]
  s_add_u32 m0, s50, 4096
  s_add_u32 s51, s47, 4096
  v_mfma_f32_16x16x32_bf16 v[68:71], a[120:123], v[20:23], v[68:71]
  v_mfma_f32_16x16x32_bf16 v[72:75], a[124:127], v[20:23], v[72:75]
  s_waitcnt lgkmcnt(2)
  v_mfma_f32_16x16x32_bf16 v[76:79], a[112:115], v[24:27], v[76:79]
  ds_read_b128 v[20:23], v2 offset:18432
  v_mfma_f32_16x16x32_bf16 v[80:83], a[116:119], v[24:27], v[80:83]
  v_mfma_f32_16x16x32_bf16 v[84:87], a[120:123], v[24:27], v[84:87]
  buffer_load_dwordx4 v1, s[4:7], s51 offen sc1 lds
  v_mfma_f32_16x16x32_bf16 v[88:91], a[124:127], v[24:27], v[88:91]
  s_waitcnt lgkmcnt(2)
  s_add_u32 m0, s50, 8192
  s_add_u32 s51, s47, 8192
  v_mfma_f32_16x16x32_bf16 v[60:63], a[128:131], v[12:15], v[60:63]
  ds_read_b128 v[24:27], v2 offset:18688
  v_mfma_f32_16x16x32_bf16 v[64:67], a[132:135], v[12:15], v[64:67]
  v_mfma_f32_16x16x32_bf16 v[68:71], a[136:139], v[12:15], v[68:71]
  v_mfma_f32_16x16x32_bf16 v[72:75], a[140:143], v[12:15], v[72:75]
  s_waitcnt lgkmcnt(2)
  v_mfma_f32_16x16x32_bf16 v[76:79], a[128:131], v[16:19], v[76:79]
  ds_read_b128 v[12:15], v2 offset:20480
  buffer_load_dwordx4 v1, s[4:7], s51 offen sc1 lds
  v_mfma_f32_16x16x32_bf16 v[80:83], a[132:135], v[16:19], v[80:83]
  s_add_u32 m0, s50, 12288
  s_add_u32 s51, s47, 12288
  v_mfma_f32_16x16x32_bf16 v[84:87], a[136:139], v[16:19], v[84:87]
  v_mfma_f32_16x16x32_bf16 v[88:91], a[140:143], v[16:19], v[88:91]
  s_waitcnt lgkmcnt(2)
  v_mfma_f32_16x16x32_bf16 v[60:63], a[144:147], v[20:23], v[60:63]
  ds_read_b128 v[16:19], v2 offset:20736
  v_mfma_f32_16x16x32_bf16 v[64:67], a[148:151], v[20:23], v[64:67]
  v_mfma_f32_16x16x32_bf16 v[68:71], a[152:155], v[20:23], v[68:71]
  buffer_load_dwordx4 v1, s[4:7], s51 offen sc1 lds
  v_mfma_f32_16x16x32_bf16 v[72:75], a[156:159], v[20:23], v[72:75]
  s_waitcnt lgkmcnt(2)
  s_add_u32 m0, s50, 16384
  s_add_u32 s51, s47, 16384
  v_mfma_f32_16x16x32_bf16 v[76:79], a[144:147], v[24:27], v[76:79]
  ds_read_b128 v[20:23], v2 offset:22528
  v_mfma_f32_16x16x32_bf16 v[80:83], a[148:151], v[24:27], v[80:83]
  v_mfma_f32_16x16x32_bf16 v[84:87], a[152:155], v[24:27], v[84:87]
  v_mfma_f32_16x16x32_bf16 v[88:91], a[156:159], v[24:27], v[88:91]
  s_waitcnt lgkmcnt(2)
  v_mfma_f32_16x16x32_bf16 v[60:63], a[160:163], v[12:15], v[60:63]
  ds_read_b128 v[24:27], v2 offset:22784
  buffer_load_dwordx4 v1, s[4:7], s51 offen sc1 lds
  v_mfma_f32_16x16x32_bf16 v[64:67], a[164:167], v[12:15], v[64:67]
  s_add_u32 m0, s50, 20480
  s_add_u32 s51, s47, 20480
  v_mfma_f32_16x16x32_bf16 v[68:71], a[168:171], v[12:15], v[68:71]
  v_mfma_f32_16x16x32_bf16 v[72:75], a[172:175], v[12:15], v[72:75]
  s_waitcnt lgkmcnt(2)
  v_mfma_f32_16x16x32_bf16 v[76:79], a[160:163], v[16:19], v[76:79]
  ds_read_b128 v[12:15], v2 offset:24576
  v_mfma_f32_16x16x32_bf16 v[80:83], a[164:167], v[16:19], v[80:83]
  v_mfma_f32_16x16x32_bf16 v[84:87], a[168:171], v[16:19], v[84:87]
  buffer_load_dwordx4 v1, s[4:7], s51 offen sc1 lds
  v_mfma_f32_16x16x32_bf16 v[88:91], a[172:175], v[16:19], v[88:91]
  s_waitcnt lgkmcnt(2)
  s_add_u32 m0, s50, 24576
  s_add_u32 s51, s47, 24576
  v_mfma_f32_16x16x32_bf16 v[60:63], a[176:179], v[20:23], v[60:63]
  ds_read_b128 v[16:19], v2 offset:24832
  v_mfma_f32_16x16x32_bf16 v[64:67], a[180:183], v[20:23], v[64:67]
  v_mfma_f32_16x16x32_bf16 v[68:71], a[184:187], v[20:23], v[68:71]
  v_mfma_f32_16x16x32_bf16 v[72:75], a[188:191], v[20:23], v[72:75]
  s_waitcnt lgkmcnt(2)
  v_mfma_f32_16x16x32_bf16 v[76:79], a[176:179], v[24:27], v[76:79]
  ds_read_b128 v[20:23], v2 offset:26624
  buffer_load_dwordx4 v1, s[4:7], s51 offen sc1 lds
  v_mfma_f32_16x16x32_bf16 v[80:83], a[180:183], v[24:27], v[80:83]
  s_add_u32 m0, s50, 28672
  s_add_u32 s51, s47, 28672
  v_mfma_f32_16x16x32_bf16 v[84:87], a[184:187], v[24:27], v[84:87]
  v_mfma_f32_16x16x32_bf16 v[88:91], a[188:191], v[24:27], v[88:91]
  s_waitcnt lgkmcnt(2)
  v_mfma_f32_16x16x32_bf16 v[60:63], a[192:195], v[12:15], v[60:63]
  ds_read_b128 v[24:27], v2 offset:26880
  v_mfma_f32_16x16x32_bf16 v[64:67], a[196:199], v[12:15], v[64:67]
  v_mfma_f32_16x16x32_bf16 v[68:71], a[200:203], v[12:15], v[68:71]
  buffer_load_dwordx4 v1, s[4:7], s51 offen sc1 lds
  v_mfma_f32_16x16x32_bf16 v[72:75], a[204:207], v[12:15], v[72:75]
  s_waitcnt lgkmcnt(2)
  s_xor_b32 s95, s95, 1024
  s_mov_b32 m0, s95
  v_mfma_f32_16x16x32_bf16 v[76:79], a[192:195], v[16:19], v[76:79]
  s_waitcnt vmcnt(8)
  s_barrier
  ds_read_b128 v[12:15], v2 offset:28672
  v_mfma_f32_16x16x32_bf16 v[80:83], a[196:199], v[16:19], v[80:83]
  v_xor_b32 v171, 1024, v171
  v_mov_b32 v7, s62
  v_mfma_f32_16x16x32_bf16 v[84:87], a[200:203], v[16:19], v[84:87]
  buffer_load_dword v4, s[4:7], s48 offen sc1 lds
  ds_read_b128 v[124:127], v3 offset:0
  v_mfma_f32_16x16x32_bf16 v[88:91], a[204:207], v[16:19], v[88:91]
  s_waitcnt lgkmcnt(3)
  s_add_u32 m0, s50, 32768
  s_add_u32 s51, s47, 32768
  v_mfma_f32_16x16x32_bf16 v[60:63], a[208:211], v[20:23], v[60:63]
  ds_read_b128 v[16:19], v2 offset:28928
  buffer_load_dwordx4 v1, s[4:7], s51 offen sc1 lds
  v_mfma_f32_16x16x32_bf16 v[64:67], a[212:215], v[20:23], v[64:67]
  s_add_u32 m0, s50, 36864
  s_add_u32 s51, s47, 36864
  ds_read_b128 v[128:131], v3 offset:256
  v_mfma_f32_16x16x32_bf16 v[68:71], a[216:219], v[20:23], v[68:71]
  buffer_store_dword v7, v0, s[4:7], s61 offen offset:0 sc1
  v_mfma_f32_16x16x32_bf16 v[72:75], a[220:223], v[20:23], v[72:75]
  s_waitcnt lgkmcnt(4)
  s_mul_i32 s52, s44, 2359296
  s_add_u32 s57, s53, s52
  v_mfma_f32_16x16x32_bf16 v[76:79], a[208:211], v[24:27], v[76:79]
  s_lshl_b32 s52, s43, 21
  s_add_u32 s52, s52, s57
  ds_read_b128 v[20:23], v2 offset:30720
  v_mfma_f32_16x16x32_bf16 v[80:83], a[212:215], v[24:27], v[80:83]
  s_lshr_b32 s52, s52, 8
  s_and_b32 s52, s52, 0x2000
  s_xor_b32 s57, s57, s52
  v_mfma_f32_16x16x32_bf16 v[84:87], a[216:219], v[24:27], v[84:87]
  s_mov_b32 s61, 0
  s_add_u32 s61, s61, s54
  buffer_load_dwordx4 v1, s[4:7], s51 offen sc1 lds
  v_mfma_f32_16x16x32_bf16 v[88:91], a[220:223], v[24:27], v[88:91]
  s_waitcnt lgkmcnt(4)
  s_add_u32 m0, s50, 40960
  s_add_u32 s51, s47, 40960
  v_mfma_f32_16x16x32_bf16 v[60:63], a[224:227], v[12:15], v[60:63]
  s_mul_i32 s52, s43, 18432
  s_add_u32 s61, s61, s52
  ds_read_b128 v[24:27], v2 offset:30976
  v_mfma_f32_16x16x32_bf16 v[64:67], a[228:231], v[12:15], v[64:67]
  s_add_u32 s62, s44, 1
  ds_read_b128 v[132:135], v3 offset:512
  ds_read_b128 v[136:139], v3 offset:768
  v_mfma_f32_16x16x32_bf16 v[68:71], a[232:235], v[12:15], v[68:71]
  ds_read_b128 v[140:143], v3 offset:1024
  v_mfma_f32_16x16x32_bf16 v[72:75], a[236:239], v[12:15], v[72:75]
  s_waitcnt lgkmcnt(6)
  v_mfma_f32_16x16x32_bf16 v[76:79], a[224:227], v[16:19], v[76:79]
  ds_read_b128 v[12:15], v2 offset:32768
  buffer_load_dwordx4 v9, s[4:7], s51 offen sc1 lds
  v_mfma_f32_16x16x32_bf16 v[80:83], a[228:231], v[16:19], v[80:83]
  s_cmp_eq_u32 s42, 62
  s_cselect_b64 s[86:87], s[88:89], s[86:87]
  s_and_b32 s83, s86, 1
  v_mfma_f32_16x16x32_bf16 v[84:87], a[232:235], v[16:19], v[84:87]
  s_cselect_b32 s84, s91, s90
  s_lshr_b64 s[86:87], s[86:87], 1
  s_add_u32 s91, s91, s83
  v_mfma_f32_16x16x32_bf16 v[88:91], a[236:239], v[16:19], v[88:91]
  s_waitcnt lgkmcnt(5)
  s_xor_b32 s52, s83, 1
  s_add_u32 s90, s90, s52
  v_mfma_f32_16x16x32_bf16 v[60:63], a[240:243], v[20:23], v[60:63]
  s_cmp_eq_u32 s90, 8
  s_cselect_b32 s90, 20, s90
  ds_read_b128 v[16:19], v2 offset:33024
  v_mfma_f32_16x16x32_bf16 v[64:67], a[244:247], v[20:23], v[64:67]
  s_lshl_b32 s52, s43, 8
  s_add_u32 s52, s52, s62
  s_cmp_eq_u32 s52, s81
  v_mfma_f32_16x16x32_bf16 v[68:71], a[248:251], v[20:23], v[68:71]
  s_cselect_b32 s62, s82, s62
  s_mov_b32 s85, 3145728
  s_mul_i32 s52, s83, 5767168
  v_mfma_f32_16x16x32_bf16 v[72:75], a[252:255], v[20:23], v[72:75]
  s_waitcnt lgkmcnt(5)
  s_add_u32 s85, s85, s52
  s_mul_i32 s52, s84, 45056
  v_mfma_f32_16x16x32_bf16 v[76:79], a[240:243], v[24:27], v[76:79]
  s_add_u32 s85, s85, s52
  s_add_u32 s85, s85, s63
  ds_read_b128 v[20:23], v2 offset:34816
  v_mfma_f32_16x16x32_bf16 v[80:83], a[244:247], v[24:27], v[80:83]
  s_waitcnt lgkmcnt(3)
  v_add_f32 v124, v124, v128
  v_add_f32 v125, v125, v129
  v_mfma_f32_16x16x32_bf16 v[84:87], a[248:251], v[24:27], v[84:87]
  v_add_f32 v126, v126, v130
  v_add_f32 v127, v127, v131
  v_mfma_f32_16x16x32_bf16 v[88:91], a[252:255], v[24:27], v[88:91]
  s_waitcnt lgkmcnt(2)
  v_add_f32 v124, v124, v132
  v_add_f32 v125, v125, v133
  v_mfma_f32_16x16x32_bf16 v[60:63], v[192:195], v[12:15], v[60:63]
  ds_read_b128 v[24:27], v2 offset:35072
  v_add_f32 v126, v126, v134
  v_mfma_f32_16x16x32_bf16 v[64:67], v[196:199], v[12:15], v[64:67]
  v_add_f32 v127, v127, v135
  v_add_f32 v124, v124, v136
  v_mfma_f32_16x16x32_bf16 v[68:71], v[200:203], v[12:15], v[68:71]
  v_add_f32 v125, v125, v137
  v_add_f32 v126, v126, v138
  v_mfma_f32_16x16x32_bf16 v[72:75], v[204:207], v[12:15], v[72:75]
  s_waitcnt lgkmcnt(2)
  v_add_f32 v127, v127, v139
  v_add_f32 v124, v124, v140
  v_mfma_f32_16x16x32_bf16 v[76:79], v[192:195], v[16:19], v[76:79]
  ds_read_b128 v[12:15], v2 offset:36864
  v_add_f32 v125, v125, v141
  v_mfma_f32_16x16x32_bf16 v[80:83], v[196:199], v[16:19], v[80:83]
  v_add_f32 v126, v126, v142
  v_add_f32 v127, v127, v143
  v_mfma_f32_16x16x32_bf16 v[84:87], v[200:203], v[16:19], v[84:87]
  v_mul_f32 v124, 0xbacccccd, v124
  v_mul_f32 v125, 0x3acccccd, v125
  v_mfma_f32_16x16x32_bf16 v[88:91], v[204:207], v[16:19], v[88:91]
  s_waitcnt lgkmcnt(2)
  v_mul_f32 v126, 0xbacccccd, v126
  v_mul_f32 v127, 0x3acccccd, v127
  v_mfma_f32_16x16x32_bf16 v[60:63], v[208:211], v[20:23], v[60:63]
  ds_read_b128 v[16:19], v2 offset:37120
  v_fma_f32 v125, -v124, v124, v125
  v_mfma_f32_16x16x32_bf16 v[64:67], v[212:215], v[20:23], v[64:67]
  v_fma_f32 v127, -v126, v126, v127
  v_max_f32 v125, 0, v125
  v_mfma_f32_16x16x32_bf16 v[68:71], v[216:219], v[20:23], v[68:71]
  v_max_f32 v127, 0, v127
  v_add_f32 v125, 0x3727c5ac, v125
  v_mfma_f32_16x16x32_bf16 v[72:75], v[220:223], v[20:23], v[72:75]
  s_waitcnt lgkmcnt(2)
  v_add_f32 v127, 0x3727c5ac, v127
  v_mfma_f32_16x16x32_bf16 v[76:79], v[208:211], v[24:27], v[76:79]
  ds_read_b128 v[20:23], v2 offset:38912
  v_mfma_f32_16x16x32_bf16 v[80:83], v[212:215], v[24:27], v[80:83]
  v_rsq_f32 v125, v125
  v_mfma_f32_16x16x32_bf16 v[84:87], v[216:219], v[24:27], v[84:87]
  v_rsq_f32 v127, v127
  v_mfma_f32_16x16x32_bf16 v[88:91], v[220:223], v[24:27], v[88:91]
  s_waitcnt lgkmcnt(2)
  v_mfma_f32_16x16x32_bf16 v[60:63], v[224:227], v[12:15], v[60:63]
  ds_read_b128 v[24:27], v2 offset:39168
  v_mfma_f32_16x16x32_bf16 v[64:67], v[228:231], v[12:15], v[64:67]
  v_add_u32 v2, s55, v2
  v_add_u32 v3, s55, v3
  v_mfma_f32_16x16x32_bf16 v[68:71], v[232:235], v[12:15], v[68:71]
  s_sub_u32 s55, 0, s55
  v_mfma_f32_16x16x32_bf16 v[72:75], v[236:239], v[12:15], v[72:75]
  s_waitcnt lgkmcnt(2)
  v_mfma_f32_16x16x32_bf16 v[76:79], v[224:227], v[16:19], v[76:79]
  v_mfma_f32_16x16x32_bf16 v[80:83], v[228:231], v[16:19], v[80:83]
  v_mfma_f32_16x16x32_bf16 v[84:87], v[232:235], v[16:19], v[84:87]
  s_cmp_eq_u32 s49, 0
  s_cbranch_scc1 L_qk_slow1
  v_mfma_f32_16x16x32_bf16 v[88:91], v[236:239], v[16:19], v[88:91]
  s_waitcnt vmcnt(4) lgkmcnt(0)
  s_barrier
  ds_read_b128 v[12:15], v2 offset:0
  v_mfma_f32_16x16x32_bf16 v[60:63], v[240:243], v[20:23], v[60:63]
  ds_read_b128 v[16:19], v2 offset:256
  v_mfma_f32_16x16x32_bf16 v[64:67], v[244:247], v[20:23], v[64:67]
  v_mfma_f32_16x16x32_bf16 v[68:71], v[248:251], v[20:23], v[68:71]
  v_mfma_f32_16x16x32_bf16 v[72:75], v[252:255], v[20:23], v[72:75]
  ds_read_b128 v[20:23], v2 offset:2048
  v_mfma_f32_16x16x32_bf16 v[76:79], v[240:243], v[24:27], v[76:79]
  v_mfma_f32_16x16x32_bf16 v[80:83], v[244:247], v[24:27], v[80:83]
  v_mfma_f32_16x16x32_bf16 v[84:87], v[248:251], v[24:27], v[84:87]
  v_mfma_f32_16x16x32_bf16 v[88:91], v[252:255], v[24:27], v[88:91]
  s_branch L_qk_body0
L_qk_entry0:
  s_barrier
  ds_read_b128 v[12:15], v2 offset:0
  ds_read_b128 v[16:19], v2 offset:256
  ds_read_b128 v[20:23], v2 offset:2048
  s_branch L_qk_body0
L_qk_slow0:
  v_mfma_f32_16x16x32_bf16 v[56:59], v[236:239], v[16:19], v[56:59]
  s_waitcnt lgkmcnt(0)
  v_mfma_f32_16x16x32_bf16 v[28:31], v[240:243], v[20:23], v[28:31]
  v_mfma_f32_16x16x32_bf16 v[32:35], v[244:247], v[20:23], v[32:35]
  v_mfma_f32_16x16x32_bf16 v[36:39], v[248:251], v[20:23], v[36:39]
  v_mfma_f32_16x16x32_bf16 v[40:43], v[252:255], v[20:23], v[40:43]
  v_mfma_f32_16x16x32_bf16 v[44:47], v[240:243], v[24:27], v[44:47]
  v_mfma_f32_16x16x32_bf16 v[48:51], v[244:247], v[24:27], v[48:51]
  v_mfma_f32_16x16x32_bf16 v[52:55], v[248:251], v[24:27], v[52:55]
  v_mfma_f32_16x16x32_bf16 v[56:59], v[252:255], v[24:27], v[56:59]
  s_mov_b32 s47, s64
  s_cmp_eq_u32 s42, s80
  s_cbranch_scc1 L_nonext_5127
  s_waitcnt vmcnt(0)
  s_barrier
  ds_read_b32 v5, v171
  s_waitcnt lgkmcnt(0)
  v_cmp_ge_i32 vcc, s46, v5
  s_cmp_eq_u32 s45, 0
  s_cselect_b32 s51, vcc_lo, vcc_hi
  s_cmp_lg_u32 s51, 0
  s_cbranch_scc1 L_nonext_5127
  s_add_u32 m0, s50, 0
  s_add_u32 s51, s47, 0
  buffer_load_dwordx4 v1, s[4:7], s51 offen sc1 lds
  s_add_u32 m0, s50, 4096
  s_add_u32 s51, s47, 4096
  buffer_load_dwordx4 v1, s[4:7], s51 offen sc1 lds
  s_add_u32 m0, s50, 8192
  s_add_u32 s51, s47, 8192
  buffer_load_dwordx4 v1, s[4:7], s51 offen sc1 lds
  s_add_u32 m0, s50, 12288
  s_add_u32 s51, s47, 12288
  buffer_load_dwordx4 v1, s[4:7], s51 offen sc1 lds
  s_add_u32 m0, s50, 16384
  s_add_u32 s51, s47, 16384
  buffer_load_dwordx4 v1, s[4:7], s51 offen sc1 lds
  s_add_u32 m0, s50, 20480
  s_add_u32 s51, s47, 20480
  buffer_load_dwordx4 v1, s[4:7], s51 offen sc1 lds
  s_add_u32 m0, s50, 24576
  s_add_u32 s51, s47, 24576
  buffer_load_dwordx4 v1, s[4:7], s51 offen sc1 lds
  s_add_u32 m0, s50, 28672
  s_add_u32 s51, s47, 28672
  buffer_load_dwordx4 v1, s[4:7], s51 offen sc1 lds
  s_add_u32 m0, s50, 32768
  s_add_u32 s51, s47, 32768
  buffer_load_dwordx4 v1, s[4:7], s51 offen sc1 lds
  s_add_u32 m0, s50, 36864
  s_add_u32 s51, s47, 36864
  buffer_load_dwordx4 v1, s[4:7], s51 offen sc1 lds
  s_add_u32 m0, s50, 40960
  s_add_u32 s51, s47, 40960
  buffer_load_dwordx4 v9, s[4:7], s51 offen sc1 lds
  v_pk_fma_f32 v[28:29], v[108:109], v[124:125], v[28:29] op_sel_hi:[1,0,1]
  v_pk_fma_f32 v[30:31], v[110:111], v[124:125], v[30:31] op_sel_hi:[1,0,1]
  v_pk_mul_f32 v[28:29], v[28:29], v[124:125] op_sel:[0,1] op_sel_hi:[1,1]
  v_pk_mul_f32 v[30:31], v[30:31], v[124:125] op_sel:[0,1] op_sel_hi:[1,1]
  v_cvt_pk_bf16_f32 v92, v28, v29
  v_cvt_pk_bf16_f32 v93, v30, v31
  v_pk_fma_f32 v[32:33], v[112:113], v[124:125], v[32:33] op_sel_hi:[1,0,1]
  v_pk_fma_f32 v[34:35], v[114:115], v[124:125], v[34:35] op_sel_hi:[1,0,1]
  v_pk_mul_f32 v[32:33], v[32:33], v[124:125] op_sel:[0,1] op_sel_hi:[1,1]
  v_pk_mul_f32 v[34:35], v[34:35], v[124:125] op_sel:[0,1] op_sel_hi:[1,1]
  v_cvt_pk_bf16_f32 v94, v32, v33
  v_cvt_pk_bf16_f32 v95, v34, v35
  buffer_store_dwordx4 v[92:95], v8, s[4:7], s57 offen offset:0 sc1
  v_pk_fma_f32 v[44:45], v[108:109], v[126:127], v[44:45] op_sel_hi:[1,0,1]
  v_pk_fma_f32 v[46:47], v[110:111], v[126:127], v[46:47] op_sel_hi:[1,0,1]
  v_pk_mul_f32 v[44:45], v[44:45], v[126:127] op_sel:[0,1] op_sel_hi:[1,1]
  v_pk_mul_f32 v[46:47], v[46:47], v[126:127] op_sel:[0,1] op_sel_hi:[1,1]
  v_cvt_pk_bf16_f32 v96, v44, v45
  v_cvt_pk_bf16_f32 v97, v46, v47
  v_pk_fma_f32 v[48:49], v[112:113], v[126:127], v[48:49] op_sel_hi:[1,0,1]
  v_pk_fma_f32 v[50:51], v[114:115], v[126:127], v[50:51] op_sel_hi:[1,0,1]
  v_pk_mul_f32 v[48:49], v[48:49], v[126:127] op_sel:[0,1] op_sel_hi:[1,1]
  v_pk_mul_f32 v[50:51], v[50:51], v[126:127] op_sel:[0,1] op_sel_hi:[1,1]
  v_cvt_pk_bf16_f32 v98, v48, v49
  v_cvt_pk_bf16_f32 v99, v50, v51
  buffer_store_dwordx4 v[96:99], v8, s[4:7], s57 offen offset:256 sc1
  v_pk_fma_f32 v[36:37], v[116:117], v[124:125], v[36:37] op_sel_hi:[1,0,1]
  v_pk_fma_f32 v[38:39], v[118:119], v[124:125], v[38:39] op_sel_hi:[1,0,1]
  v_pk_mul_f32 v[36:37], v[36:37], v[124:125] op_sel:[0,1] op_sel_hi:[1,1]
  v_pk_mul_f32 v[38:39], v[38:39], v[124:125] op_sel:[0,1] op_sel_hi:[1,1]
  v_cvt_pk_bf16_f32 v100, v36, v37
  v_cvt_pk_bf16_f32 v101, v38, v39
  v_pk_fma_f32 v[40:41], v[120:121], v[124:125], v[40:41] op_sel_hi:[1,0,1]
  v_pk_fma_f32 v[42:43], v[122:123], v[124:125], v[42:43] op_sel_hi:[1,0,1]
  v_pk_mul_f32 v[40:41], v[40:41], v[124:125] op_sel:[0,1] op_sel_hi:[1,1]
  v_pk_mul_f32 v[42:43], v[42:43], v[124:125] op_sel:[0,1] op_sel_hi:[1,1]
  v_cvt_pk_bf16_f32 v102, v40, v41
  v_cvt_pk_bf16_f32 v103, v42, v43
  buffer_store_dwordx4 v[100:103], v8, s[4:7], s57 offen offset:2048 sc1
  v_pk_fma_f32 v[52:53], v[116:117], v[126:127], v[52:53] op_sel_hi:[1,0,1]
  v_pk_fma_f32 v[54:55], v[118:119], v[126:127], v[54:55] op_sel_hi:[1,0,1]
  v_pk_mul_f32 v[52:53], v[52:53], v[126:127] op_sel:[0,1] op_sel_hi:[1,1]
  v_pk_mul_f32 v[54:55], v[54:55], v[126:127] op_sel:[0,1] op_sel_hi:[1,1]
  v_cvt_pk_bf16_f32 v104, v52, v53
  v_cvt_pk_bf16_f32 v105, v54, v55
  v_pk_fma_f32 v[56:57], v[120:121], v[126:127], v[56:57] op_sel_hi:[1,0,1]
  v_pk_fma_f32 v[58:59], v[122:123], v[126:127], v[58:59] op_sel_hi:[1,0,1]
  v_pk_mul_f32 v[56:57], v[56:57], v[126:127] op_sel:[0,1] op_sel_hi:[1,1]
  v_pk_mul_f32 v[58:59], v[58:59], v[126:127] op_sel:[0,1] op_sel_hi:[1,1]
  v_cvt_pk_bf16_f32 v106, v56, v57
  v_cvt_pk_bf16_f32 v107, v58, v59
  buffer_store_dwordx4 v[104:107], v8, s[4:7], s57 offen offset:2304 sc1
  s_mov_b32 s57, 0x20000000
  s_mov_b32 s58, 0x20000000
  s_mov_b32 s59, 0x20000000
  s_mov_b32 s60, 0x20000000
  s_waitcnt vmcnt(8)
  s_branch L_qk_entry1
L_nonext_5127:
  s_xor_b32 s95, s95, 1024
  s_mov_b32 m0, s95
  v_xor_b32 v171, 1024, v171
  buffer_load_dword v4, s[4:7], s48 offen sc1 lds
  v_pk_fma_f32 v[28:29], v[108:109], v[124:125], v[28:29] op_sel_hi:[1,0,1]
  v_pk_fma_f32 v[30:31], v[110:111], v[124:125], v[30:31] op_sel_hi:[1,0,1]
  v_pk_mul_f32 v[28:29], v[28:29], v[124:125] op_sel:[0,1] op_sel_hi:[1,1]
  v_pk_mul_f32 v[30:31], v[30:31], v[124:125] op_sel:[0,1] op_sel_hi:[1,1]
  v_cvt_pk_bf16_f32 v92, v28, v29
  v_cvt_pk_bf16_f32 v93, v30, v31
  v_pk_fma_f32 v[32:33], v[112:113], v[124:125], v[32:33] op_sel_hi:[1,0,1]
  v_pk_fma_f32 v[34:35], v[114:115], v[124:125], v[34:35] op_sel_hi:[1,0,1]
  v_pk_mul_f32 v[32:33], v[32:33], v[124:125] op_sel:[0,1] op_sel_hi:[1,1]
  v_pk_mul_f32 v[34:35], v[34:35], v[124:125] op_sel:[0,1] op_sel_hi:[1,1]
  v_cvt_pk_bf16_f32 v94, v32, v33
  v_cvt_pk_bf16_f32 v95, v34, v35
  buffer_store_dwordx4 v[92:95], v8, s[4:7], s57 offen offset:0 sc1
  v_pk_fma_f32 v[44:45], v[108:109], v[126:127], v[44:45] op_sel_hi:[1,0,1]
  v_pk_fma_f32 v[46:47], v[110:111], v[126:127], v[46:47] op_sel_hi:[1,0,1]
  v_pk_mul_f32 v[44:45], v[44:45], v[126:127] op_sel:[0,1] op_sel_hi:[1,1]
  v_pk_mul_f32 v[46:47], v[46:47], v[126:127] op_sel:[0,1] op_sel_hi:[1,1]
  v_cvt_pk_bf16_f32 v96, v44, v45
  v_cvt_pk_bf16_f32 v97, v46, v47
  v_pk_fma_f32 v[48:49], v[112:113], v[126:127], v[48:49] op_sel_hi:[1,0,1]
  v_pk_fma_f32 v[50:51], v[114:115], v[126:127], v[50:51] op_sel_hi:[1,0,1]
  v_pk_mul_f32 v[48:49], v[48:49], v[126:127] op_sel:[0,1] op_sel_hi:[1,1]
  v_pk_mul_f32 v[50:51], v[50:51], v[126:127] op_sel:[0,1] op_sel_hi:[1,1]
  v_cvt_pk_bf16_f32 v98, v48, v49
  v_cvt_pk_bf16_f32 v99, v50, v51
  buffer_store_dwordx4 v[96:99], v8, s[4:7], s57 offen offset:256 sc1
  v_pk_fma_f32 v[36:37], v[116:117], v[124:125], v[36:37] op_sel_hi:[1,0,1]
  v_pk_fma_f32 v[38:39], v[118:119], v[124:125], v[38:39] op_sel_hi:[1,0,1]
  v_pk_mul_f32 v[36:37], v[36:37], v[124:125] op_sel:[0,1] op_sel_hi:[1,1]
  v_pk_mul_f32 v[38:39], v[38:39], v[124:125] op_sel:[0,1] op_sel_hi:[1,1]
  v_cvt_pk_bf16_f32 v100, v36, v37
  v_cvt_pk_bf16_f32 v101, v38, v39
  v_pk_fma_f32 v[40:41], v[120:121], v[124:125], v[40:41] op_sel_hi:[1,0,1]
  v_pk_fma_f32 v[42:43], v[122:123], v[124:125], v[42:43] op_sel_hi:[1,0,1]
  v_pk_mul_f32 v[40:41], v[40:41], v[124:125] op_sel:[0,1] op_sel_hi:[1,1]
  v_pk_mul_f32 v[42:43], v[42:43], v[124:125] op_sel:[0,1] op_sel_hi:[1,1]
  v_cvt_pk_bf16_f32 v102, v40, v41
  v_cvt_pk_bf16_f32 v103, v42, v43
  buffer_store_dwordx4 v[100:103], v8, s[4:7], s57 offen offset:2048 sc1
  v_pk_fma_f32 v[52:53], v[116:117], v[126:127], v[52:53] op_sel_hi:[1,0,1]
  v_pk_fma_f32 v[54:55], v[118:119], v[126:127], v[54:55] op_sel_hi:[1,0,1]
  v_pk_mul_f32 v[52:53], v[52:53], v[126:127] op_sel:[0,1] op_sel_hi:[1,1]
  v_pk_mul_f32 v[54:55], v[54:55], v[126:127] op_sel:[0,1] op_sel_hi:[1,1]
  v_cvt_pk_bf16_f32 v104, v52, v53
  v_cvt_pk_bf16_f32 v105, v54, v55
  v_pk_fma_f32 v[56:57], v[120:121], v[126:127], v[56:57] op_sel_hi:[1,0,1]
  v_pk_fma_f32 v[58:59], v[122:123], v[126:127], v[58:59] op_sel_hi:[1,0,1]
  v_pk_mul_f32 v[56:57], v[56:57], v[126:127] op_sel:[0,1] op_sel_hi:[1,1]
  v_pk_mul_f32 v[58:59], v[58:59], v[126:127] op_sel:[0,1] op_sel_hi:[1,1]
  v_cvt_pk_bf16_f32 v106, v56, v57
  v_cvt_pk_bf16_f32 v107, v58, v59
  buffer_store_dwordx4 v[104:107], v8, s[4:7], s57 offen offset:2304 sc1
  s_mov_b32 s47, s64
  s_cmp_eq_u32 s42, s80
  s_cbranch_scc1 L_qk_fin0
  s_waitcnt vmcnt(4)
  s_barrier
  ds_read_b32 v5, v171
  s_waitcnt lgkmcnt(0)
  v_cmp_ge_i32 vcc, s46, v5
  s_cmp_eq_u32 s45, 0
  s_cselect_b32 s51, vcc_lo, vcc_hi
  s_cmp_lg_u32 s51, 0
  s_cbranch_scc1 L_qk_drain0
  s_add_u32 m0, s50, 0
  s_add_u32 s51, s47, 0
  buffer_load_dwordx4 v1, s[4:7], s51 offen sc1 lds
  s_add_u32 m0, s50, 4096
  s_add_u32 s51, s47, 4096
  buffer_load_dwordx4 v1, s[4:7], s51 offen sc1 lds
  s_add_u32 m0, s50, 8192
  s_add_u32 s51, s47, 8192
  buffer_load_dwordx4 v1, s[4:7], s51 offen sc1 lds
  s_add_u32 m0, s50, 12288
  s_add_u32 s51, s47, 12288
  buffer_load_dwordx4 v1, s[4:7], s51 offen sc1 lds
  s_add_u32 m0, s50, 16384
  s_add_u32 s51, s47, 16384
  buffer_load_dwordx4 v1, s[4:7], s51 offen sc1 lds
  s_add_u32 m0, s50, 20480
  s_add_u32 s51, s47, 20480
  buffer_load_dwordx4 v1, s[4:7], s51 offen sc1 lds
  s_add_u32 m0, s50, 24576
  s_add_u32 s51, s47, 24576
  buffer_load_dwordx4 v1, s[4:7], s51 offen sc1 lds
  s_add_u32 m0, s50, 28672
  s_add_u32 s51, s47, 28672
  buffer_load_dwordx4 v1, s[4:7], s51 offen sc1 lds
  s_add_u32 m0, s50, 32768
  s_add_u32 s51, s47, 32768
  buffer_load_dwordx4 v1, s[4:7], s51 offen sc1 lds
  s_add_u32 m0, s50, 36864
  s_add_u32 s51, s47, 36864
  buffer_load_dwordx4 v1, s[4:7], s51 offen sc1 lds
  s_add_u32 m0, s50, 40960
  s_add_u32 s51, s47, 40960
  buffer_load_dwordx4 v9, s[4:7], s51 offen sc1 lds
  s_waitcnt vmcnt(11)
  s_barrier
  v_mov_b32 v7, s62
  buffer_store_dword v7, v0, s[4:7], s61 offen offset:0 sc1
  s_mov_b32 s57, 0x20000000
  s_mov_b32 s58, 0x20000000
  s_mov_b32 s59, 0x20000000
  s_mov_b32 s60, 0x20000000
  s_mov_b32 s61, 0x20000000
  s_waitcnt vmcnt(5)
  s_branch L_qk_entry1
L_qk_drain0:
  s_waitcnt vmcnt(0)
  s_barrier
  v_mov_b32 v7, s62
  buffer_store_dword v7, v0, s[4:7], s61 offen offset:0 sc1
  s_mov_b32 s57, 0x20000000
  s_mov_b32 s58, 0x20000000
  s_mov_b32 s59, 0x20000000
  s_mov_b32 s60, 0x20000000
  s_mov_b32 s61, 0x20000000
L_qk_spin0:
  s_sleep 1
  s_xor_b32 s95, s95, 1024
  s_mov_b32 m0, s95
  v_xor_b32 v171, 1024, v171
  buffer_load_dword v4, s[4:7], s48 offen sc1 lds
  s_add_u32 s94, s94, 1
  s_cmp_lt_u32 s94, 100000
  s_cselect_b32 s52, s46, -2
  s_waitcnt vmcnt(0)
  s_barrier
  ds_read_b32 v5, v171
  s_waitcnt lgkmcnt(0)
  v_cmp_ge_i32 vcc, s52, v5
  s_cmp_eq_u32 s45, 0
  s_cselect_b32 s51, vcc_lo, vcc_hi
  s_cmp_lg_u32 s51, 0
  s_cbranch_scc1 L_qk_spin0
  s_add_u32 m0, s50, 0
  s_add_u32 s51, s47, 0
  buffer_load_dwordx4 v1, s[4:7], s51 offen sc1 lds
  s_add_u32 m0, s50, 4096
  s_add_u32 s51, s47, 4096
  buffer_load_dwordx4 v1, s[4:7], s51 offen sc1 lds
  s_add_u32 m0, s50, 8192
  s_add_u32 s51, s47, 8192
  buffer_load_dwordx4 v1, s[4:7], s51 offen sc1 lds
  s_add_u32 m0, s50, 12288
  s_add_u32 s51, s47, 12288
  buffer_load_dwordx4 v1, s[4:7], s51 offen sc1 lds
  s_add_u32 m0, s50, 16384
  s_add_u32 s51, s47, 16384
  buffer_load_dwordx4 v1, s[4:7], s51 offen sc1 lds
  s_add_u32 m0, s50, 20480
  s_add_u32 s51, s47, 20480
  buffer_load_dwordx4 v1, s[4:7], s51 offen sc1 lds
  s_add_u32 m0, s50, 24576
  s_add_u32 s51, s47, 24576
  buffer_load_dwordx4 v1, s[4:7], s51 offen sc1 lds
  s_add_u32 m0, s50, 28672
  s_add_u32 s51, s47, 28672
  buffer_load_dwordx4 v1, s[4:7], s51 offen sc1 lds
  s_add_u32 m0, s50, 32768
  s_add_u32 s51, s47, 32768
  buffer_load_dwordx4 v1, s[4:7], s51 offen sc1 lds
  s_add_u32 m0, s50, 36864
  s_add_u32 s51, s47, 36864
  buffer_load_dwordx4 v1, s[4:7], s51 offen sc1 lds
  s_add_u32 m0, s50, 40960
  s_add_u32 s51, s47, 40960
  buffer_load_dwordx4 v9, s[4:7], s51 offen sc1 lds
  s_waitcnt vmcnt(4)
  s_branch L_qk_entry1
L_qk_fin0:
  s_waitcnt vmcnt(0)
  s_barrier
  v_mov_b32 v7, s62
  buffer_store_dword v7, v0, s[4:7], s61 offen offset:0 sc1
  s_cmp_lg_u32 s100, 0
  s_cbranch_scc1 L_helper_done
  s_endpgm
L_qk_entry1:
  s_barrier
  ds_read_b128 v[12:15], v2 offset:0
  ds_read_b128 v[16:19], v2 offset:256
  ds_read_b128 v[20:23], v2 offset:2048
  s_branch L_qk_body1
L_qk_slow1:
  v_mfma_f32_16x16x32_bf16 v[88:91], v[236:239], v[16:19], v[88:91]
  s_waitcnt lgkmcnt(0)
  v_mfma_f32_16x16x32_bf16 v[60:63], v[240:243], v[20:23], v[60:63]
  v_mfma_f32_16x16x32_bf16 v[64:67], v[244:247], v[20:23], v[64:67]
  v_mfma_f32_16x16x32_bf16 v[68:71], v[248:251], v[20:23], v[68:71]
  v_mfma_f32_16x16x32_bf16 v[72:75], v[252:255], v[20:23], v[72:75]
  v_mfma_f32_16x16x32_bf16 v[76:79], v[240:243], v[24:27], v[76:79]
  v_mfma_f32_16x16x32_bf16 v[80:83], v[244:247], v[24:27], v[80:83]
  v_mfma_f32_16x16x32_bf16 v[84:87], v[248:251], v[24:27], v[84:87]
  v_mfma_f32_16x16x32_bf16 v[88:91], v[252:255], v[24:27], v[88:91]
  s_mov_b32 s47, s64
  s_cmp_eq_u32 s42, s80
  s_cbranch_scc1 L_nonext_5128
  s_waitcnt vmcnt(0)
  s_barrier
  ds_read_b32 v5, v171
  s_waitcnt lgkmcnt(0)
  v_cmp_ge_i32 vcc, s46, v5
  s_cmp_eq_u32 s45, 0
  s_cselect_b32 s51, vcc_lo, vcc_hi
  s_cmp_lg_u32 s51, 0
  s_cbranch_scc1 L_nonext_5128
  s_add_u32 m0, s50, 0
  s_add_u32 s51, s47, 0
  buffer_load_dwordx4 v1, s[4:7], s51 offen sc1 lds
  s_add_u32 m0, s50, 4096
  s_add_u32 s51, s47, 4096
  buffer_load_dwordx4 v1, s[4:7], s51 offen sc1 lds
  s_add_u32 m0, s50, 8192
  s_add_u32 s51, s47, 8192
  buffer_load_dwordx4 v1, s[4:7], s51 offen sc1 lds
  s_add_u32 m0, s50, 12288
  s_add_u32 s51, s47, 12288
  buffer_load_dwordx4 v1, s[4:7], s51 offen sc1 lds
  s_add_u32 m0, s50, 16384
  s_add_u32 s51, s47, 16384
  buffer_load_dwordx4 v1, s[4:7], s51 offen sc1 lds
  s_add_u32 m0, s50, 20480
  s_add_u32 s51, s47, 20480
  buffer_load_dwordx4 v1, s[4:7], s51 offen sc1 lds
  s_add_u32 m0, s50, 24576
  s_add_u32 s51, s47, 24576
  buffer_load_dwordx4 v1, s[4:7], s51 offen sc1 lds
  s_add_u32 m0, s50, 28672
  s_add_u32 s51, s47, 28672
  buffer_load_dwordx4 v1, s[4:7], s51 offen sc1 lds
  s_add_u32 m0, s50, 32768
  s_add_u32 s51, s47, 32768
  buffer_load_dwordx4 v1, s[4:7], s51 offen sc1 lds
  s_add_u32 m0, s50, 36864
  s_add_u32 s51, s47, 36864
  buffer_load_dwordx4 v1, s[4:7], s51 offen sc1 lds
  s_add_u32 m0, s50, 40960
  s_add_u32 s51, s47, 40960
  buffer_load_dwordx4 v9, s[4:7], s51 offen sc1 lds
  v_pk_fma_f32 v[60:61], v[108:109], v[124:125], v[60:61] op_sel_hi:[1,0,1]
  v_pk_fma_f32 v[62:63], v[110:111], v[124:125], v[62:63] op_sel_hi:[1,0,1]
  v_pk_mul_f32 v[60:61], v[60:61], v[124:125] op_sel:[0,1] op_sel_hi:[1,1]
  v_pk_mul_f32 v[62:63], v[62:63], v[124:125] op_sel:[0,1] op_sel_hi:[1,1]
  v_cvt_pk_bf16_f32 v92, v60, v61
  v_cvt_pk_bf16_f32 v93, v62, v63
  v_pk_fma_f32 v[64:65], v[112:113], v[124:125], v[64:65] op_sel_hi:[1,0,1]
  v_pk_fma_f32 v[66:67], v[114:115], v[124:125], v[66:67] op_sel_hi:[1,0,1]
  v_pk_mul_f32 v[64:65], v[64:65], v[124:125] op_sel:[0,1] op_sel_hi:[1,1]
  v_pk_mul_f32 v[66:67], v[66:67], v[124:125] op_sel:[0,1] op_sel_hi:[1,1]
  v_cvt_pk_bf16_f32 v94, v64, v65
  v_cvt_pk_bf16_f32 v95, v66, v67
  buffer_store_dwordx4 v[92:95], v8, s[4:7], s57 offen offset:0 sc1
  v_pk_fma_f32 v[76:77], v[108:109], v[126:127], v[76:77] op_sel_hi:[1,0,1]
  v_pk_fma_f32 v[78:79], v[110:111], v[126:127], v[78:79] op_sel_hi:[1,0,1]
  v_pk_mul_f32 v[76:77], v[76:77], v[126:127] op_sel:[0,1] op_sel_hi:[1,1]
  v_pk_mul_f32 v[78:79], v[78:79], v[126:127] op_sel:[0,1] op_sel_hi:[1,1]
  v_cvt_pk_bf16_f32 v96, v76, v77
  v_cvt_pk_bf16_f32 v97, v78, v79
  v_pk_fma_f32 v[80:81], v[112:113], v[126:127], v[80:81] op_sel_hi:[1,0,1]
  v_pk_fma_f32 v[82:83], v[114:115], v[126:127], v[82:83] op_sel_hi:[1,0,1]
  v_pk_mul_f32 v[80:81], v[80:81], v[126:127] op_sel:[0,1] op_sel_hi:[1,1]
  v_pk_mul_f32 v[82:83], v[82:83], v[126:127] op_sel:[0,1] op_sel_hi:[1,1]
  v_cvt_pk_bf16_f32 v98, v80, v81
  v_cvt_pk_bf16_f32 v99, v82, v83
  buffer_store_dwordx4 v[96:99], v8, s[4:7], s57 offen offset:256 sc1
  v_pk_fma_f32 v[68:69], v[116:117], v[124:125], v[68:69] op_sel_hi:[1,0,1]
  v_pk_fma_f32 v[70:71], v[118:119], v[124:125], v[70:71] op_sel_hi:[1,0,1]
  v_pk_mul_f32 v[68:69], v[68:69], v[124:125] op_sel:[0,1] op_sel_hi:[1,1]
  v_pk_mul_f32 v[70:71], v[70:71], v[124:125] op_sel:[0,1] op_sel_hi:[1,1]
  v_cvt_pk_bf16_f32 v100, v68, v69
  v_cvt_pk_bf16_f32 v101, v70, v71
  v_pk_fma_f32 v[72:73], v[120:121], v[124:125], v[72:73] op_sel_hi:[1,0,1]
  v_pk_fma_f32 v[74:75], v[122:123], v[124:125], v[74:75] op_sel_hi:[1,0,1]
  v_pk_mul_f32 v[72:73], v[72:73], v[124:125] op_sel:[0,1] op_sel_hi:[1,1]
  v_pk_mul_f32 v[74:75], v[74:75], v[124:125] op_sel:[0,1] op_sel_hi:[1,1]
  v_cvt_pk_bf16_f32 v102, v72, v73
  v_cvt_pk_bf16_f32 v103, v74, v75
  buffer_store_dwordx4 v[100:103], v8, s[4:7], s57 offen offset:2048 sc1
  v_pk_fma_f32 v[84:85], v[116:117], v[126:127], v[84:85] op_sel_hi:[1,0,1]
  v_pk_fma_f32 v[86:87], v[118:119], v[126:127], v[86:87] op_sel_hi:[1,0,1]
  v_pk_mul_f32 v[84:85], v[84:85], v[126:127] op_sel:[0,1] op_sel_hi:[1,1]
  v_pk_mul_f32 v[86:87], v[86:87], v[126:127] op_sel:[0,1] op_sel_hi:[1,1]
  v_cvt_pk_bf16_f32 v104, v84, v85
  v_cvt_pk_bf16_f32 v105, v86, v87
  v_pk_fma_f32 v[88:89], v[120:121], v[126:127], v[88:89] op_sel_hi:[1,0,1]
  v_pk_fma_f32 v[90:91], v[122:123], v[126:127], v[90:91] op_sel_hi:[1,0,1]
  v_pk_mul_f32 v[88:89], v[88:89], v[126:127] op_sel:[0,1] op_sel_hi:[1,1]
  v_pk_mul_f32 v[90:91], v[90:91], v[126:127] op_sel:[0,1] op_sel_hi:[1,1]
  v_cvt_pk_bf16_f32 v106, v88, v89
  v_cvt_pk_bf16_f32 v107, v90, v91
  buffer_store_dwordx4 v[104:107], v8, s[4:7], s57 offen offset:2304 sc1
  s_mov_b32 s57, 0x20000000
  s_mov_b32 s58, 0x20000000
  s_mov_b32 s59, 0x20000000
  s_mov_b32 s60, 0x20000000
  s_waitcnt vmcnt(8)
  s_branch L_qk_entry0
L_nonext_5128:
  s_xor_b32 s95, s95, 1024
  s_mov_b32 m0, s95
  v_xor_b32 v171, 1024, v171
  buffer_load_dword v4, s[4:7], s48 offen sc1 lds
  v_pk_fma_f32 v[60:61], v[108:109], v[124:125], v[60:61] op_sel_hi:[1,0,1]
  v_pk_fma_f32 v[62:63], v[110:111], v[124:125], v[62:63] op_sel_hi:[1,0,1]
  v_pk_mul_f32 v[60:61], v[60:61], v[124:125] op_sel:[0,1] op_sel_hi:[1,1]
  v_pk_mul_f32 v[62:63], v[62:63], v[124:125] op_sel:[0,1] op_sel_hi:[1,1]
  v_cvt_pk_bf16_f32 v92, v60, v61
  v_cvt_pk_bf16_f32 v93, v62, v63
  v_pk_fma_f32 v[64:65], v[112:113], v[124:125], v[64:65] op_sel_hi:[1,0,1]
  v_pk_fma_f32 v[66:67], v[114:115], v[124:125], v[66:67] op_sel_hi:[1,0,1]
  v_pk_mul_f32 v[64:65], v[64:65], v[124:125] op_sel:[0,1] op_sel_hi:[1,1]
  v_pk_mul_f32 v[66:67], v[66:67], v[124:125] op_sel:[0,1] op_sel_hi:[1,1]
  v_cvt_pk_bf16_f32 v94, v64, v65
  v_cvt_pk_bf16_f32 v95, v66, v67
  buffer_store_dwordx4 v[92:95], v8, s[4:7], s57 offen offset:0 sc1
  v_pk_fma_f32 v[76:77], v[108:109], v[126:127], v[76:77] op_sel_hi:[1,0,1]
  v_pk_fma_f32 v[78:79], v[110:111], v[126:127], v[78:79] op_sel_hi:[1,0,1]
  v_pk_mul_f32 v[76:77], v[76:77], v[126:127] op_sel:[0,1] op_sel_hi:[1,1]
  v_pk_mul_f32 v[78:79], v[78:79], v[126:127] op_sel:[0,1] op_sel_hi:[1,1]
  v_cvt_pk_bf16_f32 v96, v76, v77
  v_cvt_pk_bf16_f32 v97, v78, v79
  v_pk_fma_f32 v[80:81], v[112:113], v[126:127], v[80:81] op_sel_hi:[1,0,1]
  v_pk_fma_f32 v[82:83], v[114:115], v[126:127], v[82:83] op_sel_hi:[1,0,1]
  v_pk_mul_f32 v[80:81], v[80:81], v[126:127] op_sel:[0,1] op_sel_hi:[1,1]
  v_pk_mul_f32 v[82:83], v[82:83], v[126:127] op_sel:[0,1] op_sel_hi:[1,1]
  v_cvt_pk_bf16_f32 v98, v80, v81
  v_cvt_pk_bf16_f32 v99, v82, v83
  buffer_store_dwordx4 v[96:99], v8, s[4:7], s57 offen offset:256 sc1
  v_pk_fma_f32 v[68:69], v[116:117], v[124:125], v[68:69] op_sel_hi:[1,0,1]
  v_pk_fma_f32 v[70:71], v[118:119], v[124:125], v[70:71] op_sel_hi:[1,0,1]
  v_pk_mul_f32 v[68:69], v[68:69], v[124:125] op_sel:[0,1] op_sel_hi:[1,1]
  v_pk_mul_f32 v[70:71], v[70:71], v[124:125] op_sel:[0,1] op_sel_hi:[1,1]
  v_cvt_pk_bf16_f32 v100, v68, v69
  v_cvt_pk_bf16_f32 v101, v70, v71
  v_pk_fma_f32 v[72:73], v[120:121], v[124:125], v[72:73] op_sel_hi:[1,0,1]
  v_pk_fma_f32 v[74:75], v[122:123], v[124:125], v[74:75] op_sel_hi:[1,0,1]
  v_pk_mul_f32 v[72:73], v[72:73], v[124:125] op_sel:[0,1] op_sel_hi:[1,1]
  v_pk_mul_f32 v[74:75], v[74:75], v[124:125] op_sel:[0,1] op_sel_hi:[1,1]
  v_cvt_pk_bf16_f32 v102, v72, v73
  v_cvt_pk_bf16_f32 v103, v74, v75
  buffer_store_dwordx4 v[100:103], v8, s[4:7], s57 offen offset:2048 sc1
  v_pk_fma_f32 v[84:85], v[116:117], v[126:127], v[84:85] op_sel_hi:[1,0,1]
  v_pk_fma_f32 v[86:87], v[118:119], v[126:127], v[86:87] op_sel_hi:[1,0,1]
  v_pk_mul_f32 v[84:85], v[84:85], v[126:127] op_sel:[0,1] op_sel_hi:[1,1]
  v_pk_mul_f32 v[86:87], v[86:87], v[126:127] op_sel:[0,1] op_sel_hi:[1,1]
  v_cvt_pk_bf16_f32 v104, v84, v85
  v_cvt_pk_bf16_f32 v105, v86, v87
  v_pk_fma_f32 v[88:89], v[120:121], v[126:127], v[88:89] op_sel_hi:[1,0,1]
  v_pk_fma_f32 v[90:91], v[122:123], v[126:127], v[90:91] op_sel_hi:[1,0,1]
  v_pk_mul_f32 v[88:89], v[88:89], v[126:127] op_sel:[0,1] op_sel_hi:[1,1]
  v_pk_mul_f32 v[90:91], v[90:91], v[126:127] op_sel:[0,1] op_sel_hi:[1,1]
  v_cvt_pk_bf16_f32 v106, v88, v89
  v_cvt_pk_bf16_f32 v107, v90, v91
  buffer_store_dwordx4 v[104:107], v8, s[4:7], s57 offen offset:2304 sc1
  s_mov_b32 s47, s64
  s_cmp_eq_u32 s42, s80
  s_cbranch_scc1 L_qk_fin1
  s_waitcnt vmcnt(4)
  s_barrier
  ds_read_b32 v5, v171
  s_waitcnt lgkmcnt(0)
  v_cmp_ge_i32 vcc, s46, v5
  s_cmp_eq_u32 s45, 0
  s_cselect_b32 s51, vcc_lo, vcc_hi
  s_cmp_lg_u32 s51, 0
  s_cbranch_scc1 L_qk_drain1
  s_add_u32 m0, s50, 0
  s_add_u32 s51, s47, 0
  buffer_load_dwordx4 v1, s[4:7], s51 offen sc1 lds
  s_add_u32 m0, s50, 4096
  s_add_u32 s51, s47, 4096
  buffer_load_dwordx4 v1, s[4:7], s51 offen sc1 lds
  s_add_u32 m0, s50, 8192
  s_add_u32 s51, s47, 8192
  buffer_load_dwordx4 v1, s[4:7], s51 offen sc1 lds
  s_add_u32 m0, s50, 12288
  s_add_u32 s51, s47, 12288
  buffer_load_dwordx4 v1, s[4:7], s51 offen sc1 lds
  s_add_u32 m0, s50, 16384
  s_add_u32 s51, s47, 16384
  buffer_load_dwordx4 v1, s[4:7], s51 offen sc1 lds
  s_add_u32 m0, s50, 20480
  s_add_u32 s51, s47, 20480
  buffer_load_dwordx4 v1, s[4:7], s51 offen sc1 lds
  s_add_u32 m0, s50, 24576
  s_add_u32 s51, s47, 24576
  buffer_load_dwordx4 v1, s[4:7], s51 offen sc1 lds
  s_add_u32 m0, s50, 28672
  s_add_u32 s51, s47, 28672
  buffer_load_dwordx4 v1, s[4:7], s51 offen sc1 lds
  s_add_u32 m0, s50, 32768
  s_add_u32 s51, s47, 32768
  buffer_load_dwordx4 v1, s[4:7], s51 offen sc1 lds
  s_add_u32 m0, s50, 36864
  s_add_u32 s51, s47, 36864
  buffer_load_dwordx4 v1, s[4:7], s51 offen sc1 lds
  s_add_u32 m0, s50, 40960
  s_add_u32 s51, s47, 40960
  buffer_load_dwordx4 v9, s[4:7], s51 offen sc1 lds
  s_waitcnt vmcnt(11)
  s_barrier
  v_mov_b32 v7, s62
  buffer_store_dword v7, v0, s[4:7], s61 offen offset:0 sc1
  s_mov_b32 s57, 0x20000000
  s_mov_b32 s58, 0x20000000
  s_mov_b32 s59, 0x20000000
  s_mov_b32 s60, 0x20000000
  s_mov_b32 s61, 0x20000000
  s_waitcnt vmcnt(5)
  s_branch L_qk_entry0
L_qk_drain1:
  s_waitcnt vmcnt(0)
  s_barrier
  v_mov_b32 v7, s62
  buffer_store_dword v7, v0, s[4:7], s61 offen offset:0 sc1
  s_mov_b32 s57, 0x20000000
  s_mov_b32 s58, 0x20000000
  s_mov_b32 s59, 0x20000000
  s_mov_b32 s60, 0x20000000
  s_mov_b32 s61, 0x20000000
L_qk_spin1:
  s_sleep 1
  s_xor_b32 s95, s95, 1024
  s_mov_b32 m0, s95
  v_xor_b32 v171, 1024, v171
  buffer_load_dword v4, s[4:7], s48 offen sc1 lds
  s_add_u32 s94, s94, 1
  s_cmp_lt_u32 s94, 100000
  s_cselect_b32 s52, s46, -2
  s_waitcnt vmcnt(0)
  s_barrier
  ds_read_b32 v5, v171
  s_waitcnt lgkmcnt(0)
  v_cmp_ge_i32 vcc, s52, v5
  s_cmp_eq_u32 s45, 0
  s_cselect_b32 s51, vcc_lo, vcc_hi
  s_cmp_lg_u32 s51, 0
  s_cbranch_scc1 L_qk_spin1
  s_add_u32 m0, s50, 0
  s_add_u32 s51, s47, 0
  buffer_load_dwordx4 v1, s[4:7], s51 offen sc1 lds
  s_add_u32 m0, s50, 4096
  s_add_u32 s51, s47, 4096
  buffer_load_dwordx4 v1, s[4:7], s51 offen sc1 lds
  s_add_u32 m0, s50, 8192
  s_add_u32 s51, s47, 8192
  buffer_load_dwordx4 v1, s[4:7], s51 offen sc1 lds
  s_add_u32 m0, s50, 12288
  s_add_u32 s51, s47, 12288
  buffer_load_dwordx4 v1, s[4:7], s51 offen sc1 lds
  s_add_u32 m0, s50, 16384
  s_add_u32 s51, s47, 16384
  buffer_load_dwordx4 v1, s[4:7], s51 offen sc1 lds
  s_add_u32 m0, s50, 20480
  s_add_u32 s51, s47, 20480
  buffer_load_dwordx4 v1, s[4:7], s51 offen sc1 lds
  s_add_u32 m0, s50, 24576
  s_add_u32 s51, s47, 24576
  buffer_load_dwordx4 v1, s[4:7], s51 offen sc1 lds
  s_add_u32 m0, s50, 28672
  s_add_u32 s51, s47, 28672
  buffer_load_dwordx4 v1, s[4:7], s51 offen sc1 lds
  s_add_u32 m0, s50, 32768
  s_add_u32 s51, s47, 32768
  buffer_load_dwordx4 v1, s[4:7], s51 offen sc1 lds
  s_add_u32 m0, s50, 36864
  s_add_u32 s51, s47, 36864
  buffer_load_dwordx4 v1, s[4:7], s51 offen sc1 lds
  s_add_u32 m0, s50, 40960
  s_add_u32 s51, s47, 40960
  buffer_load_dwordx4 v9, s[4:7], s51 offen sc1 lds
  s_waitcnt vmcnt(4)
  s_branch L_qk_entry0
L_qk_fin1:
  s_waitcnt vmcnt(0)
  s_barrier
  v_mov_b32 v7, s62
  buffer_store_dword v7, v0, s[4:7], s61 offen offset:0 sc1
  s_cmp_lg_u32 s100, 0
  s_cbranch_scc1 L_helper_done
  s_endpgm
L_qkv_v:
  v_and_b32 v3, 3, v0
  v_lshrrev_b32 v6, 4, v0
  v_lshl_add_u32 v3, v6, 2, v3
  v_lshlrev_b32 v3, 4, v3
  v_add_u32 v3, 40960, v3
  s_mov_b32 s15, s93
  s_and_b32 s3, s92, 0xffff
  s_cmp_lt_u32 s3, 48
  s_cbranch_scc1 L_rslow_127
  s_and_b32 s3, s15, 0xffff
  s_cmp_ge_u32 s3, 32
  s_cbranch_scc1 L_rfast_128
L_rslow_127:
  v_mov_b32 v6, 8
L_rdy_129:
  global_load_dword v7, v6, s[38:39] sc1
  s_waitcnt vmcnt(0)
  v_readfirstlane_b32 s15, v7
  s_and_b32 s3, s15, 0xffff
  s_cmp_ge_u32 s3, 48
  s_cbranch_scc1 L_rdyd_130
  s_sleep 8
  s_add_u32 s14, s14, 1
  s_cmp_lt_u32 s14, 100000
  s_cbranch_scc1 L_rdy_129
L_rdyd_130:
  v_mov_b32 v6, 12
  global_load_dword v6, v6, s[38:39] sc1
  s_waitcnt vmcnt(0)
  v_readfirstlane_b32 s2, v6
  s_lshr_b32 s15, s13, 5
  s_mul_i32 s3, s15, 65
  s_and_b32 s3, s3, 0xc4
  v_mov_b32 v6, s3
L_rdy_131:
  global_load_dword v7, v6, s[38:39] sc1
  s_waitcnt vmcnt(0)
  v_readfirstlane_b32 s15, v7
  s_and_b32 s3, s15, 0xffff
  s_cmp_ge_u32 s3, 32
  s_cbranch_scc1 L_rdyd_132
  s_sleep 8
  s_add_u32 s14, s14, 1
  s_cmp_lt_u32 s14, 100000
  s_cbranch_scc1 L_rdy_131
L_rdyd_132:
L_rfast_128:
  s_lshr_b32 s15, s15, 16
  s_and_b32 s2, s2, 3
  s_mul_i32 s2, s2, 0x2001
  s_xor_b32 s2, s2, 0x2000
  s_lshr_b32 s51, s13, 5
  s_mov_b64 vcc, 0
  s_cmp_eq_u32 s51, 6
  s_cselect_b32 vcc_lo, 0xffffffff, vcc_lo
  s_cselect_b32 vcc_hi, 0x0, vcc_hi
  s_cmp_eq_u32 s51, 7
  s_cselect_b32 vcc_lo, 0x0, vcc_lo
  s_cselect_b32 vcc_hi, 0xffffffff, vcc_hi
  s_cmp_eq_u32 s15, 0
  s_cselect_b32 s51, 128, 0
  v_mov_b32 v6, s51
  v_cndmask_b32 v6, 0, v6, vcc
  v_add_u32 v4, v4, v6
  s_and_b32 s51, s2, 0x2000
  s_add_u32 s53, s53, s51
  s_cmp_eq_u32 s66, 0
  s_cselect_b32 s51, 0x2000, 0
  s_xor_b32 s53, s53, s51
  s_lshl_b32 s51, s12, 6
  s_sub_u32 s51, 80, s51
  v_mov_b32 v9, 0x10000000
  v_cmp_gt_i32 vcc, s51, v0
  s_nop 1
  v_cndmask_b32 v9, v9, v1, vcc
  v_lshlrev_b32 v171, 2, v0
  v_add_u32 v171, 155648, v171
  s_lshl_b32 s95, s12, 8
  s_add_u32 s95, s95, 155648
  v_or_b32 v0, s12, v0
  v_lshlrev_b32 v0, 24, v0
  v_min_u32 v0, 0x1000000, v0
  v_lshlrev_b32 v0, 4, v0
  s_lshl_b32 s63, s12, 10
  s_mov_b32 s50, s63
  s_mov_b32 s42, -2
  s_mov_b32 s62, 0
  s_mov_b32 s48, 0
  s_cmp_eq_u32 s12, 0
  s_cselect_b32 s48, s48, 0x20000000
  s_mov_b32 s56, 45056
  s_mov_b32 s55, 45056
  s_mov_b32 s86, 0x6d400000
  s_mov_b32 s87, 0xdadb5b6b
  s_mov_b32 s88, 0xadb5b6b6
  s_mov_b32 s89, 0xfff6d
  s_mov_b64 s[90:91], 0
  s_mov_b32 s80, 115
  s_mov_b32 s81, 8
  s_mov_b32 s82, 20
  s_mov_b32 s43, 1
  s_mov_b32 s45, 1
  s_cmp_eq_u32 s100, 0
  s_cbranch_scc1 L_main_133
  s_mov_b64 s[86:87], 0
  s_mov_b32 s90, 8
  s_mov_b32 s80, 11
  s_mov_b32 s81, 20
  s_mov_b32 s82, 64
  s_add_u32 s54, s54, 36864
  s_mov_b32 s61, s54
  s_mov_b32 s62, 8
  s_barrier
  v_mov_b32 v7, s62
  buffer_store_dword v7, v0, s[4:7], s61 offen offset:0 sc1
L_main_133:
  s_cmp_eq_u32 s42, 62
  s_cselect_b64 s[86:87], s[88:89], s[86:87]
  s_and_b32 s83, s86, 1
  s_cselect_b32 s84, s91, s90
  s_lshr_b64 s[86:87], s[86:87], 1
  s_add_u32 s91, s91, s83
  s_xor_b32 s52, s83, 1
  s_add_u32 s90, s90, s52
  s_cmp_eq_u32 s90, 8
  s_cselect_b32 s90, 20, s90
  s_lshl_b32 s52, s43, 8
  s_add_u32 s52, s52, s62
  s_cmp_eq_u32 s52, s81
  s_cselect_b32 s62, s82, s62
  s_mov_b32 s85, 3145728
  s_mul_i32 s52, s83, 5767168
  s_add_u32 s85, s85, s52
  s_mul_i32 s52, s84, 45056
  s_add_u32 s85, s85, s52
  s_add_u32 s85, s85, s63
  s_mov_b32 s43, s45
  s_mov_b32 s44, s46
  s_mov_b32 s46, s84
  s_mov_b32 s45, s83
  s_mov_b32 s64, s85
  s_add_u32 s42, s42, 1
  s_cmp_eq_u32 s42, 62
  s_cselect_b64 s[86:87], s[88:89], s[86:87]
  s_and_b32 s83, s86, 1
  s_cselect_b32 s84, s91, s90
  s_lshr_b64 s[86:87], s[86:87], 1
  s_add_u32 s91, s91, s83
  s_xor_b32 s52, s83, 1
  s_add_u32 s90, s90, s52
  s_cmp_eq_u32 s90, 8
  s_cselect_b32 s90, 20, s90
  s_lshl_b32 s52, s43, 8
  s_add_u32 s52, s52, s62
  s_cmp_eq_u32 s52, s81
  s_cselect_b32 s62, s82, s62
  s_mov_b32 s85, 3145728
  s_mul_i32 s52, s83, 5767168
  s_add_u32 s85, s85, s52
  s_mul_i32 s52, s84, 45056
  s_add_u32 s85, s85, s52
  s_add_u32 s85, s85, s63
  s_mov_b32 s57, 0x20000000
  s_mov_b32 s58, 0x20000000
  s_mov_b32 s59, 0x20000000
  s_mov_b32 s60, 0x20000000
  s_mov_b32 s61, 0x20000000
  s_mov_b32 s47, s64
  s_mov_b32 s49, 0
  s_mov_b32 s94, 0
  s_branch L_v_spin1
L_v_body0:
  s_waitcnt lgkmcnt(2)
  v_mfma_f32_16x16x32_bf16 v[28:31], v[12:15], a[0:3], 0
  s_mov_b32 s43, s45
  ds_read_b128 v[24:27], v2 offset:2304
  ds_read_b32 v5, v171
  v_mfma_f32_16x16x32_bf16 v[32:35], v[12:15], a[4:7], 0
  s_mov_b32 s44, s46
  v_fmac_f32_dpp v60, v124, v144 quad_perm:[0,0,0,0] row_mask:0xf bank_mask:0xf
  v_fmac_f32_dpp v61, v124, v144 quad_perm:[1,1,1,1] row_mask:0xf bank_mask:0xf
  v_mfma_f32_16x16x32_bf16 v[36:39], v[12:15], a[8:11], 0
  s_mov_b32 s46, s84
  v_fmac_f32_dpp v62, v124, v144 quad_perm:[2,2,2,2] row_mask:0xf bank_mask:0xf
  v_fmac_f32_dpp v63, v124, v144 quad_perm:[3,3,3,3] row_mask:0xf bank_mask:0xf
  v_mfma_f32_16x16x32_bf16 v[40:43], v[12:15], a[12:15], 0
  s_waitcnt lgkmcnt(3)
  v_mul_f32_dpp v60, v125, v60 quad_perm:[0,0,0,0] row_mask:0xf bank_mask:0xf
  v_mul_f32_dpp v61, v125, v61 quad_perm:[1,1,1,1] row_mask:0xf bank_mask:0xf
  v_mfma_f32_16x16x32_bf16 v[44:47], v[16:19], a[0:3], 0
  s_mov_b32 s45, s83
  ds_read_b128 v[12:15], v2 offset:4096
  v_mul_f32_dpp v62, v125, v62 quad_perm:[2,2,2,2] row_mask:0xf bank_mask:0xf
  v_mfma_f32_16x16x32_bf16 v[48:51], v[16:19], a[4:7], 0
  s_mov_b32 s64, s85
  v_mul_f32_dpp v63, v125, v63 quad_perm:[3,3,3,3] row_mask:0xf bank_mask:0xf
  v_cvt_pk_bf16_f32 v92, v60, v61
  v_mfma_f32_16x16x32_bf16 v[52:55], v[16:19], a[8:11], 0
  s_add_u32 s42, s42, 1
  v_cvt_pk_bf16_f32 v93, v62, v63
  v_fmac_f32_dpp v76, v126, v144 quad_perm:[0,0,0,0] row_mask:0xf bank_mask:0xf
  v_mfma_f32_16x16x32_bf16 v[56:59], v[16:19], a[12:15], 0
  s_waitcnt lgkmcnt(3)
  v_fmac_f32_dpp v77, v126, v144 quad_perm:[1,1,1,1] row_mask:0xf bank_mask:0xf
  v_fmac_f32_dpp v78, v126, v144 quad_perm:[2,2,2,2] row_mask:0xf bank_mask:0xf
  v_mfma_f32_16x16x32_bf16 v[28:31], v[20:23], a[16:19], v[28:31]
  s_waitcnt lgkmcnt(1)
  ds_read_b128 v[16:19], v2 offset:4352
  v_fmac_f32_dpp v79, v126, v144 quad_perm:[3,3,3,3] row_mask:0xf bank_mask:0xf
  v_mfma_f32_16x16x32_bf16 v[32:35], v[20:23], a[20:23], v[32:35]
  v_mul_f32_dpp v76, v127, v76 quad_perm:[0,0,0,0] row_mask:0xf bank_mask:0xf
  v_mul_f32_dpp v77, v127, v77 quad_perm:[1,1,1,1] row_mask:0xf bank_mask:0xf
  v_mfma_f32_16x16x32_bf16 v[36:39], v[20:23], a[24:27], v[36:39]
  v_mul_f32_dpp v78, v127, v78 quad_perm:[2,2,2,2] row_mask:0xf bank_mask:0xf
  v_mul_f32_dpp v79, v127, v79 quad_perm:[3,3,3,3] row_mask:0xf bank_mask:0xf
  v_mfma_f32_16x16x32_bf16 v[40:43], v[20:23], a[28:31], v[40:43]
  v_cvt_pk_bf16_f32 v94, v76, v77
  v_cvt_pk_bf16_f32 v95, v78, v79
  v_mfma_f32_16x16x32_bf16 v[44:47], v[24:27], a[16:19], v[44:47]
  ds_read_b128 v[20:23], v2 offset:6144
  v_cmp_ge_i32 vcc, s46, v5
  v_mfma_f32_16x16x32_bf16 v[48:51], v[24:27], a[20:23], v[48:51]
  buffer_store_dwordx4 v[92:95], v1, s[4:7], s57 offen offset:0 sc1
  v_mfma_f32_16x16x32_bf16 v[52:55], v[24:27], a[24:27], v[52:55]
  v_fmac_f32_dpp v64, v124, v148 quad_perm:[0,0,0,0] row_mask:0xf bank_mask:0xf
  v_fmac_f32_dpp v65, v124, v148 quad_perm:[1,1,1,1] row_mask:0xf bank_mask:0xf
  v_mfma_f32_16x16x32_bf16 v[56:59], v[24:27], a[28:31], v[56:59]
  s_waitcnt lgkmcnt(2)
  v_fmac_f32_dpp v66, v124, v148 quad_perm:[2,2,2,2] row_mask:0xf bank_mask:0xf
  v_fmac_f32_dpp v67, v124, v148 quad_perm:[3,3,3,3] row_mask:0xf bank_mask:0xf
  v_mfma_f32_16x16x32_bf16 v[28:31], v[12:15], a[32:35], v[28:31]
  s_cmp_eq_u32 s45, 0
  ds_read_b128 v[24:27], v2 offset:6400
  v_mul_f32_dpp v64, v125, v64 quad_perm:[0,0,0,0] row_mask:0xf bank_mask:0xf
  v_mfma_f32_16x16x32_bf16 v[32:35], v[12:15], a[36:39], v[32:35]
  s_cselect_b32 s51, vcc_lo, vcc_hi
  v_mul_f32_dpp v65, v125, v65 quad_perm:[1,1,1,1] row_mask:0xf bank_mask:0xf
  v_mul_f32_dpp v66, v125, v66 quad_perm:[2,2,2,2] row_mask:0xf bank_mask:0xf
  v_mfma_f32_16x16x32_bf16 v[36:39], v[12:15], a[40:43], v[36:39]
  s_cmp_lg_u32 s51, 0
  v_mul_f32_dpp v67, v125, v67 quad_perm:[3,3,3,3] row_mask:0xf bank_mask:0xf
  v_cvt_pk_bf16_f32 v96, v64, v65
  v_mfma_f32_16x16x32_bf16 v[40:43], v[12:15], a[44:47], v[40:43]
  s_waitcnt lgkmcnt(2)
  v_cvt_pk_bf16_f32 v97, v66, v67
  v_fmac_f32_dpp v80, v126, v148 quad_perm:[0,0,0,0] row_mask:0xf bank_mask:0xf
  v_mfma_f32_16x16x32_bf16 v[44:47], v[16:19], a[32:35], v[44:47]
  s_cselect_b32 s49, 0, 1
  ds_read_b128 v[12:15], v2 offset:8192
  v_fmac_f32_dpp v81, v126, v148 quad_perm:[1,1,1,1] row_mask:0xf bank_mask:0xf
  v_mfma_f32_16x16x32_bf16 v[48:51], v[16:19], a[36:39], v[48:51]
  s_cmp_lt_u32 s42, s80
  v_fmac_f32_dpp v82, v126, v148 quad_perm:[2,2,2,2] row_mask:0xf bank_mask:0xf
  v_fmac_f32_dpp v83, v126, v148 quad_perm:[3,3,3,3] row_mask:0xf bank_mask:0xf
  v_mfma_f32_16x16x32_bf16 v[52:55], v[16:19], a[40:43], v[52:55]
  s_cselect_b32 s49, s49, 0
  v_mul_f32_dpp v80, v127, v80 quad_perm:[0,0,0,0] row_mask:0xf bank_mask:0xf
  v_mul_f32_dpp v81, v127, v81 quad_perm:[1,1,1,1] row_mask:0xf bank_mask:0xf
  v_mfma_f32_16x16x32_bf16 v[56:59], v[16:19], a[44:47], v[56:59]
  s_waitcnt lgkmcnt(2)
  v_mul_f32_dpp v82, v127, v82 quad_perm:[2,2,2,2] row_mask:0xf bank_mask:0xf
  v_mul_f32_dpp v83, v127, v83 quad_perm:[3,3,3,3] row_mask:0xf bank_mask:0xf
  v_mfma_f32_16x16x32_bf16 v[28:31], v[20:23], a[48:51], v[28:31]
  s_cmp_lg_u32 s49, 0
  ds_read_b128 v[16:19], v2 offset:8448
  v_cvt_pk_bf16_f32 v98, v80, v81
  v_mfma_f32_16x16x32_bf16 v[32:35], v[20:23], a[52:55], v[32:35]
  s_cselect_b32 s47, s64, 0x20000000
  s_xor_b32 s50, s50, s56
  v_cvt_pk_bf16_f32 v99, v82, v83
  v_mfma_f32_16x16x32_bf16 v[36:39], v[20:23], a[56:59], v[36:39]
  buffer_store_dwordx4 v[96:99], v1, s[4:7], s57 offen offset:1024 sc1
  v_mfma_f32_16x16x32_bf16 v[40:43], v[20:23], a[60:63], v[40:43]
  s_waitcnt lgkmcnt(2)
  v_fmac_f32_dpp v68, v124, v152 quad_perm:[0,0,0,0] row_mask:0xf bank_mask:0xf
  v_fmac_f32_dpp v69, v124, v152 quad_perm:[1,1,1,1] row_mask:0xf bank_mask:0xf
  v_mfma_f32_16x16x32_bf16 v[44:47], v[24:27], a[48:51], v[44:47]
  ds_read_b128 v[20:23], v2 offset:10240
  v_fmac_f32_dpp v70, v124, v152 quad_perm:[2,2,2,2] row_mask:0xf bank_mask:0xf
  v_mfma_f32_16x16x32_bf16 v[48:51], v[24:27], a[52:55], v[48:51]
  v_fmac_f32_dpp v71, v124, v152 quad_perm:[3,3,3,3] row_mask:0xf bank_mask:0xf
  v_mul_f32_dpp v68, v125, v68 quad_perm:[0,0,0,0] row_mask:0xf bank_mask:0xf
  v_mfma_f32_16x16x32_bf16 v[52:55], v[24:27], a[56:59], v[52:55]
  v_mul_f32_dpp v69, v125, v69 quad_perm:[1,1,1,1] row_mask:0xf bank_mask:0xf
  v_mul_f32_dpp v70, v125, v70 quad_perm:[2,2,2,2] row_mask:0xf bank_mask:0xf
  v_mfma_f32_16x16x32_bf16 v[56:59], v[24:27], a[60:63], v[56:59]
  s_waitcnt lgkmcnt(2)
  v_mul_f32_dpp v71, v125, v71 quad_perm:[3,3,3,3] row_mask:0xf bank_mask:0xf
  v_cvt_pk_bf16_f32 v100, v68, v69
  v_mfma_f32_16x16x32_bf16 v[28:31], v[12:15], a[64:67], v[28:31]
  ds_read_b128 v[24:27], v2 offset:10496
  v_cvt_pk_bf16_f32 v101, v70, v71
  v_mfma_f32_16x16x32_bf16 v[32:35], v[12:15], a[68:71], v[32:35]
  v_fmac_f32_dpp v84, v126, v152 quad_perm:[0,0,0,0] row_mask:0xf bank_mask:0xf
  v_fmac_f32_dpp v85, v126, v152 quad_perm:[1,1,1,1] row_mask:0xf bank_mask:0xf
  v_mfma_f32_16x16x32_bf16 v[36:39], v[12:15], a[72:75], v[36:39]
  v_fmac_f32_dpp v86, v126, v152 quad_perm:[2,2,2,2] row_mask:0xf bank_mask:0xf
  v_fmac_f32_dpp v87, v126, v152 quad_perm:[3,3,3,3] row_mask:0xf bank_mask:0xf
  v_mfma_f32_16x16x32_bf16 v[40:43], v[12:15], a[76:79], v[40:43]
  s_waitcnt lgkmcnt(2)
  v_mul_f32_dpp v84, v127, v84 quad_perm:[0,0,0,0] row_mask:0xf bank_mask:0xf
  v_mul_f32_dpp v85, v127, v85 quad_perm:[1,1,1,1] row_mask:0xf bank_mask:0xf
  v_mfma_f32_16x16x32_bf16 v[44:47], v[16:19], a[64:67], v[44:47]
  ds_read_b128 v[12:15], v2 offset:12288
  v_mul_f32_dpp v86, v127, v86 quad_perm:[2,2,2,2] row_mask:0xf bank_mask:0xf
  v_mfma_f32_16x16x32_bf16 v[48:51], v[16:19], a[68:71], v[48:51]
  v_mul_f32_dpp v87, v127, v87 quad_perm:[3,3,3,3] row_mask:0xf bank_mask:0xf
  v_cvt_pk_bf16_f32 v102, v84, v85
  v_mfma_f32_16x16x32_bf16 v[52:55], v[16:19], a[72:75], v[52:55]
  v_cvt_pk_bf16_f32 v103, v86, v87
  v_mfma_f32_16x16x32_bf16 v[56:59], v[16:19], a[76:79], v[56:59]
  s_waitcnt lgkmcnt(2)
  buffer_store_dwordx4 v[100:103], v1, s[4:7], s57 offen offset:2048 sc1
  v_mfma_f32_16x16x32_bf16 v[28:31], v[20:23], a[80:83], v[28:31]
  ds_read_b128 v[16:19], v2 offset:12544
  v_fmac_f32_dpp v72, v124, v156 quad_perm:[0,0,0,0] row_mask:0xf bank_mask:0xf
  v_mfma_f32_16x16x32_bf16 v[32:35], v[20:23], a[84:87], v[32:35]
  v_fmac_f32_dpp v73, v124, v156 quad_perm:[1,1,1,1] row_mask:0xf bank_mask:0xf
  v_fmac_f32_dpp v74, v124, v156 quad_perm:[2,2,2,2] row_mask:0xf bank_mask:0xf
  v_mfma_f32_16x16x32_bf16 v[36:39], v[20:23], a[88:91], v[36:39]
  v_fmac_f32_dpp v75, v124, v156 quad_perm:[3,3,3,3] row_mask:0xf bank_mask:0xf
  v_mul_f32_dpp v72, v125, v72 quad_perm:[0,0,0,0] row_mask:0xf bank_mask:0xf
  v_mfma_f32_16x16x32_bf16 v[40:43], v[20:23], a[92:95], v[40:43]
  s_waitcnt lgkmcnt(2)
  v_mul_f32_dpp v73, v125, v73 quad_perm:[1,1,1,1] row_mask:0xf bank_mask:0xf
  v_mul_f32_dpp v74, v125, v74 quad_perm:[2,2,2,2] row_mask:0xf bank_mask:0xf
  v_mfma_f32_16x16x32_bf16 v[44:47], v[24:27], a[80:83], v[44:47]
  ds_read_b128 v[20:23], v2 offset:14336
  v_mul_f32_dpp v75, v125, v75 quad_perm:[3,3,3,3] row_mask:0xf bank_mask:0xf
  v_mfma_f32_16x16x32_bf16 v[48:51], v[24:27], a[84:87], v[48:51]
  v_cvt_pk_bf16_f32 v104, v72, v73
  v_cvt_pk_bf16_f32 v105, v74, v75
  v_mfma_f32_16x16x32_bf16 v[52:55], v[24:27], a[88:91], v[52:55]
  v_fmac_f32_dpp v88, v126, v156 quad_perm:[0,0,0,0] row_mask:0xf bank_mask:0xf
  v_fmac_f32_dpp v89, v126, v156 quad_perm:[1,1,1,1] row_mask:0xf bank_mask:0xf
  v_mfma_f32_16x16x32_bf16 v[56:59], v[24:27], a[92:95], v[56:59]
  s_waitcnt lgkmcnt(2)
  v_fmac_f32_dpp v90, v126, v156 quad_perm:[2,2,2,2] row_mask:0xf bank_mask:0xf
  v_fmac_f32_dpp v91, v126, v156 quad_perm:[3,3,3,3] row_mask:0xf bank_mask:0xf
  v_mfma_f32_16x16x32_bf16 v[28:31], v[12:15], a[96:99], v[28:31]
  ds_read_b128 v[24:27], v2 offset:14592
  v_mul_f32_dpp v88, v127, v88 quad_perm:[0,0,0,0] row_mask:0xf bank_mask:0xf
  v_mfma_f32_16x16x32_bf16 v[32:35], v[12:15], a[100:103], v[32:35]
  v_mul_f32_dpp v89, v127, v89 quad_perm:[1,1,1,1] row_mask:0xf bank_mask:0xf
  v_mul_f32_dpp v90, v127, v90 quad_perm:[2,2,2,2] row_mask:0xf bank_mask:0xf
  v_mfma_f32_16x16x32_bf16 v[36:39], v[12:15], a[104:107], v[36:39]
  v_mul_f32_dpp v91, v127, v91 quad_perm:[3,3,3,3] row_mask:0xf bank_mask:0xf
  v_cvt_pk_bf16_f32 v106, v88, v89
  v_mfma_f32_16x16x32_bf16 v[40:43], v[12:15], a[108:111], v[40:43]
  s_waitcnt lgkmcnt(2)
  v_cvt_pk_bf16_f32 v107, v90, v91
  v_mfma_f32_16x16x32_bf16 v[44:47], v[16:19], a[96:99], v[44:47]
  ds_read_b128 v[12:15], v2 offset:16384
  v_mfma_f32_16x16x32_bf16 v[48:51], v[16:19], a[100:103], v[48:51]
  buffer_store_dwordx4 v[104:107], v1, s[4:7], s57 offen offset:3072 sc1
  v_mfma_f32_16x16x32_bf16 v[52:55], v[16:19], a[104:107], v[52:55]
  v_mfma_f32_16x16x32_bf16 v[56:59], v[16:19], a[108:111], v[56:59]
  s_waitcnt lgkmcnt(2)
  s_add_u32 m0, s50, 0
  s_add_u32 s51, s47, 0
  v_mfma_f32_16x16x32_bf16 v[28:31], v[20:23], a[112:115], v[28:31]
  ds_read_b128 v[16:19], v2 offset:16640
  buffer_load_dwordx4 v1, s[4:7], s51 offen sc1 lds
  v_mfma_f32_16x16x32_bf16 v[32:35], v[20:23], a[116:119], v[32:35]
  s_add_u32 m0, s50, 4096
  s_add_u32 s51, s47, 4096
  v_mfma_f32_16x16x32_bf16 v[36:39], v[20:23], a[120:123], v[36:39]
  v_mfma_f32_16x16x32_bf16 v[40:43], v[20:23], a[124:127], v[40:43]
  s_waitcnt lgkmcnt(2)
  v_mfma_f32_16x16x32_bf16 v[44:47], v[24:27], a[112:115], v[44:47]
  ds_read_b128 v[20:23], v2 offset:18432
  v_mfma_f32_16x16x32_bf16 v[48:51], v[24:27], a[116:119], v[48:51]
  v_mfma_f32_16x16x32_bf16 v[52:55], v[24:27], a[120:123], v[52:55]
  buffer_load_dwordx4 v1, s[4:7], s51 offen sc1 lds
  v_mfma_f32_16x16x32_bf16 v[56:59], v[24:27], a[124:127], v[56:59]
  s_waitcnt lgkmcnt(2)
  s_add_u32 m0, s50, 8192
  s_add_u32 s51, s47, 8192
  v_mfma_f32_16x16x32_bf16 v[28:31], v[12:15], a[128:131], v[28:31]
  ds_read_b128 v[24:27], v2 offset:18688
  v_mfma_f32_16x16x32_bf16 v[32:35], v[12:15], a[132:135], v[32:35]
  v_mfma_f32_16x16x32_bf16 v[36:39], v[12:15], a[136:139], v[36:39]
  v_mfma_f32_16x16x32_bf16 v[40:43], v[12:15], a[140:143], v[40:43]
  s_waitcnt lgkmcnt(2)
  v_mfma_f32_16x16x32_bf16 v[44:47], v[16:19], a[128:131], v[44:47]
  ds_read_b128 v[12:15], v2 offset:20480
  buffer_load_dwordx4 v1, s[4:7], s51 offen sc1 lds
  v_mfma_f32_16x16x32_bf16 v[48:51], v[16:19], a[132:135], v[48:51]
  s_add_u32 m0, s50, 12288
  s_add_u32 s51, s47, 12288
  v_mfma_f32_16x16x32_bf16 v[52:55], v[16:19], a[136:139], v[52:55]
  v_mfma_f32_16x16x32_bf16 v[56:59], v[16:19], a[140:143], v[56:59]
  s_waitcnt lgkmcnt(2)
  v_mfma_f32_16x16x32_bf16 v[28:31], v[20:23], a[144:147], v[28:31]
  ds_read_b128 v[16:19], v2 offset:20736
  v_mfma_f32_16x16x32_bf16 v[32:35], v[20:23], a[148:151], v[32:35]
  v_mfma_f32_16x16x32_bf16 v[36:39], v[20:23], a[152:155], v[36:39]
  buffer_load_dwordx4 v1, s[4:7], s51 offen sc1 lds
  v_mfma_f32_16x16x32_bf16 v[40:43], v[20:23], a[156:159], v[40:43]
  s_waitcnt lgkmcnt(2)
  s_add_u32 m0, s50, 16384
  s_add_u32 s51, s47, 16384
  v_mfma_f32_16x16x32_bf16 v[44:47], v[24:27], a[144:147], v[44:47]
  ds_read_b128 v[20:23], v2 offset:22528
  v_mfma_f32_16x16x32_bf16 v[48:51], v[24:27], a[148:151], v[48:51]
  v_mfma_f32_16x16x32_bf16 v[52:55], v[24:27], a[152:155], v[52:55]
  v_mfma_f32_16x16x32_bf16 v[56:59], v[24:27], a[156:159], v[56:59]
  s_waitcnt lgkmcnt(2)
  v_mfma_f32_16x16x32_bf16 v[28:31], v[12:15], a[160:163], v[28:31]
  ds_read_b128 v[24:27], v2 offset:22784
  buffer_load_dwordx4 v1, s[4:7], s51 offen sc1 lds
  v_mfma_f32_16x16x32_bf16 v[32:35], v[12:15], a[164:167], v[32:35]
  s_add_u32 m0, s50, 20480
  s_add_u32 s51, s47, 20480
  v_mfma_f32_16x16x32_bf16 v[36:39], v[12:15], a[168:171], v[36:39]
  v_mfma_f32_16x16x32_bf16 v[40:43], v[12:15], a[172:175], v[40:43]
  s_waitcnt lgkmcnt(2)
  v_mfma_f32_16x16x32_bf16 v[44:47], v[16:19], a[160:163], v[44:47]
  ds_read_b128 v[12:15], v2 offset:24576
  v_mfma_f32_16x16x32_bf16 v[48:51], v[16:19], a[164:167], v[48:51]
  v_mfma_f32_16x16x32_bf16 v[52:55], v[16:19], a[168:171], v[52:55]
  buffer_load_dwordx4 v1, s[4:7], s51 offen sc1 lds
  v_mfma_f32_16x16x32_bf16 v[56:59], v[16:19], a[172:175], v[56:59]
  s_waitcnt lgkmcnt(2)
  s_add_u32 m0, s50, 24576
  s_add_u32 s51, s47, 24576
  v_mfma_f32_16x16x32_bf16 v[28:31], v[20:23], a[176:179], v[28:31]
  ds_read_b128 v[16:19], v2 offset:24832
  v_mfma_f32_16x16x32_bf16 v[32:35], v[20:23], a[180:183], v[32:35]
  v_mfma_f32_16x16x32_bf16 v[36:39], v[20:23], a[184:187], v[36:39]
  v_mfma_f32_16x16x32_bf16 v[40:43], v[20:23], a[188:191], v[40:43]
  s_waitcnt lgkmcnt(2)
  v_mfma_f32_16x16x32_bf16 v[44:47], v[24:27], a[176:179], v[44:47]
  ds_read_b128 v[20:23], v2 offset:26624
  buffer_load_dwordx4 v1, s[4:7], s51 offen sc1 lds
  v_mfma_f32_16x16x32_bf16 v[48:51], v[24:27], a[180:183], v[48:51]
  s_add_u32 m0, s50, 28672
  s_add_u32 s51, s47, 28672
  v_mfma_f32_16x16x32_bf16 v[52:55], v[24:27], a[184:187], v[52:55]
  v_mfma_f32_16x16x32_bf16 v[56:59], v[24:27], a[188:191], v[56:59]
  s_waitcnt lgkmcnt(2)
  v_mfma_f32_16x16x32_bf16 v[28:31], v[12:15], a[192:195], v[28:31]
  ds_read_b128 v[24:27], v2 offset:26880
  v_mfma_f32_16x16x32_bf16 v[32:35], v[12:15], a[196:199], v[32:35]
  v_mfma_f32_16x16x32_bf16 v[36:39], v[12:15], a[200:203], v[36:39]
  buffer_load_dwordx4 v1, s[4:7], s51 offen sc1 lds
  v_mfma_f32_16x16x32_bf16 v[40:43], v[12:15], a[204:207], v[40:43]
  s_waitcnt lgkmcnt(2)
  s_xor_b32 s95, s95, 1024
  s_mov_b32 m0, s95
  v_mfma_f32_16x16x32_bf16 v[44:47], v[16:19], a[192:195], v[44:47]
  s_waitcnt vmcnt(8)
  s_barrier
  ds_read_b128 v[12:15], v2 offset:28672
  v_mfma_f32_16x16x32_bf16 v[48:51], v[16:19], a[196:199], v[48:51]
  v_xor_b32 v171, 1024, v171
  v_mov_b32 v7, s62
  v_mfma_f32_16x16x32_bf16 v[52:55], v[16:19], a[200:203], v[52:55]
  buffer_load_dword v4, s[4:7], s48 offen sc1 lds
  ds_read_b128 v[124:127], v3 offset:0
  v_mfma_f32_16x16x32_bf16 v[56:59], v[16:19], a[204:207], v[56:59]
  s_waitcnt lgkmcnt(3)
  s_add_u32 m0, s50, 32768
  s_add_u32 s51, s47, 32768
  v_mfma_f32_16x16x32_bf16 v[28:31], v[20:23], a[208:211], v[28:31]
  ds_read_b128 v[16:19], v2 offset:28928
  buffer_load_dwordx4 v1, s[4:7], s51 offen sc1 lds
  v_mfma_f32_16x16x32_bf16 v[32:35], v[20:23], a[212:215], v[32:35]
  s_add_u32 m0, s50, 36864
  s_add_u32 s51, s47, 36864
  ds_read_b128 v[128:131], v3 offset:256
  v_mfma_f32_16x16x32_bf16 v[36:39], v[20:23], a[216:219], v[36:39]
  buffer_store_dword v7, v0, s[4:7], s61 offen offset:0 sc1
  v_mfma_f32_16x16x32_bf16 v[40:43], v[20:23], a[220:223], v[40:43]
  s_waitcnt lgkmcnt(4)
  s_mul_i32 s52, s44, 2359296
  s_add_u32 s57, s53, s52
  v_mfma_f32_16x16x32_bf16 v[44:47], v[24:27], a[208:211], v[44:47]
  s_lshl_b32 s52, s43, 21
  s_add_u32 s52, s52, s57
  ds_read_b128 v[20:23], v2 offset:30720
  v_mfma_f32_16x16x32_bf16 v[48:51], v[24:27], a[212:215], v[48:51]
  s_lshr_b32 s52, s52, 8
  s_and_b32 s52, s52, 0x2000
  s_xor_b32 s57, s57, s52
  v_mfma_f32_16x16x32_bf16 v[52:55], v[24:27], a[216:219], v[52:55]
  s_mov_b32 s61, 0
  s_add_u32 s61, s61, s54
  buffer_load_dwordx4 v1, s[4:7], s51 offen sc1 lds
  v_mfma_f32_16x16x32_bf16 v[56:59], v[24:27], a[220:223], v[56:59]
  s_waitcnt lgkmcnt(4)
  s_add_u32 m0, s50, 40960
  s_add_u32 s51, s47, 40960
  v_mfma_f32_16x16x32_bf16 v[28:31], v[12:15], a[224:227], v[28:31]
  s_mul_i32 s52, s43, 18432
  s_add_u32 s61, s61, s52
  ds_read_b128 v[24:27], v2 offset:30976
  v_mfma_f32_16x16x32_bf16 v[32:35], v[12:15], a[228:231], v[32:35]
  s_add_u32 s62, s44, 1
  ds_read_b128 v[132:135], v3 offset:512
  ds_read_b128 v[136:139], v3 offset:768
  v_mfma_f32_16x16x32_bf16 v[36:39], v[12:15], a[232:235], v[36:39]
  ds_read_b128 v[140:143], v3 offset:1024
  v_mfma_f32_16x16x32_bf16 v[40:43], v[12:15], a[236:239], v[40:43]
  s_waitcnt lgkmcnt(6)
  v_mfma_f32_16x16x32_bf16 v[44:47], v[16:19], a[224:227], v[44:47]
  ds_read_b128 v[12:15], v2 offset:32768
  buffer_load_dwordx4 v9, s[4:7], s51 offen sc1 lds
  v_mfma_f32_16x16x32_bf16 v[48:51], v[16:19], a[228:231], v[48:51]
  s_cmp_eq_u32 s42, 62
  s_cselect_b64 s[86:87], s[88:89], s[86:87]
  s_and_b32 s83, s86, 1
  v_mfma_f32_16x16x32_bf16 v[52:55], v[16:19], a[232:235], v[52:55]
  s_cselect_b32 s84, s91, s90
  s_lshr_b64 s[86:87], s[86:87], 1
  s_add_u32 s91, s91, s83
  v_mfma_f32_16x16x32_bf16 v[56:59], v[16:19], a[236:239], v[56:59]
  s_waitcnt lgkmcnt(5)
  s_xor_b32 s52, s83, 1
  s_add_u32 s90, s90, s52
  v_mfma_f32_16x16x32_bf16 v[28:31], v[20:23], a[240:243], v[28:31]
  s_cmp_eq_u32 s90, 8
  s_cselect_b32 s90, 20, s90
  ds_read_b128 v[16:19], v2 offset:33024
  v_mfma_f32_16x16x32_bf16 v[32:35], v[20:23], a[244:247], v[32:35]
  s_lshl_b32 s52, s43, 8
  s_add_u32 s52, s52, s62
  s_cmp_eq_u32 s52, s81
  v_mfma_f32_16x16x32_bf16 v[36:39], v[20:23], a[248:251], v[36:39]
  s_cselect_b32 s62, s82, s62
  s_mov_b32 s85, 3145728
  s_mul_i32 s52, s83, 5767168
  v_mfma_f32_16x16x32_bf16 v[40:43], v[20:23], a[252:255], v[40:43]
  s_waitcnt lgkmcnt(5)
  s_add_u32 s85, s85, s52
  s_mul_i32 s52, s84, 45056
  v_mfma_f32_16x16x32_bf16 v[44:47], v[24:27], a[240:243], v[44:47]
  s_add_u32 s85, s85, s52
  s_add_u32 s85, s85, s63
  ds_read_b128 v[20:23], v2 offset:34816
  v_mfma_f32_16x16x32_bf16 v[48:51], v[24:27], a[244:247], v[48:51]
  s_waitcnt lgkmcnt(3)
  v_add_f32 v124, v124, v128
  v_add_f32 v125, v125, v129
  v_mfma_f32_16x16x32_bf16 v[52:55], v[24:27], a[248:251], v[52:55]
  v_add_f32 v126, v126, v130
  v_add_f32 v127, v127, v131
  v_mfma_f32_16x16x32_bf16 v[56:59], v[24:27], a[252:255], v[56:59]
  s_waitcnt lgkmcnt(2)
  v_add_f32 v124, v124, v132
  v_add_f32 v125, v125, v133
  v_mfma_f32_16x16x32_bf16 v[28:31], v[12:15], v[192:195], v[28:31]
  ds_read_b128 v[24:27], v2 offset:35072
  v_add_f32 v126, v126, v134
  v_mfma_f32_16x16x32_bf16 v[32:35], v[12:15], v[196:199], v[32:35]
  v_add_f32 v127, v127, v135
  v_add_f32 v124, v124, v136
  v_mfma_f32_16x16x32_bf16 v[36:39], v[12:15], v[200:203], v[36:39]
  v_add_f32 v125, v125, v137
  v_add_f32 v126, v126, v138
  v_mfma_f32_16x16x32_bf16 v[40:43], v[12:15], v[204:207], v[40:43]
  s_waitcnt lgkmcnt(2)
  v_add_f32 v127, v127, v139
  v_add_f32 v124, v124, v140
  v_mfma_f32_16x16x32_bf16 v[44:47], v[16:19], v[192:195], v[44:47]
  ds_read_b128 v[12:15], v2 offset:36864
  v_add_f32 v125, v125, v141
  v_mfma_f32_16x16x32_bf16 v[48:51], v[16:19], v[196:199], v[48:51]
  v_add_f32 v126, v126, v142
  v_add_f32 v127, v127, v143
  v_mfma_f32_16x16x32_bf16 v[52:55], v[16:19], v[200:203], v[52:55]
  v_mul_f32 v124, 0xbacccccd, v124
  v_mul_f32 v125, 0x3acccccd, v125
  v_mfma_f32_16x16x32_bf16 v[56:59], v[16:19], v[204:207], v[56:59]
  s_waitcnt lgkmcnt(2)
  v_mul_f32 v126, 0xbacccccd, v126
  v_mul_f32 v127, 0x3acccccd, v127
  v_mfma_f32_16x16x32_bf16 v[28:31], v[20:23], v[208:211], v[28:31]
  ds_read_b128 v[16:19], v2 offset:37120
  v_fma_f32 v125, -v124, v124, v125
  v_mfma_f32_16x16x32_bf16 v[32:35], v[20:23], v[212:215], v[32:35]
  v_fma_f32 v127, -v126, v126, v127
  v_max_f32 v125, 0, v125
  v_mfma_f32_16x16x32_bf16 v[36:39], v[20:23], v[216:219], v[36:39]
  v_max_f32 v127, 0, v127
  v_add_f32 v125, 0x3727c5ac, v125
  v_mfma_f32_16x16x32_bf16 v[40:43], v[20:23], v[220:223], v[40:43]
  s_waitcnt lgkmcnt(2)
  v_add_f32 v127, 0x3727c5ac, v127
  v_mfma_f32_16x16x32_bf16 v[44:47], v[24:27], v[208:211], v[44:47]
  ds_read_b128 v[20:23], v2 offset:38912
  v_mfma_f32_16x16x32_bf16 v[48:51], v[24:27], v[212:215], v[48:51]
  v_rsq_f32 v125, v125
  v_mfma_f32_16x16x32_bf16 v[52:55], v[24:27], v[216:219], v[52:55]
  v_rsq_f32 v127, v127
  v_mfma_f32_16x16x32_bf16 v[56:59], v[24:27], v[220:223], v[56:59]
  s_waitcnt lgkmcnt(2)
  v_mfma_f32_16x16x32_bf16 v[28:31], v[12:15], v[224:227], v[28:31]
  ds_read_b128 v[24:27], v2 offset:39168
  v_mfma_f32_16x16x32_bf16 v[32:35], v[12:15], v[228:231], v[32:35]
  v_add_u32 v2, s55, v2
  v_add_u32 v3, s55, v3
  v_mfma_f32_16x16x32_bf16 v[36:39], v[12:15], v[232:235], v[36:39]
  s_sub_u32 s55, 0, s55
  v_mfma_f32_16x16x32_bf16 v[40:43], v[12:15], v[236:239], v[40:43]
  s_waitcnt lgkmcnt(2)
  v_mfma_f32_16x16x32_bf16 v[44:47], v[16:19], v[224:227], v[44:47]
  v_mfma_f32_16x16x32_bf16 v[48:51], v[16:19], v[228:231], v[48:51]
  v_mfma_f32_16x16x32_bf16 v[52:55], v[16:19], v[232:235], v[52:55]
  s_cmp_eq_u32 s49, 0
  s_cbranch_scc1 L_v_slow0
  v_mfma_f32_16x16x32_bf16 v[56:59], v[16:19], v[236:239], v[56:59]
  s_waitcnt vmcnt(4) lgkmcnt(0)
  s_barrier
  ds_read_b128 v[12:15], v2 offset:0
  v_mfma_f32_16x16x32_bf16 v[28:31], v[20:23], v[240:243], v[28:31]
  ds_read_b128 v[16:19], v2 offset:256
  v_mfma_f32_16x16x32_bf16 v[32:35], v[20:23], v[244:247], v[32:35]
  v_mfma_f32_16x16x32_bf16 v[36:39], v[20:23], v[248:251], v[36:39]
  v_mfma_f32_16x16x32_bf16 v[40:43], v[20:23], v[252:255], v[40:43]
  ds_read_b128 v[20:23], v2 offset:2048
  v_mfma_f32_16x16x32_bf16 v[44:47], v[24:27], v[240:243], v[44:47]
  v_mfma_f32_16x16x32_bf16 v[48:51], v[24:27], v[244:247], v[48:51]
  v_mfma_f32_16x16x32_bf16 v[52:55], v[24:27], v[248:251], v[52:55]
  v_mfma_f32_16x16x32_bf16 v[56:59], v[24:27], v[252:255], v[56:59]
L_v_body1:
  s_waitcnt lgkmcnt(2)
  v_mfma_f32_16x16x32_bf16 v[60:63], v[12:15], a[0:3], 0
  s_mov_b32 s43, s45
  ds_read_b128 v[24:27], v2 offset:2304
  ds_read_b32 v5, v171
  v_mfma_f32_16x16x32_bf16 v[64:67], v[12:15], a[4:7], 0
  s_mov_b32 s44, s46
  v_fmac_f32_dpp v28, v124, v144 quad_perm:[0,0,0,0] row_mask:0xf bank_mask:0xf
  v_fmac_f32_dpp v29, v124, v144 quad_perm:[1,1,1,1] row_mask:0xf bank_mask:0xf
  v_mfma_f32_16x16x32_bf16 v[68:71], v[12:15], a[8:11], 0
  s_mov_b32 s46, s84
  v_fmac_f32_dpp v30, v124, v144 quad_perm:[2,2,2,2] row_mask:0xf bank_mask:0xf
  v_fmac_f32_dpp v31, v124, v144 quad_perm:[3,3,3,3] row_mask:0xf bank_mask:0xf
  v_mfma_f32_16x16x32_bf16 v[72:75], v[12:15], a[12:15], 0
  s_waitcnt lgkmcnt(3)
  v_mul_f32_dpp v28, v125, v28 quad_perm:[0,0,0,0] row_mask:0xf bank_mask:0xf
  v_mul_f32_dpp v29, v125, v29 quad_perm:[1,1,1,1] row_mask:0xf bank_mask:0xf
  v_mfma_f32_16x16x32_bf16 v[76:79], v[16:19], a[0:3], 0
  s_mov_b32 s45, s83
  ds_read_b128 v[12:15], v2 offset:4096
  v_mul_f32_dpp v30, v125, v30 quad_perm:[2,2,2,2] row_mask:0xf bank_mask:0xf
  v_mfma_f32_16x16x32_bf16 v[80:83], v[16:19], a[4:7], 0
  s_mov_b32 s64, s85
  v_mul_f32_dpp v31, v125, v31 quad_perm:[3,3,3,3] row_mask:0xf bank_mask:0xf
  v_cvt_pk_bf16_f32 v92, v28, v29
  v_mfma_f32_16x16x32_bf16 v[84:87], v[16:19], a[8:11], 0
  s_add_u32 s42, s42, 1
  v_cvt_pk_bf16_f32 v93, v30, v31
  v_fmac_f32_dpp v44, v126, v144 quad_perm:[0,0,0,0] row_mask:0xf bank_mask:0xf
  v_mfma_f32_16x16x32_bf16 v[88:91], v[16:19], a[12:15], 0
  s_waitcnt lgkmcnt(3)
  v_fmac_f32_dpp v45, v126, v144 quad_perm:[1,1,1,1] row_mask:0xf bank_mask:0xf
  v_fmac_f32_dpp v46, v126, v144 quad_perm:[2,2,2,2] row_mask:0xf bank_mask:0xf
  v_mfma_f32_16x16x32_bf16 v[60:63], v[20:23], a[16:19], v[60:63]
  s_waitcnt lgkmcnt(1)
  ds_read_b128 v[16:19], v2 offset:4352
  v_fmac_f32_dpp v47, v126, v144 quad_perm:[3,3,3,3] row_mask:0xf bank_mask:0xf
  v_mfma_f32_16x16x32_bf16 v[64:67], v[20:23], a[20:23], v[64:67]
  v_mul_f32_dpp v44, v127, v44 quad_perm:[0,0,0,0] row_mask:0xf bank_mask:0xf
  v_mul_f32_dpp v45, v127, v45 quad_perm:[1,1,1,1] row_mask:0xf bank_mask:0xf
  v_mfma_f32_16x16x32_bf16 v[68:71], v[20:23], a[24:27], v[68:71]
  v_mul_f32_dpp v46, v127, v46 quad_perm:[2,2,2,2] row_mask:0xf bank_mask:0xf
  v_mul_f32_dpp v47, v127, v47 quad_perm:[3,3,3,3] row_mask:0xf bank_mask:0xf
  v_mfma_f32_16x16x32_bf16 v[72:75], v[20:23], a[28:31], v[72:75]
  v_cvt_pk_bf16_f32 v94, v44, v45
  v_cvt_pk_bf16_f32 v95, v46, v47
  v_mfma_f32_16x16x32_bf16 v[76:79], v[24:27], a[16:19], v[76:79]
  ds_read_b128 v[20:23], v2 offset:6144
  v_cmp_ge_i32 vcc, s46, v5
  v_mfma_f32_16x16x32_bf16 v[80:83], v[24:27], a[20:23], v[80:83]
  buffer_store_dwordx4 v[92:95], v1, s[4:7], s57 offen offset:0 sc1
  v_mfma_f32_16x16x32_bf16 v[84:87], v[24:27], a[24:27], v[84:87]
  v_fmac_f32_dpp v32, v124, v148 quad_perm:[0,0,0,0] row_mask:0xf bank_mask:0xf
  v_fmac_f32_dpp v33, v124, v148 quad_perm:[1,1,1,1] row_mask:0xf bank_mask:0xf
  v_mfma_f32_16x16x32_bf16 v[88:91], v[24:27], a[28:31], v[88:91]
  s_waitcnt lgkmcnt(2)
  v_fmac_f32_dpp v34, v124, v148 quad_perm:[2,2,2,2] row_mask:0xf bank_mask:0xf
  v_fmac_f32_dpp v35, v124, v148 quad_perm:[3,3,3,3] row_mask:0xf bank_mask:0xf
  v_mfma_f32_16x16x32_bf16 v[60:63], v[12:15], a[32:35], v[60:63]
  s_cmp_eq_u32 s45, 0
  ds_read_b128 v[24:27], v2 offset:6400
  v_mul_f32_dpp v32, v125, v32 quad_perm:[0,0,0,0] row_mask:0xf bank_mask:0xf
  v_mfma_f32_16x16x32_bf16 v[64:67], v[12:15], a[36:39], v[64:67]
  s_cselect_b32 s51, vcc_lo, vcc_hi
  v_mul_f32_dpp v33, v125, v33 quad_perm:[1,1,1,1] row_mask:0xf bank_mask:0xf
  v_mul_f32_dpp v34, v125, v34 quad_perm:[2,2,2,2] row_mask:0xf bank_mask:0xf
  v_mfma_f32_16x16x32_bf16 v[68:71], v[12:15], a[40:43], v[68:71]
  s_cmp_lg_u32 s51, 0
  v_mul_f32_dpp v35, v125, v35 quad_perm:[3,3,3,3] row_mask:0xf bank_mask:0xf
  v_cvt_pk_bf16_f32 v96, v32, v33
  v_mfma_f32_16x16x32_bf16 v[72:75], v[12:15], a[44:47], v[72:75]
  s_waitcnt lgkmcnt(2)
  v_cvt_pk_bf16_f32 v97, v34, v35
  v_fmac_f32_dpp v48, v126, v148 quad_perm:[0,0,0,0] row_mask:0xf bank_mask:0xf
  v_mfma_f32_16x16x32_bf16 v[76:79], v[16:19], a[32:35], v[76:79]
  s_cselect_b32 s49, 0, 1
  ds_read_b128 v[12:15], v2 offset:8192
  v_fmac_f32_dpp v49, v126, v148 quad_perm:[1,1,1,1] row_mask:0xf bank_mask:0xf
  v_mfma_f32_16x16x32_bf16 v[80:83], v[16:19], a[36:39], v[80:83]
  s_cmp_lt_u32 s42, s80
  v_fmac_f32_dpp v50, v126, v148 quad_perm:[2,2,2,2] row_mask:0xf bank_mask:0xf
  v_fmac_f32_dpp v51, v126, v148 quad_perm:[3,3,3,3] row_mask:0xf bank_mask:0xf
  v_mfma_f32_16x16x32_bf16 v[84:87], v[16:19], a[40:43], v[84:87]
  s_cselect_b32 s49, s49, 0
  v_mul_f32_dpp v48, v127, v48 quad_perm:[0,0,0,0] row_mask:0xf bank_mask:0xf
  v_mul_f32_dpp v49, v127, v49 quad_perm:[1,1,1,1] row_mask:0xf bank_mask:0xf
  v_mfma_f32_16x16x32_bf16 v[88:91], v[16:19], a[44:47], v[88:91]
  s_waitcnt lgkmcnt(2)
  v_mul_f32_dpp v50, v127, v50 quad_perm:[2,2,2,2] row_mask:0xf bank_mask:0xf
  v_mul_f32_dpp v51, v127, v51 quad_perm:[3,3,3,3] row_mask:0xf bank_mask:0xf
  v_mfma_f32_16x16x32_bf16 v[60:63], v[20:23], a[48:51], v[60:63]
  s_cmp_lg_u32 s49, 0
  ds_read_b128 v[16:19], v2 offset:8448
  v_cvt_pk_bf16_f32 v98, v48, v49
  v_mfma_f32_16x16x32_bf16 v[64:67], v[20:23], a[52:55], v[64:67]
  s_cselect_b32 s47, s64, 0x20000000
  s_xor_b32 s50, s50, s56
  v_cvt_pk_bf16_f32 v99, v50, v51
  v_mfma_f32_16x16x32_bf16 v[68:71], v[20:23], a[56:59], v[68:71]
  buffer_store_dwordx4 v[96:99], v1, s[4:7], s57 offen offset:1024 sc1
  v_mfma_f32_16x16x32_bf16 v[72:75], v[20:23], a[60:63], v[72:75]
  s_waitcnt lgkmcnt(2)
  v_fmac_f32_dpp v36, v124, v152 quad_perm:[0,0,0,0] row_mask:0xf bank_mask:0xf
  v_fmac_f32_dpp v37, v124, v152 quad_perm:[1,1,1,1] row_mask:0xf bank_mask:0xf
  v_mfma_f32_16x16x32_bf16 v[76:79], v[24:27], a[48:51], v[76:79]
  ds_read_b128 v[20:23], v2 offset:10240
  v_fmac_f32_dpp v38, v124, v152 quad_perm:[2,2,2,2] row_mask:0xf bank_mask:0xf
  v_mfma_f32_16x16x32_bf16 v[80:83], v[24:27], a[52:55], v[80:83]
  v_fmac_f32_dpp v39, v124, v152 quad_perm:[3,3,3,3] row_mask:0xf bank_mask:0xf
  v_mul_f32_dpp v36, v125, v36 quad_perm:[0,0,0,0] row_mask:0xf bank_mask:0xf
  v_mfma_f32_16x16x32_bf16 v[84:87], v[24:27], a[56:59], v[84:87]
  v_mul_f32_dpp v37, v125, v37 quad_perm:[1,1,1,1] row_mask:0xf bank_mask:0xf
  v_mul_f32_dpp v38, v125, v38 quad_perm:[2,2,2,2] row_mask:0xf bank_mask:0xf
  v_mfma_f32_16x16x32_bf16 v[88:91], v[24:27], a[60:63], v[88:91]
  s_waitcnt lgkmcnt(2)
  v_mul_f32_dpp v39, v125, v39 quad_perm:[3,3,3,3] row_mask:0xf bank_mask:0xf
  v_cvt_pk_bf16_f32 v100, v36, v37
  v_mfma_f32_16x16x32_bf16 v[60:63], v[12:15], a[64:67], v[60:63]
  ds_read_b128 v[24:27], v2 offset:10496
  v_cvt_pk_bf16_f32 v101, v38, v39
  v_mfma_f32_16x16x32_bf16 v[64:67], v[12:15], a[68:71], v[64:67]
  v_fmac_f32_dpp v52, v126, v152 quad_perm:[0,0,0,0] row_mask:0xf bank_mask:0xf
  v_fmac_f32_dpp v53, v126, v152 quad_perm:[1,1,1,1] row_mask:0xf bank_mask:0xf
  v_mfma_f32_16x16x32_bf16 v[68:71], v[12:15], a[72:75], v[68:71]
  v_fmac_f32_dpp v54, v126, v152 quad_perm:[2,2,2,2] row_mask:0xf bank_mask:0xf
  v_fmac_f32_dpp v55, v126, v152 quad_perm:[3,3,3,3] row_mask:0xf bank_mask:0xf
  v_mfma_f32_16x16x32_bf16 v[72:75], v[12:15], a[76:79], v[72:75]
  s_waitcnt lgkmcnt(2)
  v_mul_f32_dpp v52, v127, v52 quad_perm:[0,0,0,0] row_mask:0xf bank_mask:0xf
  v_mul_f32_dpp v53, v127, v53 quad_perm:[1,1,1,1] row_mask:0xf bank_mask:0xf
  v_mfma_f32_16x16x32_bf16 v[76:79], v[16:19], a[64:67], v[76:79]
  ds_read_b128 v[12:15], v2 offset:12288
  v_mul_f32_dpp v54, v127, v54 quad_perm:[2,2,2,2] row_mask:0xf bank_mask:0xf
  v_mfma_f32_16x16x32_bf16 v[80:83], v[16:19], a[68:71], v[80:83]
  v_mul_f32_dpp v55, v127, v55 quad_perm:[3,3,3,3] row_mask:0xf bank_mask:0xf
  v_cvt_pk_bf16_f32 v102, v52, v53
  v_mfma_f32_16x16x32_bf16 v[84:87], v[16:19], a[72:75], v[84:87]
  v_cvt_pk_bf16_f32 v103, v54, v55
  v_mfma_f32_16x16x32_bf16 v[88:91], v[16:19], a[76:79], v[88:91]
  s_waitcnt lgkmcnt(2)
  buffer_store_dwordx4 v[100:103], v1, s[4:7], s57 offen offset:2048 sc1
  v_mfma_f32_16x16x32_bf16 v[60:63], v[20:23], a[80:83], v[60:63]
  ds_read_b128 v[16:19], v2 offset:12544
  v_fmac_f32_dpp v40, v124, v156 quad_perm:[0,0,0,0] row_mask:0xf bank_mask:0xf
  v_mfma_f32_16x16x32_bf16 v[64:67], v[20:23], a[84:87], v[64:67]
  v_fmac_f32_dpp v41, v124, v156 quad_perm:[1,1,1,1] row_mask:0xf bank_mask:0xf
  v_fmac_f32_dpp v42, v124, v156 quad_perm:[2,2,2,2] row_mask:0xf bank_mask:0xf
  v_mfma_f32_16x16x32_bf16 v[68:71], v[20:23], a[88:91], v[68:71]
  v_fmac_f32_dpp v43, v124, v156 quad_perm:[3,3,3,3] row_mask:0xf bank_mask:0xf
  v_mul_f32_dpp v40, v125, v40 quad_perm:[0,0,0,0] row_mask:0xf bank_mask:0xf
  v_mfma_f32_16x16x32_bf16 v[72:75], v[20:23], a[92:95], v[72:75]
  s_waitcnt lgkmcnt(2)
  v_mul_f32_dpp v41, v125, v41 quad_perm:[1,1,1,1] row_mask:0xf bank_mask:0xf
  v_mul_f32_dpp v42, v125, v42 quad_perm:[2,2,2,2] row_mask:0xf bank_mask:0xf
  v_mfma_f32_16x16x32_bf16 v[76:79], v[24:27], a[80:83], v[76:79]
  ds_read_b128 v[20:23], v2 offset:14336
  v_mul_f32_dpp v43, v125, v43 quad_perm:[3,3,3,3] row_mask:0xf bank_mask:0xf
  v_mfma_f32_16x16x32_bf16 v[80:83], v[24:27], a[84:87], v[80:83]
  v_cvt_pk_bf16_f32 v104, v40, v41
  v_cvt_pk_bf16_f32 v105, v42, v43
  v_mfma_f32_16x16x32_bf16 v[84:87], v[24:27], a[88:91], v[84:87]
  v_fmac_f32_dpp v56, v126, v156 quad_perm:[0,0,0,0] row_mask:0xf bank_mask:0xf
  v_fmac_f32_dpp v57, v126, v156 quad_perm:[1,1,1,1] row_mask:0xf bank_mask:0xf
  v_mfma_f32_16x16x32_bf16 v[88:91], v[24:27], a[92:95], v[88:91]
  s_waitcnt lgkmcnt(2)
  v_fmac_f32_dpp v58, v126, v156 quad_perm:[2,2,2,2] row_mask:0xf bank_mask:0xf
  v_fmac_f32_dpp v59, v126, v156 quad_perm:[3,3,3,3] row_mask:0xf bank_mask:0xf
  v_mfma_f32_16x16x32_bf16 v[60:63], v[12:15], a[96:99], v[60:63]
  ds_read_b128 v[24:27], v2 offset:14592
  v_mul_f32_dpp v56, v127, v56 quad_perm:[0,0,0,0] row_mask:0xf bank_mask:0xf
  v_mfma_f32_16x16x32_bf16 v[64:67], v[12:15], a[100:103], v[64:67]
  v_mul_f32_dpp v57, v127, v57 quad_perm:[1,1,1,1] row_mask:0xf bank_mask:0xf
  v_mul_f32_dpp v58, v127, v58 quad_perm:[2,2,2,2] row_mask:0xf bank_mask:0xf
  v_mfma_f32_16x16x32_bf16 v[68:71], v[12:15], a[104:107], v[68:71]
  v_mul_f32_dpp v59, v127, v59 quad_perm:[3,3,3,3] row_mask:0xf bank_mask:0xf
  v_cvt_pk_bf16_f32 v106, v56, v57
  v_mfma_f32_16x16x32_bf16 v[72:75], v[12:15], a[108:111], v[72:75]
  s_waitcnt lgkmcnt(2)
  v_cvt_pk_bf16_f32 v107, v58, v59
  v_mfma_f32_16x16x32_bf16 v[76:79], v[16:19], a[96:99], v[76:79]
  ds_read_b128 v[12:15], v2 offset:16384
  v_mfma_f32_16x16x32_bf16 v[80:83], v[16:19], a[100:103], v[80:83]
  buffer_store_dwordx4 v[104:107], v1, s[4:7], s57 offen offset:3072 sc1
  v_mfma_f32_16x16x32_bf16 v[84:87], v[16:19], a[104:107], v[84:87]
  v_mfma_f32_16x16x32_bf16 v[88:91], v[16:19], a[108:111], v[88:91]
  s_waitcnt lgkmcnt(2)
  s_add_u32 m0, s50, 0
  s_add_u32 s51, s47, 0
  v_mfma_f32_16x16x32_bf16 v[60:63], v[20:23], a[112:115], v[60:63]
  ds_read_b128 v[16:19], v2 offset:16640
  buffer_load_dwordx4 v1, s[4:7], s51 offen sc1 lds
  v_mfma_f32_16x16x32_bf16 v[64:67], v[20:23], a[116:119], v[64:67]
  s_add_u32 m0, s50, 4096
  s_add_u32 s51, s47, 4096
  v_mfma_f32_16x16x32_bf16 v[68:71], v[20:23], a[120:123], v[68:71]
  v_mfma_f32_16x16x32_bf16 v[72:75], v[20:23], a[124:127], v[72:75]
  s_waitcnt lgkmcnt(2)
  v_mfma_f32_16x16x32_bf16 v[76:79], v[24:27], a[112:115], v[76:79]
  ds_read_b128 v[20:23], v2 offset:18432
  v_mfma_f32_16x16x32_bf16 v[80:83], v[24:27], a[116:119], v[80:83]
  v_mfma_f32_16x16x32_bf16 v[84:87], v[24:27], a[120:123], v[84:87]
  buffer_load_dwordx4 v1, s[4:7], s51 offen sc1 lds
  v_mfma_f32_16x16x32_bf16 v[88:91], v[24:27], a[124:127], v[88:91]
  s_waitcnt lgkmcnt(2)
  s_add_u32 m0, s50, 8192
  s_add_u32 s51, s47, 8192
  v_mfma_f32_16x16x32_bf16 v[60:63], v[12:15], a[128:131], v[60:63]
  ds_read_b128 v[24:27], v2 offset:18688
  v_mfma_f32_16x16x32_bf16 v[64:67], v[12:15], a[132:135], v[64:67]
  v_mfma_f32_16x16x32_bf16 v[68:71], v[12:15], a[136:139], v[68:71]
  v_mfma_f32_16x16x32_bf16 v[72:75], v[12:15], a[140:143], v[72:75]
  s_waitcnt lgkmcnt(2)
  v_mfma_f32_16x16x32_bf16 v[76:79], v[16:19], a[128:131], v[76:79]
  ds_read_b128 v[12:15], v2 offset:20480
  buffer_load_dwordx4 v1, s[4:7], s51 offen sc1 lds
  v_mfma_f32_16x16x32_bf16 v[80:83], v[16:19], a[132:135], v[80:83]
  s_add_u32 m0, s50, 12288
  s_add_u32 s51, s47, 12288
  v_mfma_f32_16x16x32_bf16 v[84:87], v[16:19], a[136:139], v[84:87]
  v_mfma_f32_16x16x32_bf16 v[88:91], v[16:19], a[140:143], v[88:91]
  s_waitcnt lgkmcnt(2)
  v_mfma_f32_16x16x32_bf16 v[60:63], v[20:23], a[144:147], v[60:63]
  ds_read_b128 v[16:19], v2 offset:20736
  v_mfma_f32_16x16x32_bf16 v[64:67], v[20:23], a[148:151], v[64:67]
  v_mfma_f32_16x16x32_bf16 v[68:71], v[20:23], a[152:155], v[68:71]
  buffer_load_dwordx4 v1, s[4:7], s51 offen sc1 lds
  v_mfma_f32_16x16x32_bf16 v[72:75], v[20:23], a[156:159], v[72:75]
  s_waitcnt lgkmcnt(2)
  s_add_u32 m0, s50, 16384
  s_add_u32 s51, s47, 16384
  v_mfma_f32_16x16x32_bf16 v[76:79], v[24:27], a[144:147], v[76:79]
  ds_read_b128 v[20:23], v2 offset:22528
  v_mfma_f32_16x16x32_bf16 v[80:83], v[24:27], a[148:151], v[80:83]
  v_mfma_f32_16x16x32_bf16 v[84:87], v[24:27], a[152:155], v[84:87]
  v_mfma_f32_16x16x32_bf16 v[88:91], v[24:27], a[156:159], v[88:91]
  s_waitcnt lgkmcnt(2)
  v_mfma_f32_16x16x32_bf16 v[60:63], v[12:15], a[160:163], v[60:63]
  ds_read_b128 v[24:27], v2 offset:22784
  buffer_load_dwordx4 v1, s[4:7], s51 offen sc1 lds
  v_mfma_f32_16x16x32_bf16 v[64:67], v[12:15], a[164:167], v[64:67]
  s_add_u32 m0, s50, 20480
  s_add_u32 s51, s47, 20480
  v_mfma_f32_16x16x32_bf16 v[68:71], v[12:15], a[168:171], v[68:71]
  v_mfma_f32_16x16x32_bf16 v[72:75], v[12:15], a[172:175], v[72:75]
  s_waitcnt lgkmcnt(2)
  v_mfma_f32_16x16x32_bf16 v[76:79], v[16:19], a[160:163], v[76:79]
  ds_read_b128 v[12:15], v2 offset:24576
  v_mfma_f32_16x16x32_bf16 v[80:83], v[16:19], a[164:167], v[80:83]
  v_mfma_f32_16x16x32_bf16 v[84:87], v[16:19], a[168:171], v[84:87]
  buffer_load_dwordx4 v1, s[4:7], s51 offen sc1 lds
  v_mfma_f32_16x16x32_bf16 v[88:91], v[16:19], a[172:175], v[88:91]
  s_waitcnt lgkmcnt(2)
  s_add_u32 m0, s50, 24576
  s_add_u32 s51, s47, 24576
  v_mfma_f32_16x16x32_bf16 v[60:63], v[20:23], a[176:179], v[60:63]
  ds_read_b128 v[16:19], v2 offset:24832
  v_mfma_f32_16x16x32_bf16 v[64:67], v[20:23], a[180:183], v[64:67]
  v_mfma_f32_16x16x32_bf16 v[68:71], v[20:23], a[184:187], v[68:71]
  v_mfma_f32_16x16x32_bf16 v[72:75], v[20:23], a[188:191], v[72:75]
  s_waitcnt lgkmcnt(2)
  v_mfma_f32_16x16x32_bf16 v[76:79], v[24:27], a[176:179], v[76:79]
  ds_read_b128 v[20:23], v2 offset:26624
  buffer_load_dwordx4 v1, s[4:7], s51 offen sc1 lds
  v_mfma_f32_16x16x32_bf16 v[80:83], v[24:27], a[180:183], v[80:83]
  s_add_u32 m0, s50, 28672
  s_add_u32 s51, s47, 28672
  v_mfma_f32_16x16x32_bf16 v[84:87], v[24:27], a[184:187], v[84:87]
  v_mfma_f32_16x16x32_bf16 v[88:91], v[24:27], a[188:191], v[88:91]
  s_waitcnt lgkmcnt(2)
  v_mfma_f32_16x16x32_bf16 v[60:63], v[12:15], a[192:195], v[60:63]
  ds_read_b128 v[24:27], v2 offset:26880
  v_mfma_f32_16x16x32_bf16 v[64:67], v[12:15], a[196:199], v[64:67]
  v_mfma_f32_16x16x32_bf16 v[68:71], v[12:15], a[200:203], v[68:71]
  buffer_load_dwordx4 v1, s[4:7], s51 offen sc1 lds
  v_mfma_f32_16x16x32_bf16 v[72:75], v[12:15], a[204:207], v[72:75]
  s_waitcnt lgkmcnt(2)
  s_xor_b32 s95, s95, 1024
  s_mov_b32 m0, s95
  v_mfma_f32_16x16x32_bf16 v[76:79], v[16:19], a[192:195], v[76:79]
  s_waitcnt vmcnt(8)
  s_barrier
  ds_read_b128 v[12:15], v2 offset:28672
  v_mfma_f32_16x16x32_bf16 v[80:83], v[16:19], a[196:199], v[80:83]
  v_xor_b32 v171, 1024, v171
  v_mov_b32 v7, s62
  v_mfma_f32_16x16x32_bf16 v[84:87], v[16:19], a[200:203], v[84:87]
  buffer_load_dword v4, s[4:7], s48 offen sc1 lds
  ds_read_b128 v[124:127], v3 offset:0
  v_mfma_f32_16x16x32_bf16 v[88:91], v[16:19], a[204:207], v[88:91]
  s_waitcnt lgkmcnt(3)
  s_add_u32 m0, s50, 32768
  s_add_u32 s51, s47, 32768
  v_mfma_f32_16x16x32_bf16 v[60:63], v[20:23], a[208:211], v[60:63]
  ds_read_b128 v[16:19], v2 offset:28928
  buffer_load_dwordx4 v1, s[4:7], s51 offen sc1 lds
  v_mfma_f32_16x16x32_bf16 v[64:67], v[20:23], a[212:215], v[64:67]
  s_add_u32 m0, s50, 36864
  s_add_u32 s51, s47, 36864
  ds_read_b128 v[128:131], v3 offset:256
  v_mfma_f32_16x16x32_bf16 v[68:71], v[20:23], a[216:219], v[68:71]
  buffer_store_dword v7, v0, s[4:7], s61 offen offset:0 sc1
  v_mfma_f32_16x16x32_bf16 v[72:75], v[20:23], a[220:223], v[72:75]
  s_waitcnt lgkmcnt(4)
  s_mul_i32 s52, s44, 2359296
  s_add_u32 s57, s53, s52
  v_mfma_f32_16x16x32_bf16 v[76:79], v[24:27], a[208:211], v[76:79]
  s_lshl_b32 s52, s43, 21
  s_add_u32 s52, s52, s57
  ds_read_b128 v[20:23], v2 offset:30720
  v_mfma_f32_16x16x32_bf16 v[80:83], v[24:27], a[212:215], v[80:83]
  s_lshr_b32 s52, s52, 8
  s_and_b32 s52, s52, 0x2000
  s_xor_b32 s57, s57, s52
  v_mfma_f32_16x16x32_bf16 v[84:87], v[24:27], a[216:219], v[84:87]
  s_mov_b32 s61, 0
  s_add_u32 s61, s61, s54
  buffer_load_dwordx4 v1, s[4:7], s51 offen sc1 lds
  v_mfma_f32_16x16x32_bf16 v[88:91], v[24:27], a[220:223], v[88:91]
  s_waitcnt lgkmcnt(4)
  s_add_u32 m0, s50, 40960
  s_add_u32 s51, s47, 40960
  v_mfma_f32_16x16x32_bf16 v[60:63], v[12:15], a[224:227], v[60:63]
  s_mul_i32 s52, s43, 18432
  s_add_u32 s61, s61, s52
  ds_read_b128 v[24:27], v2 offset:30976
  v_mfma_f32_16x16x32_bf16 v[64:67], v[12:15], a[228:231], v[64:67]
  s_add_u32 s62, s44, 1
  ds_read_b128 v[132:135], v3 offset:512
  ds_read_b128 v[136:139], v3 offset:768
  v_mfma_f32_16x16x32_bf16 v[68:71], v[12:15], a[232:235], v[68:71]
  ds_read_b128 v[140:143], v3 offset:1024
  v_mfma_f32_16x16x32_bf16 v[72:75], v[12:15], a[236:239], v[72:75]
  s_waitcnt lgkmcnt(6)
  v_mfma_f32_16x16x32_bf16 v[76:79], v[16:19], a[224:227], v[76:79]
  ds_read_b128 v[12:15], v2 offset:32768
  buffer_load_dwordx4 v9, s[4:7], s51 offen sc1 lds
  v_mfma_f32_16x16x32_bf16 v[80:83], v[16:19], a[228:231], v[80:83]
  s_cmp_eq_u32 s42, 62
  s_cselect_b64 s[86:87], s[88:89], s[86:87]
  s_and_b32 s83, s86, 1
  v_mfma_f32_16x16x32_bf16 v[84:87], v[16:19], a[232:235], v[84:87]
  s_cselect_b32 s84, s91, s90
  s_lshr_b64 s[86:87], s[86:87], 1
  s_add_u32 s91, s91, s83
  v_mfma_f32_16x16x32_bf16 v[88:91], v[16:19], a[236:239], v[88:91]
  s_waitcnt lgkmcnt(5)
  s_xor_b32 s52, s83, 1
  s_add_u32 s90, s90, s52
  v_mfma_f32_16x16x32_bf16 v[60:63], v[20:23], a[240:243], v[60:63]
  s_cmp_eq_u32 s90, 8
  s_cselect_b32 s90, 20, s90
  ds_read_b128 v[16:19], v2 offset:33024
  v_mfma_f32_16x16x32_bf16 v[64:67], v[20:23], a[244:247], v[64:67]
  s_lshl_b32 s52, s43, 8
  s_add_u32 s52, s52, s62
  s_cmp_eq_u32 s52, s81
  v_mfma_f32_16x16x32_bf16 v[68:71], v[20:23], a[248:251], v[68:71]
  s_cselect_b32 s62, s82, s62
  s_mov_b32 s85, 3145728
  s_mul_i32 s52, s83, 5767168
  v_mfma_f32_16x16x32_bf16 v[72:75], v[20:23], a[252:255], v[72:75]
  s_waitcnt lgkmcnt(5)
  s_add_u32 s85, s85, s52
  s_mul_i32 s52, s84, 45056
  v_mfma_f32_16x16x32_bf16 v[76:79], v[24:27], a[240:243], v[76:79]
  s_add_u32 s85, s85, s52
  s_add_u32 s85, s85, s63
  ds_read_b128 v[20:23], v2 offset:34816
  v_mfma_f32_16x16x32_bf16 v[80:83], v[24:27], a[244:247], v[80:83]
  s_waitcnt lgkmcnt(3)
  v_add_f32 v124, v124, v128
  v_add_f32 v125, v125, v129
  v_mfma_f32_16x16x32_bf16 v[84:87], v[24:27], a[248:251], v[84:87]
  v_add_f32 v126, v126, v130
  v_add_f32 v127, v127, v131
  v_mfma_f32_16x16x32_bf16 v[88:91], v[24:27], a[252:255], v[88:91]
  s_waitcnt lgkmcnt(2)
  v_add_f32 v124, v124, v132
  v_add_f32 v125, v125, v133
  v_mfma_f32_16x16x32_bf16 v[60:63], v[12:15], v[192:195], v[60:63]
  ds_read_b128 v[24:27], v2 offset:35072
  v_add_f32 v126, v126, v134
  v_mfma_f32_16x16x32_bf16 v[64:67], v[12:15], v[196:199], v[64:67]
  v_add_f32 v127, v127, v135
  v_add_f32 v124, v124, v136
  v_mfma_f32_16x16x32_bf16 v[68:71], v[12:15], v[200:203], v[68:71]
  v_add_f32 v125, v125, v137
  v_add_f32 v126, v126, v138
  v_mfma_f32_16x16x32_bf16 v[72:75], v[12:15], v[204:207], v[72:75]
  s_waitcnt lgkmcnt(2)
  v_add_f32 v127, v127, v139
  v_add_f32 v124, v124, v140
  v_mfma_f32_16x16x32_bf16 v[76:79], v[16:19], v[192:195], v[76:79]
  ds_read_b128 v[12:15], v2 offset:36864
  v_add_f32 v125, v125, v141
  v_mfma_f32_16x16x32_bf16 v[80:83], v[16:19], v[196:199], v[80:83]
  v_add_f32 v126, v126, v142
  v_add_f32 v127, v127, v143
  v_mfma_f32_16x16x32_bf16 v[84:87], v[16:19], v[200:203], v[84:87]
  v_mul_f32 v124, 0xbacccccd, v124
  v_mul_f32 v125, 0x3acccccd, v125
  v_mfma_f32_16x16x32_bf16 v[88:91], v[16:19], v[204:207], v[88:91]
  s_waitcnt lgkmcnt(2)
  v_mul_f32 v126, 0xbacccccd, v126
  v_mul_f32 v127, 0x3acccccd, v127
  v_mfma_f32_16x16x32_bf16 v[60:63], v[20:23], v[208:211], v[60:63]
  ds_read_b128 v[16:19], v2 offset:37120
  v_fma_f32 v125, -v124, v124, v125
  v_mfma_f32_16x16x32_bf16 v[64:67], v[20:23], v[212:215], v[64:67]
  v_fma_f32 v127, -v126, v126, v127
  v_max_f32 v125, 0, v125
  v_mfma_f32_16x16x32_bf16 v[68:71], v[20:23], v[216:219], v[68:71]
  v_max_f32 v127, 0, v127
  v_add_f32 v125, 0x3727c5ac, v125
  v_mfma_f32_16x16x32_bf16 v[72:75], v[20:23], v[220:223], v[72:75]
  s_waitcnt lgkmcnt(2)
  v_add_f32 v127, 0x3727c5ac, v127
  v_mfma_f32_16x16x32_bf16 v[76:79], v[24:27], v[208:211], v[76:79]
  ds_read_b128 v[20:23], v2 offset:38912
  v_mfma_f32_16x16x32_bf16 v[80:83], v[24:27], v[212:215], v[80:83]
  v_rsq_f32 v125, v125
  v_mfma_f32_16x16x32_bf16 v[84:87], v[24:27], v[216:219], v[84:87]
  v_rsq_f32 v127, v127
  v_mfma_f32_16x16x32_bf16 v[88:91], v[24:27], v[220:223], v[88:91]
  s_waitcnt lgkmcnt(2)
  v_mfma_f32_16x16x32_bf16 v[60:63], v[12:15], v[224:227], v[60:63]
  ds_read_b128 v[24:27], v2 offset:39168
  v_mfma_f32_16x16x32_bf16 v[64:67], v[12:15], v[228:231], v[64:67]
  v_add_u32 v2, s55, v2
  v_add_u32 v3, s55, v3
  v_mfma_f32_16x16x32_bf16 v[68:71], v[12:15], v[232:235], v[68:71]
  s_sub_u32 s55, 0, s55
  v_mfma_f32_16x16x32_bf16 v[72:75], v[12:15], v[236:239], v[72:75]
  s_waitcnt lgkmcnt(2)
  v_mfma_f32_16x16x32_bf16 v[76:79], v[16:19], v[224:227], v[76:79]
  v_mfma_f32_16x16x32_bf16 v[80:83], v[16:19], v[228:231], v[80:83]
  v_mfma_f32_16x16x32_bf16 v[84:87], v[16:19], v[232:235], v[84:87]
  s_cmp_eq_u32 s49, 0
  s_cbranch_scc1 L_v_slow1
  v_mfma_f32_16x16x32_bf16 v[88:91], v[16:19], v[236:239], v[88:91]
  s_waitcnt vmcnt(4) lgkmcnt(0)
  s_barrier
  ds_read_b128 v[12:15], v2 offset:0
  v_mfma_f32_16x16x32_bf16 v[60:63], v[20:23], v[240:243], v[60:63]
  ds_read_b128 v[16:19], v2 offset:256
  v_mfma_f32_16x16x32_bf16 v[64:67], v[20:23], v[244:247], v[64:67]
  v_mfma_f32_16x16x32_bf16 v[68:71], v[20:23], v[248:251], v[68:71]
  v_mfma_f32_16x16x32_bf16 v[72:75], v[20:23], v[252:255], v[72:75]
  ds_read_b128 v[20:23], v2 offset:2048
  v_mfma_f32_16x16x32_bf16 v[76:79], v[24:27], v[240:243], v[76:79]
  v_mfma_f32_16x16x32_bf16 v[80:83], v[24:27], v[244:247], v[80:83]
  v_mfma_f32_16x16x32_bf16 v[84:87], v[24:27], v[248:251], v[84:87]
  v_mfma_f32_16x16x32_bf16 v[88:91], v[24:27], v[252:255], v[88:91]
  s_branch L_v_body0
L_v_entry0:
  s_barrier
  ds_read_b128 v[12:15], v2 offset:0
  ds_read_b128 v[16:19], v2 offset:256
  ds_read_b128 v[20:23], v2 offset:2048
  s_branch L_v_body0
L_v_slow0:
  v_mfma_f32_16x16x32_bf16 v[56:59], v[16:19], v[236:239], v[56:59]
  s_waitcnt lgkmcnt(0)
  v_mfma_f32_16x16x32_bf16 v[28:31], v[20:23], v[240:243], v[28:31]
  v_mfma_f32_16x16x32_bf16 v[32:35], v[20:23], v[244:247], v[32:35]
  v_mfma_f32_16x16x32_bf16 v[36:39], v[20:23], v[248:251], v[36:39]
  v_mfma_f32_16x16x32_bf16 v[40:43], v[20:23], v[252:255], v[40:43]
  v_mfma_f32_16x16x32_bf16 v[44:47], v[24:27], v[240:243], v[44:47]
  v_mfma_f32_16x16x32_bf16 v[48:51], v[24:27], v[244:247], v[48:51]
  v_mfma_f32_16x16x32_bf16 v[52:55], v[24:27], v[248:251], v[52:55]
  v_mfma_f32_16x16x32_bf16 v[56:59], v[24:27], v[252:255], v[56:59]
  s_mov_b32 s47, s64
  s_cmp_eq_u32 s42, s80
  s_cbranch_scc1 L_nonext_5234
  s_waitcnt vmcnt(0)
  s_barrier
  ds_read_b32 v5, v171
  s_waitcnt lgkmcnt(0)
  v_cmp_ge_i32 vcc, s46, v5
  s_cmp_eq_u32 s45, 0
  s_cselect_b32 s51, vcc_lo, vcc_hi
  s_cmp_lg_u32 s51, 0
  s_cbranch_scc1 L_nonext_5234
  s_add_u32 m0, s50, 0
  s_add_u32 s51, s47, 0
  buffer_load_dwordx4 v1, s[4:7], s51 offen sc1 lds
  s_add_u32 m0, s50, 4096
  s_add_u32 s51, s47, 4096
  buffer_load_dwordx4 v1, s[4:7], s51 offen sc1 lds
  s_add_u32 m0, s50, 8192
  s_add_u32 s51, s47, 8192
  buffer_load_dwordx4 v1, s[4:7], s51 offen sc1 lds
  s_add_u32 m0, s50, 12288
  s_add_u32 s51, s47, 12288
  buffer_load_dwordx4 v1, s[4:7], s51 offen sc1 lds
  s_add_u32 m0, s50, 16384
  s_add_u32 s51, s47, 16384
  buffer_load_dwordx4 v1, s[4:7], s51 offen sc1 lds
  s_add_u32 m0, s50, 20480
  s_add_u32 s51, s47, 20480
  buffer_load_dwordx4 v1, s[4:7], s51 offen sc1 lds
  s_add_u32 m0, s50, 24576
  s_add_u32 s51, s47, 24576
  buffer_load_dwordx4 v1, s[4:7], s51 offen sc1 lds
  s_add_u32 m0, s50, 28672
  s_add_u32 s51, s47, 28672
  buffer_load_dwordx4 v1, s[4:7], s51 offen sc1 lds
  s_add_u32 m0, s50, 32768
  s_add_u32 s51, s47, 32768
  buffer_load_dwordx4 v1, s[4:7], s51 offen sc1 lds
  s_add_u32 m0, s50, 36864
  s_add_u32 s51, s47, 36864
  buffer_load_dwordx4 v1, s[4:7], s51 offen sc1 lds
  s_add_u32 m0, s50, 40960
  s_add_u32 s51, s47, 40960
  buffer_load_dwordx4 v9, s[4:7], s51 offen sc1 lds
  v_fmac_f32_dpp v28, v124, v144 quad_perm:[0,0,0,0] row_mask:0xf bank_mask:0xf
  v_fmac_f32_dpp v29, v124, v144 quad_perm:[1,1,1,1] row_mask:0xf bank_mask:0xf
  v_fmac_f32_dpp v30, v124, v144 quad_perm:[2,2,2,2] row_mask:0xf bank_mask:0xf
  v_fmac_f32_dpp v31, v124, v144 quad_perm:[3,3,3,3] row_mask:0xf bank_mask:0xf
  v_mul_f32_dpp v28, v125, v28 quad_perm:[0,0,0,0] row_mask:0xf bank_mask:0xf
  v_mul_f32_dpp v29, v125, v29 quad_perm:[1,1,1,1] row_mask:0xf bank_mask:0xf
  v_mul_f32_dpp v30, v125, v30 quad_perm:[2,2,2,2] row_mask:0xf bank_mask:0xf
  v_mul_f32_dpp v31, v125, v31 quad_perm:[3,3,3,3] row_mask:0xf bank_mask:0xf
  v_cvt_pk_bf16_f32 v92, v28, v29
  v_cvt_pk_bf16_f32 v93, v30, v31
  v_fmac_f32_dpp v44, v126, v144 quad_perm:[0,0,0,0] row_mask:0xf bank_mask:0xf
  v_fmac_f32_dpp v45, v126, v144 quad_perm:[1,1,1,1] row_mask:0xf bank_mask:0xf
  v_fmac_f32_dpp v46, v126, v144 quad_perm:[2,2,2,2] row_mask:0xf bank_mask:0xf
  v_fmac_f32_dpp v47, v126, v144 quad_perm:[3,3,3,3] row_mask:0xf bank_mask:0xf
  v_mul_f32_dpp v44, v127, v44 quad_perm:[0,0,0,0] row_mask:0xf bank_mask:0xf
  v_mul_f32_dpp v45, v127, v45 quad_perm:[1,1,1,1] row_mask:0xf bank_mask:0xf
  v_mul_f32_dpp v46, v127, v46 quad_perm:[2,2,2,2] row_mask:0xf bank_mask:0xf
  v_mul_f32_dpp v47, v127, v47 quad_perm:[3,3,3,3] row_mask:0xf bank_mask:0xf
  v_cvt_pk_bf16_f32 v94, v44, v45
  v_cvt_pk_bf16_f32 v95, v46, v47
  buffer_store_dwordx4 v[92:95], v1, s[4:7], s57 offen offset:0 sc1
  v_fmac_f32_dpp v32, v124, v148 quad_perm:[0,0,0,0] row_mask:0xf bank_mask:0xf
  v_fmac_f32_dpp v33, v124, v148 quad_perm:[1,1,1,1] row_mask:0xf bank_mask:0xf
  v_fmac_f32_dpp v34, v124, v148 quad_perm:[2,2,2,2] row_mask:0xf bank_mask:0xf
  v_fmac_f32_dpp v35, v124, v148 quad_perm:[3,3,3,3] row_mask:0xf bank_mask:0xf
  v_mul_f32_dpp v32, v125, v32 quad_perm:[0,0,0,0] row_mask:0xf bank_mask:0xf
  v_mul_f32_dpp v33, v125, v33 quad_perm:[1,1,1,1] row_mask:0xf bank_mask:0xf
  v_mul_f32_dpp v34, v125, v34 quad_perm:[2,2,2,2] row_mask:0xf bank_mask:0xf
  v_mul_f32_dpp v35, v125, v35 quad_perm:[3,3,3,3] row_mask:0xf bank_mask:0xf
  v_cvt_pk_bf16_f32 v96, v32, v33
  v_cvt_pk_bf16_f32 v97, v34, v35
  v_fmac_f32_dpp v48, v126, v148 quad_perm:[0,0,0,0] row_mask:0xf bank_mask:0xf
  v_fmac_f32_dpp v49, v126, v148 quad_perm:[1,1,1,1] row_mask:0xf bank_mask:0xf
  v_fmac_f32_dpp v50, v126, v148 quad_perm:[2,2,2,2] row_mask:0xf bank_mask:0xf
  v_fmac_f32_dpp v51, v126, v148 quad_perm:[3,3,3,3] row_mask:0xf bank_mask:0xf
  v_mul_f32_dpp v48, v127, v48 quad_perm:[0,0,0,0] row_mask:0xf bank_mask:0xf
  v_mul_f32_dpp v49, v127, v49 quad_perm:[1,1,1,1] row_mask:0xf bank_mask:0xf
  v_mul_f32_dpp v50, v127, v50 quad_perm:[2,2,2,2] row_mask:0xf bank_mask:0xf
  v_mul_f32_dpp v51, v127, v51 quad_perm:[3,3,3,3] row_mask:0xf bank_mask:0xf
  v_cvt_pk_bf16_f32 v98, v48, v49
  v_cvt_pk_bf16_f32 v99, v50, v51
  buffer_store_dwordx4 v[96:99], v1, s[4:7], s57 offen offset:1024 sc1
  v_fmac_f32_dpp v36, v124, v152 quad_perm:[0,0,0,0] row_mask:0xf bank_mask:0xf
  v_fmac_f32_dpp v37, v124, v152 quad_perm:[1,1,1,1] row_mask:0xf bank_mask:0xf
  v_fmac_f32_dpp v38, v124, v152 quad_perm:[2,2,2,2] row_mask:0xf bank_mask:0xf
  v_fmac_f32_dpp v39, v124, v152 quad_perm:[3,3,3,3] row_mask:0xf bank_mask:0xf
  v_mul_f32_dpp v36, v125, v36 quad_perm:[0,0,0,0] row_mask:0xf bank_mask:0xf
  v_mul_f32_dpp v37, v125, v37 quad_perm:[1,1,1,1] row_mask:0xf bank_mask:0xf
  v_mul_f32_dpp v38, v125, v38 quad_perm:[2,2,2,2] row_mask:0xf bank_mask:0xf
  v_mul_f32_dpp v39, v125, v39 quad_perm:[3,3,3,3] row_mask:0xf bank_mask:0xf
  v_cvt_pk_bf16_f32 v100, v36, v37
  v_cvt_pk_bf16_f32 v101, v38, v39
  v_fmac_f32_dpp v52, v126, v152 quad_perm:[0,0,0,0] row_mask:0xf bank_mask:0xf
  v_fmac_f32_dpp v53, v126, v152 quad_perm:[1,1,1,1] row_mask:0xf bank_mask:0xf
  v_fmac_f32_dpp v54, v126, v152 quad_perm:[2,2,2,2] row_mask:0xf bank_mask:0xf
  v_fmac_f32_dpp v55, v126, v152 quad_perm:[3,3,3,3] row_mask:0xf bank_mask:0xf
  v_mul_f32_dpp v52, v127, v52 quad_perm:[0,0,0,0] row_mask:0xf bank_mask:0xf
  v_mul_f32_dpp v53, v127, v53 quad_perm:[1,1,1,1] row_mask:0xf bank_mask:0xf
  v_mul_f32_dpp v54, v127, v54 quad_perm:[2,2,2,2] row_mask:0xf bank_mask:0xf
  v_mul_f32_dpp v55, v127, v55 quad_perm:[3,3,3,3] row_mask:0xf bank_mask:0xf
  v_cvt_pk_bf16_f32 v102, v52, v53
  v_cvt_pk_bf16_f32 v103, v54, v55
  buffer_store_dwordx4 v[100:103], v1, s[4:7], s57 offen offset:2048 sc1
  v_fmac_f32_dpp v40, v124, v156 quad_perm:[0,0,0,0] row_mask:0xf bank_mask:0xf
  v_fmac_f32_dpp v41, v124, v156 quad_perm:[1,1,1,1] row_mask:0xf bank_mask:0xf
  v_fmac_f32_dpp v42, v124, v156 quad_perm:[2,2,2,2] row_mask:0xf bank_mask:0xf
  v_fmac_f32_dpp v43, v124, v156 quad_perm:[3,3,3,3] row_mask:0xf bank_mask:0xf
  v_mul_f32_dpp v40, v125, v40 quad_perm:[0,0,0,0] row_mask:0xf bank_mask:0xf
  v_mul_f32_dpp v41, v125, v41 quad_perm:[1,1,1,1] row_mask:0xf bank_mask:0xf
  v_mul_f32_dpp v42, v125, v42 quad_perm:[2,2,2,2] row_mask:0xf bank_mask:0xf
  v_mul_f32_dpp v43, v125, v43 quad_perm:[3,3,3,3] row_mask:0xf bank_mask:0xf
  v_cvt_pk_bf16_f32 v104, v40, v41
  v_cvt_pk_bf16_f32 v105, v42, v43
  v_fmac_f32_dpp v56, v126, v156 quad_perm:[0,0,0,0] row_mask:0xf bank_mask:0xf
  v_fmac_f32_dpp v57, v126, v156 quad_perm:[1,1,1,1] row_mask:0xf bank_mask:0xf
  v_fmac_f32_dpp v58, v126, v156 quad_perm:[2,2,2,2] row_mask:0xf bank_mask:0xf
  v_fmac_f32_dpp v59, v126, v156 quad_perm:[3,3,3,3] row_mask:0xf bank_mask:0xf
  v_mul_f32_dpp v56, v127, v56 quad_perm:[0,0,0,0] row_mask:0xf bank_mask:0xf
  v_mul_f32_dpp v57, v127, v57 quad_perm:[1,1,1,1] row_mask:0xf bank_mask:0xf
  v_mul_f32_dpp v58, v127, v58 quad_perm:[2,2,2,2] row_mask:0xf bank_mask:0xf
  v_mul_f32_dpp v59, v127, v59 quad_perm:[3,3,3,3] row_mask:0xf bank_mask:0xf
  v_cvt_pk_bf16_f32 v106, v56, v57
  v_cvt_pk_bf16_f32 v107, v58, v59
  buffer_store_dwordx4 v[104:107], v1, s[4:7], s57 offen offset:3072 sc1
  s_mov_b32 s57, 0x20000000
  s_mov_b32 s58, 0x20000000
  s_mov_b32 s59, 0x20000000
  s_mov_b32 s60, 0x20000000
  s_waitcnt vmcnt(8)
  s_branch L_v_entry1
L_nonext_5234:
  s_xor_b32 s95, s95, 1024
  s_mov_b32 m0, s95
  v_xor_b32 v171, 1024, v171
  buffer_load_dword v4, s[4:7], s48 offen sc1 lds
  v_fmac_f32_dpp v28, v124, v144 quad_perm:[0,0,0,0] row_mask:0xf bank_mask:0xf
  v_fmac_f32_dpp v29, v124, v144 quad_perm:[1,1,1,1] row_mask:0xf bank_mask:0xf
  v_fmac_f32_dpp v30, v124, v144 quad_perm:[2,2,2,2] row_mask:0xf bank_mask:0xf
  v_fmac_f32_dpp v31, v124, v144 quad_perm:[3,3,3,3] row_mask:0xf bank_mask:0xf
  v_mul_f32_dpp v28, v125, v28 quad_perm:[0,0,0,0] row_mask:0xf bank_mask:0xf
  v_mul_f32_dpp v29, v125, v29 quad_perm:[1,1,1,1] row_mask:0xf bank_mask:0xf
  v_mul_f32_dpp v30, v125, v30 quad_perm:[2,2,2,2] row_mask:0xf bank_mask:0xf
  v_mul_f32_dpp v31, v125, v31 quad_perm:[3,3,3,3] row_mask:0xf bank_mask:0xf
  v_cvt_pk_bf16_f32 v92, v28, v29
  v_cvt_pk_bf16_f32 v93, v30, v31
  v_fmac_f32_dpp v44, v126, v144 quad_perm:[0,0,0,0] row_mask:0xf bank_mask:0xf
  v_fmac_f32_dpp v45, v126, v144 quad_perm:[1,1,1,1] row_mask:0xf bank_mask:0xf
  v_fmac_f32_dpp v46, v126, v144 quad_perm:[2,2,2,2] row_mask:0xf bank_mask:0xf
  v_fmac_f32_dpp v47, v126, v144 quad_perm:[3,3,3,3] row_mask:0xf bank_mask:0xf
  v_mul_f32_dpp v44, v127, v44 quad_perm:[0,0,0,0] row_mask:0xf bank_mask:0xf
  v_mul_f32_dpp v45, v127, v45 quad_perm:[1,1,1,1] row_mask:0xf bank_mask:0xf
  v_mul_f32_dpp v46, v127, v46 quad_perm:[2,2,2,2] row_mask:0xf bank_mask:0xf
  v_mul_f32_dpp v47, v127, v47 quad_perm:[3,3,3,3] row_mask:0xf bank_mask:0xf
  v_cvt_pk_bf16_f32 v94, v44, v45
  v_cvt_pk_bf16_f32 v95, v46, v47
  buffer_store_dwordx4 v[92:95], v1, s[4:7], s57 offen offset:0 sc1
  v_fmac_f32_dpp v32, v124, v148 quad_perm:[0,0,0,0] row_mask:0xf bank_mask:0xf
  v_fmac_f32_dpp v33, v124, v148 quad_perm:[1,1,1,1] row_mask:0xf bank_mask:0xf
  v_fmac_f32_dpp v34, v124, v148 quad_perm:[2,2,2,2] row_mask:0xf bank_mask:0xf
  v_fmac_f32_dpp v35, v124, v148 quad_perm:[3,3,3,3] row_mask:0xf bank_mask:0xf
  v_mul_f32_dpp v32, v125, v32 quad_perm:[0,0,0,0] row_mask:0xf bank_mask:0xf
  v_mul_f32_dpp v33, v125, v33 quad_perm:[1,1,1,1] row_mask:0xf bank_mask:0xf
  v_mul_f32_dpp v34, v125, v34 quad_perm:[2,2,2,2] row_mask:0xf bank_mask:0xf
  v_mul_f32_dpp v35, v125, v35 quad_perm:[3,3,3,3] row_mask:0xf bank_mask:0xf
  v_cvt_pk_bf16_f32 v96, v32, v33
  v_cvt_pk_bf16_f32 v97, v34, v35
  v_fmac_f32_dpp v48, v126, v148 quad_perm:[0,0,0,0] row_mask:0xf bank_mask:0xf
  v_fmac_f32_dpp v49, v126, v148 quad_perm:[1,1,1,1] row_mask:0xf bank_mask:0xf
  v_fmac_f32_dpp v50, v126, v148 quad_perm:[2,2,2,2] row_mask:0xf bank_mask:0xf
  v_fmac_f32_dpp v51, v126, v148 quad_perm:[3,3,3,3] row_mask:0xf bank_mask:0xf
  v_mul_f32_dpp v48, v127, v48 quad_perm:[0,0,0,0] row_mask:0xf bank_mask:0xf
  v_mul_f32_dpp v49, v127, v49 quad_perm:[1,1,1,1] row_mask:0xf bank_mask:0xf
  v_mul_f32_dpp v50, v127, v50 quad_perm:[2,2,2,2] row_mask:0xf bank_mask:0xf
  v_mul_f32_dpp v51, v127, v51 quad_perm:[3,3,3,3] row_mask:0xf bank_mask:0xf
  v_cvt_pk_bf16_f32 v98, v48, v49
  v_cvt_pk_bf16_f32 v99, v50, v51
  buffer_store_dwordx4 v[96:99], v1, s[4:7], s57 offen offset:1024 sc1
  v_fmac_f32_dpp v36, v124, v152 quad_perm:[0,0,0,0] row_mask:0xf bank_mask:0xf
  v_fmac_f32_dpp v37, v124, v152 quad_perm:[1,1,1,1] row_mask:0xf bank_mask:0xf
  v_fmac_f32_dpp v38, v124, v152 quad_perm:[2,2,2,2] row_mask:0xf bank_mask:0xf
  v_fmac_f32_dpp v39, v124, v152 quad_perm:[3,3,3,3] row_mask:0xf bank_mask:0xf
  v_mul_f32_dpp v36, v125, v36 quad_perm:[0,0,0,0] row_mask:0xf bank_mask:0xf
  v_mul_f32_dpp v37, v125, v37 quad_perm:[1,1,1,1] row_mask:0xf bank_mask:0xf
  v_mul_f32_dpp v38, v125, v38 quad_perm:[2,2,2,2] row_mask:0xf bank_mask:0xf
  v_mul_f32_dpp v39, v125, v39 quad_perm:[3,3,3,3] row_mask:0xf bank_mask:0xf
  v_cvt_pk_bf16_f32 v100, v36, v37
  v_cvt_pk_bf16_f32 v101, v38, v39
  v_fmac_f32_dpp v52, v126, v152 quad_perm:[0,0,0,0] row_mask:0xf bank_mask:0xf
  v_fmac_f32_dpp v53, v126, v152 quad_perm:[1,1,1,1] row_mask:0xf bank_mask:0xf
  v_fmac_f32_dpp v54, v126, v152 quad_perm:[2,2,2,2] row_mask:0xf bank_mask:0xf
  v_fmac_f32_dpp v55, v126, v152 quad_perm:[3,3,3,3] row_mask:0xf bank_mask:0xf
  v_mul_f32_dpp v52, v127, v52 quad_perm:[0,0,0,0] row_mask:0xf bank_mask:0xf
  v_mul_f32_dpp v53, v127, v53 quad_perm:[1,1,1,1] row_mask:0xf bank_mask:0xf
  v_mul_f32_dpp v54, v127, v54 quad_perm:[2,2,2,2] row_mask:0xf bank_mask:0xf
  v_mul_f32_dpp v55, v127, v55 quad_perm:[3,3,3,3] row_mask:0xf bank_mask:0xf
  v_cvt_pk_bf16_f32 v102, v52, v53
  v_cvt_pk_bf16_f32 v103, v54, v55
  buffer_store_dwordx4 v[100:103], v1, s[4:7], s57 offen offset:2048 sc1
  v_fmac_f32_dpp v40, v124, v156 quad_perm:[0,0,0,0] row_mask:0xf bank_mask:0xf
  v_fmac_f32_dpp v41, v124, v156 quad_perm:[1,1,1,1] row_mask:0xf bank_mask:0xf
  v_fmac_f32_dpp v42, v124, v156 quad_perm:[2,2,2,2] row_mask:0xf bank_mask:0xf
  v_fmac_f32_dpp v43, v124, v156 quad_perm:[3,3,3,3] row_mask:0xf bank_mask:0xf
  v_mul_f32_dpp v40, v125, v40 quad_perm:[0,0,0,0] row_mask:0xf bank_mask:0xf
  v_mul_f32_dpp v41, v125, v41 quad_perm:[1,1,1,1] row_mask:0xf bank_mask:0xf
  v_mul_f32_dpp v42, v125, v42 quad_perm:[2,2,2,2] row_mask:0xf bank_mask:0xf
  v_mul_f32_dpp v43, v125, v43 quad_perm:[3,3,3,3] row_mask:0xf bank_mask:0xf
  v_cvt_pk_bf16_f32 v104, v40, v41
  v_cvt_pk_bf16_f32 v105, v42, v43
  v_fmac_f32_dpp v56, v126, v156 quad_perm:[0,0,0,0] row_mask:0xf bank_mask:0xf
  v_fmac_f32_dpp v57, v126, v156 quad_perm:[1,1,1,1] row_mask:0xf bank_mask:0xf
  v_fmac_f32_dpp v58, v126, v156 quad_perm:[2,2,2,2] row_mask:0xf bank_mask:0xf
  v_fmac_f32_dpp v59, v126, v156 quad_perm:[3,3,3,3] row_mask:0xf bank_mask:0xf
  v_mul_f32_dpp v56, v127, v56 quad_perm:[0,0,0,0] row_mask:0xf bank_mask:0xf
  v_mul_f32_dpp v57, v127, v57 quad_perm:[1,1,1,1] row_mask:0xf bank_mask:0xf
  v_mul_f32_dpp v58, v127, v58 quad_perm:[2,2,2,2] row_mask:0xf bank_mask:0xf
  v_mul_f32_dpp v59, v127, v59 quad_perm:[3,3,3,3] row_mask:0xf bank_mask:0xf
  v_cvt_pk_bf16_f32 v106, v56, v57
  v_cvt_pk_bf16_f32 v107, v58, v59
  buffer_store_dwordx4 v[104:107], v1, s[4:7], s57 offen offset:3072 sc1
  s_mov_b32 s47, s64
  s_cmp_eq_u32 s42, s80
  s_cbranch_scc1 L_v_fin0
  s_waitcnt vmcnt(4)
  s_barrier
  ds_read_b32 v5, v171
  s_waitcnt lgkmcnt(0)
  v_cmp_ge_i32 vcc, s46, v5
  s_cmp_eq_u32 s45, 0
  s_cselect_b32 s51, vcc_lo, vcc_hi
  s_cmp_lg_u32 s51, 0
  s_cbranch_scc1 L_v_drain0
  s_add_u32 m0, s50, 0
  s_add_u32 s51, s47, 0
  buffer_load_dwordx4 v1, s[4:7], s51 offen sc1 lds
  s_add_u32 m0, s50, 4096
  s_add_u32 s51, s47, 4096
  buffer_load_dwordx4 v1, s[4:7], s51 offen sc1 lds
  s_add_u32 m0, s50, 8192
  s_add_u32 s51, s47, 8192
  buffer_load_dwordx4 v1, s[4:7], s51 offen sc1 lds
  s_add_u32 m0, s50, 12288
  s_add_u32 s51, s47, 12288
  buffer_load_dwordx4 v1, s[4:7], s51 offen sc1 lds
  s_add_u32 m0, s50, 16384
  s_add_u32 s51, s47, 16384
  buffer_load_dwordx4 v1, s[4:7], s51 offen sc1 lds
  s_add_u32 m0, s50, 20480
  s_add_u32 s51, s47, 20480
  buffer_load_dwordx4 v1, s[4:7], s51 offen sc1 lds
  s_add_u32 m0, s50, 24576
  s_add_u32 s51, s47, 24576
  buffer_load_dwordx4 v1, s[4:7], s51 offen sc1 lds
  s_add_u32 m0, s50, 28672
  s_add_u32 s51, s47, 28672
  buffer_load_dwordx4 v1, s[4:7], s51 offen sc1 lds
  s_add_u32 m0, s50, 32768
  s_add_u32 s51, s47, 32768
  buffer_load_dwordx4 v1, s[4:7], s51 offen sc1 lds
  s_add_u32 m0, s50, 36864
  s_add_u32 s51, s47, 36864
  buffer_load_dwordx4 v1, s[4:7], s51 offen sc1 lds
  s_add_u32 m0, s50, 40960
  s_add_u32 s51, s47, 40960
  buffer_load_dwordx4 v9, s[4:7], s51 offen sc1 lds
  s_waitcnt vmcnt(11)
  s_barrier
  v_mov_b32 v7, s62
  buffer_store_dword v7, v0, s[4:7], s61 offen offset:0 sc1
  s_mov_b32 s57, 0x20000000
  s_mov_b32 s58, 0x20000000
  s_mov_b32 s59, 0x20000000
  s_mov_b32 s60, 0x20000000
  s_mov_b32 s61, 0x20000000
  s_waitcnt vmcnt(5)
  s_branch L_v_entry1
L_v_drain0:
  s_waitcnt vmcnt(0)
  s_barrier
  v_mov_b32 v7, s62
  buffer_store_dword v7, v0, s[4:7], s61 offen offset:0 sc1
  s_mov_b32 s57, 0x20000000
  s_mov_b32 s58, 0x20000000
  s_mov_b32 s59, 0x20000000
  s_mov_b32 s60, 0x20000000
  s_mov_b32 s61, 0x20000000
L_v_spin0:
  s_sleep 1
  s_xor_b32 s95, s95, 1024
  s_mov_b32 m0, s95
  v_xor_b32 v171, 1024, v171
  buffer_load_dword v4, s[4:7], s48 offen sc1 lds
  s_add_u32 s94, s94, 1
  s_cmp_lt_u32 s94, 100000
  s_cselect_b32 s52, s46, -2
  s_waitcnt vmcnt(0)
  s_barrier
  ds_read_b32 v5, v171
  s_waitcnt lgkmcnt(0)
  v_cmp_ge_i32 vcc, s52, v5
  s_cmp_eq_u32 s45, 0
  s_cselect_b32 s51, vcc_lo, vcc_hi
  s_cmp_lg_u32 s51, 0
  s_cbranch_scc1 L_v_spin0
  s_add_u32 m0, s50, 0
  s_add_u32 s51, s47, 0
  buffer_load_dwordx4 v1, s[4:7], s51 offen sc1 lds
  s_add_u32 m0, s50, 4096
  s_add_u32 s51, s47, 4096
  buffer_load_dwordx4 v1, s[4:7], s51 offen sc1 lds
  s_add_u32 m0, s50, 8192
  s_add_u32 s51, s47, 8192
  buffer_load_dwordx4 v1, s[4:7], s51 offen sc1 lds
  s_add_u32 m0, s50, 12288
  s_add_u32 s51, s47, 12288
  buffer_load_dwordx4 v1, s[4:7], s51 offen sc1 lds
  s_add_u32 m0, s50, 16384
  s_add_u32 s51, s47, 16384
  buffer_load_dwordx4 v1, s[4:7], s51 offen sc1 lds
  s_add_u32 m0, s50, 20480
  s_add_u32 s51, s47, 20480
  buffer_load_dwordx4 v1, s[4:7], s51 offen sc1 lds
  s_add_u32 m0, s50, 24576
  s_add_u32 s51, s47, 24576
  buffer_load_dwordx4 v1, s[4:7], s51 offen sc1 lds
  s_add_u32 m0, s50, 28672
  s_add_u32 s51, s47, 28672
  buffer_load_dwordx4 v1, s[4:7], s51 offen sc1 lds
  s_add_u32 m0, s50, 32768
  s_add_u32 s51, s47, 32768
  buffer_load_dwordx4 v1, s[4:7], s51 offen sc1 lds
  s_add_u32 m0, s50, 36864
  s_add_u32 s51, s47, 36864
  buffer_load_dwordx4 v1, s[4:7], s51 offen sc1 lds
  s_add_u32 m0, s50, 40960
  s_add_u32 s51, s47, 40960
  buffer_load_dwordx4 v9, s[4:7], s51 offen sc1 lds
  s_waitcnt vmcnt(4)
  s_branch L_v_entry1
L_v_fin0:
  s_waitcnt vmcnt(0)
  s_barrier
  v_mov_b32 v7, s62
  buffer_store_dword v7, v0, s[4:7], s61 offen offset:0 sc1
  s_cmp_lg_u32 s100, 0
  s_cbranch_scc1 L_helper_done
  s_endpgm
L_v_entry1:
  s_barrier
  ds_read_b128 v[12:15], v2 offset:0
  ds_read_b128 v[16:19], v2 offset:256
  ds_read_b128 v[20:23], v2 offset:2048
  s_branch L_v_body1
L_v_slow1:
  v_mfma_f32_16x16x32_bf16 v[88:91], v[16:19], v[236:239], v[88:91]
  s_waitcnt lgkmcnt(0)
  v_mfma_f32_16x16x32_bf16 v[60:63], v[20:23], v[240:243], v[60:63]
  v_mfma_f32_16x16x32_bf16 v[64:67], v[20:23], v[244:247], v[64:67]
  v_mfma_f32_16x16x32_bf16 v[68:71], v[20:23], v[248:251], v[68:71]
  v_mfma_f32_16x16x32_bf16 v[72:75], v[20:23], v[252:255], v[72:75]
  v_mfma_f32_16x16x32_bf16 v[76:79], v[24:27], v[240:243], v[76:79]
  v_mfma_f32_16x16x32_bf16 v[80:83], v[24:27], v[244:247], v[80:83]
  v_mfma_f32_16x16x32_bf16 v[84:87], v[24:27], v[248:251], v[84:87]
  v_mfma_f32_16x16x32_bf16 v[88:91], v[24:27], v[252:255], v[88:91]
  s_mov_b32 s47, s64
  s_cmp_eq_u32 s42, s80
  s_cbranch_scc1 L_nonext_5235
  s_waitcnt vmcnt(0)
  s_barrier
  ds_read_b32 v5, v171
  s_waitcnt lgkmcnt(0)
  v_cmp_ge_i32 vcc, s46, v5
  s_cmp_eq_u32 s45, 0
  s_cselect_b32 s51, vcc_lo, vcc_hi
  s_cmp_lg_u32 s51, 0
  s_cbranch_scc1 L_nonext_5235
  s_add_u32 m0, s50, 0
  s_add_u32 s51, s47, 0
  buffer_load_dwordx4 v1, s[4:7], s51 offen sc1 lds
  s_add_u32 m0, s50, 4096
  s_add_u32 s51, s47, 4096
  buffer_load_dwordx4 v1, s[4:7], s51 offen sc1 lds
  s_add_u32 m0, s50, 8192
  s_add_u32 s51, s47, 8192
  buffer_load_dwordx4 v1, s[4:7], s51 offen sc1 lds
  s_add_u32 m0, s50, 12288
  s_add_u32 s51, s47, 12288
  buffer_load_dwordx4 v1, s[4:7], s51 offen sc1 lds
  s_add_u32 m0, s50, 16384
  s_add_u32 s51, s47, 16384
  buffer_load_dwordx4 v1, s[4:7], s51 offen sc1 lds
  s_add_u32 m0, s50, 20480
  s_add_u32 s51, s47, 20480
  buffer_load_dwordx4 v1, s[4:7], s51 offen sc1 lds
  s_add_u32 m0, s50, 24576
  s_add_u32 s51, s47, 24576
  buffer_load_dwordx4 v1, s[4:7], s51 offen sc1 lds
  s_add_u32 m0, s50, 28672
  s_add_u32 s51, s47, 28672
  buffer_load_dwordx4 v1, s[4:7], s51 offen sc1 lds
  s_add_u32 m0, s50, 32768
  s_add_u32 s51, s47, 32768
  buffer_load_dwordx4 v1, s[4:7], s51 offen sc1 lds
  s_add_u32 m0, s50, 36864
  s_add_u32 s51, s47, 36864
  buffer_load_dwordx4 v1, s[4:7], s51 offen sc1 lds
  s_add_u32 m0, s50, 40960
  s_add_u32 s51, s47, 40960
  buffer_load_dwordx4 v9, s[4:7], s51 offen sc1 lds
  v_fmac_f32_dpp v60, v124, v144 quad_perm:[0,0,0,0] row_mask:0xf bank_mask:0xf
  v_fmac_f32_dpp v61, v124, v144 quad_perm:[1,1,1,1] row_mask:0xf bank_mask:0xf
  v_fmac_f32_dpp v62, v124, v144 quad_perm:[2,2,2,2] row_mask:0xf bank_mask:0xf
  v_fmac_f32_dpp v63, v124, v144 quad_perm:[3,3,3,3] row_mask:0xf bank_mask:0xf
  v_mul_f32_dpp v60, v125, v60 quad_perm:[0,0,0,0] row_mask:0xf bank_mask:0xf
  v_mul_f32_dpp v61, v125, v61 quad_perm:[1,1,1,1] row_mask:0xf bank_mask:0xf
  v_mul_f32_dpp v62, v125, v62 quad_perm:[2,2,2,2] row_mask:0xf bank_mask:0xf
  v_mul_f32_dpp v63, v125, v63 quad_perm:[3,3,3,3] row_mask:0xf bank_mask:0xf
  v_cvt_pk_bf16_f32 v92, v60, v61
  v_cvt_pk_bf16_f32 v93, v62, v63
  v_fmac_f32_dpp v76, v126, v144 quad_perm:[0,0,0,0] row_mask:0xf bank_mask:0xf
  v_fmac_f32_dpp v77, v126, v144 quad_perm:[1,1,1,1] row_mask:0xf bank_mask:0xf
  v_fmac_f32_dpp v78, v126, v144 quad_perm:[2,2,2,2] row_mask:0xf bank_mask:0xf
  v_fmac_f32_dpp v79, v126, v144 quad_perm:[3,3,3,3] row_mask:0xf bank_mask:0xf
  v_mul_f32_dpp v76, v127, v76 quad_perm:[0,0,0,0] row_mask:0xf bank_mask:0xf
  v_mul_f32_dpp v77, v127, v77 quad_perm:[1,1,1,1] row_mask:0xf bank_mask:0xf
  v_mul_f32_dpp v78, v127, v78 quad_perm:[2,2,2,2] row_mask:0xf bank_mask:0xf
  v_mul_f32_dpp v79, v127, v79 quad_perm:[3,3,3,3] row_mask:0xf bank_mask:0xf
  v_cvt_pk_bf16_f32 v94, v76, v77
  v_cvt_pk_bf16_f32 v95, v78, v79
  buffer_store_dwordx4 v[92:95], v1, s[4:7], s57 offen offset:0 sc1
  v_fmac_f32_dpp v64, v124, v148 quad_perm:[0,0,0,0] row_mask:0xf bank_mask:0xf
  v_fmac_f32_dpp v65, v124, v148 quad_perm:[1,1,1,1] row_mask:0xf bank_mask:0xf
  v_fmac_f32_dpp v66, v124, v148 quad_perm:[2,2,2,2] row_mask:0xf bank_mask:0xf
  v_fmac_f32_dpp v67, v124, v148 quad_perm:[3,3,3,3] row_mask:0xf bank_mask:0xf
  v_mul_f32_dpp v64, v125, v64 quad_perm:[0,0,0,0] row_mask:0xf bank_mask:0xf
  v_mul_f32_dpp v65, v125, v65 quad_perm:[1,1,1,1] row_mask:0xf bank_mask:0xf
  v_mul_f32_dpp v66, v125, v66 quad_perm:[2,2,2,2] row_mask:0xf bank_mask:0xf
  v_mul_f32_dpp v67, v125, v67 quad_perm:[3,3,3,3] row_mask:0xf bank_mask:0xf
  v_cvt_pk_bf16_f32 v96, v64, v65
  v_cvt_pk_bf16_f32 v97, v66, v67
  v_fmac_f32_dpp v80, v126, v148 quad_perm:[0,0,0,0] row_mask:0xf bank_mask:0xf
  v_fmac_f32_dpp v81, v126, v148 quad_perm:[1,1,1,1] row_mask:0xf bank_mask:0xf
  v_fmac_f32_dpp v82, v126, v148 quad_perm:[2,2,2,2] row_mask:0xf bank_mask:0xf
  v_fmac_f32_dpp v83, v126, v148 quad_perm:[3,3,3,3] row_mask:0xf bank_mask:0xf
  v_mul_f32_dpp v80, v127, v80 quad_perm:[0,0,0,0] row_mask:0xf bank_mask:0xf
  v_mul_f32_dpp v81, v127, v81 quad_perm:[1,1,1,1] row_mask:0xf bank_mask:0xf
  v_mul_f32_dpp v82, v127, v82 quad_perm:[2,2,2,2] row_mask:0xf bank_mask:0xf
  v_mul_f32_dpp v83, v127, v83 quad_perm:[3,3,3,3] row_mask:0xf bank_mask:0xf
  v_cvt_pk_bf16_f32 v98, v80, v81
  v_cvt_pk_bf16_f32 v99, v82, v83
  buffer_store_dwordx4 v[96:99], v1, s[4:7], s57 offen offset:1024 sc1
  v_fmac_f32_dpp v68, v124, v152 quad_perm:[0,0,0,0] row_mask:0xf bank_mask:0xf
  v_fmac_f32_dpp v69, v124, v152 quad_perm:[1,1,1,1] row_mask:0xf bank_mask:0xf
  v_fmac_f32_dpp v70, v124, v152 quad_perm:[2,2,2,2] row_mask:0xf bank_mask:0xf
  v_fmac_f32_dpp v71, v124, v152 quad_perm:[3,3,3,3] row_mask:0xf bank_mask:0xf
  v_mul_f32_dpp v68, v125, v68 quad_perm:[0,0,0,0] row_mask:0xf bank_mask:0xf
  v_mul_f32_dpp v69, v125, v69 quad_perm:[1,1,1,1] row_mask:0xf bank_mask:0xf
  v_mul_f32_dpp v70, v125, v70 quad_perm:[2,2,2,2] row_mask:0xf bank_mask:0xf
  v_mul_f32_dpp v71, v125, v71 quad_perm:[3,3,3,3] row_mask:0xf bank_mask:0xf
  v_cvt_pk_bf16_f32 v100, v68, v69
  v_cvt_pk_bf16_f32 v101, v70, v71
  v_fmac_f32_dpp v84, v126, v152 quad_perm:[0,0,0,0] row_mask:0xf bank_mask:0xf
  v_fmac_f32_dpp v85, v126, v152 quad_perm:[1,1,1,1] row_mask:0xf bank_mask:0xf
  v_fmac_f32_dpp v86, v126, v152 quad_perm:[2,2,2,2] row_mask:0xf bank_mask:0xf
  v_fmac_f32_dpp v87, v126, v152 quad_perm:[3,3,3,3] row_mask:0xf bank_mask:0xf
  v_mul_f32_dpp v84, v127, v84 quad_perm:[0,0,0,0] row_mask:0xf bank_mask:0xf
  v_mul_f32_dpp v85, v127, v85 quad_perm:[1,1,1,1] row_mask:0xf bank_mask:0xf
  v_mul_f32_dpp v86, v127, v86 quad_perm:[2,2,2,2] row_mask:0xf bank_mask:0xf
  v_mul_f32_dpp v87, v127, v87 quad_perm:[3,3,3,3] row_mask:0xf bank_mask:0xf
  v_cvt_pk_bf16_f32 v102, v84, v85
  v_cvt_pk_bf16_f32 v103, v86, v87
  buffer_store_dwordx4 v[100:103], v1, s[4:7], s57 offen offset:2048 sc1
  v_fmac_f32_dpp v72, v124, v156 quad_perm:[0,0,0,0] row_mask:0xf bank_mask:0xf
  v_fmac_f32_dpp v73, v124, v156 quad_perm:[1,1,1,1] row_mask:0xf bank_mask:0xf
  v_fmac_f32_dpp v74, v124, v156 quad_perm:[2,2,2,2] row_mask:0xf bank_mask:0xf
  v_fmac_f32_dpp v75, v124, v156 quad_perm:[3,3,3,3] row_mask:0xf bank_mask:0xf
  v_mul_f32_dpp v72, v125, v72 quad_perm:[0,0,0,0] row_mask:0xf bank_mask:0xf
  v_mul_f32_dpp v73, v125, v73 quad_perm:[1,1,1,1] row_mask:0xf bank_mask:0xf
  v_mul_f32_dpp v74, v125, v74 quad_perm:[2,2,2,2] row_mask:0xf bank_mask:0xf
  v_mul_f32_dpp v75, v125, v75 quad_perm:[3,3,3,3] row_mask:0xf bank_mask:0xf
  v_cvt_pk_bf16_f32 v104, v72, v73
  v_cvt_pk_bf16_f32 v105, v74, v75
  v_fmac_f32_dpp v88, v126, v156 quad_perm:[0,0,0,0] row_mask:0xf bank_mask:0xf
  v_fmac_f32_dpp v89, v126, v156 quad_perm:[1,1,1,1] row_mask:0xf bank_mask:0xf
  v_fmac_f32_dpp v90, v126, v156 quad_perm:[2,2,2,2] row_mask:0xf bank_mask:0xf
  v_fmac_f32_dpp v91, v126, v156 quad_perm:[3,3,3,3] row_mask:0xf bank_mask:0xf
  v_mul_f32_dpp v88, v127, v88 quad_perm:[0,0,0,0] row_mask:0xf bank_mask:0xf
  v_mul_f32_dpp v89, v127, v89 quad_perm:[1,1,1,1] row_mask:0xf bank_mask:0xf
  v_mul_f32_dpp v90, v127, v90 quad_perm:[2,2,2,2] row_mask:0xf bank_mask:0xf
  v_mul_f32_dpp v91, v127, v91 quad_perm:[3,3,3,3] row_mask:0xf bank_mask:0xf
  v_cvt_pk_bf16_f32 v106, v88, v89
  v_cvt_pk_bf16_f32 v107, v90, v91
  buffer_store_dwordx4 v[104:107], v1, s[4:7], s57 offen offset:3072 sc1
  s_mov_b32 s57, 0x20000000
  s_mov_b32 s58, 0x20000000
  s_mov_b32 s59, 0x20000000
  s_mov_b32 s60, 0x20000000
  s_waitcnt vmcnt(8)
  s_branch L_v_entry0
L_nonext_5235:
  s_xor_b32 s95, s95, 1024
  s_mov_b32 m0, s95
  v_xor_b32 v171, 1024, v171
  buffer_load_dword v4, s[4:7], s48 offen sc1 lds
  v_fmac_f32_dpp v60, v124, v144 quad_perm:[0,0,0,0] row_mask:0xf bank_mask:0xf
  v_fmac_f32_dpp v61, v124, v144 quad_perm:[1,1,1,1] row_mask:0xf bank_mask:0xf
  v_fmac_f32_dpp v62, v124, v144 quad_perm:[2,2,2,2] row_mask:0xf bank_mask:0xf
  v_fmac_f32_dpp v63, v124, v144 quad_perm:[3,3,3,3] row_mask:0xf bank_mask:0xf
  v_mul_f32_dpp v60, v125, v60 quad_perm:[0,0,0,0] row_mask:0xf bank_mask:0xf
  v_mul_f32_dpp v61, v125, v61 quad_perm:[1,1,1,1] row_mask:0xf bank_mask:0xf
  v_mul_f32_dpp v62, v125, v62 quad_perm:[2,2,2,2] row_mask:0xf bank_mask:0xf
  v_mul_f32_dpp v63, v125, v63 quad_perm:[3,3,3,3] row_mask:0xf bank_mask:0xf
  v_cvt_pk_bf16_f32 v92, v60, v61
  v_cvt_pk_bf16_f32 v93, v62, v63
  v_fmac_f32_dpp v76, v126, v144 quad_perm:[0,0,0,0] row_mask:0xf bank_mask:0xf
  v_fmac_f32_dpp v77, v126, v144 quad_perm:[1,1,1,1] row_mask:0xf bank_mask:0xf
  v_fmac_f32_dpp v78, v126, v144 quad_perm:[2,2,2,2] row_mask:0xf bank_mask:0xf
  v_fmac_f32_dpp v79, v126, v144 quad_perm:[3,3,3,3] row_mask:0xf bank_mask:0xf
  v_mul_f32_dpp v76, v127, v76 quad_perm:[0,0,0,0] row_mask:0xf bank_mask:0xf
  v_mul_f32_dpp v77, v127, v77 quad_perm:[1,1,1,1] row_mask:0xf bank_mask:0xf
  v_mul_f32_dpp v78, v127, v78 quad_perm:[2,2,2,2] row_mask:0xf bank_mask:0xf
  v_mul_f32_dpp v79, v127, v79 quad_perm:[3,3,3,3] row_mask:0xf bank_mask:0xf
  v_cvt_pk_bf16_f32 v94, v76, v77
  v_cvt_pk_bf16_f32 v95, v78, v79
  buffer_store_dwordx4 v[92:95], v1, s[4:7], s57 offen offset:0 sc1
  v_fmac_f32_dpp v64, v124, v148 quad_perm:[0,0,0,0] row_mask:0xf bank_mask:0xf
  v_fmac_f32_dpp v65, v124, v148 quad_perm:[1,1,1,1] row_mask:0xf bank_mask:0xf
  v_fmac_f32_dpp v66, v124, v148 quad_perm:[2,2,2,2] row_mask:0xf bank_mask:0xf
  v_fmac_f32_dpp v67, v124, v148 quad_perm:[3,3,3,3] row_mask:0xf bank_mask:0xf
  v_mul_f32_dpp v64, v125, v64 quad_perm:[0,0,0,0] row_mask:0xf bank_mask:0xf
  v_mul_f32_dpp v65, v125, v65 quad_perm:[1,1,1,1] row_mask:0xf bank_mask:0xf
  v_mul_f32_dpp v66, v125, v66 quad_perm:[2,2,2,2] row_mask:0xf bank_mask:0xf
  v_mul_f32_dpp v67, v125, v67 quad_perm:[3,3,3,3] row_mask:0xf bank_mask:0xf
  v_cvt_pk_bf16_f32 v96, v64, v65
  v_cvt_pk_bf16_f32 v97, v66, v67
  v_fmac_f32_dpp v80, v126, v148 quad_perm:[0,0,0,0] row_mask:0xf bank_mask:0xf
  v_fmac_f32_dpp v81, v126, v148 quad_perm:[1,1,1,1] row_mask:0xf bank_mask:0xf
  v_fmac_f32_dpp v82, v126, v148 quad_perm:[2,2,2,2] row_mask:0xf bank_mask:0xf
  v_fmac_f32_dpp v83, v126, v148 quad_perm:[3,3,3,3] row_mask:0xf bank_mask:0xf
  v_mul_f32_dpp v80, v127, v80 quad_perm:[0,0,0,0] row_mask:0xf bank_mask:0xf
  v_mul_f32_dpp v81, v127, v81 quad_perm:[1,1,1,1] row_mask:0xf bank_mask:0xf
  v_mul_f32_dpp v82, v127, v82 quad_perm:[2,2,2,2] row_mask:0xf bank_mask:0xf
  v_mul_f32_dpp v83, v127, v83 quad_perm:[3,3,3,3] row_mask:0xf bank_mask:0xf
  v_cvt_pk_bf16_f32 v98, v80, v81
  v_cvt_pk_bf16_f32 v99, v82, v83
  buffer_store_dwordx4 v[96:99], v1, s[4:7], s57 offen offset:1024 sc1
  v_fmac_f32_dpp v68, v124, v152 quad_perm:[0,0,0,0] row_mask:0xf bank_mask:0xf
  v_fmac_f32_dpp v69, v124, v152 quad_perm:[1,1,1,1] row_mask:0xf bank_mask:0xf
  v_fmac_f32_dpp v70, v124, v152 quad_perm:[2,2,2,2] row_mask:0xf bank_mask:0xf
  v_fmac_f32_dpp v71, v124, v152 quad_perm:[3,3,3,3] row_mask:0xf bank_mask:0xf
  v_mul_f32_dpp v68, v125, v68 quad_perm:[0,0,0,0] row_mask:0xf bank_mask:0xf
  v_mul_f32_dpp v69, v125, v69 quad_perm:[1,1,1,1] row_mask:0xf bank_mask:0xf
  v_mul_f32_dpp v70, v125, v70 quad_perm:[2,2,2,2] row_mask:0xf bank_mask:0xf
  v_mul_f32_dpp v71, v125, v71 quad_perm:[3,3,3,3] row_mask:0xf bank_mask:0xf
  v_cvt_pk_bf16_f32 v100, v68, v69
  v_cvt_pk_bf16_f32 v101, v70, v71
  v_fmac_f32_dpp v84, v126, v152 quad_perm:[0,0,0,0] row_mask:0xf bank_mask:0xf
  v_fmac_f32_dpp v85, v126, v152 quad_perm:[1,1,1,1] row_mask:0xf bank_mask:0xf
  v_fmac_f32_dpp v86, v126, v152 quad_perm:[2,2,2,2] row_mask:0xf bank_mask:0xf
  v_fmac_f32_dpp v87, v126, v152 quad_perm:[3,3,3,3] row_mask:0xf bank_mask:0xf
  v_mul_f32_dpp v84, v127, v84 quad_perm:[0,0,0,0] row_mask:0xf bank_mask:0xf
  v_mul_f32_dpp v85, v127, v85 quad_perm:[1,1,1,1] row_mask:0xf bank_mask:0xf
  v_mul_f32_dpp v86, v127, v86 quad_perm:[2,2,2,2] row_mask:0xf bank_mask:0xf
  v_mul_f32_dpp v87, v127, v87 quad_perm:[3,3,3,3] row_mask:0xf bank_mask:0xf
  v_cvt_pk_bf16_f32 v102, v84, v85
  v_cvt_pk_bf16_f32 v103, v86, v87
  buffer_store_dwordx4 v[100:103], v1, s[4:7], s57 offen offset:2048 sc1
  v_fmac_f32_dpp v72, v124, v156 quad_perm:[0,0,0,0] row_mask:0xf bank_mask:0xf
  v_fmac_f32_dpp v73, v124, v156 quad_perm:[1,1,1,1] row_mask:0xf bank_mask:0xf
  v_fmac_f32_dpp v74, v124, v156 quad_perm:[2,2,2,2] row_mask:0xf bank_mask:0xf
  v_fmac_f32_dpp v75, v124, v156 quad_perm:[3,3,3,3] row_mask:0xf bank_mask:0xf
  v_mul_f32_dpp v72, v125, v72 quad_perm:[0,0,0,0] row_mask:0xf bank_mask:0xf
  v_mul_f32_dpp v73, v125, v73 quad_perm:[1,1,1,1] row_mask:0xf bank_mask:0xf
  v_mul_f32_dpp v74, v125, v74 quad_perm:[2,2,2,2] row_mask:0xf bank_mask:0xf
  v_mul_f32_dpp v75, v125, v75 quad_perm:[3,3,3,3] row_mask:0xf bank_mask:0xf
  v_cvt_pk_bf16_f32 v104, v72, v73
  v_cvt_pk_bf16_f32 v105, v74, v75
  v_fmac_f32_dpp v88, v126, v156 quad_perm:[0,0,0,0] row_mask:0xf bank_mask:0xf
  v_fmac_f32_dpp v89, v126, v156 quad_perm:[1,1,1,1] row_mask:0xf bank_mask:0xf
  v_fmac_f32_dpp v90, v126, v156 quad_perm:[2,2,2,2] row_mask:0xf bank_mask:0xf
  v_fmac_f32_dpp v91, v126, v156 quad_perm:[3,3,3,3] row_mask:0xf bank_mask:0xf
  v_mul_f32_dpp v88, v127, v88 quad_perm:[0,0,0,0] row_mask:0xf bank_mask:0xf
  v_mul_f32_dpp v89, v127, v89 quad_perm:[1,1,1,1] row_mask:0xf bank_mask:0xf
  v_mul_f32_dpp v90, v127, v90 quad_perm:[2,2,2,2] row_mask:0xf bank_mask:0xf
  v_mul_f32_dpp v91, v127, v91 quad_perm:[3,3,3,3] row_mask:0xf bank_mask:0xf
  v_cvt_pk_bf16_f32 v106, v88, v89
  v_cvt_pk_bf16_f32 v107, v90, v91
  buffer_store_dwordx4 v[104:107], v1, s[4:7], s57 offen offset:3072 sc1
  s_mov_b32 s47, s64
  s_cmp_eq_u32 s42, s80
  s_cbranch_scc1 L_v_fin1
  s_waitcnt vmcnt(4)
  s_barrier
  ds_read_b32 v5, v171
  s_waitcnt lgkmcnt(0)
  v_cmp_ge_i32 vcc, s46, v5
  s_cmp_eq_u32 s45, 0
  s_cselect_b32 s51, vcc_lo, vcc_hi
  s_cmp_lg_u32 s51, 0
  s_cbranch_scc1 L_v_drain1
  s_add_u32 m0, s50, 0
  s_add_u32 s51, s47, 0
  buffer_load_dwordx4 v1, s[4:7], s51 offen sc1 lds
  s_add_u32 m0, s50, 4096
  s_add_u32 s51, s47, 4096
  buffer_load_dwordx4 v1, s[4:7], s51 offen sc1 lds
  s_add_u32 m0, s50, 8192
  s_add_u32 s51, s47, 8192
  buffer_load_dwordx4 v1, s[4:7], s51 offen sc1 lds
  s_add_u32 m0, s50, 12288
  s_add_u32 s51, s47, 12288
  buffer_load_dwordx4 v1, s[4:7], s51 offen sc1 lds
  s_add_u32 m0, s50, 16384
  s_add_u32 s51, s47, 16384
  buffer_load_dwordx4 v1, s[4:7], s51 offen sc1 lds
  s_add_u32 m0, s50, 20480
  s_add_u32 s51, s47, 20480
  buffer_load_dwordx4 v1, s[4:7], s51 offen sc1 lds
  s_add_u32 m0, s50, 24576
  s_add_u32 s51, s47, 24576
  buffer_load_dwordx4 v1, s[4:7], s51 offen sc1 lds
  s_add_u32 m0, s50, 28672
  s_add_u32 s51, s47, 28672
  buffer_load_dwordx4 v1, s[4:7], s51 offen sc1 lds
  s_add_u32 m0, s50, 32768
  s_add_u32 s51, s47, 32768
  buffer_load_dwordx4 v1, s[4:7], s51 offen sc1 lds
  s_add_u32 m0, s50, 36864
  s_add_u32 s51, s47, 36864
  buffer_load_dwordx4 v1, s[4:7], s51 offen sc1 lds
  s_add_u32 m0, s50, 40960
  s_add_u32 s51, s47, 40960
  buffer_load_dwordx4 v9, s[4:7], s51 offen sc1 lds
  s_waitcnt vmcnt(11)
  s_barrier
  v_mov_b32 v7, s62
  buffer_store_dword v7, v0, s[4:7], s61 offen offset:0 sc1
  s_mov_b32 s57, 0x20000000
  s_mov_b32 s58, 0x20000000
  s_mov_b32 s59, 0x20000000
  s_mov_b32 s60, 0x20000000
  s_mov_b32 s61, 0x20000000
  s_waitcnt vmcnt(5)
  s_branch L_v_entry0
L_v_drain1:
  s_waitcnt vmcnt(0)
  s_barrier
  v_mov_b32 v7, s62
  buffer_store_dword v7, v0, s[4:7], s61 offen offset:0 sc1
  s_mov_b32 s57, 0x20000000
  s_mov_b32 s58, 0x20000000
  s_mov_b32 s59, 0x20000000
  s_mov_b32 s60, 0x20000000
  s_mov_b32 s61, 0x20000000
L_v_spin1:
  s_sleep 1
  s_xor_b32 s95, s95, 1024
  s_mov_b32 m0, s95
  v_xor_b32 v171, 1024, v171
  buffer_load_dword v4, s[4:7], s48 offen sc1 lds
  s_add_u32 s94, s94, 1
  s_cmp_lt_u32 s94, 100000
  s_cselect_b32 s52, s46, -2
  s_waitcnt vmcnt(0)
  s_barrier
  ds_read_b32 v5, v171
  s_waitcnt lgkmcnt(0)
  v_cmp_ge_i32 vcc, s52, v5
  s_cmp_eq_u32 s45, 0
  s_cselect_b32 s51, vcc_lo, vcc_hi
  s_cmp_lg_u32 s51, 0
  s_cbranch_scc1 L_v_spin1
  s_add_u32 m0, s50, 0
  s_add_u32 s51, s47, 0
  buffer_load_dwordx4 v1, s[4:7], s51 offen sc1 lds
  s_add_u32 m0, s50, 4096
  s_add_u32 s51, s47, 4096
  buffer_load_dwordx4 v1, s[4:7], s51 offen sc1 lds
  s_add_u32 m0, s50, 8192
  s_add_u32 s51, s47, 8192
  buffer_load_dwordx4 v1, s[4:7], s51 offen sc1 lds
  s_add_u32 m0, s50, 12288
  s_add_u32 s51, s47, 12288
  buffer_load_dwordx4 v1, s[4:7], s51 offen sc1 lds
  s_add_u32 m0, s50, 16384
  s_add_u32 s51, s47, 16384
  buffer_load_dwordx4 v1, s[4:7], s51 offen sc1 lds
  s_add_u32 m0, s50, 20480
  s_add_u32 s51, s47, 20480
  buffer_load_dwordx4 v1, s[4:7], s51 offen sc1 lds
  s_add_u32 m0, s50, 24576
  s_add_u32 s51, s47, 24576
  buffer_load_dwordx4 v1, s[4:7], s51 offen sc1 lds
  s_add_u32 m0, s50, 28672
  s_add_u32 s51, s47, 28672
  buffer_load_dwordx4 v1, s[4:7], s51 offen sc1 lds
  s_add_u32 m0, s50, 32768
  s_add_u32 s51, s47, 32768
  buffer_load_dwordx4 v1, s[4:7], s51 offen sc1 lds
  s_add_u32 m0, s50, 36864
  s_add_u32 s51, s47, 36864
  buffer_load_dwordx4 v1, s[4:7], s51 offen sc1 lds
  s_add_u32 m0, s50, 40960
  s_add_u32 s51, s47, 40960
  buffer_load_dwordx4 v9, s[4:7], s51 offen sc1 lds
  s_waitcnt vmcnt(4)
  s_branch L_v_entry0
L_v_fin1:
  s_waitcnt vmcnt(0)
  s_barrier
  v_mov_b32 v7, s62
  buffer_store_dword v7, v0, s[4:7], s61 offen offset:0 sc1
  s_cmp_lg_u32 s100, 0
  s_cbranch_scc1 L_helper_done
  s_endpgm
L_role_leaf:
  s_cmp_lg_u32 s12, 0
  s_cbranch_scc1 L_hold_234
  v_mov_b32 v6, 8
L_rdy_236:
  global_load_dword v7, v6, s[38:39] sc1
  s_waitcnt vmcnt(0)
  v_readfirstlane_b32 s15, v7
  s_and_b32 s3, s15, 0xffff
  s_cmp_ge_u32 s3, 48
  s_cbranch_scc1 L_rdyd_237
  s_sleep 32
  s_add_u32 s14, s14, 1
  s_cmp_lt_u32 s14, 100000
  s_cbranch_scc1 L_rdy_236
L_rdyd_237:
L_hold_235:
  s_sleep 16
  buffer_load_dword v6, off, s[4:7], 0 offset:0 sc1
  s_add_u32 s14, s14, 1
  s_waitcnt vmcnt(0)
  v_readfirstlane_b32 s3, v6
  s_cmp_ge_u32 s14, 100000
  s_cbranch_scc1 L_hold_234
  s_cmp_lt_i32 s3, 10
  s_cbranch_scc1 L_hold_235
L_hold_234:
  s_barrier
  s_mul_i32 s67, s101, 52
  s_lshr_b32 s67, s67, 8
  s_mul_i32 s51, s67, 5
  s_sub_u32 s66, s101, s51
  s_mul_i32 s68, s67, 960
  v_lshlrev_b32 v1, 4, v0
  v_lshrrev_b32 v20, 4, v0
  v_mul_u32_u24 v20, 1024, v20
  v_add_u32 v20, v20, v1
  s_mov_b32 s70, 0
  s_mul_i32 s51, s68, 1280
  s_add_u32 s70, s70, s51
  s_mul_i32 s51, s66, 256
  s_add_u32 s70, s70, s51
  v_lshrrev_b32 v6, 4, v0
  v_bfe_u32 v21, v0, 2, 2
  v_lshl_add_u32 v21, v6, 3, v21
  v_mul_u32_u24 v21, 256, v21
  v_and_b32 v6, 3, v0
  v_lshl_add_u32 v21, v6, 4, v21
  s_lshl_b32 s51, s12, 6
  v_add_u32 v21, s51, v21
  s_mov_b32 s8, s26
  s_mov_b32 s9, s27
  s_mov_b32 s10, 7864320
  s_mov_b32 s11, 0x20000
  s_mul_i32 s51, s12, 20480
  s_add_u32 s70, s70, s51
  s_mul_i32 s52, s12, 4096
  s_add_u32 m0, s52, 0
  s_add_u32 s51, s70, 0
  buffer_load_dwordx4 v20, s[8:11], s51 offen  lds
  s_add_u32 m0, s52, 1024
  s_add_u32 s51, s70, 5120
  buffer_load_dwordx4 v20, s[8:11], s51 offen  lds
  s_add_u32 m0, s52, 2048
  s_add_u32 s51, s70, 10240
  buffer_load_dwordx4 v20, s[8:11], s51 offen  lds
  s_add_u32 m0, s52, 3072
  s_add_u32 s51, s70, 15360
  buffer_load_dwordx4 v20, s[8:11], s51 offen  lds
  s_add_u32 m0, s52, 16384
  s_add_u32 s51, s70, 81920
  buffer_load_dwordx4 v20, s[8:11], s51 offen  lds
  s_add_u32 m0, s52, 17408
  s_add_u32 s51, s70, 87040
  buffer_load_dwordx4 v20, s[8:11], s51 offen  lds
  s_add_u32 m0, s52, 18432
  s_add_u32 s51, s70, 92160
  buffer_load_dwordx4 v20, s[8:11], s51 offen  lds
  s_add_u32 m0, s52, 19456
  s_add_u32 s51, s70, 97280
  buffer_load_dwordx4 v20, s[8:11], s51 offen  lds
  s_add_u32 m0, s52, 32768
  s_add_u32 s51, s70, 163840
  buffer_load_dwordx4 v20, s[8:11], s51 offen  lds
  s_add_u32 m0, s52, 33792
  s_add_u32 s51, s70, 168960
  buffer_load_dwordx4 v20, s[8:11], s51 offen  lds
  s_add_u32 m0, s52, 34816
  s_add_u32 s51, s70, 174080
  buffer_load_dwordx4 v20, s[8:11], s51 offen  lds
  s_add_u32 m0, s52, 35840
  s_add_u32 s51, s70, 179200
  buffer_load_dwordx4 v20, s[8:11], s51 offen  lds
  s_add_u32 m0, s52, 49152
  s_add_u32 s51, s70, 245760
  buffer_load_dwordx4 v20, s[8:11], s51 offen  lds
  s_add_u32 m0, s52, 50176
  s_add_u32 s51, s70, 250880
  buffer_load_dwordx4 v20, s[8:11], s51 offen  lds
  s_add_u32 m0, s52, 51200
  s_add_u32 s51, s70, 256000
  buffer_load_dwordx4 v20, s[8:11], s51 offen  lds
  s_add_u32 m0, s52, 52224
  s_add_u32 s51, s70, 261120
  buffer_load_dwordx4 v20, s[8:11], s51 offen  lds
  s_add_u32 m0, s52, 65536
  s_add_u32 s51, s70, 327680
  buffer_load_dwordx4 v20, s[8:11], s51 offen  lds
  s_add_u32 m0, s52, 66560
  s_add_u32 s51, s70, 332800
  buffer_load_dwordx4 v20, s[8:11], s51 offen  lds
  s_add_u32 m0, s52, 67584
  s_add_u32 s51, s70, 337920
  buffer_load_dwordx4 v20, s[8:11], s51 offen  lds
  s_add_u32 m0, s52, 68608
  s_add_u32 s51, s70, 343040
  buffer_load_dwordx4 v20, s[8:11], s51 offen  lds
  s_add_u32 m0, s52, 81920
  s_add_u32 s51, s70, 409600
  buffer_load_dwordx4 v20, s[8:11], s51 offen  lds
  s_add_u32 m0, s52, 82944
  s_add_u32 s51, s70, 414720
  buffer_load_dwordx4 v20, s[8:11], s51 offen  lds
  s_add_u32 m0, s52, 83968
  s_add_u32 s51, s70, 419840
  buffer_load_dwordx4 v20, s[8:11], s51 offen  lds
  s_add_u32 m0, s52, 84992
  s_add_u32 s51, s70, 424960
  buffer_load_dwordx4 v20, s[8:11], s51 offen  lds
  s_add_u32 m0, s52, 98304
  s_add_u32 s51, s70, 491520
  buffer_load_dwordx4 v20, s[8:11], s51 offen  lds
  s_add_u32 m0, s52, 99328
  s_add_u32 s51, s70, 496640
  buffer_load_dwordx4 v20, s[8:11], s51 offen  lds
  s_add_u32 m0, s52, 100352
  s_add_u32 s51, s70, 501760
  buffer_load_dwordx4 v20, s[8:11], s51 offen  lds
  s_add_u32 m0, s52, 101376
  s_add_u32 s51, s70, 506880
  buffer_load_dwordx4 v20, s[8:11], s51 offen  lds
  s_add_u32 m0, s52, 114688
  s_add_u32 s51, s70, 573440
  buffer_load_dwordx4 v20, s[8:11], s51 offen  lds
  s_add_u32 m0, s52, 115712
  s_add_u32 s51, s70, 578560
  buffer_load_dwordx4 v20, s[8:11], s51 offen  lds
  s_add_u32 m0, s52, 116736
  s_add_u32 s51, s70, 583680
  buffer_load_dwordx4 v20, s[8:11], s51 offen  lds
  s_add_u32 m0, s52, 117760
  s_add_u32 s51, s70, 588800
  buffer_load_dwordx4 v20, s[8:11], s51 offen  lds
  s_waitcnt vmcnt(28) lgkmcnt(0)
  s_barrier
  s_add_u32 m0, s52, 131072
  s_add_u32 s51, s70, 655360
  buffer_load_dwordx4 v20, s[8:11], s51 offen  lds
  s_add_u32 m0, s52, 132096
  s_add_u32 s51, s70, 660480
  buffer_load_dwordx4 v20, s[8:11], s51 offen  lds
  s_add_u32 m0, s52, 133120
  s_add_u32 s51, s70, 665600
  buffer_load_dwordx4 v20, s[8:11], s51 offen  lds
  s_add_u32 m0, s52, 134144
  s_add_u32 s51, s70, 670720
  buffer_load_dwordx4 v20, s[8:11], s51 offen  lds
  v_add_u32 v22, 0, v21
  ds_read_b64_tr_b16 a[0:1], v22 offset:0
  ds_read_b64_tr_b16 a[2:3], v22 offset:1024
  ds_read_b64_tr_b16 a[4:5], v22 offset:8
  ds_read_b64_tr_b16 a[6:7], v22 offset:1032
  ds_read_b64_tr_b16 a[8:9], v22 offset:8192
  ds_read_b64_tr_b16 a[10:11], v22 offset:9216
  ds_read_b64_tr_b16 a[12:13], v22 offset:8200
  ds_read_b64_tr_b16 a[14:15], v22 offset:9224
  s_waitcnt vmcnt(28) lgkmcnt(0)
  s_barrier
  s_add_u32 m0, s52, 0
  s_add_u32 s51, s70, 737280
  buffer_load_dwordx4 v20, s[8:11], s51 offen  lds
  s_add_u32 m0, s52, 1024
  s_add_u32 s51, s70, 742400
  buffer_load_dwordx4 v20, s[8:11], s51 offen  lds
  s_add_u32 m0, s52, 2048
  s_add_u32 s51, s70, 747520
  buffer_load_dwordx4 v20, s[8:11], s51 offen  lds
  s_add_u32 m0, s52, 3072
  s_add_u32 s51, s70, 752640
  buffer_load_dwordx4 v20, s[8:11], s51 offen  lds
  v_add_u32 v22, 16384, v21
  ds_read_b64_tr_b16 a[16:17], v22 offset:0
  ds_read_b64_tr_b16 a[18:19], v22 offset:1024
  ds_read_b64_tr_b16 a[20:21], v22 offset:8
  ds_read_b64_tr_b16 a[22:23], v22 offset:1032
  ds_read_b64_tr_b16 a[24:25], v22 offset:8192
  ds_read_b64_tr_b16 a[26:27], v22 offset:9216
  ds_read_b64_tr_b16 a[28:29], v22 offset:8200
  ds_read_b64_tr_b16 a[30:31], v22 offset:9224
  s_waitcnt vmcnt(28) lgkmcnt(0)
  s_barrier
  s_add_u32 m0, s52, 16384
  s_add_u32 s51, s70, 819200
  buffer_load_dwordx4 v20, s[8:11], s51 offen  lds
  s_add_u32 m0, s52, 17408
  s_add_u32 s51, s70, 824320
  buffer_load_dwordx4 v20, s[8:11], s51 offen  lds
  s_add_u32 m0, s52, 18432
  s_add_u32 s51, s70, 829440
  buffer_load_dwordx4 v20, s[8:11], s51 offen  lds
  s_add_u32 m0, s52, 19456
  s_add_u32 s51, s70, 834560
  buffer_load_dwordx4 v20, s[8:11], s51 offen  lds
  v_add_u32 v22, 32768, v21
  ds_read_b64_tr_b16 a[32:33], v22 offset:0
  ds_read_b64_tr_b16 a[34:35], v22 offset:1024
  ds_read_b64_tr_b16 a[36:37], v22 offset:8
  ds_read_b64_tr_b16 a[38:39], v22 offset:1032
  ds_read_b64_tr_b16 a[40:41], v22 offset:8192
  ds_read_b64_tr_b16 a[42:43], v22 offset:9216
  ds_read_b64_tr_b16 a[44:45], v22 offset:8200
  ds_read_b64_tr_b16 a[46:47], v22 offset:9224
  s_waitcnt vmcnt(28) lgkmcnt(0)
  s_barrier
  s_add_u32 m0, s52, 32768
  s_add_u32 s51, s70, 901120
  buffer_load_dwordx4 v20, s[8:11], s51 offen  lds
  s_add_u32 m0, s52, 33792
  s_add_u32 s51, s70, 906240
  buffer_load_dwordx4 v20, s[8:11], s51 offen  lds
  s_add_u32 m0, s52, 34816
  s_add_u32 s51, s70, 911360
  buffer_load_dwordx4 v20, s[8:11], s51 offen  lds
  s_add_u32 m0, s52, 35840
  s_add_u32 s51, s70, 916480
  buffer_load_dwordx4 v20, s[8:11], s51 offen  lds
  v_add_u32 v22, 49152, v21
  ds_read_b64_tr_b16 a[48:49], v22 offset:0
  ds_read_b64_tr_b16 a[50:51], v22 offset:1024
  ds_read_b64_tr_b16 a[52:53], v22 offset:8
  ds_read_b64_tr_b16 a[54:55], v22 offset:1032
  ds_read_b64_tr_b16 a[56:57], v22 offset:8192
  ds_read_b64_tr_b16 a[58:59], v22 offset:9216
  ds_read_b64_tr_b16 a[60:61], v22 offset:8200
  ds_read_b64_tr_b16 a[62:63], v22 offset:9224
  s_waitcnt vmcnt(28) lgkmcnt(0)
  s_barrier
  s_add_u32 m0, s52, 49152
  s_add_u32 s51, s70, 983040
  buffer_load_dwordx4 v20, s[8:11], s51 offen  lds
  s_add_u32 m0, s52, 50176
  s_add_u32 s51, s70, 988160
  buffer_load_dwordx4 v20, s[8:11], s51 offen  lds
  s_add_u32 m0, s52, 51200
  s_add_u32 s51, s70, 993280
  buffer_load_dwordx4 v20, s[8:11], s51 offen  lds
  s_add_u32 m0, s52, 52224
  s_add_u32 s51, s70, 998400
  buffer_load_dwordx4 v20, s[8:11], s51 offen  lds
  v_add_u32 v22, 65536, v21
  ds_read_b64_tr_b16 a[64:65], v22 offset:0
  ds_read_b64_tr_b16 a[66:67], v22 offset:1024
  ds_read_b64_tr_b16 a[68:69], v22 offset:8
  ds_read_b64_tr_b16 a[70:71], v22 offset:1032
  ds_read_b64_tr_b16 a[72:73], v22 offset:8192
  ds_read_b64_tr_b16 a[74:75], v22 offset:9216
  ds_read_b64_tr_b16 a[76:77], v22 offset:8200
  ds_read_b64_tr_b16 a[78:79], v22 offset:9224
  s_waitcnt vmcnt(28) lgkmcnt(0)
  s_barrier
  s_add_u32 m0, s52, 65536
  s_add_u32 s51, s70, 1064960
  buffer_load_dwordx4 v20, s[8:11], s51 offen  lds
  s_add_u32 m0, s52, 66560
  s_add_u32 s51, s70, 1070080
  buffer_load_dwordx4 v20, s[8:11], s51 offen  lds
  s_add_u32 m0, s52, 67584
  s_add_u32 s51, s70, 1075200
  buffer_load_dwordx4 v20, s[8:11], s51 offen  lds
  s_add_u32 m0, s52, 68608
  s_add_u32 s51, s70, 1080320
  buffer_load_dwordx4 v20, s[8:11], s51 offen  lds
  v_add_u32 v22, 81920, v21
  ds_read_b64_tr_b16 a[80:81], v22 offset:0
  ds_read_b64_tr_b16 a[82:83], v22 offset:1024
  ds_read_b64_tr_b16 a[84:85], v22 offset:8
  ds_read_b64_tr_b16 a[86:87], v22 offset:1032
  ds_read_b64_tr_b16 a[88:89], v22 offset:8192
  ds_read_b64_tr_b16 a[90:91], v22 offset:9216
  ds_read_b64_tr_b16 a[92:93], v22 offset:8200
  ds_read_b64_tr_b16 a[94:95], v22 offset:9224
  s_waitcnt vmcnt(28) lgkmcnt(0)
  s_barrier
  s_add_u32 m0, s52, 81920
  s_add_u32 s51, s70, 1146880
  buffer_load_dwordx4 v20, s[8:11], s51 offen  lds
  s_add_u32 m0, s52, 82944
  s_add_u32 s51, s70, 1152000
  buffer_load_dwordx4 v20, s[8:11], s51 offen  lds
  s_add_u32 m0, s52, 83968
  s_add_u32 s51, s70, 1157120
  buffer_load_dwordx4 v20, s[8:11], s51 offen  lds
  s_add_u32 m0, s52, 84992
  s_add_u32 s51, s70, 1162240
  buffer_load_dwordx4 v20, s[8:11], s51 offen  lds
  v_add_u32 v22, 98304, v21
  ds_read_b64_tr_b16 a[96:97], v22 offset:0
  ds_read_b64_tr_b16 a[98:99], v22 offset:1024
  ds_read_b64_tr_b16 a[100:101], v22 offset:8
  ds_read_b64_tr_b16 a[102:103], v22 offset:1032
  ds_read_b64_tr_b16 a[104:105], v22 offset:8192
  ds_read_b64_tr_b16 a[106:107], v22 offset:9216
  ds_read_b64_tr_b16 a[108:109], v22 offset:8200
  ds_read_b64_tr_b16 a[110:111], v22 offset:9224
  s_waitcnt vmcnt(28) lgkmcnt(0)
  s_barrier
  v_add_u32 v22, 114688, v21
  ds_read_b64_tr_b16 a[112:113], v22 offset:0
  ds_read_b64_tr_b16 a[114:115], v22 offset:1024
  ds_read_b64_tr_b16 a[116:117], v22 offset:8
  ds_read_b64_tr_b16 a[118:119], v22 offset:1032
  ds_read_b64_tr_b16 a[120:121], v22 offset:8192
  ds_read_b64_tr_b16 a[122:123], v22 offset:9216
  ds_read_b64_tr_b16 a[124:125], v22 offset:8200
  ds_read_b64_tr_b16 a[126:127], v22 offset:9224
  s_waitcnt vmcnt(24) lgkmcnt(0)
  s_barrier
  v_add_u32 v22, 131072, v21
  ds_read_b64_tr_b16 a[128:129], v22 offset:0
  ds_read_b64_tr_b16 a[130:131], v22 offset:1024
  ds_read_b64_tr_b16 a[132:133], v22 offset:8
  ds_read_b64_tr_b16 a[134:135], v22 offset:1032
  ds_read_b64_tr_b16 a[136:137], v22 offset:8192
  ds_read_b64_tr_b16 a[138:139], v22 offset:9216
  ds_read_b64_tr_b16 a[140:141], v22 offset:8200
  ds_read_b64_tr_b16 a[142:143], v22 offset:9224
  s_waitcnt vmcnt(20) lgkmcnt(0)
  s_barrier
  v_add_u32 v22, 0, v21
  ds_read_b64_tr_b16 a[144:145], v22 offset:0
  ds_read_b64_tr_b16 a[146:147], v22 offset:1024
  ds_read_b64_tr_b16 a[148:149], v22 offset:8
  ds_read_b64_tr_b16 a[150:151], v22 offset:1032
  ds_read_b64_tr_b16 a[152:153], v22 offset:8192
  ds_read_b64_tr_b16 a[154:155], v22 offset:9216
  ds_read_b64_tr_b16 a[156:157], v22 offset:8200
  ds_read_b64_tr_b16 a[158:159], v22 offset:9224
  s_waitcnt vmcnt(16) lgkmcnt(0)
  s_barrier
  v_add_u32 v22, 16384, v21
  ds_read_b64_tr_b16 a[160:161], v22 offset:0
  ds_read_b64_tr_b16 a[162:163], v22 offset:1024
  ds_read_b64_tr_b16 a[164:165], v22 offset:8
  ds_read_b64_tr_b16 a[166:167], v22 offset:1032
  ds_read_b64_tr_b16 a[168:169], v22 offset:8192
  ds_read_b64_tr_b16 a[170:171], v22 offset:9216
  ds_read_b64_tr_b16 a[172:173], v22 offset:8200
  ds_read_b64_tr_b16 a[174:175], v22 offset:9224
  s_waitcnt vmcnt(12) lgkmcnt(0)
  s_barrier
  v_add_u32 v22, 32768, v21
  ds_read_b64_tr_b16 a[176:177], v22 offset:0
  ds_read_b64_tr_b16 a[178:179], v22 offset:1024
  ds_read_b64_tr_b16 a[180:181], v22 offset:8
  ds_read_b64_tr_b16 a[182:183], v22 offset:1032
  ds_read_b64_tr_b16 a[184:185], v22 offset:8192
  ds_read_b64_tr_b16 a[186:187], v22 offset:9216
  ds_read_b64_tr_b16 a[188:189], v22 offset:8200
  ds_read_b64_tr_b16 a[190:191], v22 offset:9224
  s_waitcnt vmcnt(8) lgkmcnt(0)
  s_barrier
  s_lshr_b32 s3, s13, 5
  s_mul_i32 s3, s3, 65
  s_and_b32 s3, s3, 0xc4
  v_mov_b32 v5, s3
  v_writelane_b32 v5, 8, 0
  v_writelane_b32 v5, 12, 2
  global_load_dword v5, v5, s[38:39] sc1
  v_add_u32 v22, 49152, v21
  ds_read_b64_tr_b16 a[192:193], v22 offset:0
  ds_read_b64_tr_b16 a[194:195], v22 offset:1024
  ds_read_b64_tr_b16 a[196:197], v22 offset:8
  ds_read_b64_tr_b16 a[198:199], v22 offset:1032
  ds_read_b64_tr_b16 a[200:201], v22 offset:8192
  ds_read_b64_tr_b16 a[202:203], v22 offset:9216
  ds_read_b64_tr_b16 a[204:205], v22 offset:8200
  ds_read_b64_tr_b16 a[206:207], v22 offset:9224
  s_waitcnt vmcnt(4) lgkmcnt(0)
  s_barrier
  v_add_u32 v22, 65536, v21
  ds_read_b64_tr_b16 a[208:209], v22 offset:0
  ds_read_b64_tr_b16 a[210:211], v22 offset:1024
  ds_read_b64_tr_b16 a[212:213], v22 offset:8
  ds_read_b64_tr_b16 a[214:215], v22 offset:1032
  ds_read_b64_tr_b16 a[216:217], v22 offset:8192
  ds_read_b64_tr_b16 a[218:219], v22 offset:9216
  ds_read_b64_tr_b16 a[220:221], v22 offset:8200
  ds_read_b64_tr_b16 a[222:223], v22 offset:9224
  s_waitcnt vmcnt(0) lgkmcnt(0)
  s_barrier
  v_add_u32 v22, 81920, v21
  ds_read_b64_tr_b16 a[224:225], v22 offset:0
  ds_read_b64_tr_b16 a[226:227], v22 offset:1024
  ds_read_b64_tr_b16 a[228:229], v22 offset:8
  ds_read_b64_tr_b16 a[230:231], v22 offset:1032
  ds_read_b64_tr_b16 a[232:233], v22 offset:8192
  ds_read_b64_tr_b16 a[234:235], v22 offset:9216
  ds_read_b64_tr_b16 a[236:237], v22 offset:8200
  ds_read_b64_tr_b16 a[238:239], v22 offset:9224
  s_waitcnt lgkmcnt(0)
  v_readlane_b32 s92, v5, 0
  v_readlane_b32 s93, v5, 1
  v_readlane_b32 s2, v5, 2
  s_waitcnt lgkmcnt(0)
  s_barrier
  v_lshlrev_b32 v10, 3, v0
  v_mov_b32 v2, v1
  v_add_u32 v3, 0x10000, v1
  v_and_b32 v4, 31, v0
  v_min_u32 v4, 0, v4
  v_lshlrev_b32 v4, 8, v4
  s_mul_i32 s51, s68, 683
  s_lshr_b32 s51, s51, 17
  s_lshl_b32 s51, s51, 1
  s_add_u32 s52, s68, 896
  s_mul_i32 s52, s52, 683
  s_lshr_b32 s52, s52, 17
  s_lshl_b32 s52, s52, 1
  s_add_u32 s52, s52, 1
  v_and_b32 v4, 31, v0
  v_add_u32 v4, s51, v4
  v_min_u32 v4, s52, v4
  v_lshlrev_b32 v4, 8, v4
  v_and_b32 v9, 0xf0, v1
  v_lshrrev_b32 v6, 4, v0
  v_lshl_add_u32 v8, v6, 9, v9
  v_mov_b32 v2, v8
  v_add_u32 v3, 0x10000, v2
  s_mov_b32 s53, 232783872
  s_mul_i32 s51, s67, 40960
  s_add_u32 s53, s53, s51
  s_mul_i32 s51, s66, 8192
  s_add_u32 s53, s53, s51
  s_mul_i32 s51, s12, 2048
  s_add_u32 s53, s53, s51
  s_mov_b32 s54, 93184
  s_mul_i32 s51, s66, 1280
  s_add_u32 s54, s54, s51
  s_mul_i32 s51, s67, 256
  s_add_u32 s54, s54, s51
  s_mov_b32 s15, s93
  s_and_b32 s3, s92, 0xffff
  s_cmp_lt_u32 s3, 48
  s_cbranch_scc1 L_rslow_238
  s_and_b32 s3, s15, 0xffff
  s_cmp_ge_u32 s3, 32
  s_cbranch_scc1 L_rfast_239
L_rslow_238:
  v_mov_b32 v6, 8
L_rdy_240:
  global_load_dword v7, v6, s[38:39] sc1
  s_waitcnt vmcnt(0)
  v_readfirstlane_b32 s15, v7
  s_and_b32 s3, s15, 0xffff
  s_cmp_ge_u32 s3, 48
  s_cbranch_scc1 L_rdyd_241
  s_sleep 8
  s_add_u32 s14, s14, 1
  s_cmp_lt_u32 s14, 100000
  s_cbranch_scc1 L_rdy_240
L_rdyd_241:
  v_mov_b32 v6, 12
  global_load_dword v6, v6, s[38:39] sc1
  s_waitcnt vmcnt(0)
  v_readfirstlane_b32 s2, v6
  s_lshr_b32 s15, s13, 5
  s_mul_i32 s3, s15, 65
  s_and_b32 s3, s3, 0xc4
  v_mov_b32 v6, s3
L_rdy_242:
  global_load_dword v7, v6, s[38:39] sc1
  s_waitcnt vmcnt(0)
  v_readfirstlane_b32 s15, v7
  s_and_b32 s3, s15, 0xffff
  s_cmp_ge_u32 s3, 32
  s_cbranch_scc1 L_rdyd_243
  s_sleep 8
  s_add_u32 s14, s14, 1
  s_cmp_lt_u32 s14, 100000
  s_cbranch_scc1 L_rdy_242
L_rdyd_243:
L_rfast_239:
  s_lshr_b32 s15, s15, 16
  s_and_b32 s2, s2, 3
  s_mul_i32 s2, s2, 0x2001
  s_xor_b32 s2, s2, 0x2000
  s_lshl_b32 s68, s67, 17
  s_and_b32 s51, s2, 0x2000
  s_add_u32 s68, s68, s51
  v_lshrrev_b32 v6, 5, v0
  v_mul_u32_u24 v6, 16384, v6
  v_add_u32 v4, v4, v6
  v_lshlrev_b32 v171, 2, v0
  v_add_u32 v171, 155648, v171
  s_lshl_b32 s95, s12, 8
  s_add_u32 s95, s95, 155648
  v_or_b32 v0, s12, v0
  v_lshlrev_b32 v0, 24, v0
  v_min_u32 v0, 0x1000000, v0
  v_lshlrev_b32 v0, 4, v0
  s_lshl_b32 s63, s12, 10
  s_mov_b32 s50, s63
  s_mov_b32 s42, -2
  s_mov_b32 s62, 0
  s_mov_b32 s48, 60416
  s_cmp_eq_u32 s12, 0
  s_cselect_b32 s48, s48, 0x20000000
  s_mov_b32 s56, 61440
  s_mov_b32 s55, 61440
  s_mov_b32 s86, 0xaaaaa000
  s_mov_b32 s87, 0xaaaaaaaa
  s_mov_b32 s88, 0xaaaaaaaa
  s_mov_b32 s89, 0xfffaaaaa
  s_mov_b64 s[90:91], 0
  s_mov_b32 s80, 127
  s_cmp_eq_u32 s42, 62
  s_cselect_b64 s[86:87], s[88:89], s[86:87]
  s_and_b32 s83, s86, 1
  s_cselect_b32 s84, s91, s90
  s_lshr_b64 s[86:87], s[86:87], 1
  s_add_u32 s91, s91, s83
  s_xor_b32 s52, s83, 1
  s_add_u32 s90, s90, s52
  s_mov_b32 s85, 165675008
  s_mul_i32 s52, s84, 1048576
  s_add_u32 s85, s85, s52
  s_add_u32 s85, s85, s68
  s_add_u32 s85, s85, s63
  s_lshl_b32 s52, s83, 21
  s_add_u32 s52, s52, s85
  s_lshr_b32 s52, s52, 8
  s_and_b32 s52, s52, 0x2000
  s_xor_b32 s85, s85, s52
  s_mov_b32 s43, s45
  s_mov_b32 s44, s46
  s_mov_b32 s46, s84
  s_mov_b32 s45, s83
  s_mov_b32 s64, s85
  s_add_u32 s42, s42, 1
  s_cmp_eq_u32 s42, 62
  s_cselect_b64 s[86:87], s[88:89], s[86:87]
  s_and_b32 s83, s86, 1
  s_cselect_b32 s84, s91, s90
  s_lshr_b64 s[86:87], s[86:87], 1
  s_add_u32 s91, s91, s83
  s_xor_b32 s52, s83, 1
  s_add_u32 s90, s90, s52
  s_mov_b32 s85, 165675008
  s_mul_i32 s52, s84, 1048576
  s_add_u32 s85, s85, s52
  s_add_u32 s85, s85, s68
  s_add_u32 s85, s85, s63
  s_lshl_b32 s52, s83, 21
  s_add_u32 s52, s52, s85
  s_lshr_b32 s52, s52, 8
  s_and_b32 s52, s52, 0x2000
  s_xor_b32 s85, s85, s52
  s_mov_b32 s57, 0x20000000
  s_mov_b32 s58, 0x20000000
  s_mov_b32 s59, 0x20000000
  s_mov_b32 s60, 0x20000000
  s_mov_b32 s61, 0x20000000
  s_mov_b32 s47, s64
  s_mov_b32 s49, 0
  s_mov_b32 s94, 0
  s_branch L_leaf_spin1
L_leaf_body0:
  s_waitcnt lgkmcnt(4)
  v_mfma_f32_16x16x32_bf16 v[44:47], a[0:3], v[12:15], 0
  s_mov_b32 s43, s45
  ds_read_b128 v[32:35], v2 offset:4352
  ds_read_b32 v5, v171
  v_mfma_f32_16x16x32_bf16 v[48:51], a[4:7], v[12:15], 0
  s_waitcnt lgkmcnt(5)
  v_cvt_pk_bf16_f32 v76, v60, v61
  v_cvt_pk_bf16_f32 v77, v62, v63
  v_mfma_f32_16x16x32_bf16 v[52:55], a[0:3], v[16:19], 0
  s_mov_b32 s44, s46
  ds_read_b128 v[36:39], v2 offset:6144
  v_cvt_pk_bf16_f32 v78, v64, v65
  v_mfma_f32_16x16x32_bf16 v[56:59], a[4:7], v[16:19], 0
  s_waitcnt lgkmcnt(5)
  s_mov_b32 s46, s84
  v_cvt_pk_bf16_f32 v79, v66, v67
  v_mfma_f32_16x16x32_bf16 v[44:47], a[8:11], v[20:23], v[44:47]
  s_mov_b32 s45, s83
  s_mov_b32 s64, s85
  ds_read_b128 v[40:43], v2 offset:6400
  v_mfma_f32_16x16x32_bf16 v[48:51], a[12:15], v[20:23], v[48:51]
  s_waitcnt lgkmcnt(5)
  buffer_store_dwordx4 v[76:79], v8, s[4:7], s57 offen offset:0 sc1
  v_mfma_f32_16x16x32_bf16 v[52:55], a[8:11], v[24:27], v[52:55]
  s_add_u32 s42, s42, 1
  ds_read_b128 v[12:15], v2 offset:8192
  v_cvt_pk_bf16_f32 v80, v68, v69
  v_mfma_f32_16x16x32_bf16 v[56:59], a[12:15], v[24:27], v[56:59]
  s_waitcnt lgkmcnt(5)
  v_cvt_pk_bf16_f32 v81, v70, v71
  v_cvt_pk_bf16_f32 v82, v72, v73
  v_mfma_f32_16x16x32_bf16 v[44:47], a[16:19], v[28:31], v[44:47]
  s_waitcnt lgkmcnt(3)
  ds_read_b128 v[16:19], v2 offset:8448
  v_cvt_pk_bf16_f32 v83, v74, v75
  v_mfma_f32_16x16x32_bf16 v[48:51], a[20:23], v[28:31], v[48:51]
  buffer_store_dwordx4 v[80:83], v8, s[4:7], s57 offen offset:256 sc1
  v_mfma_f32_16x16x32_bf16 v[52:55], a[16:19], v[32:35], v[52:55]
  ds_read_b128 v[20:23], v2 offset:10240
  v_cmp_ge_i32 vcc, s46, v5
  v_mfma_f32_16x16x32_bf16 v[56:59], a[20:23], v[32:35], v[56:59]
  s_waitcnt lgkmcnt(4)
  v_mfma_f32_16x16x32_bf16 v[44:47], a[24:27], v[36:39], v[44:47]
  ds_read_b128 v[24:27], v2 offset:10496
  v_mfma_f32_16x16x32_bf16 v[48:51], a[28:31], v[36:39], v[48:51]
  s_waitcnt lgkmcnt(4)
  s_cmp_eq_u32 s45, 0
  s_cselect_b32 s51, vcc_lo, vcc_hi
  v_mfma_f32_16x16x32_bf16 v[52:55], a[24:27], v[40:43], v[52:55]
  s_cmp_lg_u32 s51, 0
  s_cselect_b32 s49, 0, 1
  ds_read_b128 v[28:31], v2 offset:12288
  v_mfma_f32_16x16x32_bf16 v[56:59], a[28:31], v[40:43], v[56:59]
  s_waitcnt lgkmcnt(4)
  s_cmp_lt_u32 s42, s80
  s_cselect_b32 s49, s49, 0
  v_mfma_f32_16x16x32_bf16 v[44:47], a[32:35], v[12:15], v[44:47]
  s_cmp_lg_u32 s49, 0
  s_cselect_b32 s47, s64, 0x20000000
  ds_read_b128 v[32:35], v2 offset:12544
  v_mfma_f32_16x16x32_bf16 v[48:51], a[36:39], v[12:15], v[48:51]
  s_waitcnt lgkmcnt(4)
  s_xor_b32 s50, s50, s56
  v_mfma_f32_16x16x32_bf16 v[52:55], a[32:35], v[16:19], v[52:55]
  s_add_u32 m0, s50, 0
  s_add_u32 s51, s47, 0
  ds_read_b128 v[36:39], v2 offset:14336
  v_mfma_f32_16x16x32_bf16 v[56:59], a[36:39], v[16:19], v[56:59]
  s_waitcnt lgkmcnt(4)
  buffer_load_dwordx4 v1, s[4:7], s51 offen sc1 lds
  v_mfma_f32_16x16x32_bf16 v[44:47], a[40:43], v[20:23], v[44:47]
  s_add_u32 m0, s50, 4096
  s_add_u32 s51, s47, 4096
  ds_read_b128 v[40:43], v2 offset:14592
  v_mfma_f32_16x16x32_bf16 v[48:51], a[44:47], v[20:23], v[48:51]
  s_waitcnt lgkmcnt(4)
  v_mfma_f32_16x16x32_bf16 v[52:55], a[40:43], v[24:27], v[52:55]
  ds_read_b128 v[12:15], v2 offset:16384
  v_mfma_f32_16x16x32_bf16 v[56:59], a[44:47], v[24:27], v[56:59]
  s_waitcnt lgkmcnt(4)
  buffer_load_dwordx4 v1, s[4:7], s51 offen sc1 lds
  v_mfma_f32_16x16x32_bf16 v[44:47], a[48:51], v[28:31], v[44:47]
  s_add_u32 m0, s50, 8192
  s_add_u32 s51, s47, 16384
  ds_read_b128 v[16:19], v2 offset:16640
  v_mfma_f32_16x16x32_bf16 v[48:51], a[52:55], v[28:31], v[48:51]
  s_waitcnt lgkmcnt(4)
  v_mfma_f32_16x16x32_bf16 v[52:55], a[48:51], v[32:35], v[52:55]
  ds_read_b128 v[20:23], v2 offset:18432
  v_mfma_f32_16x16x32_bf16 v[56:59], a[52:55], v[32:35], v[56:59]
  s_waitcnt lgkmcnt(4)
  buffer_load_dwordx4 v1, s[4:7], s51 offen sc1 lds
  v_mfma_f32_16x16x32_bf16 v[44:47], a[56:59], v[36:39], v[44:47]
  s_add_u32 m0, s50, 12288
  s_add_u32 s51, s47, 20480
  ds_read_b128 v[24:27], v2 offset:18688
  v_mfma_f32_16x16x32_bf16 v[48:51], a[60:63], v[36:39], v[48:51]
  s_waitcnt lgkmcnt(4)
  v_mfma_f32_16x16x32_bf16 v[52:55], a[56:59], v[40:43], v[52:55]
  ds_read_b128 v[28:31], v2 offset:20480
  v_mfma_f32_16x16x32_bf16 v[56:59], a[60:63], v[40:43], v[56:59]
  s_waitcnt lgkmcnt(4)
  buffer_load_dwordx4 v1, s[4:7], s51 offen sc1 lds
  v_mfma_f32_16x16x32_bf16 v[44:47], a[64:67], v[12:15], v[44:47]
  s_add_u32 m0, s50, 16384
  s_add_u32 s51, s47, 32768
  ds_read_b128 v[32:35], v2 offset:20736
  v_mfma_f32_16x16x32_bf16 v[48:51], a[68:71], v[12:15], v[48:51]
  s_waitcnt lgkmcnt(4)
  v_mfma_f32_16x16x32_bf16 v[52:55], a[64:67], v[16:19], v[52:55]
  ds_read_b128 v[36:39], v2 offset:22528
  v_mfma_f32_16x16x32_bf16 v[56:59], a[68:71], v[16:19], v[56:59]
  s_waitcnt lgkmcnt(4)
  buffer_load_dwordx4 v1, s[4:7], s51 offen sc1 lds
  v_mfma_f32_16x16x32_bf16 v[44:47], a[72:75], v[20:23], v[44:47]
  s_add_u32 m0, s50, 20480
  s_add_u32 s51, s47, 36864
  ds_read_b128 v[40:43], v2 offset:22784
  v_mfma_f32_16x16x32_bf16 v[48:51], a[76:79], v[20:23], v[48:51]
  s_waitcnt lgkmcnt(4)
  v_mfma_f32_16x16x32_bf16 v[52:55], a[72:75], v[24:27], v[52:55]
  ds_read_b128 v[12:15], v2 offset:24576
  v_mfma_f32_16x16x32_bf16 v[56:59], a[76:79], v[24:27], v[56:59]
  s_waitcnt lgkmcnt(4)
  buffer_load_dwordx4 v1, s[4:7], s51 offen sc1 lds
  v_mfma_f32_16x16x32_bf16 v[44:47], a[80:83], v[28:31], v[44:47]
  s_add_u32 m0, s50, 24576
  s_add_u32 s51, s47, 49152
  ds_read_b128 v[16:19], v2 offset:24832
  v_mfma_f32_16x16x32_bf16 v[48:51], a[84:87], v[28:31], v[48:51]
  s_waitcnt lgkmcnt(4)
  v_mfma_f32_16x16x32_bf16 v[52:55], a[80:83], v[32:35], v[52:55]
  ds_read_b128 v[20:23], v2 offset:26624
  v_mfma_f32_16x16x32_bf16 v[56:59], a[84:87], v[32:35], v[56:59]
  s_waitcnt lgkmcnt(4)
  buffer_load_dwordx4 v1, s[4:7], s51 offen sc1 lds
  v_mfma_f32_16x16x32_bf16 v[44:47], a[88:91], v[36:39], v[44:47]
  s_add_u32 m0, s50, 28672
  s_add_u32 s51, s47, 53248
  ds_read_b128 v[24:27], v2 offset:26880
  v_mfma_f32_16x16x32_bf16 v[48:51], a[92:95], v[36:39], v[48:51]
  s_waitcnt lgkmcnt(4)
  v_mfma_f32_16x16x32_bf16 v[52:55], a[88:91], v[40:43], v[52:55]
  ds_read_b128 v[28:31], v2 offset:28672
  v_mfma_f32_16x16x32_bf16 v[56:59], a[92:95], v[40:43], v[56:59]
  s_waitcnt lgkmcnt(4)
  buffer_load_dwordx4 v1, s[4:7], s51 offen sc1 lds
  v_mfma_f32_16x16x32_bf16 v[44:47], a[96:99], v[12:15], v[44:47]
  s_add_u32 m0, s50, 32768
  s_add_u32 s51, s47, 65536
  ds_read_b128 v[32:35], v2 offset:28928
  v_mfma_f32_16x16x32_bf16 v[48:51], a[100:103], v[12:15], v[48:51]
  s_waitcnt lgkmcnt(4)
  v_mfma_f32_16x16x32_bf16 v[52:55], a[96:99], v[16:19], v[52:55]
  ds_read_b128 v[36:39], v2 offset:30720
  v_mfma_f32_16x16x32_bf16 v[56:59], a[100:103], v[16:19], v[56:59]
  s_waitcnt lgkmcnt(4)
  buffer_load_dwordx4 v1, s[4:7], s51 offen sc1 lds
  v_mfma_f32_16x16x32_bf16 v[44:47], a[104:107], v[20:23], v[44:47]
  s_add_u32 m0, s50, 36864
  s_add_u32 s51, s47, 69632
  ds_read_b128 v[40:43], v2 offset:30976
  v_mfma_f32_16x16x32_bf16 v[48:51], a[108:111], v[20:23], v[48:51]
  s_waitcnt lgkmcnt(4)
  v_mfma_f32_16x16x32_bf16 v[52:55], a[104:107], v[24:27], v[52:55]
  s_waitcnt vmcnt(9)
  s_barrier
  ds_read_b128 v[12:15], v2 offset:32768
  v_mfma_f32_16x16x32_bf16 v[56:59], a[108:111], v[24:27], v[56:59]
  s_waitcnt lgkmcnt(4)
  buffer_load_dwordx4 v1, s[4:7], s51 offen sc1 lds
  v_mov_b32 v7, s62
  v_mfma_f32_16x16x32_bf16 v[44:47], a[112:115], v[28:31], v[44:47]
  s_add_u32 m0, s50, 40960
  s_add_u32 s51, s47, 81920
  ds_read_b128 v[16:19], v2 offset:33024
  v_mfma_f32_16x16x32_bf16 v[48:51], a[116:119], v[28:31], v[48:51]
  s_waitcnt lgkmcnt(4)
  buffer_store_dword v7, v0, s[4:7], s61 offen offset:0 sc1
  v_mfma_f32_16x16x32_bf16 v[52:55], a[112:115], v[32:35], v[52:55]
  ds_read_b128 v[20:23], v2 offset:34816
  v_mfma_f32_16x16x32_bf16 v[56:59], a[116:119], v[32:35], v[56:59]
  s_waitcnt lgkmcnt(4)
  buffer_load_dwordx4 v1, s[4:7], s51 offen sc1 lds
  v_mfma_f32_16x16x32_bf16 v[44:47], a[120:123], v[36:39], v[44:47]
  s_xor_b32 s95, s95, 1024
  s_mov_b32 m0, s95
  ds_read_b128 v[24:27], v2 offset:35072
  v_mfma_f32_16x16x32_bf16 v[48:51], a[124:127], v[36:39], v[48:51]
  s_waitcnt lgkmcnt(4)
  v_xor_b32 v171, 1024, v171
  v_mfma_f32_16x16x32_bf16 v[52:55], a[120:123], v[40:43], v[52:55]
  ds_read_b128 v[28:31], v2 offset:36864
  buffer_load_dword v4, s[4:7], s48 offen sc1 lds
  v_mfma_f32_16x16x32_bf16 v[56:59], a[124:127], v[40:43], v[56:59]
  s_waitcnt lgkmcnt(4)
  s_add_u32 m0, s50, 45056
  s_add_u32 s51, s47, 86016
  v_mfma_f32_16x16x32_bf16 v[44:47], a[128:131], v[12:15], v[44:47]
  ds_read_b128 v[32:35], v2 offset:37120
  buffer_load_dwordx4 v1, s[4:7], s51 offen sc1 lds
  v_mfma_f32_16x16x32_bf16 v[48:51], a[132:135], v[12:15], v[48:51]
  s_waitcnt lgkmcnt(4)
  s_add_u32 m0, s50, 49152
  s_add_u32 s51, s47, 98304
  v_mfma_f32_16x16x32_bf16 v[52:55], a[128:131], v[16:19], v[52:55]
  ds_read_b128 v[36:39], v2 offset:38912
  v_mfma_f32_16x16x32_bf16 v[56:59], a[132:135], v[16:19], v[56:59]
  s_waitcnt lgkmcnt(4)
  buffer_store_dword v7, v0, s[4:7], s61 offen offset:128
  v_mfma_f32_16x16x32_bf16 v[44:47], a[136:139], v[20:23], v[44:47]
  s_mov_b32 s57, 0
  ds_read_b128 v[40:43], v2 offset:39168
  buffer_load_dwordx4 v1, s[4:7], s51 offen sc1 lds
  v_mfma_f32_16x16x32_bf16 v[48:51], a[140:143], v[20:23], v[48:51]
  s_waitcnt lgkmcnt(4)
  s_add_u32 m0, s50, 53248
  s_add_u32 s51, s47, 102400
  v_mfma_f32_16x16x32_bf16 v[52:55], a[136:139], v[24:27], v[52:55]
  s_add_u32 s57, s57, s53
  s_mul_i32 s52, s43, 13107200
  ds_read_b128 v[12:15], v2 offset:40960
  v_mfma_f32_16x16x32_bf16 v[56:59], a[140:143], v[24:27], v[56:59]
  s_waitcnt lgkmcnt(4)
  s_add_u32 s57, s57, s52
  s_mul_i32 s52, s44, 204800
  v_mfma_f32_16x16x32_bf16 v[44:47], a[144:147], v[28:31], v[44:47]
  s_add_u32 s57, s57, s52
  ds_read_b128 v[16:19], v2 offset:41216
  buffer_load_dwordx4 v1, s[4:7], s51 offen sc1 lds
  v_mfma_f32_16x16x32_bf16 v[48:51], a[148:151], v[28:31], v[48:51]
  s_waitcnt lgkmcnt(4)
  s_add_u32 m0, s50, 57344
  s_add_u32 s51, s47, 114688
  v_mfma_f32_16x16x32_bf16 v[52:55], a[144:147], v[32:35], v[52:55]
  s_mov_b32 s61, 0
  s_add_u32 s61, s61, s54
  ds_read_b128 v[20:23], v2 offset:43008
  v_mfma_f32_16x16x32_bf16 v[56:59], a[148:151], v[32:35], v[56:59]
  s_waitcnt lgkmcnt(4)
  s_mul_i32 s52, s43, 6400
  s_add_u32 s61, s61, s52
  v_mfma_f32_16x16x32_bf16 v[44:47], a[152:155], v[36:39], v[44:47]
  s_add_u32 s62, s44, 1
  ds_read_b128 v[24:27], v2 offset:43264
  buffer_load_dwordx4 v1, s[4:7], s51 offen sc1 lds
  v_mfma_f32_16x16x32_bf16 v[48:51], a[156:159], v[36:39], v[48:51]
  s_waitcnt lgkmcnt(4)
  s_cmp_eq_u32 s42, 62
  s_cselect_b64 s[86:87], s[88:89], s[86:87]
  v_mfma_f32_16x16x32_bf16 v[52:55], a[152:155], v[40:43], v[52:55]
  s_and_b32 s83, s86, 1
  s_cselect_b32 s84, s91, s90
  ds_read_b128 v[28:31], v2 offset:45056
  v_mfma_f32_16x16x32_bf16 v[56:59], a[156:159], v[40:43], v[56:59]
  s_waitcnt lgkmcnt(4)
  s_lshr_b64 s[86:87], s[86:87], 1
  s_add_u32 s91, s91, s83
  v_mfma_f32_16x16x32_bf16 v[44:47], a[160:163], v[12:15], v[44:47]
  s_xor_b32 s52, s83, 1
  s_add_u32 s90, s90, s52
  ds_read_b128 v[32:35], v2 offset:45312
  v_mfma_f32_16x16x32_bf16 v[48:51], a[164:167], v[12:15], v[48:51]
  s_waitcnt lgkmcnt(4)
  s_mov_b32 s85, 165675008
  s_mul_i32 s52, s84, 1048576
  v_mfma_f32_16x16x32_bf16 v[52:55], a[160:163], v[16:19], v[52:55]
  s_add_u32 s85, s85, s52
  s_add_u32 s85, s85, s68
  ds_read_b128 v[36:39], v2 offset:47104
  v_mfma_f32_16x16x32_bf16 v[56:59], a[164:167], v[16:19], v[56:59]
  s_waitcnt lgkmcnt(4)
  s_add_u32 s85, s85, s63
  s_lshl_b32 s52, s83, 21
  v_mfma_f32_16x16x32_bf16 v[44:47], a[168:171], v[20:23], v[44:47]
  s_add_u32 s52, s52, s85
  s_lshr_b32 s52, s52, 8
  ds_read_b128 v[40:43], v2 offset:47360
  v_mfma_f32_16x16x32_bf16 v[48:51], a[172:175], v[20:23], v[48:51]
  s_waitcnt lgkmcnt(4)
  s_and_b32 s52, s52, 0x2000
  s_xor_b32 s85, s85, s52
  v_mfma_f32_16x16x32_bf16 v[52:55], a[168:171], v[24:27], v[52:55]
  ds_read_b128 v[12:15], v2 offset:49152
  v_mfma_f32_16x16x32_bf16 v[56:59], a[172:175], v[24:27], v[56:59]
  s_waitcnt lgkmcnt(4)
  v_mfma_f32_16x16x32_bf16 v[44:47], a[176:179], v[28:31], v[44:47]
  ds_read_b128 v[16:19], v2 offset:49408
  v_mfma_f32_16x16x32_bf16 v[48:51], a[180:183], v[28:31], v[48:51]
  s_waitcnt lgkmcnt(4)
  v_mfma_f32_16x16x32_bf16 v[52:55], a[176:179], v[32:35], v[52:55]
  ds_read_b128 v[20:23], v2 offset:51200
  v_mfma_f32_16x16x32_bf16 v[56:59], a[180:183], v[32:35], v[56:59]
  s_waitcnt lgkmcnt(4)
  v_mfma_f32_16x16x32_bf16 v[44:47], a[184:187], v[36:39], v[44:47]
  ds_read_b128 v[24:27], v2 offset:51456
  v_mfma_f32_16x16x32_bf16 v[48:51], a[188:191], v[36:39], v[48:51]
  s_waitcnt lgkmcnt(4)
  v_mfma_f32_16x16x32_bf16 v[52:55], a[184:187], v[40:43], v[52:55]
  ds_read_b128 v[28:31], v2 offset:53248
  v_mfma_f32_16x16x32_bf16 v[56:59], a[188:191], v[40:43], v[56:59]
  s_waitcnt lgkmcnt(4)
  v_mfma_f32_16x16x32_bf16 v[44:47], a[192:195], v[12:15], v[44:47]
  ds_read_b128 v[32:35], v2 offset:53504
  v_mfma_f32_16x16x32_bf16 v[48:51], a[196:199], v[12:15], v[48:51]
  s_waitcnt lgkmcnt(4)
  v_mfma_f32_16x16x32_bf16 v[52:55], a[192:195], v[16:19], v[52:55]
  ds_read_b128 v[36:39], v2 offset:55296
  v_mfma_f32_16x16x32_bf16 v[56:59], a[196:199], v[16:19], v[56:59]
  s_waitcnt lgkmcnt(4)
  v_mfma_f32_16x16x32_bf16 v[44:47], a[200:203], v[20:23], v[44:47]
  ds_read_b128 v[40:43], v2 offset:55552
  v_mfma_f32_16x16x32_bf16 v[48:51], a[204:207], v[20:23], v[48:51]
  s_waitcnt lgkmcnt(4)
  v_mfma_f32_16x16x32_bf16 v[52:55], a[200:203], v[24:27], v[52:55]
  ds_read_b128 v[12:15], v2 offset:57344
  v_mfma_f32_16x16x32_bf16 v[56:59], a[204:207], v[24:27], v[56:59]
  s_waitcnt lgkmcnt(4)
  v_mfma_f32_16x16x32_bf16 v[44:47], a[208:211], v[28:31], v[44:47]
  ds_read_b128 v[16:19], v2 offset:57600
  v_mfma_f32_16x16x32_bf16 v[48:51], a[212:215], v[28:31], v[48:51]
  s_waitcnt lgkmcnt(4)
  v_mfma_f32_16x16x32_bf16 v[52:55], a[208:211], v[32:35], v[52:55]
  ds_read_b128 v[20:23], v2 offset:59392
  v_mfma_f32_16x16x32_bf16 v[56:59], a[212:215], v[32:35], v[56:59]
  s_waitcnt lgkmcnt(4)
  v_mfma_f32_16x16x32_bf16 v[44:47], a[216:219], v[36:39], v[44:47]
  ds_read_b128 v[24:27], v2 offset:59648
  v_mfma_f32_16x16x32_bf16 v[48:51], a[220:223], v[36:39], v[48:51]
  s_waitcnt lgkmcnt(4)
  v_add_u32 v2, s55, v2
  v_add_u32 v3, s55, v3
  v_mfma_f32_16x16x32_bf16 v[52:55], a[216:219], v[40:43], v[52:55]
  s_sub_u32 s55, 0, s55
  v_mfma_f32_16x16x32_bf16 v[56:59], a[220:223], v[40:43], v[56:59]
  s_waitcnt lgkmcnt(3)
  v_mfma_f32_16x16x32_bf16 v[44:47], a[224:227], v[12:15], v[44:47]
  s_cmp_eq_u32 s49, 0
  s_cbranch_scc1 L_leaf_slow0
  v_mfma_f32_16x16x32_bf16 v[48:51], a[228:231], v[12:15], v[48:51]
  s_waitcnt vmcnt(5) lgkmcnt(0)
  s_barrier
  ds_read_b128 v[28:31], v2 offset:0
  v_mfma_f32_16x16x32_bf16 v[52:55], a[224:227], v[16:19], v[52:55]
  ds_read_b128 v[32:35], v2 offset:256
  v_mfma_f32_16x16x32_bf16 v[56:59], a[228:231], v[16:19], v[56:59]
  ds_read_b128 v[36:39], v2 offset:2048
  ds_read_b128 v[40:43], v2 offset:2304
  v_mfma_f32_16x16x32_bf16 v[44:47], a[232:235], v[20:23], v[44:47]
  ds_read_b128 v[12:15], v2 offset:4096
  v_mfma_f32_16x16x32_bf16 v[48:51], a[236:239], v[20:23], v[48:51]
  v_mfma_f32_16x16x32_bf16 v[52:55], a[232:235], v[24:27], v[52:55]
  v_mfma_f32_16x16x32_bf16 v[56:59], a[236:239], v[24:27], v[56:59]
L_leaf_body1:
  s_waitcnt lgkmcnt(4)
  v_mfma_f32_16x16x32_bf16 v[60:63], a[0:3], v[28:31], 0
  s_mov_b32 s43, s45
  ds_read_b128 v[16:19], v2 offset:4352
  ds_read_b32 v5, v171
  v_mfma_f32_16x16x32_bf16 v[64:67], a[4:7], v[28:31], 0
  s_waitcnt lgkmcnt(5)
  v_cvt_pk_bf16_f32 v76, v44, v45
  v_cvt_pk_bf16_f32 v77, v46, v47
  v_mfma_f32_16x16x32_bf16 v[68:71], a[0:3], v[32:35], 0
  s_mov_b32 s44, s46
  ds_read_b128 v[20:23], v2 offset:6144
  v_cvt_pk_bf16_f32 v78, v48, v49
  v_mfma_f32_16x16x32_bf16 v[72:75], a[4:7], v[32:35], 0
  s_waitcnt lgkmcnt(5)
  s_mov_b32 s46, s84
  v_cvt_pk_bf16_f32 v79, v50, v51
  v_mfma_f32_16x16x32_bf16 v[60:63], a[8:11], v[36:39], v[60:63]
  s_mov_b32 s45, s83
  s_mov_b32 s64, s85
  ds_read_b128 v[24:27], v2 offset:6400
  v_mfma_f32_16x16x32_bf16 v[64:67], a[12:15], v[36:39], v[64:67]
  s_waitcnt lgkmcnt(5)
  buffer_store_dwordx4 v[76:79], v8, s[4:7], s57 offen offset:0 sc1
  v_mfma_f32_16x16x32_bf16 v[68:71], a[8:11], v[40:43], v[68:71]
  s_add_u32 s42, s42, 1
  ds_read_b128 v[28:31], v2 offset:8192
  v_cvt_pk_bf16_f32 v80, v52, v53
  v_mfma_f32_16x16x32_bf16 v[72:75], a[12:15], v[40:43], v[72:75]
  s_waitcnt lgkmcnt(5)
  v_cvt_pk_bf16_f32 v81, v54, v55
  v_cvt_pk_bf16_f32 v82, v56, v57
  v_mfma_f32_16x16x32_bf16 v[60:63], a[16:19], v[12:15], v[60:63]
  s_waitcnt lgkmcnt(3)
  ds_read_b128 v[32:35], v2 offset:8448
  v_cvt_pk_bf16_f32 v83, v58, v59
  v_mfma_f32_16x16x32_bf16 v[64:67], a[20:23], v[12:15], v[64:67]
  buffer_store_dwordx4 v[80:83], v8, s[4:7], s57 offen offset:256 sc1
  v_mfma_f32_16x16x32_bf16 v[68:71], a[16:19], v[16:19], v[68:71]
  ds_read_b128 v[36:39], v2 offset:10240
  v_cmp_ge_i32 vcc, s46, v5
  v_mfma_f32_16x16x32_bf16 v[72:75], a[20:23], v[16:19], v[72:75]
  s_waitcnt lgkmcnt(4)
  v_mfma_f32_16x16x32_bf16 v[60:63], a[24:27], v[20:23], v[60:63]
  ds_read_b128 v[40:43], v2 offset:10496
  v_mfma_f32_16x16x32_bf16 v[64:67], a[28:31], v[20:23], v[64:67]
  s_waitcnt lgkmcnt(4)
  s_cmp_eq_u32 s45, 0
  s_cselect_b32 s51, vcc_lo, vcc_hi
  v_mfma_f32_16x16x32_bf16 v[68:71], a[24:27], v[24:27], v[68:71]
  s_cmp_lg_u32 s51, 0
  s_cselect_b32 s49, 0, 1
  ds_read_b128 v[12:15], v2 offset:12288
  v_mfma_f32_16x16x32_bf16 v[72:75], a[28:31], v[24:27], v[72:75]
  s_waitcnt lgkmcnt(4)
  s_cmp_lt_u32 s42, s80
  s_cselect_b32 s49, s49, 0
  v_mfma_f32_16x16x32_bf16 v[60:63], a[32:35], v[28:31], v[60:63]
  s_cmp_lg_u32 s49, 0
  s_cselect_b32 s47, s64, 0x20000000
  ds_read_b128 v[16:19], v2 offset:12544
  v_mfma_f32_16x16x32_bf16 v[64:67], a[36:39], v[28:31], v[64:67]
  s_waitcnt lgkmcnt(4)
  s_xor_b32 s50, s50, s56
  v_mfma_f32_16x16x32_bf16 v[68:71], a[32:35], v[32:35], v[68:71]
  s_add_u32 m0, s50, 0
  s_add_u32 s51, s47, 0
  ds_read_b128 v[20:23], v2 offset:14336
  v_mfma_f32_16x16x32_bf16 v[72:75], a[36:39], v[32:35], v[72:75]
  s_waitcnt lgkmcnt(4)
  buffer_load_dwordx4 v1, s[4:7], s51 offen sc1 lds
  v_mfma_f32_16x16x32_bf16 v[60:63], a[40:43], v[36:39], v[60:63]
  s_add_u32 m0, s50, 4096
  s_add_u32 s51, s47, 4096
  ds_read_b128 v[24:27], v2 offset:14592
  v_mfma_f32_16x16x32_bf16 v[64:67], a[44:47], v[36:39], v[64:67]
  s_waitcnt lgkmcnt(4)
  v_mfma_f32_16x16x32_bf16 v[68:71], a[40:43], v[40:43], v[68:71]
  ds_read_b128 v[28:31], v2 offset:16384
  v_mfma_f32_16x16x32_bf16 v[72:75], a[44:47], v[40:43], v[72:75]
  s_waitcnt lgkmcnt(4)
  buffer_load_dwordx4 v1, s[4:7], s51 offen sc1 lds
  v_mfma_f32_16x16x32_bf16 v[60:63], a[48:51], v[12:15], v[60:63]
  s_add_u32 m0, s50, 8192
  s_add_u32 s51, s47, 16384
  ds_read_b128 v[32:35], v2 offset:16640
  v_mfma_f32_16x16x32_bf16 v[64:67], a[52:55], v[12:15], v[64:67]
  s_waitcnt lgkmcnt(4)
  v_mfma_f32_16x16x32_bf16 v[68:71], a[48:51], v[16:19], v[68:71]
  ds_read_b128 v[36:39], v2 offset:18432
  v_mfma_f32_16x16x32_bf16 v[72:75], a[52:55], v[16:19], v[72:75]
  s_waitcnt lgkmcnt(4)
  buffer_load_dwordx4 v1, s[4:7], s51 offen sc1 lds
  v_mfma_f32_16x16x32_bf16 v[60:63], a[56:59], v[20:23], v[60:63]
  s_add_u32 m0, s50, 12288
  s_add_u32 s51, s47, 20480
  ds_read_b128 v[40:43], v2 offset:18688
  v_mfma_f32_16x16x32_bf16 v[64:67], a[60:63], v[20:23], v[64:67]
  s_waitcnt lgkmcnt(4)
  v_mfma_f32_16x16x32_bf16 v[68:71], a[56:59], v[24:27], v[68:71]
  ds_read_b128 v[12:15], v2 offset:20480
  v_mfma_f32_16x16x32_bf16 v[72:75], a[60:63], v[24:27], v[72:75]
  s_waitcnt lgkmcnt(4)
  buffer_load_dwordx4 v1, s[4:7], s51 offen sc1 lds
  v_mfma_f32_16x16x32_bf16 v[60:63], a[64:67], v[28:31], v[60:63]
  s_add_u32 m0, s50, 16384
  s_add_u32 s51, s47, 32768
  ds_read_b128 v[16:19], v2 offset:20736
  v_mfma_f32_16x16x32_bf16 v[64:67], a[68:71], v[28:31], v[64:67]
  s_waitcnt lgkmcnt(4)
  v_mfma_f32_16x16x32_bf16 v[68:71], a[64:67], v[32:35], v[68:71]
  ds_read_b128 v[20:23], v2 offset:22528
  v_mfma_f32_16x16x32_bf16 v[72:75], a[68:71], v[32:35], v[72:75]
  s_waitcnt lgkmcnt(4)
  buffer_load_dwordx4 v1, s[4:7], s51 offen sc1 lds
  v_mfma_f32_16x16x32_bf16 v[60:63], a[72:75], v[36:39], v[60:63]
  s_add_u32 m0, s50, 20480
  s_add_u32 s51, s47, 36864
  ds_read_b128 v[24:27], v2 offset:22784
  v_mfma_f32_16x16x32_bf16 v[64:67], a[76:79], v[36:39], v[64:67]
  s_waitcnt lgkmcnt(4)
  v_mfma_f32_16x16x32_bf16 v[68:71], a[72:75], v[40:43], v[68:71]
  ds_read_b128 v[28:31], v2 offset:24576
  v_mfma_f32_16x16x32_bf16 v[72:75], a[76:79], v[40:43], v[72:75]
  s_waitcnt lgkmcnt(4)
  buffer_load_dwordx4 v1, s[4:7], s51 offen sc1 lds
  v_mfma_f32_16x16x32_bf16 v[60:63], a[80:83], v[12:15], v[60:63]
  s_add_u32 m0, s50, 24576
  s_add_u32 s51, s47, 49152
  ds_read_b128 v[32:35], v2 offset:24832
  v_mfma_f32_16x16x32_bf16 v[64:67], a[84:87], v[12:15], v[64:67]
  s_waitcnt lgkmcnt(4)
  v_mfma_f32_16x16x32_bf16 v[68:71], a[80:83], v[16:19], v[68:71]
  ds_read_b128 v[36:39], v2 offset:26624
  v_mfma_f32_16x16x32_bf16 v[72:75], a[84:87], v[16:19], v[72:75]
  s_waitcnt lgkmcnt(4)
  buffer_load_dwordx4 v1, s[4:7], s51 offen sc1 lds
  v_mfma_f32_16x16x32_bf16 v[60:63], a[88:91], v[20:23], v[60:63]
  s_add_u32 m0, s50, 28672
  s_add_u32 s51, s47, 53248
  ds_read_b128 v[40:43], v2 offset:26880
  v_mfma_f32_16x16x32_bf16 v[64:67], a[92:95], v[20:23], v[64:67]
  s_waitcnt lgkmcnt(4)
  v_mfma_f32_16x16x32_bf16 v[68:71], a[88:91], v[24:27], v[68:71]
  ds_read_b128 v[12:15], v2 offset:28672
  v_mfma_f32_16x16x32_bf16 v[72:75], a[92:95], v[24:27], v[72:75]
  s_waitcnt lgkmcnt(4)
  buffer_load_dwordx4 v1, s[4:7], s51 offen sc1 lds
  v_mfma_f32_16x16x32_bf16 v[60:63], a[96:99], v[28:31], v[60:63]
  s_add_u32 m0, s50, 32768
  s_add_u32 s51, s47, 65536
  ds_read_b128 v[16:19], v2 offset:28928
  v_mfma_f32_16x16x32_bf16 v[64:67], a[100:103], v[28:31], v[64:67]
  s_waitcnt lgkmcnt(4)
  v_mfma_f32_16x16x32_bf16 v[68:71], a[96:99], v[32:35], v[68:71]
  ds_read_b128 v[20:23], v2 offset:30720
  v_mfma_f32_16x16x32_bf16 v[72:75], a[100:103], v[32:35], v[72:75]
  s_waitcnt lgkmcnt(4)
  buffer_load_dwordx4 v1, s[4:7], s51 offen sc1 lds
  v_mfma_f32_16x16x32_bf16 v[60:63], a[104:107], v[36:39], v[60:63]
  s_add_u32 m0, s50, 36864
  s_add_u32 s51, s47, 69632
  ds_read_b128 v[24:27], v2 offset:30976
  v_mfma_f32_16x16x32_bf16 v[64:67], a[108:111], v[36:39], v[64:67]
  s_waitcnt lgkmcnt(4)
  v_mfma_f32_16x16x32_bf16 v[68:71], a[104:107], v[40:43], v[68:71]
  s_waitcnt vmcnt(9)
  s_barrier
  ds_read_b128 v[28:31], v2 offset:32768
  v_mfma_f32_16x16x32_bf16 v[72:75], a[108:111], v[40:43], v[72:75]
  s_waitcnt lgkmcnt(4)
  buffer_load_dwordx4 v1, s[4:7], s51 offen sc1 lds
  v_mov_b32 v7, s62
  v_mfma_f32_16x16x32_bf16 v[60:63], a[112:115], v[12:15], v[60:63]
  s_add_u32 m0, s50, 40960
  s_add_u32 s51, s47, 81920
  ds_read_b128 v[32:35], v2 offset:33024
  v_mfma_f32_16x16x32_bf16 v[64:67], a[116:119], v[12:15], v[64:67]
  s_waitcnt lgkmcnt(4)
  buffer_store_dword v7, v0, s[4:7], s61 offen offset:0 sc1
  v_mfma_f32_16x16x32_bf16 v[68:71], a[112:115], v[16:19], v[68:71]
  ds_read_b128 v[36:39], v2 offset:34816
  v_mfma_f32_16x16x32_bf16 v[72:75], a[116:119], v[16:19], v[72:75]
  s_waitcnt lgkmcnt(4)
  buffer_load_dwordx4 v1, s[4:7], s51 offen sc1 lds
  v_mfma_f32_16x16x32_bf16 v[60:63], a[120:123], v[20:23], v[60:63]
  s_xor_b32 s95, s95, 1024
  s_mov_b32 m0, s95
  ds_read_b128 v[40:43], v2 offset:35072
  v_mfma_f32_16x16x32_bf16 v[64:67], a[124:127], v[20:23], v[64:67]
  s_waitcnt lgkmcnt(4)
  v_xor_b32 v171, 1024, v171
  v_mfma_f32_16x16x32_bf16 v[68:71], a[120:123], v[24:27], v[68:71]
  ds_read_b128 v[12:15], v2 offset:36864
  buffer_load_dword v4, s[4:7], s48 offen sc1 lds
  v_mfma_f32_16x16x32_bf16 v[72:75], a[124:127], v[24:27], v[72:75]
  s_waitcnt lgkmcnt(4)
  s_add_u32 m0, s50, 45056
  s_add_u32 s51, s47, 86016
  v_mfma_f32_16x16x32_bf16 v[60:63], a[128:131], v[28:31], v[60:63]
  ds_read_b128 v[16:19], v2 offset:37120
  buffer_load_dwordx4 v1, s[4:7], s51 offen sc1 lds
  v_mfma_f32_16x16x32_bf16 v[64:67], a[132:135], v[28:31], v[64:67]
  s_waitcnt lgkmcnt(4)
  s_add_u32 m0, s50, 49152
  s_add_u32 s51, s47, 98304
  v_mfma_f32_16x16x32_bf16 v[68:71], a[128:131], v[32:35], v[68:71]
  ds_read_b128 v[20:23], v2 offset:38912
  v_mfma_f32_16x16x32_bf16 v[72:75], a[132:135], v[32:35], v[72:75]
  s_waitcnt lgkmcnt(4)
  buffer_store_dword v7, v0, s[4:7], s61 offen offset:128
  v_mfma_f32_16x16x32_bf16 v[60:63], a[136:139], v[36:39], v[60:63]
  s_mov_b32 s57, 0
  ds_read_b128 v[24:27], v2 offset:39168
  buffer_load_dwordx4 v1, s[4:7], s51 offen sc1 lds
  v_mfma_f32_16x16x32_bf16 v[64:67], a[140:143], v[36:39], v[64:67]
  s_waitcnt lgkmcnt(4)
  s_add_u32 m0, s50, 53248
  s_add_u32 s51, s47, 102400
  v_mfma_f32_16x16x32_bf16 v[68:71], a[136:139], v[40:43], v[68:71]
  s_add_u32 s57, s57, s53
  s_mul_i32 s52, s43, 13107200
  ds_read_b128 v[28:31], v2 offset:40960
  v_mfma_f32_16x16x32_bf16 v[72:75], a[140:143], v[40:43], v[72:75]
  s_waitcnt lgkmcnt(4)
  s_add_u32 s57, s57, s52
  s_mul_i32 s52, s44, 204800
  v_mfma_f32_16x16x32_bf16 v[60:63], a[144:147], v[12:15], v[60:63]
  s_add_u32 s57, s57, s52
  ds_read_b128 v[32:35], v2 offset:41216
  buffer_load_dwordx4 v1, s[4:7], s51 offen sc1 lds
  v_mfma_f32_16x16x32_bf16 v[64:67], a[148:151], v[12:15], v[64:67]
  s_waitcnt lgkmcnt(4)
  s_add_u32 m0, s50, 57344
  s_add_u32 s51, s47, 114688
  v_mfma_f32_16x16x32_bf16 v[68:71], a[144:147], v[16:19], v[68:71]
  s_mov_b32 s61, 0
  s_add_u32 s61, s61, s54
  ds_read_b128 v[36:39], v2 offset:43008
  v_mfma_f32_16x16x32_bf16 v[72:75], a[148:151], v[16:19], v[72:75]
  s_waitcnt lgkmcnt(4)
  s_mul_i32 s52, s43, 6400
  s_add_u32 s61, s61, s52
  v_mfma_f32_16x16x32_bf16 v[60:63], a[152:155], v[20:23], v[60:63]
  s_add_u32 s62, s44, 1
  ds_read_b128 v[40:43], v2 offset:43264
  buffer_load_dwordx4 v1, s[4:7], s51 offen sc1 lds
  v_mfma_f32_16x16x32_bf16 v[64:67], a[156:159], v[20:23], v[64:67]
  s_waitcnt lgkmcnt(4)
  s_cmp_eq_u32 s42, 62
  s_cselect_b64 s[86:87], s[88:89], s[86:87]
  v_mfma_f32_16x16x32_bf16 v[68:71], a[152:155], v[24:27], v[68:71]
  s_and_b32 s83, s86, 1
  s_cselect_b32 s84, s91, s90
  ds_read_b128 v[12:15], v2 offset:45056
  v_mfma_f32_16x16x32_bf16 v[72:75], a[156:159], v[24:27], v[72:75]
  s_waitcnt lgkmcnt(4)
  s_lshr_b64 s[86:87], s[86:87], 1
  s_add_u32 s91, s91, s83
  v_mfma_f32_16x16x32_bf16 v[60:63], a[160:163], v[28:31], v[60:63]
  s_xor_b32 s52, s83, 1
  s_add_u32 s90, s90, s52
  ds_read_b128 v[16:19], v2 offset:45312
  v_mfma_f32_16x16x32_bf16 v[64:67], a[164:167], v[28:31], v[64:67]
  s_waitcnt lgkmcnt(4)
  s_mov_b32 s85, 165675008
  s_mul_i32 s52, s84, 1048576
  v_mfma_f32_16x16x32_bf16 v[68:71], a[160:163], v[32:35], v[68:71]
  s_add_u32 s85, s85, s52
  s_add_u32 s85, s85, s68
  ds_read_b128 v[20:23], v2 offset:47104
  v_mfma_f32_16x16x32_bf16 v[72:75], a[164:167], v[32:35], v[72:75]
  s_waitcnt lgkmcnt(4)
  s_add_u32 s85, s85, s63
  s_lshl_b32 s52, s83, 21
  v_mfma_f32_16x16x32_bf16 v[60:63], a[168:171], v[36:39], v[60:63]
  s_add_u32 s52, s52, s85
  s_lshr_b32 s52, s52, 8
  ds_read_b128 v[24:27], v2 offset:47360
  v_mfma_f32_16x16x32_bf16 v[64:67], a[172:175], v[36:39], v[64:67]
  s_waitcnt lgkmcnt(4)
  s_and_b32 s52, s52, 0x2000
  s_xor_b32 s85, s85, s52
  v_mfma_f32_16x16x32_bf16 v[68:71], a[168:171], v[40:43], v[68:71]
  ds_read_b128 v[28:31], v2 offset:49152
  v_mfma_f32_16x16x32_bf16 v[72:75], a[172:175], v[40:43], v[72:75]
  s_waitcnt lgkmcnt(4)
  v_mfma_f32_16x16x32_bf16 v[60:63], a[176:179], v[12:15], v[60:63]
  ds_read_b128 v[32:35], v2 offset:49408
  v_mfma_f32_16x16x32_bf16 v[64:67], a[180:183], v[12:15], v[64:67]
  s_waitcnt lgkmcnt(4)
  v_mfma_f32_16x16x32_bf16 v[68:71], a[176:179], v[16:19], v[68:71]
  ds_read_b128 v[36:39], v2 offset:51200
  v_mfma_f32_16x16x32_bf16 v[72:75], a[180:183], v[16:19], v[72:75]
  s_waitcnt lgkmcnt(4)
  v_mfma_f32_16x16x32_bf16 v[60:63], a[184:187], v[20:23], v[60:63]
  ds_read_b128 v[40:43], v2 offset:51456
  v_mfma_f32_16x16x32_bf16 v[64:67], a[188:191], v[20:23], v[64:67]
  s_waitcnt lgkmcnt(4)
  v_mfma_f32_16x16x32_bf16 v[68:71], a[184:187], v[24:27], v[68:71]
  ds_read_b128 v[12:15], v2 offset:53248
  v_mfma_f32_16x16x32_bf16 v[72:75], a[188:191], v[24:27], v[72:75]
  s_waitcnt lgkmcnt(4)
  v_mfma_f32_16x16x32_bf16 v[60:63], a[192:195], v[28:31], v[60:63]
  ds_read_b128 v[16:19], v2 offset:53504
  v_mfma_f32_16x16x32_bf16 v[64:67], a[196:199], v[28:31], v[64:67]
  s_waitcnt lgkmcnt(4)
  v_mfma_f32_16x16x32_bf16 v[68:71], a[192:195], v[32:35], v[68:71]
  ds_read_b128 v[20:23], v2 offset:55296
  v_mfma_f32_16x16x32_bf16 v[72:75], a[196:199], v[32:35], v[72:75]
  s_waitcnt lgkmcnt(4)
  v_mfma_f32_16x16x32_bf16 v[60:63], a[200:203], v[36:39], v[60:63]
  ds_read_b128 v[24:27], v2 offset:55552
  v_mfma_f32_16x16x32_bf16 v[64:67], a[204:207], v[36:39], v[64:67]
  s_waitcnt lgkmcnt(4)
  v_mfma_f32_16x16x32_bf16 v[68:71], a[200:203], v[40:43], v[68:71]
  ds_read_b128 v[28:31], v2 offset:57344
  v_mfma_f32_16x16x32_bf16 v[72:75], a[204:207], v[40:43], v[72:75]
  s_waitcnt lgkmcnt(4)
  v_mfma_f32_16x16x32_bf16 v[60:63], a[208:211], v[12:15], v[60:63]
  ds_read_b128 v[32:35], v2 offset:57600
  v_mfma_f32_16x16x32_bf16 v[64:67], a[212:215], v[12:15], v[64:67]
  s_waitcnt lgkmcnt(4)
  v_mfma_f32_16x16x32_bf16 v[68:71], a[208:211], v[16:19], v[68:71]
  ds_read_b128 v[36:39], v2 offset:59392
  v_mfma_f32_16x16x32_bf16 v[72:75], a[212:215], v[16:19], v[72:75]
  s_waitcnt lgkmcnt(4)
  v_mfma_f32_16x16x32_bf16 v[60:63], a[216:219], v[20:23], v[60:63]
  ds_read_b128 v[40:43], v2 offset:59648
  v_mfma_f32_16x16x32_bf16 v[64:67], a[220:223], v[20:23], v[64:67]
  s_waitcnt lgkmcnt(4)
  v_add_u32 v2, s55, v2
  v_add_u32 v3, s55, v3
  v_mfma_f32_16x16x32_bf16 v[68:71], a[216:219], v[24:27], v[68:71]
  s_sub_u32 s55, 0, s55
  v_mfma_f32_16x16x32_bf16 v[72:75], a[220:223], v[24:27], v[72:75]
  s_waitcnt lgkmcnt(3)
  v_mfma_f32_16x16x32_bf16 v[60:63], a[224:227], v[28:31], v[60:63]
  s_cmp_eq_u32 s49, 0
  s_cbranch_scc1 L_leaf_slow1
  v_mfma_f32_16x16x32_bf16 v[64:67], a[228:231], v[28:31], v[64:67]
  s_waitcnt vmcnt(5) lgkmcnt(0)
  s_barrier
  ds_read_b128 v[12:15], v2 offset:0
  v_mfma_f32_16x16x32_bf16 v[68:71], a[224:227], v[32:35], v[68:71]
  ds_read_b128 v[16:19], v2 offset:256
  v_mfma_f32_16x16x32_bf16 v[72:75], a[228:231], v[32:35], v[72:75]
  ds_read_b128 v[20:23], v2 offset:2048
  ds_read_b128 v[24:27], v2 offset:2304
  v_mfma_f32_16x16x32_bf16 v[60:63], a[232:235], v[36:39], v[60:63]
  ds_read_b128 v[28:31], v2 offset:4096
  v_mfma_f32_16x16x32_bf16 v[64:67], a[236:239], v[36:39], v[64:67]
  v_mfma_f32_16x16x32_bf16 v[68:71], a[232:235], v[40:43], v[68:71]
  v_mfma_f32_16x16x32_bf16 v[72:75], a[236:239], v[40:43], v[72:75]
  s_branch L_leaf_body0
L_leaf_entry0:
  s_barrier
  ds_read_b128 v[12:15], v2 offset:0
  ds_read_b128 v[16:19], v2 offset:256
  ds_read_b128 v[20:23], v2 offset:2048
  ds_read_b128 v[24:27], v2 offset:2304
  ds_read_b128 v[28:31], v2 offset:4096
  s_branch L_leaf_body0
L_leaf_slow0:
  v_mfma_f32_16x16x32_bf16 v[48:51], a[228:231], v[12:15], v[48:51]
  s_waitcnt lgkmcnt(0)
  v_mfma_f32_16x16x32_bf16 v[52:55], a[224:227], v[16:19], v[52:55]
  v_mfma_f32_16x16x32_bf16 v[56:59], a[228:231], v[16:19], v[56:59]
  v_mfma_f32_16x16x32_bf16 v[44:47], a[232:235], v[20:23], v[44:47]
  v_mfma_f32_16x16x32_bf16 v[48:51], a[236:239], v[20:23], v[48:51]
  v_mfma_f32_16x16x32_bf16 v[52:55], a[232:235], v[24:27], v[52:55]
  v_mfma_f32_16x16x32_bf16 v[56:59], a[236:239], v[24:27], v[56:59]
  s_mov_b32 s47, s64
  s_cmp_eq_u32 s42, s80
  s_cbranch_scc1 L_nonext_5344
  s_waitcnt vmcnt(0)
  s_barrier
  ds_read_b32 v5, v171
  s_waitcnt lgkmcnt(0)
  v_cmp_ge_i32 vcc, s46, v5
  s_cmp_eq_u32 s45, 0
  s_cselect_b32 s51, vcc_lo, vcc_hi
  s_cmp_lg_u32 s51, 0
  s_cbranch_scc1 L_nonext_5344
  s_add_u32 m0, s50, 0
  s_add_u32 s51, s47, 0
  buffer_load_dwordx4 v1, s[4:7], s51 offen sc1 lds
  s_add_u32 m0, s50, 4096
  s_add_u32 s51, s47, 4096
  buffer_load_dwordx4 v1, s[4:7], s51 offen sc1 lds
  s_add_u32 m0, s50, 8192
  s_add_u32 s51, s47, 16384
  buffer_load_dwordx4 v1, s[4:7], s51 offen sc1 lds
  s_add_u32 m0, s50, 12288
  s_add_u32 s51, s47, 20480
  buffer_load_dwordx4 v1, s[4:7], s51 offen sc1 lds
  s_add_u32 m0, s50, 16384
  s_add_u32 s51, s47, 32768
  buffer_load_dwordx4 v1, s[4:7], s51 offen sc1 lds
  s_add_u32 m0, s50, 20480
  s_add_u32 s51, s47, 36864
  buffer_load_dwordx4 v1, s[4:7], s51 offen sc1 lds
  s_add_u32 m0, s50, 24576
  s_add_u32 s51, s47, 49152
  buffer_load_dwordx4 v1, s[4:7], s51 offen sc1 lds
  s_add_u32 m0, s50, 28672
  s_add_u32 s51, s47, 53248
  buffer_load_dwordx4 v1, s[4:7], s51 offen sc1 lds
  s_add_u32 m0, s50, 32768
  s_add_u32 s51, s47, 65536
  buffer_load_dwordx4 v1, s[4:7], s51 offen sc1 lds
  s_add_u32 m0, s50, 36864
  s_add_u32 s51, s47, 69632
  buffer_load_dwordx4 v1, s[4:7], s51 offen sc1 lds
  s_add_u32 m0, s50, 40960
  s_add_u32 s51, s47, 81920
  buffer_load_dwordx4 v1, s[4:7], s51 offen sc1 lds
  s_add_u32 m0, s50, 45056
  s_add_u32 s51, s47, 86016
  buffer_load_dwordx4 v1, s[4:7], s51 offen sc1 lds
  s_add_u32 m0, s50, 49152
  s_add_u32 s51, s47, 98304
  buffer_load_dwordx4 v1, s[4:7], s51 offen sc1 lds
  s_add_u32 m0, s50, 53248
  s_add_u32 s51, s47, 102400
  buffer_load_dwordx4 v1, s[4:7], s51 offen sc1 lds
  s_add_u32 m0, s50, 57344
  s_add_u32 s51, s47, 114688
  buffer_load_dwordx4 v1, s[4:7], s51 offen sc1 lds
  v_cvt_pk_bf16_f32 v76, v44, v45
  v_cvt_pk_bf16_f32 v77, v46, v47
  v_cvt_pk_bf16_f32 v78, v48, v49
  v_cvt_pk_bf16_f32 v79, v50, v51
  buffer_store_dwordx4 v[76:79], v8, s[4:7], s57 offen offset:0 sc1
  v_cvt_pk_bf16_f32 v80, v52, v53
  v_cvt_pk_bf16_f32 v81, v54, v55
  v_cvt_pk_bf16_f32 v82, v56, v57
  v_cvt_pk_bf16_f32 v83, v58, v59
  buffer_store_dwordx4 v[80:83], v8, s[4:7], s57 offen offset:256 sc1
  s_mov_b32 s57, 0x20000000
  s_mov_b32 s58, 0x20000000
  s_mov_b32 s59, 0x20000000
  s_mov_b32 s60, 0x20000000
  s_waitcnt vmcnt(9)
  s_branch L_leaf_entry1
L_nonext_5344:
  s_xor_b32 s95, s95, 1024
  s_mov_b32 m0, s95
  v_xor_b32 v171, 1024, v171
  buffer_load_dword v4, s[4:7], s48 offen sc1 lds
  v_cvt_pk_bf16_f32 v76, v44, v45
  v_cvt_pk_bf16_f32 v77, v46, v47
  v_cvt_pk_bf16_f32 v78, v48, v49
  v_cvt_pk_bf16_f32 v79, v50, v51
  buffer_store_dwordx4 v[76:79], v8, s[4:7], s57 offen offset:0 sc1
  v_cvt_pk_bf16_f32 v80, v52, v53
  v_cvt_pk_bf16_f32 v81, v54, v55
  v_cvt_pk_bf16_f32 v82, v56, v57
  v_cvt_pk_bf16_f32 v83, v58, v59
  buffer_store_dwordx4 v[80:83], v8, s[4:7], s57 offen offset:256 sc1
  s_mov_b32 s47, s64
  s_cmp_eq_u32 s42, s80
  s_cbranch_scc1 L_leaf_fin0
  s_waitcnt vmcnt(2)
  s_barrier
  ds_read_b32 v5, v171
  s_waitcnt lgkmcnt(0)
  v_cmp_ge_i32 vcc, s46, v5
  s_cmp_eq_u32 s45, 0
  s_cselect_b32 s51, vcc_lo, vcc_hi
  s_cmp_lg_u32 s51, 0
  s_cbranch_scc1 L_leaf_drain0
  s_add_u32 m0, s50, 0
  s_add_u32 s51, s47, 0
  buffer_load_dwordx4 v1, s[4:7], s51 offen sc1 lds
  s_add_u32 m0, s50, 4096
  s_add_u32 s51, s47, 4096
  buffer_load_dwordx4 v1, s[4:7], s51 offen sc1 lds
  s_add_u32 m0, s50, 8192
  s_add_u32 s51, s47, 16384
  buffer_load_dwordx4 v1, s[4:7], s51 offen sc1 lds
  s_add_u32 m0, s50, 12288
  s_add_u32 s51, s47, 20480
  buffer_load_dwordx4 v1, s[4:7], s51 offen sc1 lds
  s_add_u32 m0, s50, 16384
  s_add_u32 s51, s47, 32768
  buffer_load_dwordx4 v1, s[4:7], s51 offen sc1 lds
  s_add_u32 m0, s50, 20480
  s_add_u32 s51, s47, 36864
  buffer_load_dwordx4 v1, s[4:7], s51 offen sc1 lds
  s_add_u32 m0, s50, 24576
  s_add_u32 s51, s47, 49152
  buffer_load_dwordx4 v1, s[4:7], s51 offen sc1 lds
  s_add_u32 m0, s50, 28672
  s_add_u32 s51, s47, 53248
  buffer_load_dwordx4 v1, s[4:7], s51 offen sc1 lds
  s_add_u32 m0, s50, 32768
  s_add_u32 s51, s47, 65536
  buffer_load_dwordx4 v1, s[4:7], s51 offen sc1 lds
  s_add_u32 m0, s50, 36864
  s_add_u32 s51, s47, 69632
  buffer_load_dwordx4 v1, s[4:7], s51 offen sc1 lds
  s_add_u32 m0, s50, 40960
  s_add_u32 s51, s47, 81920
  buffer_load_dwordx4 v1, s[4:7], s51 offen sc1 lds
  s_add_u32 m0, s50, 45056
  s_add_u32 s51, s47, 86016
  buffer_load_dwordx4 v1, s[4:7], s51 offen sc1 lds
  s_add_u32 m0, s50, 49152
  s_add_u32 s51, s47, 98304
  buffer_load_dwordx4 v1, s[4:7], s51 offen sc1 lds
  s_add_u32 m0, s50, 53248
  s_add_u32 s51, s47, 102400
  buffer_load_dwordx4 v1, s[4:7], s51 offen sc1 lds
  s_add_u32 m0, s50, 57344
  s_add_u32 s51, s47, 114688
  buffer_load_dwordx4 v1, s[4:7], s51 offen sc1 lds
  s_waitcnt vmcnt(15)
  s_barrier
  v_mov_b32 v7, s62
  buffer_store_dword v7, v0, s[4:7], s61 offen offset:0 sc1
  buffer_store_dword v7, v0, s[4:7], s61 offen offset:128
  s_mov_b32 s57, 0x20000000
  s_mov_b32 s58, 0x20000000
  s_mov_b32 s59, 0x20000000
  s_mov_b32 s60, 0x20000000
  s_mov_b32 s61, 0x20000000
  s_waitcnt vmcnt(9)
  s_branch L_leaf_entry1
L_leaf_drain0:
  s_waitcnt vmcnt(0)
  s_barrier
  v_mov_b32 v7, s62
  buffer_store_dword v7, v0, s[4:7], s61 offen offset:0 sc1
  buffer_store_dword v7, v0, s[4:7], s61 offen offset:128
  s_mov_b32 s57, 0x20000000
  s_mov_b32 s58, 0x20000000
  s_mov_b32 s59, 0x20000000
  s_mov_b32 s60, 0x20000000
  s_mov_b32 s61, 0x20000000
L_leaf_spin0:
  s_sleep 1
  s_xor_b32 s95, s95, 1024
  s_mov_b32 m0, s95
  v_xor_b32 v171, 1024, v171
  buffer_load_dword v4, s[4:7], s48 offen sc1 lds
  s_add_u32 s94, s94, 1
  s_cmp_lt_u32 s94, 100000
  s_cselect_b32 s52, s46, -2
  s_waitcnt vmcnt(0)
  s_barrier
  ds_read_b32 v5, v171
  s_waitcnt lgkmcnt(0)
  v_cmp_ge_i32 vcc, s52, v5
  s_cmp_eq_u32 s45, 0
  s_cselect_b32 s51, vcc_lo, vcc_hi
  s_cmp_lg_u32 s51, 0
  s_cbranch_scc1 L_leaf_spin0
  s_add_u32 m0, s50, 0
  s_add_u32 s51, s47, 0
  buffer_load_dwordx4 v1, s[4:7], s51 offen sc1 lds
  s_add_u32 m0, s50, 4096
  s_add_u32 s51, s47, 4096
  buffer_load_dwordx4 v1, s[4:7], s51 offen sc1 lds
  s_add_u32 m0, s50, 8192
  s_add_u32 s51, s47, 16384
  buffer_load_dwordx4 v1, s[4:7], s51 offen sc1 lds
  s_add_u32 m0, s50, 12288
  s_add_u32 s51, s47, 20480
  buffer_load_dwordx4 v1, s[4:7], s51 offen sc1 lds
  s_add_u32 m0, s50, 16384
  s_add_u32 s51, s47, 32768
  buffer_load_dwordx4 v1, s[4:7], s51 offen sc1 lds
  s_add_u32 m0, s50, 20480
  s_add_u32 s51, s47, 36864
  buffer_load_dwordx4 v1, s[4:7], s51 offen sc1 lds
  s_add_u32 m0, s50, 24576
  s_add_u32 s51, s47, 49152
  buffer_load_dwordx4 v1, s[4:7], s51 offen sc1 lds
  s_add_u32 m0, s50, 28672
  s_add_u32 s51, s47, 53248
  buffer_load_dwordx4 v1, s[4:7], s51 offen sc1 lds
  s_add_u32 m0, s50, 32768
  s_add_u32 s51, s47, 65536
  buffer_load_dwordx4 v1, s[4:7], s51 offen sc1 lds
  s_add_u32 m0, s50, 36864
  s_add_u32 s51, s47, 69632
  buffer_load_dwordx4 v1, s[4:7], s51 offen sc1 lds
  s_add_u32 m0, s50, 40960
  s_add_u32 s51, s47, 81920
  buffer_load_dwordx4 v1, s[4:7], s51 offen sc1 lds
  s_add_u32 m0, s50, 45056
  s_add_u32 s51, s47, 86016
  buffer_load_dwordx4 v1, s[4:7], s51 offen sc1 lds
  s_add_u32 m0, s50, 49152
  s_add_u32 s51, s47, 98304
  buffer_load_dwordx4 v1, s[4:7], s51 offen sc1 lds
  s_add_u32 m0, s50, 53248
  s_add_u32 s51, s47, 102400
  buffer_load_dwordx4 v1, s[4:7], s51 offen sc1 lds
  s_add_u32 m0, s50, 57344
  s_add_u32 s51, s47, 114688
  buffer_load_dwordx4 v1, s[4:7], s51 offen sc1 lds
  s_waitcnt vmcnt(7)
  s_branch L_leaf_entry1
L_leaf_fin0:
  s_waitcnt vmcnt(0)
  s_barrier
  v_mov_b32 v7, s62
  buffer_store_dword v7, v0, s[4:7], s61 offen offset:0 sc1
  buffer_store_dword v7, v0, s[4:7], s61 offen offset:128
  s_endpgm
L_leaf_entry1:
  s_barrier
  ds_read_b128 v[28:31], v2 offset:0
  ds_read_b128 v[32:35], v2 offset:256
  ds_read_b128 v[36:39], v2 offset:2048
  ds_read_b128 v[40:43], v2 offset:2304
  ds_read_b128 v[12:15], v2 offset:4096
  s_branch L_leaf_body1
L_leaf_slow1:
  v_mfma_f32_16x16x32_bf16 v[64:67], a[228:231], v[28:31], v[64:67]
  s_waitcnt lgkmcnt(0)
  v_mfma_f32_16x16x32_bf16 v[68:71], a[224:227], v[32:35], v[68:71]
  v_mfma_f32_16x16x32_bf16 v[72:75], a[228:231], v[32:35], v[72:75]
  v_mfma_f32_16x16x32_bf16 v[60:63], a[232:235], v[36:39], v[60:63]
  v_mfma_f32_16x16x32_bf16 v[64:67], a[236:239], v[36:39], v[64:67]
  v_mfma_f32_16x16x32_bf16 v[68:71], a[232:235], v[40:43], v[68:71]
  v_mfma_f32_16x16x32_bf16 v[72:75], a[236:239], v[40:43], v[72:75]
  s_mov_b32 s47, s64
  s_cmp_eq_u32 s42, s80
  s_cbranch_scc1 L_nonext_5345
  s_waitcnt vmcnt(0)
  s_barrier
  ds_read_b32 v5, v171
  s_waitcnt lgkmcnt(0)
  v_cmp_ge_i32 vcc, s46, v5
  s_cmp_eq_u32 s45, 0
  s_cselect_b32 s51, vcc_lo, vcc_hi
  s_cmp_lg_u32 s51, 0
  s_cbranch_scc1 L_nonext_5345
  s_add_u32 m0, s50, 0
  s_add_u32 s51, s47, 0
  buffer_load_dwordx4 v1, s[4:7], s51 offen sc1 lds
  s_add_u32 m0, s50, 4096
  s_add_u32 s51, s47, 4096
  buffer_load_dwordx4 v1, s[4:7], s51 offen sc1 lds
  s_add_u32 m0, s50, 8192
  s_add_u32 s51, s47, 16384
  buffer_load_dwordx4 v1, s[4:7], s51 offen sc1 lds
  s_add_u32 m0, s50, 12288
  s_add_u32 s51, s47, 20480
  buffer_load_dwordx4 v1, s[4:7], s51 offen sc1 lds
  s_add_u32 m0, s50, 16384
  s_add_u32 s51, s47, 32768
  buffer_load_dwordx4 v1, s[4:7], s51 offen sc1 lds
  s_add_u32 m0, s50, 20480
  s_add_u32 s51, s47, 36864
  buffer_load_dwordx4 v1, s[4:7], s51 offen sc1 lds
  s_add_u32 m0, s50, 24576
  s_add_u32 s51, s47, 49152
  buffer_load_dwordx4 v1, s[4:7], s51 offen sc1 lds
  s_add_u32 m0, s50, 28672
  s_add_u32 s51, s47, 53248
  buffer_load_dwordx4 v1, s[4:7], s51 offen sc1 lds
  s_add_u32 m0, s50, 32768
  s_add_u32 s51, s47, 65536
  buffer_load_dwordx4 v1, s[4:7], s51 offen sc1 lds
  s_add_u32 m0, s50, 36864
  s_add_u32 s51, s47, 69632
  buffer_load_dwordx4 v1, s[4:7], s51 offen sc1 lds
  s_add_u32 m0, s50, 40960
  s_add_u32 s51, s47, 81920
  buffer_load_dwordx4 v1, s[4:7], s51 offen sc1 lds
  s_add_u32 m0, s50, 45056
  s_add_u32 s51, s47, 86016
  buffer_load_dwordx4 v1, s[4:7], s51 offen sc1 lds
  s_add_u32 m0, s50, 49152
  s_add_u32 s51, s47, 98304
  buffer_load_dwordx4 v1, s[4:7], s51 offen sc1 lds
  s_add_u32 m0, s50, 53248
  s_add_u32 s51, s47, 102400
  buffer_load_dwordx4 v1, s[4:7], s51 offen sc1 lds
  s_add_u32 m0, s50, 57344
  s_add_u32 s51, s47, 114688
  buffer_load_dwordx4 v1, s[4:7], s51 offen sc1 lds
  v_cvt_pk_bf16_f32 v76, v60, v61
  v_cvt_pk_bf16_f32 v77, v62, v63
  v_cvt_pk_bf16_f32 v78, v64, v65
  v_cvt_pk_bf16_f32 v79, v66, v67
  buffer_store_dwordx4 v[76:79], v8, s[4:7], s57 offen offset:0 sc1
  v_cvt_pk_bf16_f32 v80, v68, v69
  v_cvt_pk_bf16_f32 v81, v70, v71
  v_cvt_pk_bf16_f32 v82, v72, v73
  v_cvt_pk_bf16_f32 v83, v74, v75
  buffer_store_dwordx4 v[80:83], v8, s[4:7], s57 offen offset:256 sc1
  s_mov_b32 s57, 0x20000000
  s_mov_b32 s58, 0x20000000
  s_mov_b32 s59, 0x20000000
  s_mov_b32 s60, 0x20000000
  s_waitcnt vmcnt(9)
  s_branch L_leaf_entry0
L_nonext_5345:
  s_xor_b32 s95, s95, 1024
  s_mov_b32 m0, s95
  v_xor_b32 v171, 1024, v171
  buffer_load_dword v4, s[4:7], s48 offen sc1 lds
  v_cvt_pk_bf16_f32 v76, v60, v61
  v_cvt_pk_bf16_f32 v77, v62, v63
  v_cvt_pk_bf16_f32 v78, v64, v65
  v_cvt_pk_bf16_f32 v79, v66, v67
  buffer_store_dwordx4 v[76:79], v8, s[4:7], s57 offen offset:0 sc1
  v_cvt_pk_bf16_f32 v80, v68, v69
  v_cvt_pk_bf16_f32 v81, v70, v71
  v_cvt_pk_bf16_f32 v82, v72, v73
  v_cvt_pk_bf16_f32 v83, v74, v75
  buffer_store_dwordx4 v[80:83], v8, s[4:7], s57 offen offset:256 sc1
  s_mov_b32 s47, s64
  s_cmp_eq_u32 s42, s80
  s_cbranch_scc1 L_leaf_fin1
  s_waitcnt vmcnt(2)
  s_barrier
  ds_read_b32 v5, v171
  s_waitcnt lgkmcnt(0)
  v_cmp_ge_i32 vcc, s46, v5
  s_cmp_eq_u32 s45, 0
  s_cselect_b32 s51, vcc_lo, vcc_hi
  s_cmp_lg_u32 s51, 0
  s_cbranch_scc1 L_leaf_drain1
  s_add_u32 m0, s50, 0
  s_add_u32 s51, s47, 0
  buffer_load_dwordx4 v1, s[4:7], s51 offen sc1 lds
  s_add_u32 m0, s50, 4096
  s_add_u32 s51, s47, 4096
  buffer_load_dwordx4 v1, s[4:7], s51 offen sc1 lds
  s_add_u32 m0, s50, 8192
  s_add_u32 s51, s47, 16384
  buffer_load_dwordx4 v1, s[4:7], s51 offen sc1 lds
  s_add_u32 m0, s50, 12288
  s_add_u32 s51, s47, 20480
  buffer_load_dwordx4 v1, s[4:7], s51 offen sc1 lds
  s_add_u32 m0, s50, 16384
  s_add_u32 s51, s47, 32768
  buffer_load_dwordx4 v1, s[4:7], s51 offen sc1 lds
  s_add_u32 m0, s50, 20480
  s_add_u32 s51, s47, 36864
  buffer_load_dwordx4 v1, s[4:7], s51 offen sc1 lds
  s_add_u32 m0, s50, 24576
  s_add_u32 s51, s47, 49152
  buffer_load_dwordx4 v1, s[4:7], s51 offen sc1 lds
  s_add_u32 m0, s50, 28672
  s_add_u32 s51, s47, 53248
  buffer_load_dwordx4 v1, s[4:7], s51 offen sc1 lds
  s_add_u32 m0, s50, 32768
  s_add_u32 s51, s47, 65536
  buffer_load_dwordx4 v1, s[4:7], s51 offen sc1 lds
  s_add_u32 m0, s50, 36864
  s_add_u32 s51, s47, 69632
  buffer_load_dwordx4 v1, s[4:7], s51 offen sc1 lds
  s_add_u32 m0, s50, 40960
  s_add_u32 s51, s47, 81920
  buffer_load_dwordx4 v1, s[4:7], s51 offen sc1 lds
  s_add_u32 m0, s50, 45056
  s_add_u32 s51, s47, 86016
  buffer_load_dwordx4 v1, s[4:7], s51 offen sc1 lds
  s_add_u32 m0, s50, 49152
  s_add_u32 s51, s47, 98304
  buffer_load_dwordx4 v1, s[4:7], s51 offen sc1 lds
  s_add_u32 m0, s50, 53248
  s_add_u32 s51, s47, 102400
  buffer_load_dwordx4 v1, s[4:7], s51 offen sc1 lds
  s_add_u32 m0, s50, 57344
  s_add_u32 s51, s47, 114688
  buffer_load_dwordx4 v1, s[4:7], s51 offen sc1 lds
  s_waitcnt vmcnt(15)
  s_barrier
  v_mov_b32 v7, s62
  buffer_store_dword v7, v0, s[4:7], s61 offen offset:0 sc1
  buffer_store_dword v7, v0, s[4:7], s61 offen offset:128
  s_mov_b32 s57, 0x20000000
  s_mov_b32 s58, 0x20000000
  s_mov_b32 s59, 0x20000000
  s_mov_b32 s60, 0x20000000
  s_mov_b32 s61, 0x20000000
  s_waitcnt vmcnt(9)
  s_branch L_leaf_entry0
L_leaf_drain1:
  s_waitcnt vmcnt(0)
  s_barrier
  v_mov_b32 v7, s62
  buffer_store_dword v7, v0, s[4:7], s61 offen offset:0 sc1
  buffer_store_dword v7, v0, s[4:7], s61 offen offset:128
  s_mov_b32 s57, 0x20000000
  s_mov_b32 s58, 0x20000000
  s_mov_b32 s59, 0x20000000
  s_mov_b32 s60, 0x20000000
  s_mov_b32 s61, 0x20000000
L_leaf_spin1:
  s_sleep 1
  s_xor_b32 s95, s95, 1024
  s_mov_b32 m0, s95
  v_xor_b32 v171, 1024, v171
  buffer_load_dword v4, s[4:7], s48 offen sc1 lds
  s_add_u32 s94, s94, 1
  s_cmp_lt_u32 s94, 100000
  s_cselect_b32 s52, s46, -2
  s_waitcnt vmcnt(0)
  s_barrier
  ds_read_b32 v5, v171
  s_waitcnt lgkmcnt(0)
  v_cmp_ge_i32 vcc, s52, v5
  s_cmp_eq_u32 s45, 0
  s_cselect_b32 s51, vcc_lo, vcc_hi
  s_cmp_lg_u32 s51, 0
  s_cbranch_scc1 L_leaf_spin1
  s_add_u32 m0, s50, 0
  s_add_u32 s51, s47, 0
  buffer_load_dwordx4 v1, s[4:7], s51 offen sc1 lds
  s_add_u32 m0, s50, 4096
  s_add_u32 s51, s47, 4096
  buffer_load_dwordx4 v1, s[4:7], s51 offen sc1 lds
  s_add_u32 m0, s50, 8192
  s_add_u32 s51, s47, 16384
  buffer_load_dwordx4 v1, s[4:7], s51 offen sc1 lds
  s_add_u32 m0, s50, 12288
  s_add_u32 s51, s47, 20480
  buffer_load_dwordx4 v1, s[4:7], s51 offen sc1 lds
  s_add_u32 m0, s50, 16384
  s_add_u32 s51, s47, 32768
  buffer_load_dwordx4 v1, s[4:7], s51 offen sc1 lds
  s_add_u32 m0, s50, 20480
  s_add_u32 s51, s47, 36864
  buffer_load_dwordx4 v1, s[4:7], s51 offen sc1 lds
  s_add_u32 m0, s50, 24576
  s_add_u32 s51, s47, 49152
  buffer_load_dwordx4 v1, s[4:7], s51 offen sc1 lds
  s_add_u32 m0, s50, 28672
  s_add_u32 s51, s47, 53248
  buffer_load_dwordx4 v1, s[4:7], s51 offen sc1 lds
  s_add_u32 m0, s50, 32768
  s_add_u32 s51, s47, 65536
  buffer_load_dwordx4 v1, s[4:7], s51 offen sc1 lds
  s_add_u32 m0, s50, 36864
  s_add_u32 s51, s47, 69632
  buffer_load_dwordx4 v1, s[4:7], s51 offen sc1 lds
  s_add_u32 m0, s50, 40960
  s_add_u32 s51, s47, 81920
  buffer_load_dwordx4 v1, s[4:7], s51 offen sc1 lds
  s_add_u32 m0, s50, 45056
  s_add_u32 s51, s47, 86016
  buffer_load_dwordx4 v1, s[4:7], s51 offen sc1 lds
  s_add_u32 m0, s50, 49152
  s_add_u32 s51, s47, 98304
  buffer_load_dwordx4 v1, s[4:7], s51 offen sc1 lds
  s_add_u32 m0, s50, 53248
  s_add_u32 s51, s47, 102400
  buffer_load_dwordx4 v1, s[4:7], s51 offen sc1 lds
  s_add_u32 m0, s50, 57344
  s_add_u32 s51, s47, 114688
  buffer_load_dwordx4 v1, s[4:7], s51 offen sc1 lds
  s_waitcnt vmcnt(7)
  s_branch L_leaf_entry0
L_leaf_fin1:
  s_waitcnt vmcnt(0)
  s_barrier
  v_mov_b32 v7, s62
  buffer_store_dword v7, v0, s[4:7], s61 offen offset:0 sc1
  buffer_store_dword v7, v0, s[4:7], s61 offen offset:128
  s_endpgm
L_role_bq:
  s_cmp_ge_u32 s101, 8
  s_cbranch_scc1 L_bq_np
  s_cmp_lg_u32 s12, 0
  s_cbranch_scc1 L_probe_345
  v_and_b32 v4, 7, v0
  v_lshlrev_b32 v4, 4, v4
  v_lshrrev_b32 v5, 3, v0
  v_lshl_add_u32 v8, v5, 12, v4
  s_lshl_b32 s42, s101, 8
  s_add_u32 s42, s42, 3014656
  s_add_u32 s43, s42, 0
  buffer_store_dwordx4 v[4:7], v8, s[4:7], s43 offen sc1
  s_mov_b64 exec, 1
  s_mov_b32 s43, -1
  s_mov_b32 s44, 0
  s_waitcnt vmcnt(0)
L_probe_344:
  s_xor_b32 s47, s44, s101
  s_bfe_u32 s45, s47, 0x20001
  s_lshl_b32 s46, s47, 12
  s_add_u32 s46, s46, s42
  s_memtime s[48:49]
  s_waitcnt lgkmcnt(0)
  buffer_load_dword v5, off, s[4:7], s46 sc1
  s_waitcnt vmcnt(0)
  s_memtime s[50:51]
  s_waitcnt lgkmcnt(0)
  s_sub_u32 s50, s50, s48
  s_lshl_b32 s50, s50, 2
  s_or_b32 s50, s50, s45
  s_min_u32 s43, s43, s50
  s_add_u32 s44, s44, 1
  s_cmp_lt_u32 s44, 8
  s_cbranch_scc1 L_probe_344
  s_getreg_b32 s44, hwreg(HW_REG_XCC_ID)
  s_bfe_u32 s45, s44, 0x10002
  s_and_b32 s44, s44, 1
  s_lshl_b32 s44, s44, 1
  s_xor_b32 s43, s43, s44
  s_xor_b32 s43, s43, s45
  s_xor_b32 s43, s43, -4
  v_mov_b32 v4, 12
  v_mov_b32 v5, s43
  global_atomic_umax v4, v5, s[38:39]
  s_mov_b64 exec, -1
L_probe_345:
  s_waitcnt vmcnt(0)
  s_barrier
  s_cmp_lg_u32 s12, 0
  s_cbranch_scc1 L_sig_346
  s_mov_b64 exec, 1
  v_mov_b32 v8, 8
  v_mov_b32 v9, 1
  global_atomic_add v8, v9, s[38:39]
  s_mov_b64 exec, -1
L_sig_346:
L_bq_np:
  s_cmp_lg_u32 s12, 0
  s_cbranch_scc1 L_hold_347
  v_mov_b32 v6, 8
L_rdy_349:
  global_load_dword v7, v6, s[38:39] sc1
  s_waitcnt vmcnt(0)
  v_readfirstlane_b32 s15, v7
  s_and_b32 s3, s15, 0xffff
  s_cmp_ge_u32 s3, 48
  s_cbranch_scc1 L_rdyd_350
  s_sleep 32
  s_add_u32 s14, s14, 1
  s_cmp_lt_u32 s14, 100000
  s_cbranch_scc1 L_rdy_349
L_rdyd_350:
L_hold_348:
  s_sleep 16
  buffer_load_dword v6, off, s[4:7], 0 offset:0 sc1
  s_add_u32 s14, s14, 1
  s_waitcnt vmcnt(0)
  v_readfirstlane_b32 s3, v6
  s_cmp_ge_u32 s14, 100000
  s_cbranch_scc1 L_hold_347
  s_cmp_lt_i32 s3, 10
  s_cbranch_scc1 L_hold_348
L_hold_347:
  s_barrier
  s_lshr_b32 s45, s101, 3
  s_and_b32 s66, s101, 7
  s_mul_i32 s70, s66, 160
  s_lshl_b32 s67, s66, 2
  s_add_u32 s67, s67, s12
  v_lshlrev_b32 v1, 4, v0
  v_and_b32 v6, 31, v0
  v_mul_u32_u24 v7, 26, v6
  v_lshrrev_b32 v7, 8, v7
  v_mul_u32_u24 v84, 1120, v7
  v_lshl_add_u32 v84, v6, 4, v84
  v_lshrrev_b32 v7, 5, v0
  v_mul_u32_u24 v7, 3840, v7
  v_add_u32 v84, v84, v7
  v_mov_b32 v7, 0x20000000
  v_cmp_gt_u32 vcc, 30, v6
  s_nop 1
  v_cndmask_b32 v84, v7, v84, vcc
  v_mov_b32 v6, 0x3020100
  v_mov_b32 v7, 0x17161514
  v_and_b32 v85, 16, v0
  v_cmp_eq_u32 vcc, 0, v85
  s_nop 1
  v_cndmask_b32 v6, v7, v6, vcc
  v_and_b32 v7, 3, v0
  v_lshlrev_b32 v7, 3, v7
  v_bfe_u32 v6, v6, v7, 8
  v_lshrrev_b32 v7, 5, v0
  v_mul_u32_u24 v7, 8, v7
  v_bfe_u32 v85, v0, 2, 2
  v_add_u32 v85, v85, v7
  v_mul_u32_u24 v85, 512, v85
  v_lshl_add_u32 v85, v6, 3, v85
  s_mul_i32 s51, s12, 40
  v_mov_b32 v6, s51
  v_add_u32 v85, v85, v6
  v_mov_b32 v6, 0x2b292a28
  v_mov_b32 v7, 0x3c182c04
  v_and_b32 v86, 16, v0
  v_cmp_eq_u32 vcc, 0, v86
  s_nop 1
  v_cndmask_b32 v6, v7, v6, vcc
  v_and_b32 v7, 3, v0
  v_lshlrev_b32 v7, 3, v7
  v_bfe_u32 v6, v6, v7, 8
  v_lshrrev_b32 v7, 5, v0
  v_mul_u32_u24 v7, 8, v7
  v_bfe_u32 v86, v0, 2, 2
  v_add_u32 v86, v86, v7
  v_mul_u32_u24 v86, 512, v86
  v_lshl_add_u32 v86, v6, 3, v86
  s_mul_i32 s51, s12, 40
  v_mov_b32 v6, s51
  v_and_b32 v7, 19, v0
  v_cmp_ne_u32 vcc, 19, v7
  s_nop 1
  v_cndmask_b32 v6, 0, v6, vcc
  v_add_u32 v86, v86, v6
  s_mov_b32 s8, s32
  s_mov_b32 s9, s33
  s_mov_b32 s10, 2457600
  s_mov_b32 s11, 0x20000
  s_mul_i32 s51, s12, 30720
  s_add_u32 s70, s70, s51
  s_mul_i32 s52, s12, 4096
  s_add_u32 m0, s52, 0
  s_add_u32 s51, s70, 0
  buffer_load_dwordx4 v84, s[8:11], s51 offen  lds
  s_add_u32 m0, s52, 1024
  s_add_u32 s51, s70, 7680
  buffer_load_dwordx4 v84, s[8:11], s51 offen  lds
  s_add_u32 m0, s52, 2048
  s_add_u32 s51, s70, 15360
  buffer_load_dwordx4 v84, s[8:11], s51 offen  lds
  s_add_u32 m0, s52, 3072
  s_add_u32 s51, s70, 23040
  buffer_load_dwordx4 v84, s[8:11], s51 offen  lds
  s_add_u32 m0, s52, 16384
  s_add_u32 s51, s70, 122880
  buffer_load_dwordx4 v84, s[8:11], s51 offen  lds
  s_add_u32 m0, s52, 17408
  s_add_u32 s51, s70, 130560
  buffer_load_dwordx4 v84, s[8:11], s51 offen  lds
  s_add_u32 m0, s52, 18432
  s_add_u32 s51, s70, 138240
  buffer_load_dwordx4 v84, s[8:11], s51 offen  lds
  s_add_u32 m0, s52, 19456
  s_add_u32 s51, s70, 145920
  buffer_load_dwordx4 v84, s[8:11], s51 offen  lds
  s_add_u32 m0, s52, 32768
  s_add_u32 s51, s70, 245760
  buffer_load_dwordx4 v84, s[8:11], s51 offen  lds
  s_add_u32 m0, s52, 33792
  s_add_u32 s51, s70, 253440
  buffer_load_dwordx4 v84, s[8:11], s51 offen  lds
  s_add_u32 m0, s52, 34816
  s_add_u32 s51, s70, 261120
  buffer_load_dwordx4 v84, s[8:11], s51 offen  lds
  s_add_u32 m0, s52, 35840
  s_add_u32 s51, s70, 268800
  buffer_load_dwordx4 v84, s[8:11], s51 offen  lds
  s_add_u32 m0, s52, 49152
  s_add_u32 s51, s70, 368640
  buffer_load_dwordx4 v84, s[8:11], s51 offen  lds
  s_add_u32 m0, s52, 50176
  s_add_u32 s51, s70, 376320
  buffer_load_dwordx4 v84, s[8:11], s51 offen  lds
  s_add_u32 m0, s52, 51200
  s_add_u32 s51, s70, 384000
  buffer_load_dwordx4 v84, s[8:11], s51 offen  lds
  s_add_u32 m0, s52, 52224
  s_add_u32 s51, s70, 391680
  buffer_load_dwordx4 v84, s[8:11], s51 offen  lds
  s_add_u32 m0, s52, 65536
  s_add_u32 s51, s70, 491520
  buffer_load_dwordx4 v84, s[8:11], s51 offen  lds
  s_add_u32 m0, s52, 66560
  s_add_u32 s51, s70, 499200
  buffer_load_dwordx4 v84, s[8:11], s51 offen  lds
  s_add_u32 m0, s52, 67584
  s_add_u32 s51, s70, 506880
  buffer_load_dwordx4 v84, s[8:11], s51 offen  lds
  s_add_u32 m0, s52, 68608
  s_add_u32 s51, s70, 514560
  buffer_load_dwordx4 v84, s[8:11], s51 offen  lds
  s_add_u32 m0, s52, 81920
  s_add_u32 s51, s70, 614400
  buffer_load_dwordx4 v84, s[8:11], s51 offen  lds
  s_add_u32 m0, s52, 82944
  s_add_u32 s51, s70, 622080
  buffer_load_dwordx4 v84, s[8:11], s51 offen  lds
  s_add_u32 m0, s52, 83968
  s_add_u32 s51, s70, 629760
  buffer_load_dwordx4 v84, s[8:11], s51 offen  lds
  s_add_u32 m0, s52, 84992
  s_add_u32 s51, s70, 637440
  buffer_load_dwordx4 v84, s[8:11], s51 offen  lds
  s_add_u32 m0, s52, 98304
  s_add_u32 s51, s70, 737280
  buffer_load_dwordx4 v84, s[8:11], s51 offen  lds
  s_add_u32 m0, s52, 99328
  s_add_u32 s51, s70, 744960
  buffer_load_dwordx4 v84, s[8:11], s51 offen  lds
  s_add_u32 m0, s52, 100352
  s_add_u32 s51, s70, 752640
  buffer_load_dwordx4 v84, s[8:11], s51 offen  lds
  s_add_u32 m0, s52, 101376
  s_add_u32 s51, s70, 760320
  buffer_load_dwordx4 v84, s[8:11], s51 offen  lds
  s_add_u32 m0, s52, 114688
  s_add_u32 s51, s70, 860160
  buffer_load_dwordx4 v84, s[8:11], s51 offen  lds
  s_add_u32 m0, s52, 115712
  s_add_u32 s51, s70, 867840
  buffer_load_dwordx4 v84, s[8:11], s51 offen  lds
  s_add_u32 m0, s52, 116736
  s_add_u32 s51, s70, 875520
  buffer_load_dwordx4 v84, s[8:11], s51 offen  lds
  s_add_u32 m0, s52, 117760
  s_add_u32 s51, s70, 883200
  buffer_load_dwordx4 v84, s[8:11], s51 offen  lds
  s_waitcnt vmcnt(28) lgkmcnt(0)
  s_barrier
  s_add_u32 m0, s52, 131072
  s_add_u32 s51, s70, 983040
  buffer_load_dwordx4 v84, s[8:11], s51 offen  lds
  s_add_u32 m0, s52, 132096
  s_add_u32 s51, s70, 990720
  buffer_load_dwordx4 v84, s[8:11], s51 offen  lds
  s_add_u32 m0, s52, 133120
  s_add_u32 s51, s70, 998400
  buffer_load_dwordx4 v84, s[8:11], s51 offen  lds
  s_add_u32 m0, s52, 134144
  s_add_u32 s51, s70, 1006080
  buffer_load_dwordx4 v84, s[8:11], s51 offen  lds
  v_add_u32 v87, 0, v85
  ds_read_b64_tr_b16 a[0:1], v87 offset:0
  ds_read_b64_tr_b16 a[2:3], v87 offset:2048
  ds_read_b64_tr_b16 a[8:9], v87 offset:8192
  ds_read_b64_tr_b16 a[10:11], v87 offset:10240
  v_add_u32 v88, 0, v86
  ds_read_b64_tr_b16 a[4:5], v88 offset:0
  ds_read_b64_tr_b16 a[6:7], v88 offset:2048
  ds_read_b64_tr_b16 a[12:13], v88 offset:8192
  ds_read_b64_tr_b16 a[14:15], v88 offset:10240
  s_waitcnt vmcnt(28) lgkmcnt(0)
  s_barrier
  s_add_u32 m0, s52, 0
  s_add_u32 s51, s70, 1105920
  buffer_load_dwordx4 v84, s[8:11], s51 offen  lds
  s_add_u32 m0, s52, 1024
  s_add_u32 s51, s70, 1113600
  buffer_load_dwordx4 v84, s[8:11], s51 offen  lds
  s_add_u32 m0, s52, 2048
  s_add_u32 s51, s70, 1121280
  buffer_load_dwordx4 v84, s[8:11], s51 offen  lds
  s_add_u32 m0, s52, 3072
  s_add_u32 s51, s70, 1128960
  buffer_load_dwordx4 v84, s[8:11], s51 offen  lds
  v_add_u32 v87, 16384, v85
  ds_read_b64_tr_b16 a[16:17], v87 offset:0
  ds_read_b64_tr_b16 a[18:19], v87 offset:2048
  ds_read_b64_tr_b16 a[24:25], v87 offset:8192
  ds_read_b64_tr_b16 a[26:27], v87 offset:10240
  v_add_u32 v88, 16384, v86
  ds_read_b64_tr_b16 a[20:21], v88 offset:0
  ds_read_b64_tr_b16 a[22:23], v88 offset:2048
  ds_read_b64_tr_b16 a[28:29], v88 offset:8192
  ds_read_b64_tr_b16 a[30:31], v88 offset:10240
  s_waitcnt vmcnt(28) lgkmcnt(0)
  s_barrier
  s_add_u32 m0, s52, 16384
  s_add_u32 s51, s70, 1228800
  buffer_load_dwordx4 v84, s[8:11], s51 offen  lds
  s_add_u32 m0, s52, 17408
  s_add_u32 s51, s70, 1236480
  buffer_load_dwordx4 v84, s[8:11], s51 offen  lds
  s_add_u32 m0, s52, 18432
  s_add_u32 s51, s70, 1244160
  buffer_load_dwordx4 v84, s[8:11], s51 offen  lds
  s_add_u32 m0, s52, 19456
  s_add_u32 s51, s70, 1251840
  buffer_load_dwordx4 v84, s[8:11], s51 offen  lds
  v_add_u32 v87, 32768, v85
  ds_read_b64_tr_b16 a[32:33], v87 offset:0
  ds_read_b64_tr_b16 a[34:35], v87 offset:2048
  ds_read_b64_tr_b16 a[40:41], v87 offset:8192
  ds_read_b64_tr_b16 a[42:43], v87 offset:10240
  v_add_u32 v88, 32768, v86
  ds_read_b64_tr_b16 a[36:37], v88 offset:0
  ds_read_b64_tr_b16 a[38:39], v88 offset:2048
  ds_read_b64_tr_b16 a[44:45], v88 offset:8192
  ds_read_b64_tr_b16 a[46:47], v88 offset:10240
  s_waitcnt vmcnt(28) lgkmcnt(0)
  s_barrier
  s_add_u32 m0, s52, 32768
  s_add_u32 s51, s70, 1351680
  buffer_load_dwordx4 v84, s[8:11], s51 offen  lds
  s_add_u32 m0, s52, 33792
  s_add_u32 s51, s70, 1359360
  buffer_load_dwordx4 v84, s[8:11], s51 offen  lds
  s_add_u32 m0, s52, 34816
  s_add_u32 s51, s70, 1367040
  buffer_load_dwordx4 v84, s[8:11], s51 offen  lds
  s_add_u32 m0, s52, 35840
  s_add_u32 s51, s70, 1374720
  buffer_load_dwordx4 v84, s[8:11], s51 offen  lds
  v_add_u32 v87, 49152, v85
  ds_read_b64_tr_b16 a[48:49], v87 offset:0
  ds_read_b64_tr_b16 a[50:51], v87 offset:2048
  ds_read_b64_tr_b16 a[56:57], v87 offset:8192
  ds_read_b64_tr_b16 a[58:59], v87 offset:10240
  v_add_u32 v88, 49152, v86
  ds_read_b64_tr_b16 a[52:53], v88 offset:0
  ds_read_b64_tr_b16 a[54:55], v88 offset:2048
  ds_read_b64_tr_b16 a[60:61], v88 offset:8192
  ds_read_b64_tr_b16 a[62:63], v88 offset:10240
  s_waitcnt vmcnt(28) lgkmcnt(0)
  s_barrier
  s_add_u32 m0, s52, 49152
  s_add_u32 s51, s70, 1474560
  buffer_load_dwordx4 v84, s[8:11], s51 offen  lds
  s_add_u32 m0, s52, 50176
  s_add_u32 s51, s70, 1482240
  buffer_load_dwordx4 v84, s[8:11], s51 offen  lds
  s_add_u32 m0, s52, 51200
  s_add_u32 s51, s70, 1489920
  buffer_load_dwordx4 v84, s[8:11], s51 offen  lds
  s_add_u32 m0, s52, 52224
  s_add_u32 s51, s70, 1497600
  buffer_load_dwordx4 v84, s[8:11], s51 offen  lds
  v_add_u32 v87, 65536, v85
  ds_read_b64_tr_b16 a[64:65], v87 offset:0
  ds_read_b64_tr_b16 a[66:67], v87 offset:2048
  ds_read_b64_tr_b16 a[72:73], v87 offset:8192
  ds_read_b64_tr_b16 a[74:75], v87 offset:10240
  v_add_u32 v88, 65536, v86
  ds_read_b64_tr_b16 a[68:69], v88 offset:0
  ds_read_b64_tr_b16 a[70:71], v88 offset:2048
  ds_read_b64_tr_b16 a[76:77], v88 offset:8192
  ds_read_b64_tr_b16 a[78:79], v88 offset:10240
  s_waitcnt vmcnt(28) lgkmcnt(0)
  s_barrier
  s_add_u32 m0, s52, 65536
  s_add_u32 s51, s70, 1597440
  buffer_load_dwordx4 v84, s[8:11], s51 offen  lds
  s_add_u32 m0, s52, 66560
  s_add_u32 s51, s70, 1605120
  buffer_load_dwordx4 v84, s[8:11], s51 offen  lds
  s_add_u32 m0, s52, 67584
  s_add_u32 s51, s70, 1612800
  buffer_load_dwordx4 v84, s[8:11], s51 offen  lds
  s_add_u32 m0, s52, 68608
  s_add_u32 s51, s70, 1620480
  buffer_load_dwordx4 v84, s[8:11], s51 offen  lds
  v_add_u32 v87, 81920, v85
  ds_read_b64_tr_b16 a[80:81], v87 offset:0
  ds_read_b64_tr_b16 a[82:83], v87 offset:2048
  ds_read_b64_tr_b16 a[88:89], v87 offset:8192
  ds_read_b64_tr_b16 a[90:91], v87 offset:10240
  v_add_u32 v88, 81920, v86
  ds_read_b64_tr_b16 a[84:85], v88 offset:0
  ds_read_b64_tr_b16 a[86:87], v88 offset:2048
  ds_read_b64_tr_b16 a[92:93], v88 offset:8192
  ds_read_b64_tr_b16 a[94:95], v88 offset:10240
  s_waitcnt vmcnt(28) lgkmcnt(0)
  s_barrier
  s_add_u32 m0, s52, 81920
  s_add_u32 s51, s70, 1720320
  buffer_load_dwordx4 v84, s[8:11], s51 offen  lds
  s_add_u32 m0, s52, 82944
  s_add_u32 s51, s70, 1728000
  buffer_load_dwordx4 v84, s[8:11], s51 offen  lds
  s_add_u32 m0, s52, 83968
  s_add_u32 s51, s70, 1735680
  buffer_load_dwordx4 v84, s[8:11], s51 offen  lds
  s_add_u32 m0, s52, 84992
  s_add_u32 s51, s70, 1743360
  buffer_load_dwordx4 v84, s[8:11], s51 offen  lds
  v_add_u32 v87, 98304, v85
  ds_read_b64_tr_b16 a[96:97], v87 offset:0
  ds_read_b64_tr_b16 a[98:99], v87 offset:2048
  ds_read_b64_tr_b16 a[104:105], v87 offset:8192
  ds_read_b64_tr_b16 a[106:107], v87 offset:10240
  v_add_u32 v88, 98304, v86
  ds_read_b64_tr_b16 a[100:101], v88 offset:0
  ds_read_b64_tr_b16 a[102:103], v88 offset:2048
  ds_read_b64_tr_b16 a[108:109], v88 offset:8192
  ds_read_b64_tr_b16 a[110:111], v88 offset:10240
  s_waitcnt vmcnt(28) lgkmcnt(0)
  s_barrier
  s_add_u32 m0, s52, 98304
  s_add_u32 s51, s70, 1843200
  buffer_load_dwordx4 v84, s[8:11], s51 offen  lds
  s_add_u32 m0, s52, 99328
  s_add_u32 s51, s70, 1850880
  buffer_load_dwordx4 v84, s[8:11], s51 offen  lds
  s_add_u32 m0, s52, 100352
  s_add_u32 s51, s70, 1858560
  buffer_load_dwordx4 v84, s[8:11], s51 offen  lds
  s_add_u32 m0, s52, 101376
  s_add_u32 s51, s70, 1866240
  buffer_load_dwordx4 v84, s[8:11], s51 offen  lds
  v_add_u32 v87, 114688, v85
  ds_read_b64_tr_b16 a[112:113], v87 offset:0
  ds_read_b64_tr_b16 a[114:115], v87 offset:2048
  ds_read_b64_tr_b16 a[120:121], v87 offset:8192
  ds_read_b64_tr_b16 a[122:123], v87 offset:10240
  v_add_u32 v88, 114688, v86
  ds_read_b64_tr_b16 a[116:117], v88 offset:0
  ds_read_b64_tr_b16 a[118:119], v88 offset:2048
  ds_read_b64_tr_b16 a[124:125], v88 offset:8192
  ds_read_b64_tr_b16 a[126:127], v88 offset:10240
  s_waitcnt vmcnt(28) lgkmcnt(0)
  s_barrier
  s_add_u32 m0, s52, 114688
  s_add_u32 s51, s70, 1966080
  buffer_load_dwordx4 v84, s[8:11], s51 offen  lds
  s_add_u32 m0, s52, 115712
  s_add_u32 s51, s70, 1973760
  buffer_load_dwordx4 v84, s[8:11], s51 offen  lds
  s_add_u32 m0, s52, 116736
  s_add_u32 s51, s70, 1981440
  buffer_load_dwordx4 v84, s[8:11], s51 offen  lds
  s_add_u32 m0, s52, 117760
  s_add_u32 s51, s70, 1989120
  buffer_load_dwordx4 v84, s[8:11], s51 offen  lds
  v_add_u32 v87, 131072, v85
  ds_read_b64_tr_b16 a[128:129], v87 offset:0
  ds_read_b64_tr_b16 a[130:131], v87 offset:2048
  ds_read_b64_tr_b16 a[136:137], v87 offset:8192
  ds_read_b64_tr_b16 a[138:139], v87 offset:10240
  v_add_u32 v88, 131072, v86
  ds_read_b64_tr_b16 a[132:133], v88 offset:0
  ds_read_b64_tr_b16 a[134:135], v88 offset:2048
  ds_read_b64_tr_b16 a[140:141], v88 offset:8192
  ds_read_b64_tr_b16 a[142:143], v88 offset:10240
  s_waitcnt vmcnt(28) lgkmcnt(0)
  s_barrier
  s_add_u32 m0, s52, 131072
  s_add_u32 s51, s70, 2088960
  buffer_load_dwordx4 v84, s[8:11], s51 offen  lds
  s_add_u32 m0, s52, 132096
  s_add_u32 s51, s70, 2096640
  buffer_load_dwordx4 v84, s[8:11], s51 offen  lds
  s_add_u32 m0, s52, 133120
  s_add_u32 s51, s70, 2104320
  buffer_load_dwordx4 v84, s[8:11], s51 offen  lds
  s_add_u32 m0, s52, 134144
  s_add_u32 s51, s70, 2112000
  buffer_load_dwordx4 v84, s[8:11], s51 offen  lds
  v_add_u32 v87, 0, v85
  ds_read_b64_tr_b16 a[144:145], v87 offset:0
  ds_read_b64_tr_b16 a[146:147], v87 offset:2048
  ds_read_b64_tr_b16 a[152:153], v87 offset:8192
  ds_read_b64_tr_b16 a[154:155], v87 offset:10240
  v_add_u32 v88, 0, v86
  ds_read_b64_tr_b16 a[148:149], v88 offset:0
  ds_read_b64_tr_b16 a[150:151], v88 offset:2048
  ds_read_b64_tr_b16 a[156:157], v88 offset:8192
  ds_read_b64_tr_b16 a[158:159], v88 offset:10240
  s_waitcnt vmcnt(28) lgkmcnt(0)
  s_barrier
  s_add_u32 m0, s52, 0
  s_add_u32 s51, s70, 2211840
  buffer_load_dwordx4 v84, s[8:11], s51 offen  lds
  s_add_u32 m0, s52, 1024
  s_add_u32 s51, s70, 2219520
  buffer_load_dwordx4 v84, s[8:11], s51 offen  lds
  s_add_u32 m0, s52, 2048
  s_add_u32 s51, s70, 2227200
  buffer_load_dwordx4 v84, s[8:11], s51 offen  lds
  s_add_u32 m0, s52, 3072
  s_add_u32 s51, s70, 2234880
  buffer_load_dwordx4 v84, s[8:11], s51 offen  lds
  v_add_u32 v87, 16384, v85
  ds_read_b64_tr_b16 a[160:161], v87 offset:0
  ds_read_b64_tr_b16 a[162:163], v87 offset:2048
  ds_read_b64_tr_b16 a[168:169], v87 offset:8192
  ds_read_b64_tr_b16 a[170:171], v87 offset:10240
  v_add_u32 v88, 16384, v86
  ds_read_b64_tr_b16 a[164:165], v88 offset:0
  ds_read_b64_tr_b16 a[166:167], v88 offset:2048
  ds_read_b64_tr_b16 a[172:173], v88 offset:8192
  ds_read_b64_tr_b16 a[174:175], v88 offset:10240
  s_waitcnt vmcnt(28) lgkmcnt(0)
  s_barrier
  s_add_u32 m0, s52, 16384
  s_add_u32 s51, s70, 2334720
  buffer_load_dwordx4 v84, s[8:11], s51 offen  lds
  s_add_u32 m0, s52, 17408
  s_add_u32 s51, s70, 2342400
  buffer_load_dwordx4 v84, s[8:11], s51 offen  lds
  s_add_u32 m0, s52, 18432
  s_add_u32 s51, s70, 2350080
  buffer_load_dwordx4 v84, s[8:11], s51 offen  lds
  s_add_u32 m0, s52, 19456
  s_add_u32 s51, s70, 2357760
  buffer_load_dwordx4 v84, s[8:11], s51 offen  lds
  v_add_u32 v87, 32768, v85
  ds_read_b64_tr_b16 a[176:177], v87 offset:0
  ds_read_b64_tr_b16 a[178:179], v87 offset:2048
  ds_read_b64_tr_b16 a[184:185], v87 offset:8192
  ds_read_b64_tr_b16 a[186:187], v87 offset:10240
  v_add_u32 v88, 32768, v86
  ds_read_b64_tr_b16 a[180:181], v88 offset:0
  ds_read_b64_tr_b16 a[182:183], v88 offset:2048
  ds_read_b64_tr_b16 a[188:189], v88 offset:8192
  ds_read_b64_tr_b16 a[190:191], v88 offset:10240
  s_waitcnt vmcnt(28) lgkmcnt(0)
  s_barrier
  v_add_u32 v87, 49152, v85
  ds_read_b64_tr_b16 a[192:193], v87 offset:0
  ds_read_b64_tr_b16 a[194:195], v87 offset:2048
  ds_read_b64_tr_b16 a[200:201], v87 offset:8192
  ds_read_b64_tr_b16 a[202:203], v87 offset:10240
  v_add_u32 v88, 49152, v86
  ds_read_b64_tr_b16 a[196:197], v88 offset:0
  ds_read_b64_tr_b16 a[198:199], v88 offset:2048
  ds_read_b64_tr_b16 a[204:205], v88 offset:8192
  ds_read_b64_tr_b16 a[206:207], v88 offset:10240
  s_waitcnt vmcnt(24) lgkmcnt(0)
  s_barrier
  v_add_u32 v87, 65536, v85
  ds_read_b64_tr_b16 a[208:209], v87 offset:0
  ds_read_b64_tr_b16 a[210:211], v87 offset:2048
  ds_read_b64_tr_b16 a[216:217], v87 offset:8192
  ds_read_b64_tr_b16 a[218:219], v87 offset:10240
  v_add_u32 v88, 65536, v86
  ds_read_b64_tr_b16 a[212:213], v88 offset:0
  ds_read_b64_tr_b16 a[214:215], v88 offset:2048
  ds_read_b64_tr_b16 a[220:221], v88 offset:8192
  ds_read_b64_tr_b16 a[222:223], v88 offset:10240
  s_waitcnt vmcnt(20) lgkmcnt(0)
  s_barrier
  v_add_u32 v87, 81920, v85
  ds_read_b64_tr_b16 a[224:225], v87 offset:0
  ds_read_b64_tr_b16 a[226:227], v87 offset:2048
  ds_read_b64_tr_b16 a[232:233], v87 offset:8192
  ds_read_b64_tr_b16 a[234:235], v87 offset:10240
  v_add_u32 v88, 81920, v86
  ds_read_b64_tr_b16 a[228:229], v88 offset:0
  ds_read_b64_tr_b16 a[230:231], v88 offset:2048
  ds_read_b64_tr_b16 a[236:237], v88 offset:8192
  ds_read_b64_tr_b16 a[238:239], v88 offset:10240
  s_waitcnt vmcnt(16) lgkmcnt(0)
  s_barrier
  v_add_u32 v87, 98304, v85
  ds_read_b64_tr_b16 a[240:241], v87 offset:0
  ds_read_b64_tr_b16 a[242:243], v87 offset:2048
  ds_read_b64_tr_b16 a[248:249], v87 offset:8192
  ds_read_b64_tr_b16 a[250:251], v87 offset:10240
  v_add_u32 v88, 98304, v86
  ds_read_b64_tr_b16 a[244:245], v88 offset:0
  ds_read_b64_tr_b16 a[246:247], v88 offset:2048
  ds_read_b64_tr_b16 a[252:253], v88 offset:8192
  ds_read_b64_tr_b16 a[254:255], v88 offset:10240
  s_waitcnt vmcnt(12) lgkmcnt(0)
  s_barrier
  v_add_u32 v87, 114688, v85
  ds_read_b64_tr_b16 v[192:193], v87 offset:0
  ds_read_b64_tr_b16 v[194:195], v87 offset:2048
  ds_read_b64_tr_b16 v[200:201], v87 offset:8192
  ds_read_b64_tr_b16 v[202:203], v87 offset:10240
  v_add_u32 v88, 114688, v86
  ds_read_b64_tr_b16 v[196:197], v88 offset:0
  ds_read_b64_tr_b16 v[198:199], v88 offset:2048
  ds_read_b64_tr_b16 v[204:205], v88 offset:8192
  ds_read_b64_tr_b16 v[206:207], v88 offset:10240
  s_waitcnt vmcnt(8) lgkmcnt(0)
  s_barrier
  s_lshr_b32 s3, s13, 5
  s_mul_i32 s3, s3, 65
  s_and_b32 s3, s3, 0xc4
  v_mov_b32 v5, s3
  v_writelane_b32 v5, 8, 0
  v_writelane_b32 v5, 12, 2
  global_load_dword v5, v5, s[38:39] sc1
  v_add_u32 v87, 131072, v85
  ds_read_b64_tr_b16 v[208:209], v87 offset:0
  ds_read_b64_tr_b16 v[210:211], v87 offset:2048
  ds_read_b64_tr_b16 v[216:217], v87 offset:8192
  ds_read_b64_tr_b16 v[218:219], v87 offset:10240
  v_add_u32 v88, 131072, v86
  ds_read_b64_tr_b16 v[212:213], v88 offset:0
  ds_read_b64_tr_b16 v[214:215], v88 offset:2048
  ds_read_b64_tr_b16 v[220:221], v88 offset:8192
  ds_read_b64_tr_b16 v[222:223], v88 offset:10240
  s_waitcnt vmcnt(4) lgkmcnt(0)
  s_barrier
  v_add_u32 v87, 0, v85
  ds_read_b64_tr_b16 v[224:225], v87 offset:0
  ds_read_b64_tr_b16 v[226:227], v87 offset:2048
  ds_read_b64_tr_b16 v[232:233], v87 offset:8192
  ds_read_b64_tr_b16 v[234:235], v87 offset:10240
  v_add_u32 v88, 0, v86
  ds_read_b64_tr_b16 v[228:229], v88 offset:0
  ds_read_b64_tr_b16 v[230:231], v88 offset:2048
  ds_read_b64_tr_b16 v[236:237], v88 offset:8192
  ds_read_b64_tr_b16 v[238:239], v88 offset:10240
  s_waitcnt vmcnt(0) lgkmcnt(0)
  s_barrier
  v_add_u32 v87, 16384, v85
  ds_read_b64_tr_b16 v[240:241], v87 offset:0
  ds_read_b64_tr_b16 v[242:243], v87 offset:2048
  ds_read_b64_tr_b16 v[248:249], v87 offset:8192
  ds_read_b64_tr_b16 v[250:251], v87 offset:10240
  v_add_u32 v88, 16384, v86
  ds_read_b64_tr_b16 v[244:245], v88 offset:0
  ds_read_b64_tr_b16 v[246:247], v88 offset:2048
  ds_read_b64_tr_b16 v[252:253], v88 offset:8192
  ds_read_b64_tr_b16 v[254:255], v88 offset:10240
  s_waitcnt lgkmcnt(0)
  v_readlane_b32 s92, v5, 0
  v_readlane_b32 s93, v5, 1
  v_readlane_b32 s2, v5, 2
  s_waitcnt lgkmcnt(0)
  s_barrier
  v_lshlrev_b32 v10, 3, v0
  v_mov_b32 v2, v1
  v_add_u32 v3, 0x10000, v1
  v_and_b32 v4, 31, v0
  v_min_u32 v4, 4, v4
  v_lshlrev_b32 v4, 8, v4
  v_mov_b32 v12, 0x3f803f80
  v_mov_b32 v13, 0x3f803f80
  v_mov_b32 v14, 0x3f803f80
  v_mov_b32 v15, 0x3f803f80
  s_nop 1
  v_mfma_f32_32x32x16_bf16 v[132:147], a[0:3], v[12:15], 0
  v_mfma_f32_32x32x16_bf16 v[148:163], a[4:7], v[12:15], 0
  v_mfma_f32_32x32x16_bf16 v[132:147], a[8:11], v[12:15], v[132:147]
  v_mfma_f32_32x32x16_bf16 v[148:163], a[12:15], v[12:15], v[148:163]
  v_mfma_f32_32x32x16_bf16 v[132:147], a[16:19], v[12:15], v[132:147]
  v_mfma_f32_32x32x16_bf16 v[148:163], a[20:23], v[12:15], v[148:163]
  v_mfma_f32_32x32x16_bf16 v[132:147], a[24:27], v[12:15], v[132:147]
  v_mfma_f32_32x32x16_bf16 v[148:163], a[28:31], v[12:15], v[148:163]
  v_mfma_f32_32x32x16_bf16 v[132:147], a[32:35], v[12:15], v[132:147]
  v_mfma_f32_32x32x16_bf16 v[148:163], a[36:39], v[12:15], v[148:163]
  v_mfma_f32_32x32x16_bf16 v[132:147], a[40:43], v[12:15], v[132:147]
  v_mfma_f32_32x32x16_bf16 v[148:163], a[44:47], v[12:15], v[148:163]
  v_mfma_f32_32x32x16_bf16 v[132:147], a[48:51], v[12:15], v[132:147]
  v_mfma_f32_32x32x16_bf16 v[148:163], a[52:55], v[12:15], v[148:163]
  v_mfma_f32_32x32x16_bf16 v[132:147], a[56:59], v[12:15], v[132:147]
  v_mfma_f32_32x32x16_bf16 v[148:163], a[60:63], v[12:15], v[148:163]
  v_mfma_f32_32x32x16_bf16 v[132:147], a[64:67], v[12:15], v[132:147]
  v_mfma_f32_32x32x16_bf16 v[148:163], a[68:71], v[12:15], v[148:163]
  v_mfma_f32_32x32x16_bf16 v[132:147], a[72:75], v[12:15], v[132:147]
  v_mfma_f32_32x32x16_bf16 v[148:163], a[76:79], v[12:15], v[148:163]
  v_mfma_f32_32x32x16_bf16 v[132:147], a[80:83], v[12:15], v[132:147]
  v_mfma_f32_32x32x16_bf16 v[148:163], a[84:87], v[12:15], v[148:163]
  v_mfma_f32_32x32x16_bf16 v[132:147], a[88:91], v[12:15], v[132:147]
  v_mfma_f32_32x32x16_bf16 v[148:163], a[92:95], v[12:15], v[148:163]
  v_mfma_f32_32x32x16_bf16 v[132:147], a[96:99], v[12:15], v[132:147]
  v_mfma_f32_32x32x16_bf16 v[148:163], a[100:103], v[12:15], v[148:163]
  v_mfma_f32_32x32x16_bf16 v[132:147], a[104:107], v[12:15], v[132:147]
  v_mfma_f32_32x32x16_bf16 v[148:163], a[108:111], v[12:15], v[148:163]
  v_mfma_f32_32x32x16_bf16 v[132:147], a[112:115], v[12:15], v[132:147]
  v_mfma_f32_32x32x16_bf16 v[148:163], a[116:119], v[12:15], v[148:163]
  v_mfma_f32_32x32x16_bf16 v[132:147], a[120:123], v[12:15], v[132:147]
  v_mfma_f32_32x32x16_bf16 v[148:163], a[124:127], v[12:15], v[148:163]
  v_mfma_f32_32x32x16_bf16 v[132:147], a[128:131], v[12:15], v[132:147]
  v_mfma_f32_32x32x16_bf16 v[148:163], a[132:135], v[12:15], v[148:163]
  v_mfma_f32_32x32x16_bf16 v[132:147], a[136:139], v[12:15], v[132:147]
  v_mfma_f32_32x32x16_bf16 v[148:163], a[140:143], v[12:15], v[148:163]
  v_mfma_f32_32x32x16_bf16 v[132:147], a[144:147], v[12:15], v[132:147]
  v_mfma_f32_32x32x16_bf16 v[148:163], a[148:151], v[12:15], v[148:163]
  v_mfma_f32_32x32x16_bf16 v[132:147], a[152:155], v[12:15], v[132:147]
  v_mfma_f32_32x32x16_bf16 v[148:163], a[156:159], v[12:15], v[148:163]
  v_mfma_f32_32x32x16_bf16 v[132:147], a[160:163], v[12:15], v[132:147]
  v_mfma_f32_32x32x16_bf16 v[148:163], a[164:167], v[12:15], v[148:163]
  v_mfma_f32_32x32x16_bf16 v[132:147], a[168:171], v[12:15], v[132:147]
  v_mfma_f32_32x32x16_bf16 v[148:163], a[172:175], v[12:15], v[148:163]
  v_mfma_f32_32x32x16_bf16 v[132:147], a[176:179], v[12:15], v[132:147]
  v_mfma_f32_32x32x16_bf16 v[148:163], a[180:183], v[12:15], v[148:163]
  v_mfma_f32_32x32x16_bf16 v[132:147], a[184:187], v[12:15], v[132:147]
  v_mfma_f32_32x32x16_bf16 v[148:163], a[188:191], v[12:15], v[148:163]
  v_mfma_f32_32x32x16_bf16 v[132:147], a[192:195], v[12:15], v[132:147]
  v_mfma_f32_32x32x16_bf16 v[148:163], a[196:199], v[12:15], v[148:163]
  v_mfma_f32_32x32x16_bf16 v[132:147], a[200:203], v[12:15], v[132:147]
  v_mfma_f32_32x32x16_bf16 v[148:163], a[204:207], v[12:15], v[148:163]
  v_mfma_f32_32x32x16_bf16 v[132:147], a[208:211], v[12:15], v[132:147]
  v_mfma_f32_32x32x16_bf16 v[148:163], a[212:215], v[12:15], v[148:163]
  v_mfma_f32_32x32x16_bf16 v[132:147], a[216:219], v[12:15], v[132:147]
  v_mfma_f32_32x32x16_bf16 v[148:163], a[220:223], v[12:15], v[148:163]
  v_mfma_f32_32x32x16_bf16 v[132:147], a[224:227], v[12:15], v[132:147]
  v_mfma_f32_32x32x16_bf16 v[148:163], a[228:231], v[12:15], v[148:163]
  v_mfma_f32_32x32x16_bf16 v[132:147], a[232:235], v[12:15], v[132:147]
  v_mfma_f32_32x32x16_bf16 v[148:163], a[236:239], v[12:15], v[148:163]
  v_mfma_f32_32x32x16_bf16 v[132:147], a[240:243], v[12:15], v[132:147]
  v_mfma_f32_32x32x16_bf16 v[148:163], a[244:247], v[12:15], v[148:163]
  v_mfma_f32_32x32x16_bf16 v[132:147], a[248:251], v[12:15], v[132:147]
  v_mfma_f32_32x32x16_bf16 v[148:163], a[252:255], v[12:15], v[148:163]
  v_mfma_f32_32x32x16_bf16 v[132:147], v[192:195], v[12:15], v[132:147]
  v_mfma_f32_32x32x16_bf16 v[148:163], v[196:199], v[12:15], v[148:163]
  v_mfma_f32_32x32x16_bf16 v[132:147], v[200:203], v[12:15], v[132:147]
  v_mfma_f32_32x32x16_bf16 v[148:163], v[204:207], v[12:15], v[148:163]
  v_mfma_f32_32x32x16_bf16 v[132:147], v[208:211], v[12:15], v[132:147]
  v_mfma_f32_32x32x16_bf16 v[148:163], v[212:215], v[12:15], v[148:163]
  v_mfma_f32_32x32x16_bf16 v[132:147], v[216:219], v[12:15], v[132:147]
  v_mfma_f32_32x32x16_bf16 v[148:163], v[220:223], v[12:15], v[148:163]
  v_mfma_f32_32x32x16_bf16 v[132:147], v[224:227], v[12:15], v[132:147]
  v_mfma_f32_32x32x16_bf16 v[148:163], v[228:231], v[12:15], v[148:163]
  v_mfma_f32_32x32x16_bf16 v[132:147], v[232:235], v[12:15], v[132:147]
  v_mfma_f32_32x32x16_bf16 v[148:163], v[236:239], v[12:15], v[148:163]
  v_mfma_f32_32x32x16_bf16 v[132:147], v[240:243], v[12:15], v[132:147]
  v_mfma_f32_32x32x16_bf16 v[148:163], v[244:247], v[12:15], v[148:163]
  v_mfma_f32_32x32x16_bf16 v[132:147], v[248:251], v[12:15], v[132:147]
  v_mfma_f32_32x32x16_bf16 v[148:163], v[252:255], v[12:15], v[148:163]
  v_and_b32 v3, 0xf0, v1
  v_bfe_u32 v6, v0, 4, 1
  v_lshl_add_u32 v3, v6, 3, v3
  v_add_u32 v3, 40960, v3
  v_and_b32 v6, 1, v0
  v_lshlrev_b32 v6, 4, v6
  v_mov_b32 v7, 0x3f80
  v_lshlrev_b32 v7, v6, v7
  v_bfe_u32 v6, v0, 4, 1
  v_cmp_eq_u32 vcc, 0, v6
  s_nop 1
  v_cndmask_b32 v7, 0, v7, vcc
  v_bfe_u32 v6, v0, 2, 1
  v_lshrrev_b32 v108, 5, v0
  v_cmp_eq_u32 vcc, v6, v108
  s_nop 1
  v_cndmask_b32 v7, 0, v7, vcc
  v_bfe_u32 v6, v0, 3, 1
  v_bfe_u32 v108, v0, 1, 1
  v_lshl_add_u32 v6, v6, 1, v108
  v_cmp_eq_u32 vcc, 0, v6
  s_nop 1
  v_cndmask_b32 v108, 0, v7, vcc
  v_cmp_eq_u32 vcc, 1, v6
  s_nop 1
  v_cndmask_b32 v109, 0, v7, vcc
  v_cmp_eq_u32 vcc, 2, v6
  s_nop 1
  v_cndmask_b32 v110, 0, v7, vcc
  v_cmp_eq_u32 vcc, 3, v6
  s_nop 1
  v_cndmask_b32 v111, 0, v7, vcc
  v_and_b32 v6, 1, v0
  v_lshlrev_b32 v6, 4, v6
  v_mov_b32 v7, 0x3f80
  v_lshlrev_b32 v7, v6, v7
  v_lshrrev_b32 v6, 1, v0
  v_cmp_eq_u32 vcc, 24, v6
  s_nop 1
  v_cndmask_b32 v112, 0, v7, vcc
  v_cmp_eq_u32 vcc, 25, v6
  s_nop 1
  v_cndmask_b32 v113, 0, v7, vcc
  v_and_b32 v6, 31, v0
  v_lshrrev_b32 v7, 5, v0
  v_lshlrev_b32 v7, 2, v7
  v_sub_u32 v6, v6, v7
  v_mov_b32 v116, 0xff800000
  v_subrev_u32 v7, 0, v6
  v_and_b32 v7, 0xfffffff1, v7
  v_cmp_ne_u32 vcc, 0, v7
  s_nop 1
  v_cndmask_b32 v84, 0, v116, vcc
  v_subrev_u32 v7, 1, v6
  v_and_b32 v7, 0xfffffff1, v7
  v_cmp_ne_u32 vcc, 0, v7
  s_nop 1
  v_cndmask_b32 v85, 0, v116, vcc
  v_subrev_u32 v7, 2, v6
  v_and_b32 v7, 0xfffffff1, v7
  v_cmp_ne_u32 vcc, 0, v7
  s_nop 1
  v_cndmask_b32 v86, 0, v116, vcc
  v_subrev_u32 v7, 3, v6
  v_and_b32 v7, 0xfffffff1, v7
  v_cmp_ne_u32 vcc, 0, v7
  s_nop 1
  v_cndmask_b32 v87, 0, v116, vcc
  v_subrev_u32 v7, 8, v6
  v_and_b32 v7, 0xfffffff1, v7
  v_cmp_ne_u32 vcc, 0, v7
  s_nop 1
  v_cndmask_b32 v88, 0, v116, vcc
  v_subrev_u32 v7, 9, v6
  v_and_b32 v7, 0xfffffff1, v7
  v_cmp_ne_u32 vcc, 0, v7
  s_nop 1
  v_cndmask_b32 v89, 0, v116, vcc
  v_subrev_u32 v7, 10, v6
  v_and_b32 v7, 0xfffffff1, v7
  v_cmp_ne_u32 vcc, 0, v7
  s_nop 1
  v_cndmask_b32 v90, 0, v116, vcc
  v_subrev_u32 v7, 11, v6
  v_and_b32 v7, 0xfffffff1, v7
  v_cmp_ne_u32 vcc, 0, v7
  s_nop 1
  v_cndmask_b32 v91, 0, v116, vcc
  v_subrev_u32 v7, 16, v6
  v_and_b32 v7, 0xfffffff1, v7
  v_cmp_ne_u32 vcc, 0, v7
  s_nop 1
  v_cndmask_b32 v92, 0, v116, vcc
  v_subrev_u32 v7, 17, v6
  v_and_b32 v7, 0xfffffff1, v7
  v_cmp_ne_u32 vcc, 0, v7
  s_nop 1
  v_cndmask_b32 v93, 0, v116, vcc
  v_subrev_u32 v7, 18, v6
  v_and_b32 v7, 0xfffffff1, v7
  v_cmp_ne_u32 vcc, 0, v7
  s_nop 1
  v_cndmask_b32 v94, 0, v116, vcc
  v_subrev_u32 v7, 19, v6
  v_and_b32 v7, 0xfffffff1, v7
  v_cmp_ne_u32 vcc, 0, v7
  s_nop 1
  v_cndmask_b32 v95, 0, v116, vcc
  v_subrev_u32 v7, 24, v6
  v_and_b32 v7, 0xfffffff1, v7
  v_cmp_ne_u32 vcc, 0, v7
  s_nop 1
  v_cndmask_b32 v96, 0, v116, vcc
  v_subrev_u32 v7, 25, v6
  v_and_b32 v7, 0xfffffff1, v7
  v_cmp_ne_u32 vcc, 0, v7
  s_nop 1
  v_cndmask_b32 v97, 0, v116, vcc
  v_subrev_u32 v7, 26, v6
  v_and_b32 v7, 0xfffffff1, v7
  v_cmp_ne_u32 vcc, 0, v7
  s_nop 1
  v_cndmask_b32 v98, 0, v116, vcc
  v_subrev_u32 v7, 27, v6
  v_and_b32 v7, 0xfffffff1, v7
  v_cmp_ne_u32 vcc, 0, v7
  s_nop 1
  v_cndmask_b32 v99, 0, v116, vcc
  v_subrev_u32 v7, -16, v6
  v_and_b32 v7, 0xfffffff1, v7
  v_cmp_ne_u32 vcc, 0, v7
  s_nop 1
  v_cndmask_b32 v28, 0, v116, vcc
  v_subrev_u32 v7, -15, v6
  v_and_b32 v7, 0xfffffff1, v7
  v_cmp_ne_u32 vcc, 0, v7
  s_nop 1
  v_cndmask_b32 v29, 0, v116, vcc
  v_subrev_u32 v7, -14, v6
  v_and_b32 v7, 0xfffffff1, v7
  v_cmp_ne_u32 vcc, 0, v7
  s_nop 1
  v_cndmask_b32 v30, 0, v116, vcc
  v_subrev_u32 v7, -13, v6
  v_and_b32 v7, 0xfffffff1, v7
  v_cmp_ne_u32 vcc, 0, v7
  s_nop 1
  v_cndmask_b32 v31, 0, v116, vcc
  v_subrev_u32 v7, -8, v6
  v_and_b32 v7, 0xfffffff1, v7
  v_cmp_ne_u32 vcc, 0, v7
  s_nop 1
  v_cndmask_b32 v32, 0, v116, vcc
  v_subrev_u32 v7, -7, v6
  v_and_b32 v7, 0xfffffff1, v7
  v_cmp_ne_u32 vcc, 0, v7
  s_nop 1
  v_cndmask_b32 v33, 0, v116, vcc
  v_subrev_u32 v7, -6, v6
  v_and_b32 v7, 0xfffffff1, v7
  v_cmp_ne_u32 vcc, 0, v7
  s_nop 1
  v_cndmask_b32 v34, 0, v116, vcc
  v_subrev_u32 v7, -5, v6
  v_and_b32 v7, 0xfffffff1, v7
  v_cmp_ne_u32 vcc, 0, v7
  s_nop 1
  v_cndmask_b32 v35, 0, v116, vcc
  v_mov_b32 v100, 0xff800000
  v_mov_b32 v101, 0xff800000
  v_mov_b32 v102, 0xff800000
  v_mov_b32 v103, 0xff800000
  v_mov_b32 v104, 0xff800000
  v_mov_b32 v105, 0xff800000
  v_mov_b32 v106, 0xff800000
  v_mov_b32 v107, 0xff800000
  v_mov_b32 v74, 0
  v_mov_b32 v75, 0
  v_mov_b32 v76, 0
  v_mov_b32 v77, 0
  v_mov_b32 v78, 0
  v_mov_b32 v79, 0
  v_mov_b32 v80, 0
  v_mov_b32 v81, 0
  v_mov_b32 v82, 0
  v_mov_b32 v83, 0
  v_and_b32 v6, 1, v0
  v_cmp_eq_u32 vcc, 0, v6
  v_mov_b32 v6, 0xc0c0100
  v_mov_b32 v7, 0x1000c0c
  v_cndmask_b32 v114, v7, v6, vcc
  v_mov_b32 v6, 0xc0c0302
  v_mov_b32 v7, 0x3020c0c
  v_cndmask_b32 v115, v7, v6, vcc
  v_mov_b32 v6, 0x20000000
  v_cmp_gt_u32 vcc, 32, v0
  s_nop 1
  v_cndmask_b32 v8, v6, v10, vcc
  s_mov_b32 s68, 0x3ea52b5c
  s_mul_i32 s51, s45, 2560
  v_add_u32 v4, s51, v4
  s_mov_b32 s15, s93
  s_and_b32 s3, s92, 0xffff
  s_cmp_lt_u32 s3, 48
  s_cbranch_scc1 L_rslow_351
  s_and_b32 s3, s15, 0xffff
  s_cmp_ge_u32 s3, 32
  s_cbranch_scc1 L_rfast_352
L_rslow_351:
  v_mov_b32 v6, 8
L_rdy_353:
  global_load_dword v7, v6, s[38:39] sc1
  s_waitcnt vmcnt(0)
  v_readfirstlane_b32 s15, v7
  s_and_b32 s3, s15, 0xffff
  s_cmp_ge_u32 s3, 48
  s_cbranch_scc1 L_rdyd_354
  s_sleep 8
  s_add_u32 s14, s14, 1
  s_cmp_lt_u32 s14, 100000
  s_cbranch_scc1 L_rdy_353
L_rdyd_354:
  v_mov_b32 v6, 12
  global_load_dword v6, v6, s[38:39] sc1
  s_waitcnt vmcnt(0)
  v_readfirstlane_b32 s2, v6
  s_lshr_b32 s15, s13, 5
  s_mul_i32 s3, s15, 65
  s_and_b32 s3, s3, 0xc4
  v_mov_b32 v6, s3
L_rdy_355:
  global_load_dword v7, v6, s[38:39] sc1
  s_waitcnt vmcnt(0)
  v_readfirstlane_b32 s15, v7
  s_and_b32 s3, s15, 0xffff
  s_cmp_ge_u32 s3, 32
  s_cbranch_scc1 L_rdyd_356
  s_sleep 8
  s_add_u32 s14, s14, 1
  s_cmp_lt_u32 s14, 100000
  s_cbranch_scc1 L_rdy_355
L_rdyd_356:
L_rfast_352:
  s_lshr_b32 s15, s15, 16
  s_and_b32 s2, s2, 3
  s_mul_i32 s2, s2, 0x2001
  s_xor_b32 s2, s2, 0x2000
  s_mov_b64 vcc, 0
  s_cmp_eq_u32 s101, 12
  s_cselect_b32 vcc_lo, 0xffffffff, vcc_lo
  s_cselect_b32 vcc_hi, 0xffffffff, vcc_hi
  s_cmp_eq_u32 s101, 13
  s_cselect_b32 vcc_lo, 0xffffffff, vcc_lo
  s_cselect_b32 vcc_hi, 0xffffffff, vcc_hi
  s_cmp_eq_u32 s15, 0
  s_cselect_b32 s51, 128, 0
  v_mov_b32 v6, s51
  v_cndmask_b32 v6, 0, v6, vcc
  v_add_u32 v4, v4, v6
  s_lshl_b32 s51, s12, 6
  s_sub_u32 s51, 80, s51
  v_mov_b32 v9, 0x10000000
  v_cmp_gt_i32 vcc, s51, v0
  s_nop 1
  v_cndmask_b32 v9, v9, v1, vcc
  v_lshlrev_b32 v171, 2, v0
  v_add_u32 v171, 155648, v171
  s_lshl_b32 s95, s12, 8
  s_add_u32 s95, s95, 155648
  v_or_b32 v0, s12, v0
  v_lshlrev_b32 v0, 24, v0
  v_min_u32 v0, 0x1000000, v0
  v_lshlrev_b32 v0, 4, v0
  s_lshl_b32 s63, s12, 10
  s_mov_b32 s50, s63
  s_mov_b32 s42, -2
  s_mov_b32 s62, 0
  s_mov_b32 s48, 1280
  s_cmp_eq_u32 s12, 0
  s_cselect_b32 s48, s48, 0x20000000
  s_mov_b32 s56, 45056
  s_mov_b32 s55, 45056
  s_mov_b32 s83, s45
  s_mov_b32 s80, 63
  s_add_u32 s84, s42, 2
  s_mov_b32 s85, 6029312
  s_mul_i32 s52, s83, 5767168
  s_add_u32 s85, s85, s52
  s_mul_i32 s52, s84, 45056
  s_add_u32 s85, s85, s52
  s_add_u32 s85, s85, s63
  s_mov_b32 s43, s45
  s_mov_b32 s44, s46
  s_mov_b32 s46, s84
  s_mov_b32 s45, s83
  s_mov_b32 s64, s85
  s_add_u32 s42, s42, 1
  s_add_u32 s84, s42, 2
  s_mov_b32 s85, 6029312
  s_mul_i32 s52, s83, 5767168
  s_add_u32 s85, s85, s52
  s_mul_i32 s52, s84, 45056
  s_add_u32 s85, s85, s52
  s_add_u32 s85, s85, s63
  s_mov_b32 s57, 0x20000000
  s_mov_b32 s58, 0x20000000
  s_mov_b32 s59, 0x20000000
  s_mov_b32 s60, 0x20000000
  s_mov_b32 s61, 0x20000000
  s_mov_b32 s47, s64
  s_mov_b32 s49, 0
  s_mov_b32 s94, 0
  s_branch L_bq_spin
L_bq_top:
  s_waitcnt vmcnt(8)
L_bq_top2:
  s_barrier
  ds_read_b128 v[12:15], v2 offset:0
  ds_read_b128 v[16:19], v2 offset:1024
  ds_read_b128 v[20:23], v2 offset:2048
  buffer_store_dwordx4 v[68:71], v1, s[4:7], s57 offen offset:0 sc1
  buffer_store_dwordx2 v[72:73], v8, s[4:7], s58 offen offset:0 sc1
  s_mov_b32 s43, s45
  s_mov_b32 s44, s46
  s_mov_b32 s46, s84
  s_mov_b32 s45, s83
  s_mov_b32 s64, s85
  s_add_u32 s42, s42, 1
  s_add_u32 s84, s42, 2
  s_mov_b32 s85, 6029312
  s_mul_i32 s52, s83, 5767168
  s_add_u32 s85, s85, s52
  s_mul_i32 s52, s84, 45056
  s_add_u32 s85, s85, s52
  s_add_u32 s85, s85, s63
  s_waitcnt lgkmcnt(2)
  v_mfma_f32_32x32x16_bf16 v[36:51], a[0:3], v[12:15], 0
  ds_read_b128 v[24:27], v2 offset:3072
  v_mfma_f32_32x32x16_bf16 v[52:67], a[4:7], v[12:15], 0
  s_waitcnt lgkmcnt(2)
  v_mfma_f32_32x32x16_bf16 v[36:51], a[8:11], v[16:19], v[36:51]
  ds_read_b128 v[12:15], v2 offset:4096
  v_mfma_f32_32x32x16_bf16 v[52:67], a[12:15], v[16:19], v[52:67]
  s_waitcnt lgkmcnt(2)
  v_mfma_f32_32x32x16_bf16 v[36:51], a[16:19], v[20:23], v[36:51]
  ds_read_b128 v[16:19], v2 offset:5120
  v_mfma_f32_32x32x16_bf16 v[52:67], a[20:23], v[20:23], v[52:67]
  s_waitcnt lgkmcnt(2)
  v_mfma_f32_32x32x16_bf16 v[36:51], a[24:27], v[24:27], v[36:51]
  ds_read_b128 v[20:23], v2 offset:6144
  v_mfma_f32_32x32x16_bf16 v[52:67], a[28:31], v[24:27], v[52:67]
  s_waitcnt lgkmcnt(2)
  v_mfma_f32_32x32x16_bf16 v[36:51], a[32:35], v[12:15], v[36:51]
  ds_read_b128 v[24:27], v2 offset:7168
  v_mfma_f32_32x32x16_bf16 v[52:67], a[36:39], v[12:15], v[52:67]
  s_waitcnt lgkmcnt(2)
  v_mfma_f32_32x32x16_bf16 v[36:51], a[40:43], v[16:19], v[36:51]
  ds_read_b128 v[12:15], v2 offset:8192
  v_mfma_f32_32x32x16_bf16 v[52:67], a[44:47], v[16:19], v[52:67]
  s_waitcnt lgkmcnt(2)
  v_mfma_f32_32x32x16_bf16 v[36:51], a[48:51], v[20:23], v[36:51]
  ds_read_b128 v[16:19], v2 offset:9216
  v_mfma_f32_32x32x16_bf16 v[52:67], a[52:55], v[20:23], v[52:67]
  s_waitcnt lgkmcnt(2)
  v_mfma_f32_32x32x16_bf16 v[36:51], a[56:59], v[24:27], v[36:51]
  ds_read_b128 v[20:23], v2 offset:10240
  v_mfma_f32_32x32x16_bf16 v[52:67], a[60:63], v[24:27], v[52:67]
  s_waitcnt lgkmcnt(2)
  v_mfma_f32_32x32x16_bf16 v[36:51], a[64:67], v[12:15], v[36:51]
  ds_read_b128 v[24:27], v2 offset:11264
  v_mfma_f32_32x32x16_bf16 v[52:67], a[68:71], v[12:15], v[52:67]
  s_waitcnt lgkmcnt(2)
  v_mfma_f32_32x32x16_bf16 v[36:51], a[72:75], v[16:19], v[36:51]
  ds_read_b128 v[12:15], v2 offset:12288
  v_mfma_f32_32x32x16_bf16 v[52:67], a[76:79], v[16:19], v[52:67]
  s_waitcnt lgkmcnt(2)
  v_mfma_f32_32x32x16_bf16 v[36:51], a[80:83], v[20:23], v[36:51]
  ds_read_b128 v[16:19], v2 offset:13312
  v_mfma_f32_32x32x16_bf16 v[52:67], a[84:87], v[20:23], v[52:67]
  s_waitcnt lgkmcnt(2)
  v_mfma_f32_32x32x16_bf16 v[36:51], a[88:91], v[24:27], v[36:51]
  ds_read_b128 v[20:23], v2 offset:14336
  v_mfma_f32_32x32x16_bf16 v[52:67], a[92:95], v[24:27], v[52:67]
  s_waitcnt lgkmcnt(2)
  v_mfma_f32_32x32x16_bf16 v[36:51], a[96:99], v[12:15], v[36:51]
  ds_read_b128 v[24:27], v2 offset:15360
  v_mfma_f32_32x32x16_bf16 v[52:67], a[100:103], v[12:15], v[52:67]
  s_waitcnt lgkmcnt(2)
  v_mfma_f32_32x32x16_bf16 v[36:51], a[104:107], v[16:19], v[36:51]
  s_waitcnt vmcnt(2)
  s_barrier
  ds_read_b128 v[12:15], v2 offset:16384
  s_xor_b32 s95, s95, 1024
  s_mov_b32 m0, s95
  v_xor_b32 v171, 1024, v171
  buffer_load_dword v4, s[4:7], s48 offen sc1 lds
  v_mfma_f32_32x32x16_bf16 v[52:67], a[108:111], v[16:19], v[52:67]
  s_waitcnt lgkmcnt(2)
  v_mfma_f32_32x32x16_bf16 v[36:51], a[112:115], v[20:23], v[36:51]
  ds_read_b128 v[16:19], v2 offset:17408
  s_waitcnt vmcnt(1)
  s_barrier
  v_mov_b32 v7, s62
  buffer_store_dword v7, v0, s[4:7], s61 offen offset:0 sc1
  buffer_store_dword v7, v0, s[4:7], s61 offen offset:128
  v_mfma_f32_32x32x16_bf16 v[52:67], a[116:119], v[20:23], v[52:67]
  s_mov_b32 s57, 258998272
  s_mul_i32 s52, s43, 2621440
  s_add_u32 s57, s57, s52
  s_mul_i32 s52, s44, 40960
  s_waitcnt lgkmcnt(2)
  v_mfma_f32_32x32x16_bf16 v[36:51], a[120:123], v[24:27], v[36:51]
  ds_read_b128 v[20:23], v2 offset:18432
  s_add_u32 s57, s57, s52
  s_mov_b32 s58, 32768
  s_add_u32 s58, s58, s57
  s_mul_i32 s52, s67, 256
  v_mfma_f32_32x32x16_bf16 v[52:67], a[124:127], v[24:27], v[52:67]
  s_add_u32 s58, s58, s52
  s_lshl_b32 s52, s67, 10
  s_add_u32 s57, s57, s52
  s_mov_b32 s61, 105984
  s_mul_i32 s52, s43, 2048
  s_waitcnt lgkmcnt(2)
  v_mfma_f32_32x32x16_bf16 v[36:51], a[128:131], v[12:15], v[36:51]
  ds_read_b128 v[24:27], v2 offset:19456
  s_add_u32 s61, s61, s52
  s_mul_i32 s52, s66, 256
  s_add_u32 s61, s61, s52
  v_mfma_f32_32x32x16_bf16 v[52:67], a[132:135], v[12:15], v[52:67]
  s_waitcnt lgkmcnt(2)
  v_mfma_f32_32x32x16_bf16 v[36:51], a[136:139], v[16:19], v[36:51]
  ds_read_b128 v[12:15], v2 offset:20480
  ds_read_b64 v[172:173], v3 offset:0
  v_mfma_f32_32x32x16_bf16 v[52:67], a[140:143], v[16:19], v[52:67]
  ds_read_b64 v[174:175], v3 offset:256
  s_waitcnt lgkmcnt(4)
  v_mfma_f32_32x32x16_bf16 v[36:51], a[144:147], v[20:23], v[36:51]
  ds_read_b128 v[16:19], v2 offset:21504
  ds_read_b64 v[176:177], v3 offset:512
  v_mfma_f32_32x32x16_bf16 v[52:67], a[148:151], v[20:23], v[52:67]
  ds_read_b64 v[178:179], v3 offset:768
  s_waitcnt lgkmcnt(6)
  v_mfma_f32_32x32x16_bf16 v[36:51], a[152:155], v[24:27], v[36:51]
  ds_read_b128 v[20:23], v2 offset:22528
  ds_read_b64 v[180:181], v3 offset:1024
  v_mfma_f32_32x32x16_bf16 v[52:67], a[156:159], v[24:27], v[52:67]
  s_nop 0
  s_waitcnt lgkmcnt(7)
  v_mfma_f32_32x32x16_bf16 v[36:51], a[160:163], v[12:15], v[36:51]
  ds_read_b128 v[24:27], v2 offset:23552
  s_nop 0
  v_mfma_f32_32x32x16_bf16 v[52:67], a[164:167], v[12:15], v[52:67]
  s_nop 0
  s_waitcnt lgkmcnt(5)
  v_mfma_f32_32x32x16_bf16 v[36:51], a[168:171], v[16:19], v[36:51]
  ds_read_b128 v[12:15], v2 offset:24576
  s_waitcnt lgkmcnt(2)
  v_mfma_f32_32x32x16_bf16 v[52:67], a[172:175], v[16:19], v[52:67]
  v_add_f32 v172, v172, v174
  v_mfma_f32_32x32x16_bf16 v[36:51], a[176:179], v[20:23], v[36:51]
  ds_read_b128 v[16:19], v2 offset:25600
  v_add_f32 v173, v173, v175
  v_mfma_f32_32x32x16_bf16 v[52:67], a[180:183], v[20:23], v[52:67]
  v_add_f32 v172, v172, v176
  s_waitcnt lgkmcnt(2)
  v_mfma_f32_32x32x16_bf16 v[36:51], a[184:187], v[24:27], v[36:51]
  ds_read_b128 v[20:23], v2 offset:26624
  v_add_f32 v173, v173, v177
  v_mfma_f32_32x32x16_bf16 v[52:67], a[188:191], v[24:27], v[52:67]
  v_add_f32 v172, v172, v178
  s_waitcnt lgkmcnt(2)
  v_mfma_f32_32x32x16_bf16 v[36:51], a[192:195], v[12:15], v[36:51]
  ds_read_b128 v[24:27], v2 offset:27648
  v_add_f32 v173, v173, v179
  v_mfma_f32_32x32x16_bf16 v[52:67], a[196:199], v[12:15], v[52:67]
  v_add_f32 v172, v172, v180
  s_waitcnt lgkmcnt(2)
  v_mfma_f32_32x32x16_bf16 v[36:51], a[200:203], v[16:19], v[36:51]
  ds_read_b128 v[12:15], v2 offset:28672
  v_add_f32 v173, v173, v181
  v_mfma_f32_32x32x16_bf16 v[52:67], a[204:207], v[16:19], v[52:67]
  v_mul_f32 v172, 0xbacccccd, v172
  s_waitcnt lgkmcnt(2)
  v_mfma_f32_32x32x16_bf16 v[36:51], a[208:211], v[20:23], v[36:51]
  ds_read_b128 v[16:19], v2 offset:29696
  s_waitcnt vmcnt(2)
  s_barrier
  ds_read_b32 v5, v171
  v_mul_f32 v173, 0x3acccccd, v173
  v_mfma_f32_32x32x16_bf16 v[52:67], a[212:215], v[20:23], v[52:67]
  v_fma_f32 v173, -v172, v172, v173
  s_waitcnt lgkmcnt(3)
  v_mfma_f32_32x32x16_bf16 v[36:51], a[216:219], v[24:27], v[36:51]
  ds_read_b128 v[20:23], v2 offset:30720
  v_max_f32 v173, 0, v173
  v_mfma_f32_32x32x16_bf16 v[52:67], a[220:223], v[24:27], v[52:67]
  s_waitcnt lgkmcnt(1)
  v_cmp_ge_i32 vcc, s46, v5
  s_cmp_eq_u32 s45, 0
  s_cselect_b32 s51, vcc_lo, vcc_hi
  s_cmp_lg_u32 s51, 0
  s_cselect_b32 s49, 0, 1
  v_add_f32 v173, 0x3727c5ac, v173
  v_mfma_f32_32x32x16_bf16 v[36:51], a[224:227], v[12:15], v[36:51]
  ds_read_b128 v[24:27], v2 offset:31744
  s_cmp_lt_u32 s42, s80
  s_cselect_b32 s49, s49, 0
  v_rsq_f32 v173, v173
  v_mfma_f32_32x32x16_bf16 v[52:67], a[228:231], v[12:15], v[52:67]
  s_cmp_lg_u32 s49, 0
  s_cselect_b32 s47, s64, 0x20000000
  s_xor_b32 s50, s50, s56
  v_mfma_f32_32x32x16_bf16 v[36:51], a[232:235], v[16:19], v[36:51]
  ds_read_b128 v[12:15], v2 offset:32768
  s_add_u32 m0, s50, 0
  s_add_u32 s51, s47, 0
  buffer_load_dwordx4 v1, s[4:7], s51 offen sc1 lds
  v_mfma_f32_32x32x16_bf16 v[52:67], a[236:239], v[16:19], v[52:67]
  s_waitcnt lgkmcnt(2)
  v_mfma_f32_32x32x16_bf16 v[36:51], a[240:243], v[20:23], v[36:51]
  ds_read_b128 v[16:19], v2 offset:33792
  s_add_u32 m0, s50, 4096
  s_add_u32 s51, s47, 4096
  buffer_load_dwordx4 v1, s[4:7], s51 offen sc1 lds
  v_mfma_f32_32x32x16_bf16 v[52:67], a[244:247], v[20:23], v[52:67]
  s_waitcnt lgkmcnt(2)
  v_mfma_f32_32x32x16_bf16 v[36:51], a[248:251], v[24:27], v[36:51]
  ds_read_b128 v[20:23], v2 offset:34816
  s_add_u32 m0, s50, 8192
  s_add_u32 s51, s47, 8192
  buffer_load_dwordx4 v1, s[4:7], s51 offen sc1 lds
  v_mfma_f32_32x32x16_bf16 v[52:67], a[252:255], v[24:27], v[52:67]
  s_waitcnt lgkmcnt(2)
  v_mfma_f32_32x32x16_bf16 v[36:51], v[192:195], v[12:15], v[36:51]
  ds_read_b128 v[24:27], v2 offset:35840
  s_add_u32 m0, s50, 12288
  s_add_u32 s51, s47, 12288
  buffer_load_dwordx4 v1, s[4:7], s51 offen sc1 lds
  v_mfma_f32_32x32x16_bf16 v[52:67], v[196:199], v[12:15], v[52:67]
  s_waitcnt lgkmcnt(2)
  v_mfma_f32_32x32x16_bf16 v[36:51], v[200:203], v[16:19], v[36:51]
  ds_read_b128 v[12:15], v2 offset:36864
  s_add_u32 m0, s50, 16384
  s_add_u32 s51, s47, 16384
  buffer_load_dwordx4 v1, s[4:7], s51 offen sc1 lds
  v_mfma_f32_32x32x16_bf16 v[52:67], v[204:207], v[16:19], v[52:67]
  s_waitcnt lgkmcnt(2)
  v_mfma_f32_32x32x16_bf16 v[36:51], v[208:211], v[20:23], v[36:51]
  ds_read_b128 v[16:19], v2 offset:37888
  s_add_u32 m0, s50, 20480
  s_add_u32 s51, s47, 20480
  buffer_load_dwordx4 v1, s[4:7], s51 offen sc1 lds
  v_mfma_f32_32x32x16_bf16 v[52:67], v[212:215], v[20:23], v[52:67]
  s_waitcnt lgkmcnt(2)
  v_mfma_f32_32x32x16_bf16 v[36:51], v[216:219], v[24:27], v[36:51]
  ds_read_b128 v[20:23], v2 offset:38912
  s_add_u32 m0, s50, 24576
  s_add_u32 s51, s47, 24576
  buffer_load_dwordx4 v1, s[4:7], s51 offen sc1 lds
  v_mfma_f32_32x32x16_bf16 v[52:67], v[220:223], v[24:27], v[52:67]
  s_waitcnt lgkmcnt(2)
  v_mfma_f32_32x32x16_bf16 v[36:51], v[224:227], v[12:15], v[36:51]
  ds_read_b128 v[24:27], v2 offset:39936
  s_add_u32 m0, s50, 28672
  s_add_u32 s51, s47, 28672
  buffer_load_dwordx4 v1, s[4:7], s51 offen sc1 lds
  v_mfma_f32_32x32x16_bf16 v[52:67], v[228:231], v[12:15], v[52:67]
  s_waitcnt lgkmcnt(2)
  v_mfma_f32_32x32x16_bf16 v[36:51], v[232:235], v[16:19], v[36:51]
  s_add_u32 m0, s50, 32768
  s_add_u32 s51, s47, 32768
  buffer_load_dwordx4 v1, s[4:7], s51 offen sc1 lds
  v_mfma_f32_32x32x16_bf16 v[52:67], v[236:239], v[16:19], v[52:67]
  s_waitcnt lgkmcnt(1)
  v_mfma_f32_32x32x16_bf16 v[36:51], v[240:243], v[20:23], v[36:51]
  s_add_u32 m0, s50, 36864
  s_add_u32 s51, s47, 36864
  buffer_load_dwordx4 v1, s[4:7], s51 offen sc1 lds
  v_mfma_f32_32x32x16_bf16 v[52:67], v[244:247], v[20:23], v[52:67]
  s_waitcnt lgkmcnt(0)
  v_mfma_f32_32x32x16_bf16 v[36:51], v[248:251], v[24:27], v[36:51]
  s_add_u32 m0, s50, 40960
  s_add_u32 s51, s47, 40960
  buffer_load_dwordx4 v9, s[4:7], s51 offen sc1 lds
  v_mfma_f32_32x32x16_bf16 v[52:67], v[252:255], v[24:27], v[52:67]
  s_xor_b32 s95, s95, 1024
  s_mov_b32 m0, s95
  v_xor_b32 v171, 1024, v171
  buffer_load_dword v4, s[4:7], s48 offen sc1 lds
  v_add_u32 v2, s55, v2
  v_add_u32 v3, s55, v3
  s_sub_u32 s55, 0, s55
  s_add_u32 s62, s44, 1
  v_pk_fma_f32 v[36:37], v[132:133], v[172:173], v[36:37] op_sel_hi:[1,0,1]
  v_pk_mul_f32 v[36:37], v[36:37], v[172:173] op_sel:[0,1] op_sel_hi:[1,1]
  v_cvt_pk_bf16_f32 v116, v36, v37
  v_pk_fma_f32 v[38:39], v[134:135], v[172:173], v[38:39] op_sel_hi:[1,0,1]
  v_pk_mul_f32 v[38:39], v[38:39], v[172:173] op_sel:[0,1] op_sel_hi:[1,1]
  v_cvt_pk_bf16_f32 v117, v38, v39
  v_pk_fma_f32 v[40:41], v[136:137], v[172:173], v[40:41] op_sel_hi:[1,0,1]
  v_pk_mul_f32 v[40:41], v[40:41], v[172:173] op_sel:[0,1] op_sel_hi:[1,1]
  v_cvt_pk_bf16_f32 v118, v40, v41
  v_pk_fma_f32 v[42:43], v[138:139], v[172:173], v[42:43] op_sel_hi:[1,0,1]
  v_pk_mul_f32 v[42:43], v[42:43], v[172:173] op_sel:[0,1] op_sel_hi:[1,1]
  v_cvt_pk_bf16_f32 v119, v42, v43
  v_pk_fma_f32 v[44:45], v[140:141], v[172:173], v[44:45] op_sel_hi:[1,0,1]
  v_pk_mul_f32 v[44:45], v[44:45], v[172:173] op_sel:[0,1] op_sel_hi:[1,1]
  v_cvt_pk_bf16_f32 v120, v44, v45
  v_pk_fma_f32 v[46:47], v[142:143], v[172:173], v[46:47] op_sel_hi:[1,0,1]
  v_pk_mul_f32 v[46:47], v[46:47], v[172:173] op_sel:[0,1] op_sel_hi:[1,1]
  v_cvt_pk_bf16_f32 v121, v46, v47
  v_pk_fma_f32 v[48:49], v[144:145], v[172:173], v[48:49] op_sel_hi:[1,0,1]
  v_pk_mul_f32 v[48:49], v[48:49], v[172:173] op_sel:[0,1] op_sel_hi:[1,1]
  v_cvt_pk_bf16_f32 v122, v48, v49
  v_pk_fma_f32 v[50:51], v[146:147], v[172:173], v[50:51] op_sel_hi:[1,0,1]
  v_pk_mul_f32 v[50:51], v[50:51], v[172:173] op_sel:[0,1] op_sel_hi:[1,1]
  v_cvt_pk_bf16_f32 v123, v50, v51
  v_pk_fma_f32 v[52:53], v[148:149], v[172:173], v[52:53] op_sel_hi:[1,0,1]
  v_pk_mul_f32 v[52:53], v[52:53], v[172:173] op_sel:[0,1] op_sel_hi:[1,1]
  v_cvt_pk_bf16_f32 v124, v52, v53
  v_pk_fma_f32 v[54:55], v[150:151], v[172:173], v[54:55] op_sel_hi:[1,0,1]
  v_pk_mul_f32 v[54:55], v[54:55], v[172:173] op_sel:[0,1] op_sel_hi:[1,1]
  v_cvt_pk_bf16_f32 v125, v54, v55
  v_pk_fma_f32 v[56:57], v[152:153], v[172:173], v[56:57] op_sel_hi:[1,0,1]
  v_pk_mul_f32 v[56:57], v[56:57], v[172:173] op_sel:[0,1] op_sel_hi:[1,1]
  v_cvt_pk_bf16_f32 v126, v56, v57
  v_pk_fma_f32 v[58:59], v[154:155], v[172:173], v[58:59] op_sel_hi:[1,0,1]
  v_pk_mul_f32 v[58:59], v[58:59], v[172:173] op_sel:[0,1] op_sel_hi:[1,1]
  v_cvt_pk_bf16_f32 v127, v58, v59
  v_pk_fma_f32 v[60:61], v[156:157], v[172:173], v[60:61] op_sel_hi:[1,0,1]
  v_pk_mul_f32 v[60:61], v[60:61], v[172:173] op_sel:[0,1] op_sel_hi:[1,1]
  v_cvt_pk_bf16_f32 v128, v60, v61
  v_pk_fma_f32 v[62:63], v[158:159], v[172:173], v[62:63] op_sel_hi:[1,0,1]
  v_pk_mul_f32 v[62:63], v[62:63], v[172:173] op_sel:[0,1] op_sel_hi:[1,1]
  v_cvt_pk_bf16_f32 v129, v62, v63
  v_pk_fma_f32 v[64:65], v[160:161], v[172:173], v[64:65] op_sel_hi:[1,0,1]
  v_pk_mul_f32 v[64:65], v[64:65], v[172:173] op_sel:[0,1] op_sel_hi:[1,1]
  v_cvt_pk_bf16_f32 v130, v64, v65
  v_pk_fma_f32 v[66:67], v[162:163], v[172:173], v[66:67] op_sel_hi:[1,0,1]
  v_pk_mul_f32 v[66:67], v[66:67], v[172:173] op_sel:[0,1] op_sel_hi:[1,1]
  v_cvt_pk_bf16_f32 v131, v66, v67
  v_mfma_f32_32x32x16_bf16 v[36:51], v[120:123], v[116:119], v[84:99]
  v_mfma_f32_32x32x16_bf16 v[52:67], v[74:77], v[116:119], v[92:107]
  v_mfma_f32_32x32x16_bf16 v[172:187], v[124:127], v[108:111], 0
  v_mfma_f32_32x32x8_bf16 v[36:51], v[130:131], v[128:129], v[36:51]
  v_mfma_f32_32x32x8_bf16 v[52:67], v[78:79], v[128:129], v[52:67]
  v_mov_b32 v74, v120
  v_mov_b32 v75, v121
  v_mov_b32 v76, v122
  v_mov_b32 v77, v123
  v_mfma_f32_32x32x8_bf16 v[172:187], v[128:129], v[112:113], v[172:187]
  v_mov_b32 v78, v130
  v_mov_b32 v79, v131
  v_max_f32 v116, v36, v37
  v_max_f32 v117, v38, v39
  v_max_f32 v118, v40, v41
  v_max_f32 v119, v42, v43
  v_max_f32 v120, v44, v45
  v_max_f32 v121, v46, v47
  v_max_f32 v122, v48, v49
  v_max_f32 v123, v50, v51
  v_max_f32 v124, v60, v61
  v_max_f32 v125, v62, v63
  v_max_f32 v126, v64, v65
  v_max_f32 v127, v66, v67
  v_max3_f32 v6, v116, v117, v118
  v_max3_f32 v6, v6, v119, v120
  v_max3_f32 v6, v6, v121, v122
  v_max3_f32 v6, v6, v123, v124
  v_max3_f32 v6, v6, v125, v126
  v_max_f32 v6, v6, v127
  v_mov_b32 v7, v6
  s_nop 1
  v_permlane32_swap_b32 v6, v7
  v_max_f32 v6, v6, v7
  v_mul_f32 v6, s68, v6
  v_fma_f32 v116, v116, s68, -v6
  v_fma_f32 v117, v117, s68, -v6
  v_fma_f32 v118, v118, s68, -v6
  v_fma_f32 v119, v119, s68, -v6
  v_fma_f32 v120, v120, s68, -v6
  v_fma_f32 v121, v121, s68, -v6
  v_fma_f32 v122, v122, s68, -v6
  v_fma_f32 v123, v123, s68, -v6
  v_fma_f32 v124, v124, s68, -v6
  v_fma_f32 v125, v125, s68, -v6
  v_fma_f32 v126, v126, s68, -v6
  v_fma_f32 v127, v127, s68, -v6
  v_exp_f32 v116, v116
  v_exp_f32 v117, v117
  v_exp_f32 v118, v118
  v_exp_f32 v119, v119
  v_exp_f32 v120, v120
  v_exp_f32 v121, v121
  v_exp_f32 v122, v122
  v_exp_f32 v123, v123
  v_exp_f32 v124, v124
  v_exp_f32 v125, v125
  v_exp_f32 v126, v126
  v_exp_f32 v127, v127
  v_cvt_pk_bf16_f32 v12, v172, v173
  v_cvt_pk_bf16_f32 v13, v174, v175
  v_cvt_pk_bf16_f32 v14, v176, v177
  v_cvt_pk_bf16_f32 v15, v178, v179
  v_cvt_pk_bf16_f32 v16, v180, v181
  v_cvt_pk_bf16_f32 v17, v182, v183
  v_cvt_pk_bf16_f32 v18, v184, v185
  v_cvt_pk_bf16_f32 v19, v186, v187
  v_cvt_pk_bf16_f32 v6, v116, v117
  v_perm_b32 v20, v6, v6, v114
  v_perm_b32 v21, v6, v6, v115
  v_cvt_pk_bf16_f32 v6, v118, v119
  v_perm_b32 v22, v6, v6, v114
  v_perm_b32 v23, v6, v6, v115
  v_cvt_pk_bf16_f32 v6, v120, v121
  v_perm_b32 v24, v6, v6, v114
  v_perm_b32 v25, v6, v6, v115
  v_cvt_pk_bf16_f32 v6, v122, v123
  v_perm_b32 v26, v6, v6, v114
  v_perm_b32 v27, v6, v6, v115
  v_cvt_pk_bf16_f32 v6, v124, v125
  v_perm_b32 v164, v6, v6, v114
  v_perm_b32 v165, v6, v6, v115
  v_cvt_pk_bf16_f32 v6, v126, v127
  v_perm_b32 v166, v6, v6, v114
  v_perm_b32 v167, v6, v6, v115
  v_mfma_f32_32x32x16_bf16 v[36:51], v[12:15], v[20:23], 0
  v_add_f32 v6, v116, v117
  v_add_f32 v6, v6, v118
  v_add_f32 v6, v6, v119
  v_add_f32 v6, v6, v120
  v_add_f32 v6, v6, v121
  v_mfma_f32_32x32x16_bf16 v[36:51], v[16:19], v[24:27], v[36:51]
  v_add_f32 v6, v6, v122
  v_add_f32 v6, v6, v123
  v_add_f32 v6, v6, v124
  v_add_f32 v6, v6, v125
  v_add_f32 v6, v6, v126
  v_mfma_f32_32x32x16_bf16 v[36:51], v[80:83], v[164:167], v[36:51]
  v_add_f32 v6, v6, v127
  v_mov_b32 v7, v6
  s_nop 1
  v_permlane32_swap_b32 v6, v7
  v_add_f32 v6, v6, v7
  v_rcp_f32 v6, v6
  v_mov_b32 v80, v16
  v_mov_b32 v81, v17
  v_mov_b32 v82, v18
  v_mov_b32 v83, v19
  v_mov_b32 v100, v28
  v_mov_b32 v101, v29
  v_mov_b32 v102, v30
  v_mov_b32 v103, v31
  v_mov_b32 v104, v32
  v_mov_b32 v105, v33
  v_mov_b32 v106, v34
  v_mov_b32 v107, v35
  v_mul_f32 v36, v36, v6
  v_mul_f32 v37, v37, v6
  v_cvt_pk_bf16_f32 v68, v36, v37
  v_mul_f32 v38, v38, v6
  v_mul_f32 v39, v39, v6
  v_cvt_pk_bf16_f32 v69, v38, v39
  v_mul_f32 v40, v40, v6
  v_mul_f32 v41, v41, v6
  v_cvt_pk_bf16_f32 v70, v40, v41
  v_mul_f32 v42, v42, v6
  v_mul_f32 v43, v43, v6
  v_cvt_pk_bf16_f32 v71, v42, v43
  v_mul_f32 v44, v44, v6
  v_mul_f32 v45, v45, v6
  v_cvt_pk_bf16_f32 v72, v44, v45
  v_mul_f32 v46, v46, v6
  v_mul_f32 v47, v47, v6
  v_cvt_pk_bf16_f32 v73, v46, v47
  s_cmp_lg_u32 s49, 0
  s_cbranch_scc1 L_bq_top
  buffer_store_dwordx4 v[68:71], v1, s[4:7], s57 offen offset:0 sc1
  buffer_store_dwordx2 v[72:73], v8, s[4:7], s58 offen offset:0 sc1
  s_mov_b32 s47, s64
  s_cmp_eq_u32 s42, s80
  s_cbranch_scc1 L_bq_fin
  s_waitcnt vmcnt(2)
  s_barrier
  ds_read_b32 v5, v171
  s_waitcnt lgkmcnt(0)
  v_cmp_ge_i32 vcc, s46, v5
  s_cmp_eq_u32 s45, 0
  s_cselect_b32 s51, vcc_lo, vcc_hi
  s_cmp_lg_u32 s51, 0
  s_cbranch_scc1 L_bq_drain
  s_add_u32 m0, s50, 0
  s_add_u32 s51, s47, 0
  buffer_load_dwordx4 v1, s[4:7], s51 offen sc1 lds
  s_add_u32 m0, s50, 4096
  s_add_u32 s51, s47, 4096
  buffer_load_dwordx4 v1, s[4:7], s51 offen sc1 lds
  s_add_u32 m0, s50, 8192
  s_add_u32 s51, s47, 8192
  buffer_load_dwordx4 v1, s[4:7], s51 offen sc1 lds
  s_add_u32 m0, s50, 12288
  s_add_u32 s51, s47, 12288
  buffer_load_dwordx4 v1, s[4:7], s51 offen sc1 lds
  s_add_u32 m0, s50, 16384
  s_add_u32 s51, s47, 16384
  buffer_load_dwordx4 v1, s[4:7], s51 offen sc1 lds
  s_add_u32 m0, s50, 20480
  s_add_u32 s51, s47, 20480
  buffer_load_dwordx4 v1, s[4:7], s51 offen sc1 lds
  s_add_u32 m0, s50, 24576
  s_add_u32 s51, s47, 24576
  buffer_load_dwordx4 v1, s[4:7], s51 offen sc1 lds
  s_add_u32 m0, s50, 28672
  s_add_u32 s51, s47, 28672
  buffer_load_dwordx4 v1, s[4:7], s51 offen sc1 lds
  s_add_u32 m0, s50, 32768
  s_add_u32 s51, s47, 32768
  buffer_load_dwordx4 v1, s[4:7], s51 offen sc1 lds
  s_add_u32 m0, s50, 36864
  s_add_u32 s51, s47, 36864
  buffer_load_dwordx4 v1, s[4:7], s51 offen sc1 lds
  s_add_u32 m0, s50, 40960
  s_add_u32 s51, s47, 40960
  buffer_load_dwordx4 v9, s[4:7], s51 offen sc1 lds
  s_waitcnt vmcnt(11)
  s_barrier
  v_mov_b32 v7, s62
  buffer_store_dword v7, v0, s[4:7], s61 offen offset:0 sc1
  buffer_store_dword v7, v0, s[4:7], s61 offen offset:128
  s_mov_b32 s57, 0x20000000
  s_mov_b32 s58, 0x20000000
  s_mov_b32 s59, 0x20000000
  s_mov_b32 s60, 0x20000000
  s_mov_b32 s61, 0x20000000
  s_waitcnt vmcnt(9)
  s_branch L_bq_top2
L_bq_drain:
  s_waitcnt vmcnt(0)
  s_barrier
  v_mov_b32 v7, s62
  buffer_store_dword v7, v0, s[4:7], s61 offen offset:0 sc1
  buffer_store_dword v7, v0, s[4:7], s61 offen offset:128
  s_mov_b32 s57, 0x20000000
  s_mov_b32 s58, 0x20000000
  s_mov_b32 s59, 0x20000000
  s_mov_b32 s60, 0x20000000
  s_mov_b32 s61, 0x20000000
L_bq_spin:
  s_sleep 1
  s_xor_b32 s95, s95, 1024
  s_mov_b32 m0, s95
  v_xor_b32 v171, 1024, v171
  buffer_load_dword v4, s[4:7], s48 offen sc1 lds
  s_add_u32 s94, s94, 1
  s_cmp_lt_u32 s94, 100000
  s_cselect_b32 s52, s46, -2
  s_waitcnt vmcnt(0)
  s_barrier
  ds_read_b32 v5, v171
  s_waitcnt lgkmcnt(0)
  v_cmp_ge_i32 vcc, s52, v5
  s_cmp_eq_u32 s45, 0
  s_cselect_b32 s51, vcc_lo, vcc_hi
  s_cmp_lg_u32 s51, 0
  s_cbranch_scc1 L_bq_spin
  s_add_u32 m0, s50, 0
  s_add_u32 s51, s47, 0
  buffer_load_dwordx4 v1, s[4:7], s51 offen sc1 lds
  s_add_u32 m0, s50, 4096
  s_add_u32 s51, s47, 4096
  buffer_load_dwordx4 v1, s[4:7], s51 offen sc1 lds
  s_add_u32 m0, s50, 8192
  s_add_u32 s51, s47, 8192
  buffer_load_dwordx4 v1, s[4:7], s51 offen sc1 lds
  s_add_u32 m0, s50, 12288
  s_add_u32 s51, s47, 12288
  buffer_load_dwordx4 v1, s[4:7], s51 offen sc1 lds
  s_add_u32 m0, s50, 16384
  s_add_u32 s51, s47, 16384
  buffer_load_dwordx4 v1, s[4:7], s51 offen sc1 lds
  s_add_u32 m0, s50, 20480
  s_add_u32 s51, s47, 20480
  buffer_load_dwordx4 v1, s[4:7], s51 offen sc1 lds
  s_add_u32 m0, s50, 24576
  s_add_u32 s51, s47, 24576
  buffer_load_dwordx4 v1, s[4:7], s51 offen sc1 lds
  s_add_u32 m0, s50, 28672
  s_add_u32 s51, s47, 28672
  buffer_load_dwordx4 v1, s[4:7], s51 offen sc1 lds
  s_add_u32 m0, s50, 32768
  s_add_u32 s51, s47, 32768
  buffer_load_dwordx4 v1, s[4:7], s51 offen sc1 lds
  s_add_u32 m0, s50, 36864
  s_add_u32 s51, s47, 36864
  buffer_load_dwordx4 v1, s[4:7], s51 offen sc1 lds
  s_add_u32 m0, s50, 40960
  s_add_u32 s51, s47, 40960
  buffer_load_dwordx4 v9, s[4:7], s51 offen sc1 lds
  s_waitcnt vmcnt(7)
  s_branch L_bq_top2
L_bq_fin:
  s_waitcnt vmcnt(0)
  s_barrier
  v_mov_b32 v7, s62
  buffer_store_dword v7, v0, s[4:7], s61 offen offset:0 sc1
  buffer_store_dword v7, v0, s[4:7], s61 offen offset:128
  s_endpgm
L_role_bo:
  s_cmp_lg_u32 s12, 0
  s_cbranch_scc1 L_hold_357
  v_mov_b32 v6, 8
L_rdy_359:
  global_load_dword v7, v6, s[38:39] sc1
  s_waitcnt vmcnt(0)
  v_readfirstlane_b32 s15, v7
  s_and_b32 s3, s15, 0xffff
  s_cmp_ge_u32 s3, 48
  s_cbranch_scc1 L_rdyd_360
  s_sleep 32
  s_add_u32 s14, s14, 1
  s_cmp_lt_u32 s14, 100000
  s_cbranch_scc1 L_rdy_359
L_rdyd_360:
L_hold_358:
  s_sleep 16
  buffer_load_dword v6, off, s[4:7], 0 offset:0 sc1
  s_add_u32 s14, s14, 1
  s_waitcnt vmcnt(0)
  v_readfirstlane_b32 s3, v6
  s_cmp_ge_u32 s14, 100000
  s_cbranch_scc1 L_hold_357
  s_cmp_lt_i32 s3, 10
  s_cbranch_scc1 L_hold_358
L_hold_357:
  s_barrier
  v_lshlrev_b32 v1, 4, v0
  v_lshrrev_b32 v84, 4, v0
  v_mul_u32_u24 v84, 1024, v84
  v_add_u32 v84, v84, v1
  v_mov_b32 v6, 0x3010200
  v_mov_b32 v7, 0x7050604
  v_and_b32 v85, 16, v0
  v_cmp_eq_u32 vcc, 0, v85
  s_nop 1
  v_cndmask_b32 v6, v7, v6, vcc
  v_and_b32 v7, 3, v0
  v_lshlrev_b32 v7, 3, v7
  v_bfe_u32 v6, v6, v7, 8
  v_lshrrev_b32 v7, 5, v0
  v_mul_u32_u24 v7, 8, v7
  v_bfe_u32 v85, v0, 2, 2
  v_add_u32 v85, v85, v7
  v_mul_u32_u24 v85, 256, v85
  v_lshl_add_u32 v85, v6, 3, v85
  v_mov_b32 v6, 0x3010200
  v_mov_b32 v7, 0x7050604
  v_and_b32 v86, 16, v0
  v_cmp_eq_u32 vcc, 0, v86
  s_nop 1
  v_cndmask_b32 v6, v7, v6, vcc
  v_and_b32 v7, 3, v0
  v_lshlrev_b32 v7, 3, v7
  v_bfe_u32 v6, v6, v7, 8
  v_lshrrev_b32 v7, 5, v0
  v_mul_u32_u24 v7, 40, v7
  v_bfe_u32 v86, v0, 2, 2
  v_add_u32 v86, v86, v7
  v_mul_u32_u24 v86, 256, v86
  v_lshl_add_u32 v86, v6, 3, v86
  s_lshl_b32 s51, s12, 6
  v_add_u32 v85, s51, v85
  v_add_u32 v86, s51, v86
  s_lshl_b32 s70, s101, 8
  s_mov_b32 s8, s34
  s_mov_b32 s9, s35
  s_mov_b32 s10, 819200
  s_mov_b32 s11, 0x20000
  s_mul_i32 s51, s12, 25600
  s_add_u32 s70, s70, s51
  s_mul_i32 s52, s12, 5120
  s_add_u32 m0, s52, 0
  s_add_u32 s51, s70, 0
  buffer_load_dwordx4 v84, s[8:11], s51 offen  lds
  s_add_u32 m0, s52, 1024
  s_add_u32 s51, s70, 5120
  buffer_load_dwordx4 v84, s[8:11], s51 offen  lds
  s_add_u32 m0, s52, 2048
  s_add_u32 s51, s70, 10240
  buffer_load_dwordx4 v84, s[8:11], s51 offen  lds
  s_add_u32 m0, s52, 3072
  s_add_u32 s51, s70, 15360
  buffer_load_dwordx4 v84, s[8:11], s51 offen  lds
  s_add_u32 m0, s52, 4096
  s_add_u32 s51, s70, 20480
  buffer_load_dwordx4 v84, s[8:11], s51 offen  lds
  s_add_u32 m0, s52, 20480
  s_add_u32 s51, s70, 102400
  buffer_load_dwordx4 v84, s[8:11], s51 offen  lds
  s_add_u32 m0, s52, 21504
  s_add_u32 s51, s70, 107520
  buffer_load_dwordx4 v84, s[8:11], s51 offen  lds
  s_add_u32 m0, s52, 22528
  s_add_u32 s51, s70, 112640
  buffer_load_dwordx4 v84, s[8:11], s51 offen  lds
  s_add_u32 m0, s52, 23552
  s_add_u32 s51, s70, 117760
  buffer_load_dwordx4 v84, s[8:11], s51 offen  lds
  s_add_u32 m0, s52, 24576
  s_add_u32 s51, s70, 122880
  buffer_load_dwordx4 v84, s[8:11], s51 offen  lds
  s_add_u32 m0, s52, 40960
  s_add_u32 s51, s70, 204800
  buffer_load_dwordx4 v84, s[8:11], s51 offen  lds
  s_add_u32 m0, s52, 41984
  s_add_u32 s51, s70, 209920
  buffer_load_dwordx4 v84, s[8:11], s51 offen  lds
  s_add_u32 m0, s52, 43008
  s_add_u32 s51, s70, 215040
  buffer_load_dwordx4 v84, s[8:11], s51 offen  lds
  s_add_u32 m0, s52, 44032
  s_add_u32 s51, s70, 220160
  buffer_load_dwordx4 v84, s[8:11], s51 offen  lds
  s_add_u32 m0, s52, 45056
  s_add_u32 s51, s70, 225280
  buffer_load_dwordx4 v84, s[8:11], s51 offen  lds
  s_add_u32 m0, s52, 61440
  s_add_u32 s51, s70, 307200
  buffer_load_dwordx4 v84, s[8:11], s51 offen  lds
  s_add_u32 m0, s52, 62464
  s_add_u32 s51, s70, 312320
  buffer_load_dwordx4 v84, s[8:11], s51 offen  lds
  s_add_u32 m0, s52, 63488
  s_add_u32 s51, s70, 317440
  buffer_load_dwordx4 v84, s[8:11], s51 offen  lds
  s_add_u32 m0, s52, 64512
  s_add_u32 s51, s70, 322560
  buffer_load_dwordx4 v84, s[8:11], s51 offen  lds
  s_add_u32 m0, s52, 65536
  s_add_u32 s51, s70, 327680
  buffer_load_dwordx4 v84, s[8:11], s51 offen  lds
  s_add_u32 m0, s52, 81920
  s_add_u32 s51, s70, 409600
  buffer_load_dwordx4 v84, s[8:11], s51 offen  lds
  s_add_u32 m0, s52, 82944
  s_add_u32 s51, s70, 414720
  buffer_load_dwordx4 v84, s[8:11], s51 offen  lds
  s_add_u32 m0, s52, 83968
  s_add_u32 s51, s70, 419840
  buffer_load_dwordx4 v84, s[8:11], s51 offen  lds
  s_add_u32 m0, s52, 84992
  s_add_u32 s51, s70, 424960
  buffer_load_dwordx4 v84, s[8:11], s51 offen  lds
  s_add_u32 m0, s52, 86016
  s_add_u32 s51, s70, 430080
  buffer_load_dwordx4 v84, s[8:11], s51 offen  lds
  s_add_u32 m0, s52, 102400
  s_add_u32 s51, s70, 512000
  buffer_load_dwordx4 v84, s[8:11], s51 offen  lds
  s_add_u32 m0, s52, 103424
  s_add_u32 s51, s70, 517120
  buffer_load_dwordx4 v84, s[8:11], s51 offen  lds
  s_add_u32 m0, s52, 104448
  s_add_u32 s51, s70, 522240
  buffer_load_dwordx4 v84, s[8:11], s51 offen  lds
  s_add_u32 m0, s52, 105472
  s_add_u32 s51, s70, 527360
  buffer_load_dwordx4 v84, s[8:11], s51 offen  lds
  s_add_u32 m0, s52, 106496
  s_add_u32 s51, s70, 532480
  buffer_load_dwordx4 v84, s[8:11], s51 offen  lds
  s_waitcnt vmcnt(25) lgkmcnt(0)
  s_barrier
  s_add_u32 m0, s52, 122880
  s_add_u32 s51, s70, 614400
  buffer_load_dwordx4 v84, s[8:11], s51 offen  lds
  s_add_u32 m0, s52, 123904
  s_add_u32 s51, s70, 619520
  buffer_load_dwordx4 v84, s[8:11], s51 offen  lds
  s_add_u32 m0, s52, 124928
  s_add_u32 s51, s70, 624640
  buffer_load_dwordx4 v84, s[8:11], s51 offen  lds
  s_add_u32 m0, s52, 125952
  s_add_u32 s51, s70, 629760
  buffer_load_dwordx4 v84, s[8:11], s51 offen  lds
  s_add_u32 m0, s52, 126976
  s_add_u32 s51, s70, 634880
  buffer_load_dwordx4 v84, s[8:11], s51 offen  lds
  v_add_u32 v87, 0, v85
  v_add_u32 v88, 0, v86
  ds_read_b64_tr_b16 a[0:1], v87 offset:0
  ds_read_b64_tr_b16 a[4:5], v87 offset:5120
  ds_read_b64_tr_b16 a[8:9], v87 offset:10240
  ds_read_b64_tr_b16 a[12:13], v87 offset:15360
  ds_read_b64_tr_b16 a[128:129], v88 offset:4096
  ds_read_b64_tr_b16 a[2:3], v87 offset:1024
  ds_read_b64_tr_b16 a[6:7], v87 offset:6144
  ds_read_b64_tr_b16 a[10:11], v87 offset:11264
  ds_read_b64_tr_b16 a[14:15], v87 offset:16384
  ds_read_b64_tr_b16 a[130:131], v88 offset:9216
  s_waitcnt vmcnt(25) lgkmcnt(0)
  s_barrier
  s_add_u32 m0, s52, 0
  s_add_u32 s51, s70, 716800
  buffer_load_dwordx4 v84, s[8:11], s51 offen  lds
  s_add_u32 m0, s52, 1024
  s_add_u32 s51, s70, 721920
  buffer_load_dwordx4 v84, s[8:11], s51 offen  lds
  s_add_u32 m0, s52, 2048
  s_add_u32 s51, s70, 727040
  buffer_load_dwordx4 v84, s[8:11], s51 offen  lds
  s_add_u32 m0, s52, 3072
  s_add_u32 s51, s70, 732160
  buffer_load_dwordx4 v84, s[8:11], s51 offen  lds
  s_add_u32 m0, s52, 4096
  s_add_u32 s51, s70, 737280
  buffer_load_dwordx4 v84, s[8:11], s51 offen  lds
  v_add_u32 v87, 20480, v85
  v_add_u32 v88, 20480, v86
  ds_read_b64_tr_b16 a[16:17], v87 offset:0
  ds_read_b64_tr_b16 a[20:21], v87 offset:5120
  ds_read_b64_tr_b16 a[24:25], v87 offset:10240
  ds_read_b64_tr_b16 a[28:29], v87 offset:15360
  ds_read_b64_tr_b16 a[132:133], v88 offset:4096
  ds_read_b64_tr_b16 a[18:19], v87 offset:1024
  ds_read_b64_tr_b16 a[22:23], v87 offset:6144
  ds_read_b64_tr_b16 a[26:27], v87 offset:11264
  ds_read_b64_tr_b16 a[30:31], v87 offset:16384
  ds_read_b64_tr_b16 a[134:135], v88 offset:9216
  s_waitcnt vmcnt(25) lgkmcnt(0)
  s_barrier
  v_add_u32 v87, 40960, v85
  v_add_u32 v88, 40960, v86
  ds_read_b64_tr_b16 a[32:33], v87 offset:0
  ds_read_b64_tr_b16 a[36:37], v87 offset:5120
  ds_read_b64_tr_b16 a[40:41], v87 offset:10240
  ds_read_b64_tr_b16 a[44:45], v87 offset:15360
  ds_read_b64_tr_b16 a[136:137], v88 offset:4096
  ds_read_b64_tr_b16 a[34:35], v87 offset:1024
  ds_read_b64_tr_b16 a[38:39], v87 offset:6144
  ds_read_b64_tr_b16 a[42:43], v87 offset:11264
  ds_read_b64_tr_b16 a[46:47], v87 offset:16384
  ds_read_b64_tr_b16 a[138:139], v88 offset:9216
  s_waitcnt vmcnt(20) lgkmcnt(0)
  s_barrier
  v_add_u32 v87, 61440, v85
  v_add_u32 v88, 61440, v86
  ds_read_b64_tr_b16 a[48:49], v87 offset:0
  ds_read_b64_tr_b16 a[52:53], v87 offset:5120
  ds_read_b64_tr_b16 a[56:57], v87 offset:10240
  ds_read_b64_tr_b16 a[60:61], v87 offset:15360
  ds_read_b64_tr_b16 a[140:141], v88 offset:4096
  ds_read_b64_tr_b16 a[50:51], v87 offset:1024
  ds_read_b64_tr_b16 a[54:55], v87 offset:6144
  ds_read_b64_tr_b16 a[58:59], v87 offset:11264
  ds_read_b64_tr_b16 a[62:63], v87 offset:16384
  ds_read_b64_tr_b16 a[142:143], v88 offset:9216
  s_waitcnt vmcnt(15) lgkmcnt(0)
  s_barrier
  v_add_u32 v87, 81920, v85
  v_add_u32 v88, 81920, v86
  ds_read_b64_tr_b16 a[64:65], v87 offset:0
  ds_read_b64_tr_b16 a[68:69], v87 offset:5120
  ds_read_b64_tr_b16 a[72:73], v87 offset:10240
  ds_read_b64_tr_b16 a[76:77], v87 offset:15360
  ds_read_b64_tr_b16 a[144:145], v88 offset:4096
  ds_read_b64_tr_b16 a[66:67], v87 offset:1024
  ds_read_b64_tr_b16 a[70:71], v87 offset:6144
  ds_read_b64_tr_b16 a[74:75], v87 offset:11264
  ds_read_b64_tr_b16 a[78:79], v87 offset:16384
  ds_read_b64_tr_b16 a[146:147], v88 offset:9216
  s_waitcnt vmcnt(10) lgkmcnt(0)
  s_barrier
  s_lshr_b32 s3, s13, 5
  s_mul_i32 s3, s3, 65
  s_and_b32 s3, s3, 0xc4
  v_mov_b32 v5, s3
  v_writelane_b32 v5, 8, 0
  v_writelane_b32 v5, 12, 2
  global_load_dword v5, v5, s[38:39] sc1
  v_add_u32 v87, 102400, v85
  v_add_u32 v88, 102400, v86
  ds_read_b64_tr_b16 a[80:81], v87 offset:0
  ds_read_b64_tr_b16 a[84:85], v87 offset:5120
  ds_read_b64_tr_b16 a[88:89], v87 offset:10240
  ds_read_b64_tr_b16 a[92:93], v87 offset:15360
  ds_read_b64_tr_b16 a[148:149], v88 offset:4096
  ds_read_b64_tr_b16 a[82:83], v87 offset:1024
  ds_read_b64_tr_b16 a[86:87], v87 offset:6144
  ds_read_b64_tr_b16 a[90:91], v87 offset:11264
  ds_read_b64_tr_b16 a[94:95], v87 offset:16384
  ds_read_b64_tr_b16 a[150:151], v88 offset:9216
  s_waitcnt vmcnt(5) lgkmcnt(0)
  s_barrier
  v_add_u32 v87, 122880, v85
  v_add_u32 v88, 122880, v86
  ds_read_b64_tr_b16 a[96:97], v87 offset:0
  ds_read_b64_tr_b16 a[100:101], v87 offset:5120
  ds_read_b64_tr_b16 a[104:105], v87 offset:10240
  ds_read_b64_tr_b16 a[108:109], v87 offset:15360
  ds_read_b64_tr_b16 a[152:153], v88 offset:4096
  ds_read_b64_tr_b16 a[98:99], v87 offset:1024
  ds_read_b64_tr_b16 a[102:103], v87 offset:6144
  ds_read_b64_tr_b16 a[106:107], v87 offset:11264
  ds_read_b64_tr_b16 a[110:111], v87 offset:16384
  ds_read_b64_tr_b16 a[154:155], v88 offset:9216
  s_waitcnt vmcnt(0) lgkmcnt(0)
  s_barrier
  v_add_u32 v87, 0, v85
  v_add_u32 v88, 0, v86
  ds_read_b64_tr_b16 a[112:113], v87 offset:0
  ds_read_b64_tr_b16 a[116:117], v87 offset:5120
  ds_read_b64_tr_b16 a[120:121], v87 offset:10240
  ds_read_b64_tr_b16 a[124:125], v87 offset:15360
  ds_read_b64_tr_b16 a[156:157], v88 offset:4096
  ds_read_b64_tr_b16 a[114:115], v87 offset:1024
  ds_read_b64_tr_b16 a[118:119], v87 offset:6144
  ds_read_b64_tr_b16 a[122:123], v87 offset:11264
  ds_read_b64_tr_b16 a[126:127], v87 offset:16384
  ds_read_b64_tr_b16 a[158:159], v88 offset:9216
  s_waitcnt lgkmcnt(0)
  v_readlane_b32 s92, v5, 0
  v_readlane_b32 s93, v5, 1
  v_readlane_b32 s2, v5, 2
  s_waitcnt lgkmcnt(0)
  s_barrier
  v_lshlrev_b32 v10, 3, v0
  v_mov_b32 v2, v1
  v_add_u32 v3, 0x10000, v1
  v_and_b32 v4, 31, v0
  v_min_u32 v4, 7, v4
  v_lshlrev_b32 v4, 8, v4
  v_and_b32 v6, 1, v0
  v_lshlrev_b32 v6, 4, v6
  v_mov_b32 v7, 0x3f80
  v_lshlrev_b32 v7, v6, v7
  v_bfe_u32 v6, v0, 4, 1
  v_cmp_eq_u32 vcc, 0, v6
  s_nop 1
  v_cndmask_b32 v7, 0, v7, vcc
  v_bfe_u32 v6, v0, 2, 1
  v_lshrrev_b32 v84, 5, v0
  v_cmp_eq_u32 vcc, v6, v84
  s_nop 1
  v_cndmask_b32 v7, 0, v7, vcc
  v_bfe_u32 v6, v0, 3, 1
  v_bfe_u32 v84, v0, 1, 1
  v_lshl_add_u32 v6, v6, 1, v84
  v_cmp_eq_u32 vcc, 0, v6
  s_nop 1
  v_cndmask_b32 v84, 0, v7, vcc
  v_cmp_eq_u32 vcc, 1, v6
  s_nop 1
  v_cndmask_b32 v85, 0, v7, vcc
  v_cmp_eq_u32 vcc, 2, v6
  s_nop 1
  v_cndmask_b32 v86, 0, v7, vcc
  v_cmp_eq_u32 vcc, 3, v6
  s_nop 1
  v_cndmask_b32 v87, 0, v7, vcc
  v_and_b32 v6, 1, v0
  v_lshlrev_b32 v6, 4, v6
  v_mov_b32 v7, 0x3f80
  v_lshlrev_b32 v7, v6, v7
  v_bfe_u32 v6, v0, 4, 1
  v_cmp_eq_u32 vcc, 1, v6
  s_nop 1
  v_cndmask_b32 v7, 0, v7, vcc
  v_bfe_u32 v6, v0, 2, 1
  v_lshrrev_b32 v88, 5, v0
  v_cmp_eq_u32 vcc, v6, v88
  s_nop 1
  v_cndmask_b32 v7, 0, v7, vcc
  v_bfe_u32 v6, v0, 3, 1
  v_bfe_u32 v88, v0, 1, 1
  v_lshl_add_u32 v6, v6, 1, v88
  v_cmp_eq_u32 vcc, 0, v6
  s_nop 1
  v_cndmask_b32 v88, 0, v7, vcc
  v_cmp_eq_u32 vcc, 1, v6
  s_nop 1
  v_cndmask_b32 v89, 0, v7, vcc
  v_cmp_eq_u32 vcc, 2, v6
  s_nop 1
  v_cndmask_b32 v90, 0, v7, vcc
  v_cmp_eq_u32 vcc, 3, v6
  s_nop 1
  v_cndmask_b32 v91, 0, v7, vcc
  v_and_b32 v148, 0xf0, v1
  v_bfe_u32 v6, v0, 4, 1
  v_lshl_add_u32 v148, v6, 3, v148
  v_lshrrev_b32 v6, 5, v0
  v_lshl_add_u32 v148, v6, 8, v148
  s_lshl_b32 s51, s12, 9
  s_add_u32 s51, s51, 151552
  v_add_u32 v148, s51, v148
  v_lshlrev_b32 v150, 2, v0
  v_add_u32 v149, 151552, v150
  s_cmp_eq_u32 s12, 0
  s_cselect_b32 s51, 0, 0x20000000
  v_add_u32 v150, s51, v150
  v_and_b32 v9, 31, v0
  v_mul_u32_u24 v9, 1280, v9
  v_lshrrev_b32 v6, 5, v0
  v_lshl_add_u32 v9, v6, 4, v9
  v_and_b32 v3, 0xf8, v10
  v_lshrrev_b32 v6, 5, v0
  v_lshl_add_u32 v3, v6, 9, v3
  v_add_u32 v3, 0x8000, v3
  s_mov_b32 s69, 0
  s_mul_i32 s51, s101, 4
  s_add_u32 s69, s69, s51
  s_add_u32 s69, s69, s12
  s_mov_b32 s8, s36
  s_mov_b32 s9, s37
  s_mov_b32 s10, 2621440
  s_mov_b32 s11, 0x20000
  s_mov_b32 s15, s93
  s_and_b32 s3, s92, 0xffff
  s_cmp_lt_u32 s3, 48
  s_cbranch_scc1 L_rslow_361
  s_and_b32 s3, s15, 0xffff
  s_cmp_ge_u32 s3, 32
  s_cbranch_scc1 L_rfast_362
L_rslow_361:
  v_mov_b32 v6, 8
L_rdy_363:
  global_load_dword v7, v6, s[38:39] sc1
  s_waitcnt vmcnt(0)
  v_readfirstlane_b32 s15, v7
  s_and_b32 s3, s15, 0xffff
  s_cmp_ge_u32 s3, 48
  s_cbranch_scc1 L_rdyd_364
  s_sleep 8
  s_add_u32 s14, s14, 1
  s_cmp_lt_u32 s14, 100000
  s_cbranch_scc1 L_rdy_363
L_rdyd_364:
  v_mov_b32 v6, 12
  global_load_dword v6, v6, s[38:39] sc1
  s_waitcnt vmcnt(0)
  v_readfirstlane_b32 s2, v6
  s_lshr_b32 s15, s13, 5
  s_mul_i32 s3, s15, 65
  s_and_b32 s3, s3, 0xc4
  v_mov_b32 v6, s3
L_rdy_365:
  global_load_dword v7, v6, s[38:39] sc1
  s_waitcnt vmcnt(0)
  v_readfirstlane_b32 s15, v7
  s_and_b32 s3, s15, 0xffff
  s_cmp_ge_u32 s3, 32
  s_cbranch_scc1 L_rdyd_366
  s_sleep 8
  s_add_u32 s14, s14, 1
  s_cmp_lt_u32 s14, 100000
  s_cbranch_scc1 L_rdy_365
L_rdyd_366:
L_rfast_362:
  s_lshr_b32 s15, s15, 16
  s_and_b32 s2, s2, 3
  s_mul_i32 s2, s2, 0x2001
  s_xor_b32 s2, s2, 0x2000
  s_lshr_b32 s51, s13, 5
  s_mov_b64 vcc, 0
  s_cmp_eq_u32 s51, 4
  s_cselect_b32 vcc_lo, 0xffffffff, vcc_lo
  s_cselect_b32 vcc_hi, 0x3, vcc_hi
  s_cmp_eq_u32 s51, 5
  s_cselect_b32 vcc_lo, 0x0, vcc_lo
  s_cselect_b32 vcc_hi, 0xc, vcc_hi
  s_cmp_eq_u32 s51, 6
  s_cselect_b32 vcc_lo, 0x0, vcc_lo
  s_cselect_b32 vcc_hi, 0x30, vcc_hi
  s_cmp_eq_u32 s51, 7
  s_cselect_b32 vcc_lo, 0x0, vcc_lo
  s_cselect_b32 vcc_hi, 0xffffffc0, vcc_hi
  s_cmp_eq_u32 s15, 0
  s_cselect_b32 s51, 128, 0
  v_mov_b32 v6, s51
  v_cndmask_b32 v6, 0, v6, vcc
  v_add_u32 v4, v4, v6
  v_lshrrev_b32 v6, 5, v0
  v_mul_u32_u24 v6, 2048, v6
  v_add_u32 v4, v4, v6
  s_mov_b32 s45, 0
  v_lshlrev_b32 v171, 2, v0
  v_add_u32 v171, 155648, v171
  s_lshl_b32 s95, s12, 8
  s_add_u32 s95, s95, 155648
  v_or_b32 v0, s12, v0
  v_lshlrev_b32 v0, 24, v0
  v_min_u32 v0, 0x1000000, v0
  v_lshlrev_b32 v0, 4, v0
  s_lshl_b32 s63, s12, 10
  s_mov_b32 s50, s63
  s_mov_b32 s42, -2
  s_mov_b32 s62, 0
  s_mov_b32 s48, 105984
  s_cmp_eq_u32 s12, 0
  s_cselect_b32 s48, s48, 0x20000000
  s_mov_b32 s56, 40960
  s_mov_b32 s55, 40960
  s_mov_b32 s86, 0x55554000
  s_mov_b32 s87, 0x55555555
  s_mov_b32 s88, 0x55555555
  s_mov_b32 s89, 0xfffd5555
  s_mov_b64 s[90:91], 0
  s_mov_b32 s80, 127
  s_cmp_eq_u32 s42, 62
  s_cselect_b64 s[86:87], s[88:89], s[86:87]
  s_and_b32 s83, s86, 1
  s_cselect_b32 s84, s91, s90
  s_lshr_b64 s[86:87], s[86:87], 1
  s_add_u32 s91, s91, s83
  s_xor_b32 s52, s83, 1
  s_add_u32 s90, s90, s52
  s_mov_b32 s85, 258998272
  s_mul_i32 s52, s83, 2621440
  s_add_u32 s85, s85, s52
  s_mul_i32 s52, s84, 40960
  s_add_u32 s85, s85, s52
  s_add_u32 s85, s85, s63
  s_mov_b32 s43, s45
  s_mov_b32 s44, s46
  s_mov_b32 s46, s84
  s_mov_b32 s45, s83
  s_mov_b32 s64, s85
  s_add_u32 s42, s42, 1
  s_cmp_eq_u32 s42, 62
  s_cselect_b64 s[86:87], s[88:89], s[86:87]
  s_and_b32 s83, s86, 1
  s_cselect_b32 s84, s91, s90
  s_lshr_b64 s[86:87], s[86:87], 1
  s_add_u32 s91, s91, s83
  s_xor_b32 s52, s83, 1
  s_add_u32 s90, s90, s52
  s_mov_b32 s85, 258998272
  s_mul_i32 s52, s83, 2621440
  s_add_u32 s85, s85, s52
  s_mul_i32 s52, s84, 40960
  s_add_u32 s85, s85, s52
  s_add_u32 s85, s85, s63
  s_mov_b32 s57, 0x20000000
  s_mov_b32 s58, 0x20000000
  s_mov_b32 s59, 0x20000000
  s_mov_b32 s60, 0x20000000
  s_mov_b32 s61, 0x20000000
  s_mov_b32 s47, s64
  s_mov_b32 s49, 0
  s_mov_b32 s94, 0
  s_mov_b32 s71, 0x3f803f80
  s_branch L_bo_spin
L_bo_top:
  s_waitcnt vmcnt(7)
  s_barrier
  ds_read_b128 v[12:15], v2 offset:0
  ds_read_b128 v[16:19], v2 offset:1024
  ds_read_b128 v[20:23], v2 offset:2048
  ds_read_b128 v[24:27], v2 offset:3072
  ds_read_b128 v[28:31], v2 offset:4096
  ds_read_b32 v5, v171
  v_cvt_pk_bf16_f32 v68, v36, v37
  v_cvt_pk_bf16_f32 v69, v38, v39
  v_cvt_pk_bf16_f32 v70, v40, v41
  v_cvt_pk_bf16_f32 v71, v42, v43
  v_cvt_pk_bf16_f32 v72, v44, v45
  v_cvt_pk_bf16_f32 v73, v46, v47
  v_cvt_pk_bf16_f32 v74, v48, v49
  v_cvt_pk_bf16_f32 v75, v50, v51
  v_dot2_f32_bf16 v78, v68, s71, 0
  v_dot2_f32_bf16 v79, v68, v68, 0
  v_dot2_f32_bf16 v78, v69, s71, v78
  v_dot2_f32_bf16 v79, v69, v69, v79
  v_dot2_f32_bf16 v78, v70, s71, v78
  v_dot2_f32_bf16 v79, v70, v70, v79
  v_dot2_f32_bf16 v78, v71, s71, v78
  v_dot2_f32_bf16 v79, v71, v71, v79
  v_dot2_f32_bf16 v78, v72, s71, v78
  v_dot2_f32_bf16 v79, v72, v72, v79
  v_dot2_f32_bf16 v78, v73, s71, v78
  v_dot2_f32_bf16 v79, v73, v73, v79
  v_dot2_f32_bf16 v78, v74, s71, v78
  v_dot2_f32_bf16 v79, v74, v74, v79
  v_dot2_f32_bf16 v78, v75, s71, v78
  v_dot2_f32_bf16 v79, v75, v75, v79
L_bo_body:
  s_waitcnt lgkmcnt(5)
  v_mfma_f32_32x32x16_bf16 v[36:51], a[0:3], v[12:15], 0
  ds_read_b128 v[32:35], v2 offset:5120
  s_cmp_lg_u32 s43, 0
  s_cbranch_scc1 L_bofin_367
  buffer_store_dwordx4 v[68:71], v1, s[4:7], s57 offen offset:0 sc1
L_bojoin_368:
  s_nop 0
  ds_write_b64 v148, v[78:79]
  s_waitcnt lgkmcnt(6)
  v_mfma_f32_32x32x16_bf16 v[36:51], a[4:7], v[16:19], v[36:51]
  ds_read_b128 v[12:15], v2 offset:6144
  s_waitcnt lgkmcnt(6)
  v_mfma_f32_32x32x16_bf16 v[36:51], a[8:11], v[20:23], v[36:51]
  ds_read_b128 v[16:19], v2 offset:7168
  s_cmp_lg_u32 s43, 0
  s_cbranch_scc1 L_bofin_369
  buffer_store_dwordx4 v[72:75], v1, s[4:7], s57 offen offset:1024 sc1
L_bojoin_370:
  s_waitcnt lgkmcnt(6)
  v_mfma_f32_32x32x16_bf16 v[36:51], a[12:15], v[24:27], v[36:51]
  ds_read_b128 v[20:23], v2 offset:8192
  s_mov_b32 s43, s45
  s_mov_b32 s44, s46
  s_mov_b32 s46, s84
  s_mov_b32 s45, s83
  s_waitcnt lgkmcnt(6)
  v_mfma_f32_32x32x16_bf16 v[36:51], a[16:19], v[28:31], v[36:51]
  ds_read_b128 v[24:27], v2 offset:9216
  s_mov_b32 s64, s85
  s_add_u32 s42, s42, 1
  s_waitcnt lgkmcnt(4)
  s_barrier
  v_mfma_f32_32x32x16_bf16 v[36:51], a[20:23], v[32:35], v[36:51]
  ds_read_b128 v[28:31], v2 offset:10240
  ds_read2st64_b32 v[92:93], v149 offset0:0 offset1:1
  ds_read2st64_b32 v[94:95], v149 offset0:2 offset1:3
  ds_read2st64_b32 v[96:97], v149 offset0:4 offset1:5
  ds_read2st64_b32 v[98:99], v149 offset0:6 offset1:7
  s_waitcnt lgkmcnt(8)
  v_mfma_f32_32x32x16_bf16 v[36:51], a[24:27], v[12:15], v[36:51]
  ds_read_b128 v[32:35], v2 offset:11264
  v_cmp_ge_i32 vcc, s46, v5
  s_mov_b32 s74, 6029312
  s_mul_i32 s52, s43, 5767168
  s_waitcnt lgkmcnt(8)
  v_mfma_f32_32x32x16_bf16 v[36:51], a[28:31], v[16:19], v[36:51]
  ds_read_b128 v[12:15], v2 offset:12288
  s_cmp_eq_u32 s45, 0
  s_cselect_b32 s51, vcc_lo, vcc_hi
  s_cmp_lg_u32 s51, 0
  s_cselect_b32 s49, 0, 1
  s_waitcnt lgkmcnt(8)
  v_mfma_f32_32x32x16_bf16 v[36:51], a[32:35], v[20:23], v[36:51]
  ds_read_b128 v[16:19], v2 offset:13312
  s_waitcnt lgkmcnt(3)
  v_add_f32 v92, v92, v93
  v_add_f32 v92, v92, v94
  v_add_f32 v92, v92, v95
  v_mfma_f32_32x32x16_bf16 v[36:51], a[36:39], v[24:27], v[36:51]
  ds_read_b128 v[20:23], v2 offset:14336
  v_add_f32 v92, v92, v96
  v_add_f32 v92, v92, v97
  v_add_f32 v92, v92, v98
  v_add_f32 v92, v92, v99
  v_mfma_f32_32x32x16_bf16 v[36:51], a[40:43], v[28:31], v[36:51]
  ds_read_b128 v[24:27], v2 offset:15360
  buffer_store_dword v92, v150, s[4:7], s58 offen offset:0 sc1
  s_cmp_lt_u32 s42, s80
  s_cselect_b32 s49, s49, 0
  s_add_u32 s74, s74, s52
  s_waitcnt lgkmcnt(4)
  v_mfma_f32_32x32x16_bf16 v[36:51], a[44:47], v[32:35], v[36:51]
  ds_read_b128 v[28:31], v2 offset:16384
  s_cmp_lg_u32 s49, 0
  s_cselect_b32 s47, s64, 0x20000000
  s_xor_b32 s50, s50, s56
  s_mul_i32 s52, s44, 45056
  s_waitcnt lgkmcnt(4)
  v_mfma_f32_32x32x16_bf16 v[36:51], a[48:51], v[12:15], v[36:51]
  ds_read_b128 v[32:35], v2 offset:17408
  s_add_u32 s74, s74, s52
  s_mul_i32 s52, s69, 2048
  s_add_u32 s74, s74, s52
  buffer_load_dwordx4 v[132:135], v1, s[4:7], s74 offen offset:0 sc1
  s_waitcnt lgkmcnt(4)
  v_mfma_f32_32x32x16_bf16 v[36:51], a[52:55], v[16:19], v[36:51]
  ds_read_b128 v[12:15], v2 offset:18432
  s_waitcnt lgkmcnt(4)
  v_mfma_f32_32x32x16_bf16 v[36:51], a[56:59], v[20:23], v[36:51]
  ds_read_b128 v[16:19], v2 offset:19456
  buffer_load_dwordx4 v[136:139], v1, s[4:7], s74 offen offset:1024 sc1
  s_waitcnt lgkmcnt(4)
  v_mfma_f32_32x32x16_bf16 v[36:51], a[60:63], v[24:27], v[36:51]
  s_waitcnt vmcnt(5)
  s_barrier
  ds_read_b128 v[20:23], v2 offset:20480
  s_cmp_eq_u32 s42, 62
  s_cselect_b64 s[86:87], s[88:89], s[86:87]
  s_waitcnt lgkmcnt(4)
  v_mfma_f32_32x32x16_bf16 v[36:51], a[64:67], v[28:31], v[36:51]
  ds_read_b128 v[24:27], v2 offset:21504
  s_add_u32 m0, s50, 0
  s_add_u32 s51, s47, 0
  buffer_load_dwordx4 v1, s[4:7], s51 offen sc1 lds
  s_waitcnt lgkmcnt(4)
  v_mfma_f32_32x32x16_bf16 v[36:51], a[68:71], v[32:35], v[36:51]
  ds_read_b128 v[28:31], v2 offset:22528
  s_and_b32 s83, s86, 1
  s_cselect_b32 s84, s91, s90
  s_lshr_b64 s[86:87], s[86:87], 1
  s_add_u32 s91, s91, s83
  s_waitcnt lgkmcnt(4)
  v_mfma_f32_32x32x16_bf16 v[36:51], a[72:75], v[12:15], v[36:51]
  ds_read_b128 v[32:35], v2 offset:23552
  s_add_u32 m0, s50, 4096
  s_add_u32 s51, s47, 4096
  buffer_load_dwordx4 v1, s[4:7], s51 offen sc1 lds
  s_xor_b32 s52, s83, 1
  s_waitcnt lgkmcnt(4)
  v_mfma_f32_32x32x16_bf16 v[36:51], a[76:79], v[16:19], v[36:51]
  ds_read_b128 v[12:15], v2 offset:24576
  s_add_u32 s90, s90, s52
  s_mov_b32 s85, 258998272
  s_mul_i32 s52, s83, 2621440
  s_add_u32 s85, s85, s52
  s_waitcnt lgkmcnt(4)
  v_mfma_f32_32x32x16_bf16 v[36:51], a[80:83], v[20:23], v[36:51]
  ds_read_b128 v[16:19], v2 offset:25600
  s_add_u32 m0, s50, 8192
  s_add_u32 s51, s47, 8192
  buffer_load_dwordx4 v1, s[4:7], s51 offen sc1 lds
  s_mul_i32 s52, s84, 40960
  s_waitcnt lgkmcnt(4)
  v_mfma_f32_32x32x16_bf16 v[36:51], a[84:87], v[24:27], v[36:51]
  ds_read_b128 v[20:23], v2 offset:26624
  s_add_u32 s85, s85, s52
  s_add_u32 s85, s85, s63
  s_waitcnt lgkmcnt(4)
  v_mfma_f32_32x32x16_bf16 v[36:51], a[88:91], v[28:31], v[36:51]
  ds_read_b128 v[24:27], v2 offset:27648
  s_add_u32 m0, s50, 12288
  s_add_u32 s51, s47, 12288
  buffer_load_dwordx4 v1, s[4:7], s51 offen sc1 lds
  s_waitcnt lgkmcnt(4)
  v_mfma_f32_32x32x16_bf16 v[36:51], a[92:95], v[32:35], v[36:51]
  ds_read_b128 v[28:31], v2 offset:28672
  s_waitcnt lgkmcnt(4)
  v_mfma_f32_32x32x16_bf16 v[36:51], a[96:99], v[12:15], v[36:51]
  ds_read_b128 v[32:35], v2 offset:29696
  s_add_u32 m0, s50, 16384
  s_add_u32 s51, s47, 16384
  buffer_load_dwordx4 v1, s[4:7], s51 offen sc1 lds
  s_waitcnt lgkmcnt(4)
  v_mfma_f32_32x32x16_bf16 v[36:51], a[100:103], v[16:19], v[36:51]
  ds_read_b128 v[12:15], v2 offset:30720
  s_xor_b32 s95, s95, 1024
  s_mov_b32 m0, s95
  v_xor_b32 v171, 1024, v171
  buffer_load_dword v4, s[4:7], s48 offen sc1 lds
  s_waitcnt lgkmcnt(4)
  v_mfma_f32_32x32x16_bf16 v[36:51], a[104:107], v[20:23], v[36:51]
  ds_read_b128 v[16:19], v2 offset:31744
  s_add_u32 m0, s50, 20480
  s_add_u32 s51, s47, 20480
  buffer_load_dwordx4 v1, s[4:7], s51 offen sc1 lds
  s_waitcnt lgkmcnt(4)
  v_mfma_f32_32x32x16_bf16 v[36:51], a[108:111], v[24:27], v[36:51]
  ds_read_b64 v[20:21], v3 offset:0
  ds_read_b64 v[22:23], v3 offset:256
  s_waitcnt lgkmcnt(5)
  v_mfma_f32_32x32x16_bf16 v[36:51], a[112:115], v[28:31], v[36:51]
  ds_read_b64 v[24:25], v3 offset:1024
  ds_read_b64 v[26:27], v3 offset:1280
  s_add_u32 m0, s50, 24576
  s_add_u32 s51, s47, 24576
  buffer_load_dwordx4 v1, s[4:7], s51 offen sc1 lds
  s_waitcnt lgkmcnt(6)
  v_mfma_f32_32x32x16_bf16 v[36:51], a[116:119], v[32:35], v[36:51]
  ds_read_b64 v[28:29], v3 offset:2048
  ds_read_b64 v[30:31], v3 offset:2304
  s_waitcnt lgkmcnt(7)
  v_mfma_f32_32x32x16_bf16 v[36:51], a[120:123], v[12:15], v[36:51]
  ds_read_b64 v[32:33], v3 offset:3072
  ds_read_b64 v[34:35], v3 offset:3328
  s_add_u32 m0, s50, 28672
  s_add_u32 s51, s47, 28672
  buffer_load_dwordx4 v1, s[4:7], s51 offen sc1 lds
  s_waitcnt lgkmcnt(8)
  v_mfma_f32_32x32x16_bf16 v[36:51], a[124:127], v[16:19], v[36:51]
  ds_read_b64 v[12:13], v3 offset:4096
  ds_read_b64 v[14:15], v3 offset:4352
  s_waitcnt lgkmcnt(8)
  v_mfma_f32_32x32x16_bf16 v[36:51], a[128:131], v[20:23], v[36:51]
  ds_read_b64 v[16:17], v3 offset:5120
  ds_read_b64 v[18:19], v3 offset:5376
  s_add_u32 m0, s50, 32768
  s_add_u32 s51, s47, 32768
  buffer_load_dwordx4 v1, s[4:7], s51 offen sc1 lds
  s_waitcnt lgkmcnt(8)
  v_mfma_f32_32x32x16_bf16 v[36:51], a[132:135], v[24:27], v[36:51]
  ds_read_b64 v[20:21], v3 offset:6144
  ds_read_b64 v[22:23], v3 offset:6400
  s_waitcnt vmcnt(12)
  s_barrier
  v_mov_b32 v7, s62
  buffer_store_dword v7, v0, s[4:7], s61 offen offset:0 sc1
  buffer_store_dword v7, v0, s[4:7], s61 offen offset:128
  s_waitcnt lgkmcnt(8)
  v_mfma_f32_32x32x16_bf16 v[36:51], a[136:139], v[28:31], v[36:51]
  ds_read_b64 v[24:25], v3 offset:7168
  ds_read_b64 v[26:27], v3 offset:7424
  s_add_u32 m0, s50, 36864
  s_add_u32 s51, s47, 36864
  buffer_load_dwordx4 v1, s[4:7], s51 offen sc1 lds
  s_waitcnt lgkmcnt(8)
  v_mfma_f32_32x32x16_bf16 v[36:51], a[140:143], v[32:35], v[36:51]
  v_add_u32 v2, s55, v2
  v_add_u32 v3, s55, v3
  s_sub_u32 s55, 0, s55
  s_add_u32 s57, s74, 2883584
  s_mov_b32 s58, 8953856
  s_waitcnt lgkmcnt(6)
  v_mfma_f32_32x32x16_bf16 v[36:51], a[144:147], v[12:15], v[36:51]
  s_mul_i32 s52, s101, 256
  s_add_u32 s58, s58, s52
  s_mul_i32 s52, s44, 45056
  s_add_u32 s58, s58, s52
  s_mov_b32 s59, 0
  s_waitcnt lgkmcnt(4)
  v_mfma_f32_32x32x16_bf16 v[36:51], a[148:151], v[16:19], v[36:51]
  s_mul_i32 s52, s69, 64
  s_add_u32 s59, s59, s52
  s_mul_i32 s52, s44, 40960
  s_add_u32 s59, s59, s52
  s_mov_b32 s61, 2560
  s_waitcnt lgkmcnt(2)
  v_mfma_f32_32x32x16_bf16 v[36:51], a[152:155], v[20:23], v[36:51]
  s_mul_i32 s52, s101, 256
  s_add_u32 s61, s61, s52
  s_cmp_eq_u32 s43, 0
  s_cselect_b32 s58, s58, 0x20000000
  s_cselect_b32 s61, s61, 0x20000000
  s_waitcnt lgkmcnt(0)
  v_mfma_f32_32x32x16_bf16 v[36:51], a[156:159], v[24:27], v[36:51]
  s_add_u32 s62, s44, 1
  s_waitcnt vmcnt(13)
  v_mfma_f32_32x32x16_bf16 v[36:51], v[84:87], v[132:135], v[36:51]
  v_mfma_f32_32x32x16_bf16 v[36:51], v[88:91], v[136:139], v[36:51]
  s_cmp_lg_u32 s49, 0
  s_nop 1
  s_cbranch_scc1 L_bo_top
  s_xor_b32 s95, s95, 1024
  s_mov_b32 m0, s95
  v_xor_b32 v171, 1024, v171
  buffer_load_dword v4, s[4:7], s48 offen sc1 lds
  s_nop 5
  v_cvt_pk_bf16_f32 v68, v36, v37
  v_cvt_pk_bf16_f32 v69, v38, v39
  v_cvt_pk_bf16_f32 v70, v40, v41
  v_cvt_pk_bf16_f32 v71, v42, v43
  v_cvt_pk_bf16_f32 v72, v44, v45
  v_cvt_pk_bf16_f32 v73, v46, v47
  v_cvt_pk_bf16_f32 v74, v48, v49
  v_cvt_pk_bf16_f32 v75, v50, v51
  s_cmp_lg_u32 s43, 0
  s_cbranch_scc1 L_bofin_371
  buffer_store_dwordx4 v[68:71], v1, s[4:7], s57 offen offset:0 sc1
L_bojoin_372:
  v_dot2_f32_bf16 v78, v68, s71, 0
  v_dot2_f32_bf16 v79, v68, v68, 0
  v_dot2_f32_bf16 v78, v69, s71, v78
  v_dot2_f32_bf16 v79, v69, v69, v79
  v_dot2_f32_bf16 v78, v70, s71, v78
  v_dot2_f32_bf16 v79, v70, v70, v79
  v_dot2_f32_bf16 v78, v71, s71, v78
  v_dot2_f32_bf16 v79, v71, v71, v79
  v_dot2_f32_bf16 v78, v72, s71, v78
  v_dot2_f32_bf16 v79, v72, v72, v79
  v_dot2_f32_bf16 v78, v73, s71, v78
  v_dot2_f32_bf16 v79, v73, v73, v79
  v_dot2_f32_bf16 v78, v74, s71, v78
  v_dot2_f32_bf16 v79, v74, v74, v79
  v_dot2_f32_bf16 v78, v75, s71, v78
  v_dot2_f32_bf16 v79, v75, v75, v79
  s_cmp_lg_u32 s43, 0
  s_cbranch_scc1 L_bofin_373
  buffer_store_dwordx4 v[72:75], v1, s[4:7], s57 offen offset:1024 sc1
L_bojoin_374:
  s_nop 1
  ds_write_b64 v148, v[78:79]
  s_waitcnt lgkmcnt(0)
  s_barrier
  ds_read2st64_b32 v[92:93], v149 offset0:0 offset1:1
  ds_read2st64_b32 v[94:95], v149 offset0:2 offset1:3
  ds_read2st64_b32 v[96:97], v149 offset0:4 offset1:5
  ds_read2st64_b32 v[98:99], v149 offset0:6 offset1:7
  s_waitcnt lgkmcnt(0)
  v_add_f32 v92, v92, v93
  v_add_f32 v92, v92, v94
  v_add_f32 v92, v92, v95
  v_add_f32 v92, v92, v96
  v_add_f32 v92, v92, v97
  v_add_f32 v92, v92, v98
  v_add_f32 v92, v92, v99
  buffer_store_dword v92, v150, s[4:7], s58 offen offset:0 sc1
  s_mov_b32 s47, s64
  s_cmp_eq_u32 s42, s80
  s_cbranch_scc1 L_bo_fin
  s_waitcnt vmcnt(3)
  s_barrier
  ds_read_b32 v5, v171
  s_waitcnt lgkmcnt(0)
  v_cmp_ge_i32 vcc, s46, v5
  s_cmp_eq_u32 s45, 0
  s_cselect_b32 s51, vcc_lo, vcc_hi
  s_cmp_lg_u32 s51, 0
  s_cbranch_scc1 L_bo_drain
  s_add_u32 m0, s50, 0
  s_add_u32 s51, s47, 0
  buffer_load_dwordx4 v1, s[4:7], s51 offen sc1 lds
  s_add_u32 m0, s50, 4096
  s_add_u32 s51, s47, 4096
  buffer_load_dwordx4 v1, s[4:7], s51 offen sc1 lds
  s_add_u32 m0, s50, 8192
  s_add_u32 s51, s47, 8192
  buffer_load_dwordx4 v1, s[4:7], s51 offen sc1 lds
  s_add_u32 m0, s50, 12288
  s_add_u32 s51, s47, 12288
  buffer_load_dwordx4 v1, s[4:7], s51 offen sc1 lds
  s_add_u32 m0, s50, 16384
  s_add_u32 s51, s47, 16384
  buffer_load_dwordx4 v1, s[4:7], s51 offen sc1 lds
  s_add_u32 m0, s50, 20480
  s_add_u32 s51, s47, 20480
  buffer_load_dwordx4 v1, s[4:7], s51 offen sc1 lds
  s_add_u32 m0, s50, 24576
  s_add_u32 s51, s47, 24576
  buffer_load_dwordx4 v1, s[4:7], s51 offen sc1 lds
  s_add_u32 m0, s50, 28672
  s_add_u32 s51, s47, 28672
  buffer_load_dwordx4 v1, s[4:7], s51 offen sc1 lds
  s_add_u32 m0, s50, 32768
  s_add_u32 s51, s47, 32768
  buffer_load_dwordx4 v1, s[4:7], s51 offen sc1 lds
  s_add_u32 m0, s50, 36864
  s_add_u32 s51, s47, 36864
  buffer_load_dwordx4 v1, s[4:7], s51 offen sc1 lds
  s_waitcnt vmcnt(10)
  s_barrier
  v_mov_b32 v7, s62
  buffer_store_dword v7, v0, s[4:7], s61 offen offset:0 sc1
  buffer_store_dword v7, v0, s[4:7], s61 offen offset:128
  s_mov_b32 s57, 0x20000000
  s_mov_b32 s58, 0x20000000
  s_mov_b32 s59, 0x20000000
  s_mov_b32 s60, 0x20000000
  s_mov_b32 s61, 0x20000000
  s_waitcnt vmcnt(7)
  s_branch L_bo_entry
L_bo_drain:
  s_waitcnt vmcnt(0)
  s_barrier
  v_mov_b32 v7, s62
  buffer_store_dword v7, v0, s[4:7], s61 offen offset:0 sc1
  buffer_store_dword v7, v0, s[4:7], s61 offen offset:128
  s_mov_b32 s57, 0x20000000
  s_mov_b32 s58, 0x20000000
  s_mov_b32 s59, 0x20000000
  s_mov_b32 s60, 0x20000000
  s_mov_b32 s61, 0x20000000
L_bo_spin:
  s_sleep 1
  s_xor_b32 s95, s95, 1024
  s_mov_b32 m0, s95
  v_xor_b32 v171, 1024, v171
  buffer_load_dword v4, s[4:7], s48 offen sc1 lds
  s_add_u32 s94, s94, 1
  s_cmp_lt_u32 s94, 100000
  s_cselect_b32 s52, s46, -2
  s_waitcnt vmcnt(0)
  s_barrier
  ds_read_b32 v5, v171
  s_waitcnt lgkmcnt(0)
  v_cmp_ge_i32 vcc, s52, v5
  s_cmp_eq_u32 s45, 0
  s_cselect_b32 s51, vcc_lo, vcc_hi
  s_cmp_lg_u32 s51, 0
  s_cbranch_scc1 L_bo_spin
  s_add_u32 m0, s50, 0
  s_add_u32 s51, s47, 0
  buffer_load_dwordx4 v1, s[4:7], s51 offen sc1 lds
  s_add_u32 m0, s50, 4096
  s_add_u32 s51, s47, 4096
  buffer_load_dwordx4 v1, s[4:7], s51 offen sc1 lds
  s_add_u32 m0, s50, 8192
  s_add_u32 s51, s47, 8192
  buffer_load_dwordx4 v1, s[4:7], s51 offen sc1 lds
  s_add_u32 m0, s50, 12288
  s_add_u32 s51, s47, 12288
  buffer_load_dwordx4 v1, s[4:7], s51 offen sc1 lds
  s_add_u32 m0, s50, 16384
  s_add_u32 s51, s47, 16384
  buffer_load_dwordx4 v1, s[4:7], s51 offen sc1 lds
  s_add_u32 m0, s50, 20480
  s_add_u32 s51, s47, 20480
  buffer_load_dwordx4 v1, s[4:7], s51 offen sc1 lds
  s_add_u32 m0, s50, 24576
  s_add_u32 s51, s47, 24576
  buffer_load_dwordx4 v1, s[4:7], s51 offen sc1 lds
  s_add_u32 m0, s50, 28672
  s_add_u32 s51, s47, 28672
  buffer_load_dwordx4 v1, s[4:7], s51 offen sc1 lds
  s_add_u32 m0, s50, 32768
  s_add_u32 s51, s47, 32768
  buffer_load_dwordx4 v1, s[4:7], s51 offen sc1 lds
  s_add_u32 m0, s50, 36864
  s_add_u32 s51, s47, 36864
  buffer_load_dwordx4 v1, s[4:7], s51 offen sc1 lds
  s_waitcnt vmcnt(5)
  s_branch L_bo_entry
L_bo_fin:
  s_waitcnt vmcnt(0)
  s_barrier
  v_mov_b32 v7, s62
  buffer_store_dword v7, v0, s[4:7], s61 offen offset:0 sc1
  buffer_store_dword v7, v0, s[4:7], s61 offen offset:128
  s_endpgm
L_bo_entry:
  s_barrier
  ds_read_b128 v[12:15], v2 offset:0
  ds_read_b128 v[16:19], v2 offset:1024
  ds_read_b128 v[20:23], v2 offset:2048
  ds_read_b128 v[24:27], v2 offset:3072
  ds_read_b128 v[28:31], v2 offset:4096
  ds_read_b32 v5, v171
  s_branch L_bo_body
L_bofin_367:
  buffer_store_dwordx4 v[68:71], v9, s[8:11], s59 offen offset:0
  s_branch L_bojoin_368
L_bofin_369:
  buffer_store_dwordx4 v[72:75], v9, s[8:11], s59 offen offset:32
  s_branch L_bojoin_370
L_bofin_371:
  buffer_store_dwordx4 v[68:71], v9, s[8:11], s59 offen offset:0
  s_branch L_bojoin_372
L_bofin_373:
  buffer_store_dwordx4 v[72:75], v9, s[8:11], s59 offen offset:32
  s_branch L_bojoin_374
L_role_rec:
  s_lshr_b32 s42, s13, 6
  s_bfe_u32 s43, s13, 0x10005
  s_and_b32 s44, s13, 1
  s_bfe_u32 s45, s13, 0x50001
  s_xor_b32 s53, s44, 1
  s_lshl_b32 s71, s12, 3
  s_lshr_b32 s73, 0x140c0800, s71
  s_and_b32 s73, s73, 255
  s_lshr_b32 s74, 0x12100604, s71
  s_and_b32 s74, s74, 255
  v_lshlrev_b32 v2, 4, v0
  v_lshlrev_b32 v3, 3, v0
  v_add_u32 v151, 0, v2
  s_mov_b32 s71, 11184811
  v_mul_hi_u32 v139, v151, s71
  v_mul_u32_u24 v140, 11904, v139
  v_add_u32 v140, v140, v151
  v_add_u32 v151, 1024, v2
  s_mov_b32 s71, 11184811
  v_mul_hi_u32 v139, v151, s71
  v_mul_u32_u24 v141, 11904, v139
  v_add_u32 v141, v141, v151
  v_add_u32 v151, 2048, v2
  s_mov_b32 s71, 11184811
  v_mul_hi_u32 v139, v151, s71
  v_mul_u32_u24 v142, 11904, v139
  v_add_u32 v142, v142, v151
  v_add_u32 v151, 0, v2
  s_mov_b32 s71, 6710887
  v_mul_hi_u32 v139, v151, s71
  v_mul_u32_u24 v143, 640, v139
  v_add_u32 v143, v143, v151
  v_add_u32 v151, 1024, v2
  s_mov_b32 s71, 6710887
  v_mul_hi_u32 v139, v151, s71
  v_mul_u32_u24 v144, 640, v139
  v_add_u32 v144, v144, v151
  v_add_u32 v151, 2048, v2
  s_mov_b32 s71, 6710887
  v_mul_hi_u32 v139, v151, s71
  v_mul_u32_u24 v145, 640, v139
  v_add_u32 v145, v145, v151
  v_add_u32 v151, 3072, v2
  s_mov_b32 s71, 6710887
  v_mul_hi_u32 v139, v151, s71
  v_mul_u32_u24 v146, 640, v139
  v_add_u32 v146, v146, v151
  v_add_u32 v151, 4096, v2
  s_mov_b32 s71, 6710887
  v_mul_hi_u32 v139, v151, s71
  v_mul_u32_u24 v147, 640, v139
  v_add_u32 v147, v147, v151
  v_lshrrev_b32 v151, 5, v0
  v_lshlrev_b32 v151, 4, v151
  v_bfe_u32 v139, v0, 4, 1
  v_lshl_add_u32 v151, v139, 2, v151
  v_bfe_u32 v139, v0, 2, 1
  v_add_u32 v151, v151, v139
  v_bfe_u32 v139, v0, 3, 1
  v_lshl_add_u32 v151, v139, 3, v151
  v_and_b32 v139, 3, v0
  v_mul_u32_u24 v148, 384, v151
  v_mul_u32_u24 v150, 640, v151
  v_lshl_add_u32 v149, v139, 3, v148
  v_lshl_add_u32 v148, v139, 4, v148
  v_lshl_add_u32 v150, v139, 3, v150
  s_lshl_b32 s71, s73, 4
  v_add_u32 v148, s71, v148
  s_lshl_b32 s71, s74, 4
  v_add_u32 v149, s71, v149
  s_mul_i32 s71, s12, 160
  v_add_u32 v150, s71, v150
  s_mul_i32 s80, s44, 3932160
  s_mul_i32 s71, s45, 384
  s_add_u32 s80, s80, s71
  s_mul_i32 s71, s12, 196608
  s_add_u32 s80, s80, s71
  s_mul_i32 s81, s45, 245760
  s_mul_i32 s71, s53, 640
  s_add_u32 s81, s81, s71
  s_mul_i32 s71, s12, 10240
  s_add_u32 s81, s81, s71
  s_mul_i32 s82, s12, 6144
  s_mul_i32 s83, s12, 5120
  s_mov_b32 s8, s20
  s_mov_b32 s9, s21
  s_mov_b32 s10, 7864320
  s_mov_b32 s11, 0x20000
  s_add_u32 m0, s82, 0
  s_add_u32 s71, s80, 0
  buffer_load_dwordx4 v140, s[8:11], s71 offen  lds
  s_add_u32 m0, s82, 1024
  s_add_u32 s71, s80, 0
  buffer_load_dwordx4 v141, s[8:11], s71 offen  lds
  s_add_u32 m0, s82, 2048
  s_add_u32 s71, s80, 0
  buffer_load_dwordx4 v142, s[8:11], s71 offen  lds
  s_add_u32 m0, s82, 3072
  s_add_u32 s71, s80, 98304
  buffer_load_dwordx4 v140, s[8:11], s71 offen  lds
  s_add_u32 m0, s82, 4096
  s_add_u32 s71, s80, 98304
  buffer_load_dwordx4 v141, s[8:11], s71 offen  lds
  s_add_u32 m0, s82, 5120
  s_add_u32 s71, s80, 98304
  buffer_load_dwordx4 v142, s[8:11], s71 offen  lds
  s_add_u32 m0, s82, 24576
  s_add_u32 s71, s80, 786432
  buffer_load_dwordx4 v140, s[8:11], s71 offen  lds
  s_add_u32 m0, s82, 25600
  s_add_u32 s71, s80, 786432
  buffer_load_dwordx4 v141, s[8:11], s71 offen  lds
  s_add_u32 m0, s82, 26624
  s_add_u32 s71, s80, 786432
  buffer_load_dwordx4 v142, s[8:11], s71 offen  lds
  s_add_u32 m0, s82, 27648
  s_add_u32 s71, s80, 884736
  buffer_load_dwordx4 v140, s[8:11], s71 offen  lds
  s_add_u32 m0, s82, 28672
  s_add_u32 s71, s80, 884736
  buffer_load_dwordx4 v141, s[8:11], s71 offen  lds
  s_add_u32 m0, s82, 29696
  s_add_u32 s71, s80, 884736
  buffer_load_dwordx4 v142, s[8:11], s71 offen  lds
  s_add_u32 m0, s82, 49152
  s_add_u32 s71, s80, 1572864
  buffer_load_dwordx4 v140, s[8:11], s71 offen  lds
  s_add_u32 m0, s82, 50176
  s_add_u32 s71, s80, 1572864
  buffer_load_dwordx4 v141, s[8:11], s71 offen  lds
  s_add_u32 m0, s82, 51200
  s_add_u32 s71, s80, 1572864
  buffer_load_dwordx4 v142, s[8:11], s71 offen  lds
  s_add_u32 m0, s82, 52224
  s_add_u32 s71, s80, 1671168
  buffer_load_dwordx4 v140, s[8:11], s71 offen  lds
  s_add_u32 m0, s82, 53248
  s_add_u32 s71, s80, 1671168
  buffer_load_dwordx4 v141, s[8:11], s71 offen  lds
  s_add_u32 m0, s82, 54272
  s_add_u32 s71, s80, 1671168
  buffer_load_dwordx4 v142, s[8:11], s71 offen  lds
  s_add_u32 m0, s82, 73728
  s_add_u32 s71, s80, 2359296
  buffer_load_dwordx4 v140, s[8:11], s71 offen  lds
  s_add_u32 m0, s82, 74752
  s_add_u32 s71, s80, 2359296
  buffer_load_dwordx4 v141, s[8:11], s71 offen  lds
  s_add_u32 m0, s82, 75776
  s_add_u32 s71, s80, 2359296
  buffer_load_dwordx4 v142, s[8:11], s71 offen  lds
  s_add_u32 m0, s82, 76800
  s_add_u32 s71, s80, 2457600
  buffer_load_dwordx4 v140, s[8:11], s71 offen  lds
  s_add_u32 m0, s82, 77824
  s_add_u32 s71, s80, 2457600
  buffer_load_dwordx4 v141, s[8:11], s71 offen  lds
  s_add_u32 m0, s82, 78848
  s_add_u32 s71, s80, 2457600
  buffer_load_dwordx4 v142, s[8:11], s71 offen  lds
  s_add_u32 m0, s82, 98304
  s_add_u32 s71, s80, 3145728
  buffer_load_dwordx4 v140, s[8:11], s71 offen  lds
  s_add_u32 m0, s82, 99328
  s_add_u32 s71, s80, 3145728
  buffer_load_dwordx4 v141, s[8:11], s71 offen  lds
  s_add_u32 m0, s82, 100352
  s_add_u32 s71, s80, 3145728
  buffer_load_dwordx4 v142, s[8:11], s71 offen  lds
  s_add_u32 m0, s82, 101376
  s_add_u32 s71, s80, 3244032
  buffer_load_dwordx4 v140, s[8:11], s71 offen  lds
  s_add_u32 m0, s82, 102400
  s_add_u32 s71, s80, 3244032
  buffer_load_dwordx4 v141, s[8:11], s71 offen  lds
  s_add_u32 m0, s82, 103424
  s_add_u32 s71, s80, 3244032
  buffer_load_dwordx4 v142, s[8:11], s71 offen  lds
  s_waitcnt vmcnt(24) lgkmcnt(0)
  s_barrier
  s_mov_b32 s8, s22
  s_mov_b32 s9, s23
  s_mov_b32 s10, 7864320
  s_mov_b32 s11, 0x20000
  s_add_u32 m0, s82, 122880
  s_add_u32 s71, s80, 0
  buffer_load_dwordx4 v140, s[8:11], s71 offen  lds
  s_add_u32 m0, s82, 123904
  s_add_u32 s71, s80, 0
  buffer_load_dwordx4 v141, s[8:11], s71 offen  lds
  s_add_u32 m0, s82, 124928
  s_add_u32 s71, s80, 0
  buffer_load_dwordx4 v142, s[8:11], s71 offen  lds
  s_add_u32 m0, s82, 125952
  s_add_u32 s71, s80, 98304
  buffer_load_dwordx4 v140, s[8:11], s71 offen  lds
  s_add_u32 m0, s82, 126976
  s_add_u32 s71, s80, 98304
  buffer_load_dwordx4 v141, s[8:11], s71 offen  lds
  s_add_u32 m0, s82, 128000
  s_add_u32 s71, s80, 98304
  buffer_load_dwordx4 v142, s[8:11], s71 offen  lds
  v_add_u32 v151, 0, v148
  v_add_u32 v139, 0, v149
  ds_read_b64_tr_b16 v[8:9], v151 offset:0
  ds_read_b64_tr_b16 v[10:11], v151 offset:768
  ds_read_b64_tr_b16 v[12:13], v151 offset:12288
  ds_read_b64_tr_b16 v[14:15], v151 offset:13056
  ds_read_b64_tr_b16 a[48:49], v151 offset:8
  ds_read_b64_tr_b16 a[50:51], v151 offset:776
  ds_read_b64_tr_b16 a[52:53], v151 offset:12296
  ds_read_b64_tr_b16 a[54:55], v151 offset:13064
  ds_read_b64_tr_b16 a[120:121], v139 offset:0
  ds_read_b64_tr_b16 a[122:123], v139 offset:768
  ds_read_b64_tr_b16 a[124:125], v139 offset:12288
  ds_read_b64_tr_b16 a[126:127], v139 offset:13056
  s_waitcnt vmcnt(24) lgkmcnt(0)
  s_barrier
  s_add_u32 m0, s82, 0
  s_add_u32 s71, s80, 786432
  buffer_load_dwordx4 v140, s[8:11], s71 offen  lds
  s_add_u32 m0, s82, 1024
  s_add_u32 s71, s80, 786432
  buffer_load_dwordx4 v141, s[8:11], s71 offen  lds
  s_add_u32 m0, s82, 2048
  s_add_u32 s71, s80, 786432
  buffer_load_dwordx4 v142, s[8:11], s71 offen  lds
  s_add_u32 m0, s82, 3072
  s_add_u32 s71, s80, 884736
  buffer_load_dwordx4 v140, s[8:11], s71 offen  lds
  s_add_u32 m0, s82, 4096
  s_add_u32 s71, s80, 884736
  buffer_load_dwordx4 v141, s[8:11], s71 offen  lds
  s_add_u32 m0, s82, 5120
  s_add_u32 s71, s80, 884736
  buffer_load_dwordx4 v142, s[8:11], s71 offen  lds
  v_add_u32 v151, 24576, v148
  v_add_u32 v139, 24576, v149
  ds_read_b64_tr_b16 a[0:1], v151 offset:0
  ds_read_b64_tr_b16 a[2:3], v151 offset:768
  ds_read_b64_tr_b16 a[4:5], v151 offset:12288
  ds_read_b64_tr_b16 a[6:7], v151 offset:13056
  ds_read_b64_tr_b16 a[56:57], v151 offset:8
  ds_read_b64_tr_b16 a[58:59], v151 offset:776
  ds_read_b64_tr_b16 a[60:61], v151 offset:12296
  ds_read_b64_tr_b16 a[62:63], v151 offset:13064
  ds_read_b64_tr_b16 v[48:49], v139 offset:0
  ds_read_b64_tr_b16 v[50:51], v139 offset:768
  ds_read_b64_tr_b16 v[52:53], v139 offset:12288
  ds_read_b64_tr_b16 v[54:55], v139 offset:13056
  s_waitcnt vmcnt(24) lgkmcnt(0)
  s_barrier
  s_add_u32 m0, s82, 24576
  s_add_u32 s71, s80, 1572864
  buffer_load_dwordx4 v140, s[8:11], s71 offen  lds
  s_add_u32 m0, s82, 25600
  s_add_u32 s71, s80, 1572864
  buffer_load_dwordx4 v141, s[8:11], s71 offen  lds
  s_add_u32 m0, s82, 26624
  s_add_u32 s71, s80, 1572864
  buffer_load_dwordx4 v142, s[8:11], s71 offen  lds
  s_add_u32 m0, s82, 27648
  s_add_u32 s71, s80, 1671168
  buffer_load_dwordx4 v140, s[8:11], s71 offen  lds
  s_add_u32 m0, s82, 28672
  s_add_u32 s71, s80, 1671168
  buffer_load_dwordx4 v141, s[8:11], s71 offen  lds
  s_add_u32 m0, s82, 29696
  s_add_u32 s71, s80, 1671168
  buffer_load_dwordx4 v142, s[8:11], s71 offen  lds
  v_add_u32 v151, 49152, v148
  v_add_u32 v139, 49152, v149
  ds_read_b64_tr_b16 v[16:17], v151 offset:0
  ds_read_b64_tr_b16 v[18:19], v151 offset:768
  ds_read_b64_tr_b16 v[20:21], v151 offset:12288
  ds_read_b64_tr_b16 v[22:23], v151 offset:13056
  ds_read_b64_tr_b16 a[64:65], v151 offset:8
  ds_read_b64_tr_b16 a[66:67], v151 offset:776
  ds_read_b64_tr_b16 a[68:69], v151 offset:12296
  ds_read_b64_tr_b16 a[70:71], v151 offset:13064
  ds_read_b64_tr_b16 a[128:129], v139 offset:0
  ds_read_b64_tr_b16 a[130:131], v139 offset:768
  ds_read_b64_tr_b16 a[132:133], v139 offset:12288
  ds_read_b64_tr_b16 a[134:135], v139 offset:13056
  s_waitcnt vmcnt(24) lgkmcnt(0)
  s_barrier
  s_add_u32 m0, s82, 49152
  s_add_u32 s71, s80, 2359296
  buffer_load_dwordx4 v140, s[8:11], s71 offen  lds
  s_add_u32 m0, s82, 50176
  s_add_u32 s71, s80, 2359296
  buffer_load_dwordx4 v141, s[8:11], s71 offen  lds
  s_add_u32 m0, s82, 51200
  s_add_u32 s71, s80, 2359296
  buffer_load_dwordx4 v142, s[8:11], s71 offen  lds
  s_add_u32 m0, s82, 52224
  s_add_u32 s71, s80, 2457600
  buffer_load_dwordx4 v140, s[8:11], s71 offen  lds
  s_add_u32 m0, s82, 53248
  s_add_u32 s71, s80, 2457600
  buffer_load_dwordx4 v141, s[8:11], s71 offen  lds
  s_add_u32 m0, s82, 54272
  s_add_u32 s71, s80, 2457600
  buffer_load_dwordx4 v142, s[8:11], s71 offen  lds
  v_add_u32 v151, 73728, v148
  v_add_u32 v139, 73728, v149
  ds_read_b64_tr_b16 a[8:9], v151 offset:0
  ds_read_b64_tr_b16 a[10:11], v151 offset:768
  ds_read_b64_tr_b16 a[12:13], v151 offset:12288
  ds_read_b64_tr_b16 a[14:15], v151 offset:13056
  ds_read_b64_tr_b16 a[72:73], v151 offset:8
  ds_read_b64_tr_b16 a[74:75], v151 offset:776
  ds_read_b64_tr_b16 a[76:77], v151 offset:12296
  ds_read_b64_tr_b16 a[78:79], v151 offset:13064
  ds_read_b64_tr_b16 a[136:137], v139 offset:0
  ds_read_b64_tr_b16 a[138:139], v139 offset:768
  ds_read_b64_tr_b16 a[140:141], v139 offset:12288
  ds_read_b64_tr_b16 a[142:143], v139 offset:13056
  s_waitcnt vmcnt(24) lgkmcnt(0)
  s_barrier
  s_add_u32 m0, s82, 73728
  s_add_u32 s71, s80, 3145728
  buffer_load_dwordx4 v140, s[8:11], s71 offen  lds
  s_add_u32 m0, s82, 74752
  s_add_u32 s71, s80, 3145728
  buffer_load_dwordx4 v141, s[8:11], s71 offen  lds
  s_add_u32 m0, s82, 75776
  s_add_u32 s71, s80, 3145728
  buffer_load_dwordx4 v142, s[8:11], s71 offen  lds
  s_add_u32 m0, s82, 76800
  s_add_u32 s71, s80, 3244032
  buffer_load_dwordx4 v140, s[8:11], s71 offen  lds
  s_add_u32 m0, s82, 77824
  s_add_u32 s71, s80, 3244032
  buffer_load_dwordx4 v141, s[8:11], s71 offen  lds
  s_add_u32 m0, s82, 78848
  s_add_u32 s71, s80, 3244032
  buffer_load_dwordx4 v142, s[8:11], s71 offen  lds
  v_add_u32 v151, 98304, v148
  v_add_u32 v139, 98304, v149
  ds_read_b64_tr_b16 v[24:25], v151 offset:0
  ds_read_b64_tr_b16 v[26:27], v151 offset:768
  ds_read_b64_tr_b16 v[28:29], v151 offset:12288
  ds_read_b64_tr_b16 v[30:31], v151 offset:13056
  ds_read_b64_tr_b16 a[80:81], v151 offset:8
  ds_read_b64_tr_b16 a[82:83], v151 offset:776
  ds_read_b64_tr_b16 a[84:85], v151 offset:12296
  ds_read_b64_tr_b16 a[86:87], v151 offset:13064
  ds_read_b64_tr_b16 a[144:145], v139 offset:0
  ds_read_b64_tr_b16 a[146:147], v139 offset:768
  ds_read_b64_tr_b16 a[148:149], v139 offset:12288
  ds_read_b64_tr_b16 a[150:151], v139 offset:13056
  s_waitcnt vmcnt(24) lgkmcnt(0)
  s_barrier
  s_mov_b32 s8, s24
  s_mov_b32 s9, s25
  s_mov_b32 s10, 7864320
  s_mov_b32 s11, 0x20000
  s_add_u32 m0, s82, 98304
  s_add_u32 s71, s80, 0
  buffer_load_dwordx4 v140, s[8:11], s71 offen  lds
  s_add_u32 m0, s82, 99328
  s_add_u32 s71, s80, 0
  buffer_load_dwordx4 v141, s[8:11], s71 offen  lds
  s_add_u32 m0, s82, 100352
  s_add_u32 s71, s80, 0
  buffer_load_dwordx4 v142, s[8:11], s71 offen  lds
  s_add_u32 m0, s82, 101376
  s_add_u32 s71, s80, 98304
  buffer_load_dwordx4 v140, s[8:11], s71 offen  lds
  s_add_u32 m0, s82, 102400
  s_add_u32 s71, s80, 98304
  buffer_load_dwordx4 v141, s[8:11], s71 offen  lds
  s_add_u32 m0, s82, 103424
  s_add_u32 s71, s80, 98304
  buffer_load_dwordx4 v142, s[8:11], s71 offen  lds
  v_add_u32 v151, 122880, v148
  v_add_u32 v139, 122880, v149
  ds_read_b64_tr_b16 a[16:17], v151 offset:0
  ds_read_b64_tr_b16 a[18:19], v151 offset:768
  ds_read_b64_tr_b16 a[20:21], v151 offset:12288
  ds_read_b64_tr_b16 a[22:23], v151 offset:13056
  ds_read_b64_tr_b16 v[40:41], v151 offset:8
  ds_read_b64_tr_b16 v[42:43], v151 offset:776
  ds_read_b64_tr_b16 v[44:45], v151 offset:12296
  ds_read_b64_tr_b16 v[46:47], v151 offset:13064
  ds_read_b64_tr_b16 a[152:153], v139 offset:0
  ds_read_b64_tr_b16 a[154:155], v139 offset:768
  ds_read_b64_tr_b16 a[156:157], v139 offset:12288
  ds_read_b64_tr_b16 a[158:159], v139 offset:13056
  s_waitcnt vmcnt(24) lgkmcnt(0)
  s_barrier
  s_add_u32 m0, s82, 122880
  s_add_u32 s71, s80, 786432
  buffer_load_dwordx4 v140, s[8:11], s71 offen  lds
  s_add_u32 m0, s82, 123904
  s_add_u32 s71, s80, 786432
  buffer_load_dwordx4 v141, s[8:11], s71 offen  lds
  s_add_u32 m0, s82, 124928
  s_add_u32 s71, s80, 786432
  buffer_load_dwordx4 v142, s[8:11], s71 offen  lds
  s_add_u32 m0, s82, 125952
  s_add_u32 s71, s80, 884736
  buffer_load_dwordx4 v140, s[8:11], s71 offen  lds
  s_add_u32 m0, s82, 126976
  s_add_u32 s71, s80, 884736
  buffer_load_dwordx4 v141, s[8:11], s71 offen  lds
  s_add_u32 m0, s82, 128000
  s_add_u32 s71, s80, 884736
  buffer_load_dwordx4 v142, s[8:11], s71 offen  lds
  v_add_u32 v151, 0, v148
  v_add_u32 v139, 0, v149
  ds_read_b64_tr_b16 a[24:25], v151 offset:0
  ds_read_b64_tr_b16 a[26:27], v151 offset:768
  ds_read_b64_tr_b16 a[28:29], v151 offset:12288
  ds_read_b64_tr_b16 a[30:31], v151 offset:13056
  ds_read_b64_tr_b16 a[88:89], v151 offset:8
  ds_read_b64_tr_b16 a[90:91], v151 offset:776
  ds_read_b64_tr_b16 a[92:93], v151 offset:12296
  ds_read_b64_tr_b16 a[94:95], v151 offset:13064
  ds_read_b64_tr_b16 a[160:161], v139 offset:0
  ds_read_b64_tr_b16 a[162:163], v139 offset:768
  ds_read_b64_tr_b16 a[164:165], v139 offset:12288
  ds_read_b64_tr_b16 a[166:167], v139 offset:13056
  s_waitcnt vmcnt(24) lgkmcnt(0)
  s_barrier
  s_add_u32 m0, s82, 0
  s_add_u32 s71, s80, 1572864
  buffer_load_dwordx4 v140, s[8:11], s71 offen  lds
  s_add_u32 m0, s82, 1024
  s_add_u32 s71, s80, 1572864
  buffer_load_dwordx4 v141, s[8:11], s71 offen  lds
  s_add_u32 m0, s82, 2048
  s_add_u32 s71, s80, 1572864
  buffer_load_dwordx4 v142, s[8:11], s71 offen  lds
  s_add_u32 m0, s82, 3072
  s_add_u32 s71, s80, 1671168
  buffer_load_dwordx4 v140, s[8:11], s71 offen  lds
  s_add_u32 m0, s82, 4096
  s_add_u32 s71, s80, 1671168
  buffer_load_dwordx4 v141, s[8:11], s71 offen  lds
  s_add_u32 m0, s82, 5120
  s_add_u32 s71, s80, 1671168
  buffer_load_dwordx4 v142, s[8:11], s71 offen  lds
  v_add_u32 v151, 24576, v148
  v_add_u32 v139, 24576, v149
  ds_read_b64_tr_b16 a[32:33], v151 offset:0
  ds_read_b64_tr_b16 a[34:35], v151 offset:768
  ds_read_b64_tr_b16 a[36:37], v151 offset:12288
  ds_read_b64_tr_b16 a[38:39], v151 offset:13056
  ds_read_b64_tr_b16 a[96:97], v151 offset:8
  ds_read_b64_tr_b16 a[98:99], v151 offset:776
  ds_read_b64_tr_b16 a[100:101], v151 offset:12296
  ds_read_b64_tr_b16 a[102:103], v151 offset:13064
  ds_read_b64_tr_b16 a[168:169], v139 offset:0
  ds_read_b64_tr_b16 a[170:171], v139 offset:768
  ds_read_b64_tr_b16 a[172:173], v139 offset:12288
  ds_read_b64_tr_b16 a[174:175], v139 offset:13056
  s_waitcnt vmcnt(24) lgkmcnt(0)
  s_barrier
  s_add_u32 m0, s82, 24576
  s_add_u32 s71, s80, 2359296
  buffer_load_dwordx4 v140, s[8:11], s71 offen  lds
  s_add_u32 m0, s82, 25600
  s_add_u32 s71, s80, 2359296
  buffer_load_dwordx4 v141, s[8:11], s71 offen  lds
  s_add_u32 m0, s82, 26624
  s_add_u32 s71, s80, 2359296
  buffer_load_dwordx4 v142, s[8:11], s71 offen  lds
  s_add_u32 m0, s82, 27648
  s_add_u32 s71, s80, 2457600
  buffer_load_dwordx4 v140, s[8:11], s71 offen  lds
  s_add_u32 m0, s82, 28672
  s_add_u32 s71, s80, 2457600
  buffer_load_dwordx4 v141, s[8:11], s71 offen  lds
  s_add_u32 m0, s82, 29696
  s_add_u32 s71, s80, 2457600
  buffer_load_dwordx4 v142, s[8:11], s71 offen  lds
  v_add_u32 v151, 49152, v148
  v_add_u32 v139, 49152, v149
  ds_read_b64_tr_b16 a[40:41], v151 offset:0
  ds_read_b64_tr_b16 a[42:43], v151 offset:768
  ds_read_b64_tr_b16 a[44:45], v151 offset:12288
  ds_read_b64_tr_b16 a[46:47], v151 offset:13056
  ds_read_b64_tr_b16 a[104:105], v151 offset:8
  ds_read_b64_tr_b16 a[106:107], v151 offset:776
  ds_read_b64_tr_b16 a[108:109], v151 offset:12296
  ds_read_b64_tr_b16 a[110:111], v151 offset:13064
  ds_read_b64_tr_b16 v[56:57], v139 offset:0
  ds_read_b64_tr_b16 v[58:59], v139 offset:768
  ds_read_b64_tr_b16 v[60:61], v139 offset:12288
  ds_read_b64_tr_b16 v[62:63], v139 offset:13056
  s_waitcnt vmcnt(24) lgkmcnt(0)
  s_barrier
  s_add_u32 m0, s82, 49152
  s_add_u32 s71, s80, 3145728
  buffer_load_dwordx4 v140, s[8:11], s71 offen  lds
  s_add_u32 m0, s82, 50176
  s_add_u32 s71, s80, 3145728
  buffer_load_dwordx4 v141, s[8:11], s71 offen  lds
  s_add_u32 m0, s82, 51200
  s_add_u32 s71, s80, 3145728
  buffer_load_dwordx4 v142, s[8:11], s71 offen  lds
  s_add_u32 m0, s82, 52224
  s_add_u32 s71, s80, 3244032
  buffer_load_dwordx4 v140, s[8:11], s71 offen  lds
  s_add_u32 m0, s82, 53248
  s_add_u32 s71, s80, 3244032
  buffer_load_dwordx4 v141, s[8:11], s71 offen  lds
  s_add_u32 m0, s82, 54272
  s_add_u32 s71, s80, 3244032
  buffer_load_dwordx4 v142, s[8:11], s71 offen  lds
  v_add_u32 v151, 73728, v148
  v_add_u32 v139, 73728, v149
  ds_read_b64_tr_b16 v[32:33], v151 offset:0
  ds_read_b64_tr_b16 v[34:35], v151 offset:768
  ds_read_b64_tr_b16 v[36:37], v151 offset:12288
  ds_read_b64_tr_b16 v[38:39], v151 offset:13056
  ds_read_b64_tr_b16 a[112:113], v151 offset:8
  ds_read_b64_tr_b16 a[114:115], v151 offset:776
  ds_read_b64_tr_b16 a[116:117], v151 offset:12296
  ds_read_b64_tr_b16 a[118:119], v151 offset:13064
  ds_read_b64_tr_b16 v[64:65], v139 offset:0
  ds_read_b64_tr_b16 v[66:67], v139 offset:768
  ds_read_b64_tr_b16 v[68:69], v139 offset:12288
  ds_read_b64_tr_b16 v[70:71], v139 offset:13056
  s_waitcnt vmcnt(24) lgkmcnt(0)
  s_barrier
  s_mov_b32 s8, s26
  s_mov_b32 s9, s27
  s_mov_b32 s10, 7864320
  s_mov_b32 s11, 0x20000
  s_add_u32 m0, s83, 73728
  s_add_u32 s71, s81, 0
  buffer_load_dwordx4 v143, s[8:11], s71 offen  lds
  s_add_u32 m0, s83, 74752
  s_add_u32 s71, s81, 0
  buffer_load_dwordx4 v144, s[8:11], s71 offen  lds
  s_add_u32 m0, s83, 75776
  s_add_u32 s71, s81, 0
  buffer_load_dwordx4 v145, s[8:11], s71 offen  lds
  s_add_u32 m0, s83, 76800
  s_add_u32 s71, s81, 0
  buffer_load_dwordx4 v146, s[8:11], s71 offen  lds
  s_add_u32 m0, s83, 77824
  s_add_u32 s71, s81, 0
  buffer_load_dwordx4 v147, s[8:11], s71 offen  lds
  v_add_u32 v151, 98304, v148
  v_add_u32 v139, 98304, v149
  ds_read_b64_tr_b16 a[176:177], v151 offset:0
  ds_read_b64_tr_b16 a[178:179], v151 offset:768
  ds_read_b64_tr_b16 a[180:181], v151 offset:12288
  ds_read_b64_tr_b16 a[182:183], v151 offset:13056
  ds_read_b64_tr_b16 a[208:209], v151 offset:8
  ds_read_b64_tr_b16 a[210:211], v151 offset:776
  ds_read_b64_tr_b16 a[212:213], v151 offset:12296
  ds_read_b64_tr_b16 a[214:215], v151 offset:13064
  ds_read_b64_tr_b16 a[224:225], v139 offset:0
  ds_read_b64_tr_b16 a[226:227], v139 offset:768
  ds_read_b64_tr_b16 a[228:229], v139 offset:12288
  ds_read_b64_tr_b16 a[230:231], v139 offset:13056
  s_waitcnt vmcnt(23) lgkmcnt(0)
  s_barrier
  s_add_u32 m0, s83, 98304
  s_add_u32 s71, s81, 40960
  buffer_load_dwordx4 v143, s[8:11], s71 offen  lds
  s_add_u32 m0, s83, 99328
  s_add_u32 s71, s81, 40960
  buffer_load_dwordx4 v144, s[8:11], s71 offen  lds
  s_add_u32 m0, s83, 100352
  s_add_u32 s71, s81, 40960
  buffer_load_dwordx4 v145, s[8:11], s71 offen  lds
  s_add_u32 m0, s83, 101376
  s_add_u32 s71, s81, 40960
  buffer_load_dwordx4 v146, s[8:11], s71 offen  lds
  s_add_u32 m0, s83, 102400
  s_add_u32 s71, s81, 40960
  buffer_load_dwordx4 v147, s[8:11], s71 offen  lds
  v_add_u32 v151, 122880, v148
  v_add_u32 v139, 122880, v149
  ds_read_b64_tr_b16 a[184:185], v151 offset:0
  ds_read_b64_tr_b16 a[186:187], v151 offset:768
  ds_read_b64_tr_b16 a[188:189], v151 offset:12288
  ds_read_b64_tr_b16 a[190:191], v151 offset:13056
  ds_read_b64_tr_b16 v[80:81], v151 offset:8
  ds_read_b64_tr_b16 v[82:83], v151 offset:776
  ds_read_b64_tr_b16 v[84:85], v151 offset:12296
  ds_read_b64_tr_b16 v[86:87], v151 offset:13064
  ds_read_b64_tr_b16 a[232:233], v139 offset:0
  ds_read_b64_tr_b16 a[234:235], v139 offset:768
  ds_read_b64_tr_b16 a[236:237], v139 offset:12288
  ds_read_b64_tr_b16 a[238:239], v139 offset:13056
  s_waitcnt vmcnt(22) lgkmcnt(0)
  s_barrier
  s_add_u32 m0, s83, 122880
  s_add_u32 s71, s81, 81920
  buffer_load_dwordx4 v143, s[8:11], s71 offen  lds
  s_add_u32 m0, s83, 123904
  s_add_u32 s71, s81, 81920
  buffer_load_dwordx4 v144, s[8:11], s71 offen  lds
  s_add_u32 m0, s83, 124928
  s_add_u32 s71, s81, 81920
  buffer_load_dwordx4 v145, s[8:11], s71 offen  lds
  s_add_u32 m0, s83, 125952
  s_add_u32 s71, s81, 81920
  buffer_load_dwordx4 v146, s[8:11], s71 offen  lds
  s_add_u32 m0, s83, 126976
  s_add_u32 s71, s81, 81920
  buffer_load_dwordx4 v147, s[8:11], s71 offen  lds
  v_add_u32 v151, 0, v148
  v_add_u32 v139, 0, v149
  ds_read_b64_tr_b16 v[72:73], v151 offset:0
  ds_read_b64_tr_b16 v[74:75], v151 offset:768
  ds_read_b64_tr_b16 v[76:77], v151 offset:12288
  ds_read_b64_tr_b16 v[78:79], v151 offset:13056
  ds_read_b64_tr_b16 v[88:89], v151 offset:8
  ds_read_b64_tr_b16 v[90:91], v151 offset:776
  ds_read_b64_tr_b16 v[92:93], v151 offset:12296
  ds_read_b64_tr_b16 v[94:95], v151 offset:13064
  ds_read_b64_tr_b16 v[104:105], v139 offset:0
  ds_read_b64_tr_b16 v[106:107], v139 offset:768
  ds_read_b64_tr_b16 v[108:109], v139 offset:12288
  ds_read_b64_tr_b16 v[110:111], v139 offset:13056
  s_waitcnt vmcnt(21) lgkmcnt(0)
  s_barrier
  s_add_u32 m0, s83, 0
  s_add_u32 s71, s81, 122880
  buffer_load_dwordx4 v143, s[8:11], s71 offen  lds
  s_add_u32 m0, s83, 1024
  s_add_u32 s71, s81, 122880
  buffer_load_dwordx4 v144, s[8:11], s71 offen  lds
  s_add_u32 m0, s83, 2048
  s_add_u32 s71, s81, 122880
  buffer_load_dwordx4 v145, s[8:11], s71 offen  lds
  s_add_u32 m0, s83, 3072
  s_add_u32 s71, s81, 122880
  buffer_load_dwordx4 v146, s[8:11], s71 offen  lds
  s_add_u32 m0, s83, 4096
  s_add_u32 s71, s81, 122880
  buffer_load_dwordx4 v147, s[8:11], s71 offen  lds
  v_add_u32 v151, 24576, v148
  v_add_u32 v139, 24576, v149
  ds_read_b64_tr_b16 a[192:193], v151 offset:0
  ds_read_b64_tr_b16 a[194:195], v151 offset:768
  ds_read_b64_tr_b16 a[196:197], v151 offset:12288
  ds_read_b64_tr_b16 a[198:199], v151 offset:13056
  ds_read_b64_tr_b16 v[96:97], v151 offset:8
  ds_read_b64_tr_b16 v[98:99], v151 offset:776
  ds_read_b64_tr_b16 v[100:101], v151 offset:12296
  ds_read_b64_tr_b16 v[102:103], v151 offset:13064
  ds_read_b64_tr_b16 v[112:113], v139 offset:0
  ds_read_b64_tr_b16 v[114:115], v139 offset:768
  ds_read_b64_tr_b16 v[116:117], v139 offset:12288
  ds_read_b64_tr_b16 v[118:119], v139 offset:13056
  s_waitcnt vmcnt(20) lgkmcnt(0)
  s_barrier
  s_add_u32 m0, s83, 24576
  s_add_u32 s71, s81, 163840
  buffer_load_dwordx4 v143, s[8:11], s71 offen  lds
  s_add_u32 m0, s83, 25600
  s_add_u32 s71, s81, 163840
  buffer_load_dwordx4 v144, s[8:11], s71 offen  lds
  s_add_u32 m0, s83, 26624
  s_add_u32 s71, s81, 163840
  buffer_load_dwordx4 v145, s[8:11], s71 offen  lds
  s_add_u32 m0, s83, 27648
  s_add_u32 s71, s81, 163840
  buffer_load_dwordx4 v146, s[8:11], s71 offen  lds
  s_add_u32 m0, s83, 28672
  s_add_u32 s71, s81, 163840
  buffer_load_dwordx4 v147, s[8:11], s71 offen  lds
  v_add_u32 v151, 49152, v148
  v_add_u32 v139, 49152, v149
  ds_read_b64_tr_b16 a[200:201], v151 offset:0
  ds_read_b64_tr_b16 a[202:203], v151 offset:768
  ds_read_b64_tr_b16 a[204:205], v151 offset:12288
  ds_read_b64_tr_b16 a[206:207], v151 offset:13056
  ds_read_b64_tr_b16 a[216:217], v151 offset:8
  ds_read_b64_tr_b16 a[218:219], v151 offset:776
  ds_read_b64_tr_b16 a[220:221], v151 offset:12296
  ds_read_b64_tr_b16 a[222:223], v151 offset:13064
  ds_read_b64_tr_b16 v[120:121], v139 offset:0
  ds_read_b64_tr_b16 v[122:123], v139 offset:768
  ds_read_b64_tr_b16 v[124:125], v139 offset:12288
  ds_read_b64_tr_b16 v[126:127], v139 offset:13056
  s_waitcnt vmcnt(20) lgkmcnt(0)
  s_barrier
  s_add_u32 m0, s83, 49152
  s_add_u32 s71, s81, 204800
  buffer_load_dwordx4 v143, s[8:11], s71 offen  lds
  s_add_u32 m0, s83, 50176
  s_add_u32 s71, s81, 204800
  buffer_load_dwordx4 v144, s[8:11], s71 offen  lds
  s_add_u32 m0, s83, 51200
  s_add_u32 s71, s81, 204800
  buffer_load_dwordx4 v145, s[8:11], s71 offen  lds
  s_add_u32 m0, s83, 52224
  s_add_u32 s71, s81, 204800
  buffer_load_dwordx4 v146, s[8:11], s71 offen  lds
  s_add_u32 m0, s83, 53248
  s_add_u32 s71, s81, 204800
  buffer_load_dwordx4 v147, s[8:11], s71 offen  lds
  v_add_u32 v151, 73728, v150
  ds_read_b64_tr_b16 a[240:241], v151 offset:0
  ds_read_b64_tr_b16 a[242:243], v151 offset:1280
  ds_read_b64_tr_b16 v[160:161], v151 offset:32
  ds_read_b64_tr_b16 v[162:163], v151 offset:1312
  ds_read_b64_tr_b16 v[184:185], v151 offset:64
  ds_read_b64_tr_b16 v[186:187], v151 offset:1344
  ds_read_b64_tr_b16 v[208:209], v151 offset:96
  ds_read_b64_tr_b16 v[210:211], v151 offset:1376
  ds_read_b64_tr_b16 v[232:233], v151 offset:128
  ds_read_b64_tr_b16 v[234:235], v151 offset:1408
  s_waitcnt vmcnt(20) lgkmcnt(0)
  s_barrier
  v_add_u32 v151, 98304, v150
  ds_read_b64_tr_b16 a[244:245], v151 offset:0
  ds_read_b64_tr_b16 a[246:247], v151 offset:1280
  ds_read_b64_tr_b16 v[164:165], v151 offset:32
  ds_read_b64_tr_b16 v[166:167], v151 offset:1312
  ds_read_b64_tr_b16 v[188:189], v151 offset:64
  ds_read_b64_tr_b16 v[190:191], v151 offset:1344
  ds_read_b64_tr_b16 v[212:213], v151 offset:96
  ds_read_b64_tr_b16 v[214:215], v151 offset:1376
  ds_read_b64_tr_b16 v[236:237], v151 offset:128
  ds_read_b64_tr_b16 v[238:239], v151 offset:1408
  s_waitcnt vmcnt(15) lgkmcnt(0)
  s_barrier
  v_add_u32 v151, 122880, v150
  ds_read_b64_tr_b16 a[248:249], v151 offset:0
  ds_read_b64_tr_b16 a[250:251], v151 offset:1280
  ds_read_b64_tr_b16 v[168:169], v151 offset:32
  ds_read_b64_tr_b16 v[170:171], v151 offset:1312
  ds_read_b64_tr_b16 v[192:193], v151 offset:64
  ds_read_b64_tr_b16 v[194:195], v151 offset:1344
  ds_read_b64_tr_b16 v[216:217], v151 offset:96
  ds_read_b64_tr_b16 v[218:219], v151 offset:1376
  ds_read_b64_tr_b16 v[240:241], v151 offset:128
  ds_read_b64_tr_b16 v[242:243], v151 offset:1408
  s_waitcnt vmcnt(10) lgkmcnt(0)
  s_barrier
  v_add_u32 v151, 0, v150
  ds_read_b64_tr_b16 a[252:253], v151 offset:0
  ds_read_b64_tr_b16 a[254:255], v151 offset:1280
  ds_read_b64_tr_b16 v[172:173], v151 offset:32
  ds_read_b64_tr_b16 v[174:175], v151 offset:1312
  ds_read_b64_tr_b16 v[196:197], v151 offset:64
  ds_read_b64_tr_b16 v[198:199], v151 offset:1344
  ds_read_b64_tr_b16 v[220:221], v151 offset:96
  ds_read_b64_tr_b16 v[222:223], v151 offset:1376
  ds_read_b64_tr_b16 v[244:245], v151 offset:128
  ds_read_b64_tr_b16 v[246:247], v151 offset:1408
  s_waitcnt vmcnt(5) lgkmcnt(0)
  s_barrier
  s_lshr_b32 s3, s13, 5
  s_mul_i32 s3, s3, 65
  s_and_b32 s3, s3, 0xc4
  v_mov_b32 v128, s3
  v_writelane_b32 v128, 8, 0
  v_writelane_b32 v128, 12, 2
  global_load_dword v128, v128, s[38:39] sc1
  v_add_u32 v151, 24576, v150
  ds_read_b64_tr_b16 v[152:153], v151 offset:0
  ds_read_b64_tr_b16 v[154:155], v151 offset:1280
  ds_read_b64_tr_b16 v[176:177], v151 offset:32
  ds_read_b64_tr_b16 v[178:179], v151 offset:1312
  ds_read_b64_tr_b16 v[200:201], v151 offset:64
  ds_read_b64_tr_b16 v[202:203], v151 offset:1344
  ds_read_b64_tr_b16 v[224:225], v151 offset:96
  ds_read_b64_tr_b16 v[226:227], v151 offset:1376
  ds_read_b64_tr_b16 v[248:249], v151 offset:128
  ds_read_b64_tr_b16 v[250:251], v151 offset:1408
  s_waitcnt vmcnt(0) lgkmcnt(0)
  s_barrier
  v_readlane_b32 s92, v128, 0
  v_readlane_b32 s93, v128, 1
  v_readlane_b32 s2, v128, 2
  v_add_u32 v151, 49152, v150
  ds_read_b64_tr_b16 v[156:157], v151 offset:0
  ds_read_b64_tr_b16 v[158:159], v151 offset:1280
  ds_read_b64_tr_b16 v[180:181], v151 offset:32
  ds_read_b64_tr_b16 v[182:183], v151 offset:1312
  ds_read_b64_tr_b16 v[204:205], v151 offset:64
  ds_read_b64_tr_b16 v[206:207], v151 offset:1344
  ds_read_b64_tr_b16 v[228:229], v151 offset:96
  ds_read_b64_tr_b16 v[230:231], v151 offset:1376
  ds_read_b64_tr_b16 v[252:253], v151 offset:128
  ds_read_b64_tr_b16 v[254:255], v151 offset:1408
  s_waitcnt lgkmcnt(0)
  s_barrier
  s_mul_i32 s71, s12, 30720
  s_add_u32 s71, s71, 40960
  v_add_u32 v151, s71, v2
  ds_write_b128 v151, v[8:11] offset:0
  ds_write_b128 v151, v[12:15] offset:1024
  ds_write_b128 v151, v[16:19] offset:2048
  ds_write_b128 v151, v[20:23] offset:3072
  ds_write_b128 v151, v[24:27] offset:4096
  ds_write_b128 v151, v[28:31] offset:5120
  ds_write_b128 v151, v[32:35] offset:6144
  ds_write_b128 v151, v[36:39] offset:7168
  ds_write_b128 v151, v[40:43] offset:8192
  ds_write_b128 v151, v[44:47] offset:9216
  ds_write_b128 v151, v[48:51] offset:10240
  ds_write_b128 v151, v[52:55] offset:11264
  ds_write_b128 v151, v[56:59] offset:12288
  ds_write_b128 v151, v[60:63] offset:13312
  ds_write_b128 v151, v[64:67] offset:14336
  ds_write_b128 v151, v[68:71] offset:15360
  ds_write_b128 v151, v[72:75] offset:16384
  ds_write_b128 v151, v[76:79] offset:17408
  ds_write_b128 v151, v[80:83] offset:18432
  ds_write_b128 v151, v[84:87] offset:19456
  ds_write_b128 v151, v[88:91] offset:20480
  ds_write_b128 v151, v[92:95] offset:21504
  ds_write_b128 v151, v[96:99] offset:22528
  ds_write_b128 v151, v[100:103] offset:23552
  ds_write_b128 v151, v[104:107] offset:24576
  ds_write_b128 v151, v[108:111] offset:25600
  ds_write_b128 v151, v[112:115] offset:26624
  ds_write_b128 v151, v[116:119] offset:27648
  ds_write_b128 v151, v[120:123] offset:28672
  ds_write_b128 v151, v[124:127] offset:29696
  s_waitcnt lgkmcnt(0)
  s_mov_b32 s15, s93
  s_and_b32 s3, s92, 0xffff
  s_cmp_lt_u32 s3, 48
  s_cbranch_scc1 L_rslow_375
  s_and_b32 s3, s15, 0xffff
  s_cmp_ge_u32 s3, 32
  s_cbranch_scc1 L_rfast_376
L_rslow_375:
  v_mov_b32 v37, 8
L_rdy_377:
  global_load_dword v38, v37, s[38:39] sc1
  s_waitcnt vmcnt(0)
  v_readfirstlane_b32 s15, v38
  s_and_b32 s3, s15, 0xffff
  s_cmp_ge_u32 s3, 48
  s_cbranch_scc1 L_rdyd_378
  s_sleep 8
  s_add_u32 s14, s14, 1
  s_cmp_lt_u32 s14, 100000
  s_cbranch_scc1 L_rdy_377
L_rdyd_378:
  v_mov_b32 v37, 12
  global_load_dword v37, v37, s[38:39] sc1
  s_waitcnt vmcnt(0)
  v_readfirstlane_b32 s2, v37
  s_lshr_b32 s15, s13, 5
  s_mul_i32 s3, s15, 65
  s_and_b32 s3, s3, 0xc4
  v_mov_b32 v37, s3
L_rdy_379:
  global_load_dword v38, v37, s[38:39] sc1
  s_waitcnt vmcnt(0)
  v_readfirstlane_b32 s15, v38
  s_and_b32 s3, s15, 0xffff
  s_cmp_ge_u32 s3, 32
  s_cbranch_scc1 L_rdyd_380
  s_sleep 8
  s_add_u32 s14, s14, 1
  s_cmp_lt_u32 s14, 100000
  s_cbranch_scc1 L_rdy_379
L_rdyd_380:
L_rfast_376:
  s_lshr_b32 s15, s15, 16
  s_and_b32 s2, s2, 3
  s_mul_i32 s2, s2, 0x2001
  s_xor_b32 s2, s2, 0x2000
  v_bfe_u32 v128, v0, 0, 4
  v_bfe_u32 v129, v0, 4, 2
  v_bfe_u32 v132, v0, 4, 1
  v_bfe_u32 v133, v0, 5, 1
  v_bfe_u32 v136, v0, 3, 1
  v_lshlrev_b32 v134, 4, v128
  v_and_b32 v135, 0x70, v134
  v_bfe_u32 v130, v0, 1, 1
  v_mov_b32 v37, 0x4444
  v_mov_b32 v38, 0xeeee
  v_cmp_eq_u32 vcc, 0, v130
  s_nop 1
  v_cndmask_b32 v1, v38, v37, vcc
  v_and_b32 v130, 1, v128
  v_lshlrev_b32 v130, 4, v130
  v_mov_b32 v131, 0x3f80
  v_lshlrev_b32 v131, v130, v131
  v_and_b32 v130, 4, v128
  v_lshlrev_b32 v130, 2, v130
  v_mov_b32 v137, 0x3f80
  v_lshlrev_b32 v137, v130, v137
  v_and_b32 v130, 3, v128
  v_cmp_eq_u32 vcc, 0, v130
  s_nop 1
  v_cndmask_b32 v8, 0, v137, vcc
  v_cmp_eq_u32 vcc, 1, v130
  s_nop 1
  v_cndmask_b32 v9, 0, v137, vcc
  v_cmp_eq_u32 vcc, 2, v130
  s_nop 1
  v_cndmask_b32 v10, 0, v137, vcc
  v_cmp_eq_u32 vcc, 3, v130
  s_nop 1
  v_cndmask_b32 v11, 0, v137, vcc
  v_cmp_eq_u32 vcc, 0, v130
  s_nop 1
  v_cndmask_b32 v6, 0, 1, vcc
  v_and_b32 v7, 1, v128
  v_xor_b32 v7, 1, v7
  v_bfe_u32 v37, v128, 2, 2
  v_bfe_u32 v38, v128, 1, 1
  v_cmp_eq_u32 vcc, v37, v129
  s_nop 1
  v_cndmask_b32 v131, 0, v131, vcc
  v_mov_b32 v4, v131
  v_mov_b32 v5, v131
  v_cmp_eq_u32 vcc, 1, v38
  s_nop 1
  v_cndmask_b32 v18, 0, v131, vcc
  v_cmp_eq_u32 vcc, 0, v38
  s_nop 1
  v_cndmask_b32 v19, 0, v131, vcc
  v_mov_b32 v20, v18
  v_mov_b32 v21, v19
  s_mov_b32 s100, 0xcccccccc
  s_mov_b32 s101, 0xcccccccc
  v_mov_b32 v12, 0x3f803f80
  v_mov_b32 v13, 0x3f803f80
  v_mov_b32 v14, 0x3f803f80
  v_mov_b32 v15, 0x3f803f80
  v_mov_b32 v16, 0x3f803f80
  v_mov_b32 v17, 0
  v_mov_b32 v22, 0
  v_mov_b32 v23, 0
  v_lshl_add_u32 v29, v132, 3, v134
  v_lshl_add_u32 v28, v129, 9, v134
  v_lshl_add_u32 v29, v133, 9, v29
  v_lshlrev_b32 v131, 3, v132
  v_lshl_add_u32 v131, v133, 5, v131
  v_and_b32 v130, 1, v128
  v_lshlrev_b32 v24, 7, v130
  v_bfe_u32 v137, v128, 1, 3
  v_lshl_add_u32 v24, v137, 4, v24
  v_lshl_add_u32 v24, v129, 8, v24
  s_mul_i32 s71, s12, 1280
  v_add_u32 v25, s71, v2
  v_lshlrev_b32 v26, 2, v0
  v_add_u32 v26, s71, v26
  v_xor_b32 v130, 1, v38
  v_mul_u32_u24 v130, 3072, v130
  v_and_b32 v137, 0xd0, v134
  v_add_u32 v130, v130, v137
  v_add_u32 v31, v130, v131
  s_lshl_b32 s71, s74, 7
  s_add_u32 s71, s71, 5120
  v_add_u32 v31, s71, v31
  v_lshl_add_u32 v30, v132, 5, v130
  v_lshl_add_u32 v30, v133, 8, v30
  s_lshl_b32 s71, s73, 7
  s_add_u32 s71, s71, 5120
  v_add_u32 v30, s71, v30
  v_lshlrev_b32 v35, 2, v0
  s_mul_i32 s71, s12, 5632
  v_add_u32 v32, s71, v2
  v_add_u32 v33, s71, v35
  s_mul_i32 s71, s12, 5632
  v_add_u32 v32, s71, v2
  v_add_u32 v34, s71, v3
  s_mul_i32 s71, s12, 30720
  s_add_u32 s71, s71, 40960
  v_add_u32 v36, s71, v2
  v_min_u32 v127, 8, v128
  v_mul_u32_u24 v130, 86, v127
  v_lshrrev_b32 v130, 8, v130
  v_mul_u32_u24 v130, 93, v130
  s_mul_i32 s71, s45, 3
  v_add3_u32 v127, v127, v130, s71
  v_lshrrev_b32 v127, 2, v127
  v_lshlrev_b32 v127, 8, v127
  s_and_b32 s71, s12, 1
  s_lshl_b32 s71, s71, 3
  v_and_b32 v128, 7, v128
  v_add_u32 v128, s71, v128
  s_cmp_lt_u32 s12, 2
  s_cbranch_scc1 L_nosel_381
  v_lshl_add_u32 v130, v129, 4, v128
  v_lshlrev_b32 v8, 4, v130
  v_lshl_add_u32 v10, v136, 3, v8
  v_lshl_add_u32 v8, v136, 10, v8
  v_lshrrev_b32 v9, 1, v10
  v_lshrrev_b32 v11, 2, v10
L_nosel_381:
  v_lshlrev_b32 v130, 2, v129
  v_lshl_add_u32 v130, v136, 4, v130
  s_lshl_b32 s71, s44, 4
  v_add_u32 v128, s71, v128
  v_sub_u32 v128, v128, v130
  v_cmp_le_i32 s[80:81], 0, v128
  v_cmp_le_i32 s[82:83], 1, v128
  v_cmp_le_i32 s[84:85], 2, v128
  v_cmp_le_i32 s[86:87], 3, v128
  s_mov_b32 s69, 0x3dd53b95
  s_mov_b32 s70, 0xff800000
  s_cmp_eq_u32 s42, 0
  s_cselect_b32 s71, 36864, 0
  v_bfe_u32 v37, v0, 4, 1
  v_mul_lo_u32 v37, v37, s71
  v_add_u32 v127, v127, v37
  s_and_b32 s96, s13, 63
  s_and_b32 s97, s13, 31
  s_xor_b32 s98, s96, 1
  s_mov_b32 s47, 110592
  s_mul_i32 s71, s42, 655360
  s_add_u32 s47, s47, s71
  s_mul_i32 s71, s96, 10240
  s_add_u32 s47, s47, s71
  s_mul_i32 s71, s12, 2560
  s_add_u32 s47, s47, s71
  s_mov_b32 s48, 110592
  s_mul_i32 s71, s42, 655360
  s_add_u32 s48, s48, s71
  s_mul_i32 s71, s98, 10240
  s_add_u32 s48, s48, s71
  s_mul_i32 s71, s12, 2560
  s_add_u32 s48, s48, s71
  s_lshr_b32 s98, s97, 1
  s_mov_b32 s50, 1421312
  s_mul_i32 s71, s42, 327680
  s_add_u32 s50, s50, s71
  s_mul_i32 s71, s43, 163840
  s_add_u32 s50, s50, s71
  s_mul_i32 s71, s53, 81920
  s_add_u32 s50, s50, s71
  s_mul_i32 s71, s12, 20480
  s_add_u32 s50, s50, s71
  s_mul_i32 s71, s98, 256
  s_add_u32 s50, s50, s71
  s_add_u32 s88, s50, 0
  s_add_u32 s89, s50, 4096
  s_add_u32 s90, s50, 8192
  s_add_u32 s91, s50, 12288
  s_add_u32 s92, s50, 16384
  s_lshr_b32 s99, s97, 3
  s_add_u32 s99, s99, 1
  s_sub_u32 s99, s99, s12
  s_lshl_b32 s68, s12, 5
  s_add_u32 s68, s68, s97
  s_cmp_lt_u32 s68, 40
  s_cselect_b32 s68, 1, 0
  s_bfe_u32 s98, s97, 0x10002
  s_and_b32 s97, s97, 3
  s_mul_i32 s97, s97, 5
  s_add_u32 s99, s99, s97
  s_mov_b32 s52, 1421312
  s_mul_i32 s71, s42, 327680
  s_add_u32 s52, s52, s71
  s_mul_i32 s71, s43, 163840
  s_add_u32 s52, s52, s71
  s_mul_i32 s71, s98, 81920
  s_add_u32 s52, s52, s71
  s_mul_i32 s71, s99, 4096
  s_add_u32 s52, s52, s71
  s_xor_b32 s54, s42, s2
  s_and_b32 s54, s54, 3
  s_mov_b32 s56, 2076672
  s_mul_i32 s71, s42, 20480
  s_add_u32 s56, s56, s71
  s_mul_i32 s71, s43, 10240
  s_add_u32 s56, s56, s71
  s_mul_i32 s71, s98, 5120
  s_add_u32 s56, s56, s71
  s_mul_i32 s71, s99, 256
  s_add_u32 s56, s56, s71
  s_mov_b32 s57, 2621440
  s_mul_i32 s71, s43, 65536
  s_add_u32 s57, s57, s71
  s_mul_i32 s71, s98, 32768
  s_add_u32 s57, s57, s71
  s_mul_i32 s71, s54, 8192
  s_add_u32 s57, s57, s71
  s_mul_i32 s71, s99, 256
  s_add_u32 s57, s57, s71
  s_cmp_eq_u32 s68, 0
  s_cselect_b32 s57, 0x20000000, s57
  s_mov_b32 s79, 2076672
  s_mul_i32 s71, s42, 20480
  s_add_u32 s79, s79, s71
  s_mul_i32 s71, s43, 10240
  s_add_u32 s79, s79, s71
  s_mul_i32 s71, s44, 5120
  s_add_u32 s79, s79, s71
  s_mul_i32 s71, s12, 1280
  s_add_u32 s79, s79, s71
  s_mov_b32 s77, 2686976
  s_mul_i32 s71, s43, -65536
  s_add_u32 s77, s77, s71
  s_mul_i32 s71, s44, 32768
  s_add_u32 s77, s77, s71
  s_mul_i32 s71, s54, 8192
  s_add_u32 s77, s77, s71
  s_mul_i32 s71, s12, 1280
  s_add_u32 s77, s77, s71
  s_mov_b32 s64, 5120
  s_mul_i32 s71, s42, 18432
  s_add_u32 s64, s64, s71
  s_mov_b32 s76, 2359296
  s_lshl_b32 s99, s42, 13
  s_xor_b32 s99, s99, s2
  s_and_b32 s99, s99, 0x2000
  s_mul_i32 s97, s45, 52
  s_lshr_b32 s97, s97, 8
  s_min_u32 s97, s97, 5
  s_mov_b32 s22, 6160384
  s_mul_i32 s71, s45, 36864
  s_add_u32 s22, s22, s71
  s_mul_i32 s71, s73, 512
  s_add_u32 s22, s22, s71
  s_mul_i32 s71, s44, 256
  s_add_u32 s22, s22, s71
  s_andn2_b32 s71, s22, 0x1fff
  s_add_u32 s22, s22, s71
  s_add_u32 s22, s22, s99
  s_xor_b32 s22, s22, 0x2000
  s_lshr_b32 s71, s22, 8
  s_and_b32 s71, s71, 0x2000
  s_xor_b32 s60, s22, s71
  s_mov_b32 s23, 6160384
  s_mul_i32 s71, s45, 36864
  s_add_u32 s23, s23, s71
  s_mul_i32 s71, s74, 512
  s_add_u32 s23, s23, s71
  s_mul_i32 s71, s44, 256
  s_add_u32 s23, s23, s71
  s_andn2_b32 s71, s23, 0x1fff
  s_add_u32 s23, s23, s71
  s_add_u32 s23, s23, s99
  s_xor_b32 s23, s23, 0x2000
  s_lshr_b32 s71, s23, 8
  s_and_b32 s71, s71, 0x2000
  s_xor_b32 s61, s23, s71
  s_mov_b32 s20, 7352320
  s_mul_i32 s71, s45, 36864
  s_add_u32 s20, s20, s71
  s_mul_i32 s71, s73, 512
  s_add_u32 s20, s20, s71
  s_andn2_b32 s71, s20, 0x1fff
  s_add_u32 s20, s20, s71
  s_add_u32 s20, s20, s99
  s_lshr_b32 s71, s20, 8
  s_and_b32 s71, s71, 0x2000
  s_xor_b32 s58, s20, s71
  s_mov_b32 s21, 7352320
  s_mul_i32 s71, s45, 36864
  s_add_u32 s21, s21, s71
  s_mul_i32 s71, s74, 512
  s_add_u32 s21, s21, s71
  s_andn2_b32 s71, s21, 0x1fff
  s_add_u32 s21, s21, s71
  s_add_u32 s21, s21, s99
  s_lshr_b32 s71, s21, 8
  s_and_b32 s71, s71, 0x2000
  s_xor_b32 s59, s21, s71
  s_mov_b32 s24, 6184960
  s_mul_i32 s71, s45, 36864
  s_add_u32 s24, s24, s71
  s_mul_i32 s71, s73, 512
  s_add_u32 s24, s24, s71
  s_andn2_b32 s71, s24, 0x1fff
  s_add_u32 s24, s24, s71
  s_add_u32 s24, s24, s99
  s_lshr_b32 s71, s24, 8
  s_and_b32 s71, s71, 0x2000
  s_xor_b32 s62, s24, s71
  s_mov_b32 s25, 6184960
  s_mul_i32 s71, s45, 36864
  s_add_u32 s25, s25, s71
  s_mul_i32 s71, s74, 512
  s_add_u32 s25, s25, s71
  s_andn2_b32 s71, s25, 0x1fff
  s_add_u32 s25, s25, s71
  s_add_u32 s25, s25, s99
  s_lshr_b32 s71, s25, 8
  s_and_b32 s71, s71, 0x2000
  s_xor_b32 s63, s25, s71
  s_mov_b32 s26, 82313216
  s_mul_i32 s71, s45, 12288
  s_add_u32 s26, s26, s71
  s_mul_i32 s71, s73, 512
  s_add_u32 s26, s26, s71
  s_mul_i32 s71, s44, 256
  s_add_u32 s26, s26, s71
  s_mul_i32 s71, s97, 4096
  s_add_u32 s26, s26, s71
  s_andn2_b32 s71, s26, 0x1fff
  s_add_u32 s26, s26, s71
  s_add_u32 s26, s26, s99
  s_lshr_b32 s71, s26, 8
  s_and_b32 s71, s71, 0x2000
  s_xor_b32 s65, s26, s71
  s_mov_b32 s27, 82313216
  s_mul_i32 s71, s45, 12288
  s_add_u32 s27, s27, s71
  s_mul_i32 s71, s74, 512
  s_add_u32 s27, s27, s71
  s_mul_i32 s71, s44, 256
  s_add_u32 s27, s27, s71
  s_mul_i32 s71, s97, 4096
  s_add_u32 s27, s27, s71
  s_andn2_b32 s71, s27, 0x1fff
  s_add_u32 s27, s27, s71
  s_add_u32 s27, s27, s99
  s_lshr_b32 s71, s27, 8
  s_and_b32 s71, s71, 0x2000
  s_xor_b32 s66, s27, s71
  s_mov_b32 s67, 60416
  s_mul_i32 s71, s42, 16384
  s_add_u32 s67, s67, s71
  s_mul_i32 s71, s96, 256
  s_add_u32 s67, s67, s71
  s_cmp_eq_u32 s12, 3
  s_cselect_b32 s67, s67, 0x20000000
  s_mov_b32 s46, -1
  s_mov_b32 s54, 0
  s_mov_b32 s98, 0xffff
  s_mov_b32 s99, 0xffff
  s_cmp_lg_u32 s15, 0
  s_cbranch_scc1 L_rec_mixed
  s_mov_b32 s8, s18
  s_mov_b32 s9, s19
  s_mov_b32 s10, 10240
  s_mov_b32 s11, 0x20000
  v_bfe_u32 v37, v0, 2, 2
  v_and_b32 v38, 1, v0
  v_lshl_add_u32 v37, v37, 1, v38
  v_mul_u32_u24 v37, 1280, v37
  v_bfe_u32 v38, v0, 1, 1
  v_lshl_add_u32 v37, v38, 4, v37
  v_lshrrev_b32 v38, 4, v0
  v_lshl_add_u32 v37, v38, 5, v37
  s_mul_i32 s71, s44, 640
  buffer_load_dwordx4 v[72:75], v37, s[8:11], s71 offen offset:0
  buffer_load_dwordx4 v[76:79], v37, s[8:11], s71 offen offset:128
  buffer_load_dwordx4 v[80:83], v37, s[8:11], s71 offen offset:256
  buffer_load_dwordx4 v[84:87], v37, s[8:11], s71 offen offset:384
  buffer_load_dwordx4 v[88:91], v37, s[8:11], s71 offen offset:512
  buffer_load_dword v37, v127, s[4:7], s64 offen offset:0 sc1
  s_waitcnt vmcnt(0)
L_fq0a_top_388:
  v_cmp_ge_i32 vcc, 0, v37
  s_cbranch_vccnz L_fq0a_rt_390
L_fq0a_ok_389:
  buffer_load_dwordx4 v[40:43], v28, s[4:7], s58 offen offset:0 sc1
  buffer_load_dwordx4 v[44:47], v28, s[4:7], s58 offen offset:256 sc1
  buffer_load_dwordx2 v[48:49], v29, s[4:7], s59 offen offset:0 sc1
  buffer_load_dwordx2 v[50:51], v29, s[4:7], s59 offen offset:256 sc1
  s_cmp_eq_u32 s12, 2
  s_cselect_b32 s64, s64, 0x20000000
  s_cselect_b64 vcc, -1, 0
  v_cndmask_b32 v27, v35, v127, vcc
  v_mfma_f32_32x32x8_bf16 v[92:107], v[22:23], v[22:23], 0
  v_mfma_f32_32x32x8_bf16 v[108:123], v[22:23], v[22:23], 0
  v_mfma_f32_16x16x16_bf16 v[124:127], v[22:23], v[22:23], 0
  ds_read_b128 v[128:131], v36 offset:0
  ds_read_b128 v[132:135], v36 offset:1024
  ds_read_b128 v[136:139], v36 offset:2048
  ds_read_b128 v[140:143], v36 offset:3072
  ds_read_b128 v[144:147], v36 offset:4096
  ds_read_b128 v[148:151], v36 offset:5120
  v_lshlrev_b32 v0, 24, v0
  v_min_u32 v0, 0x1000000, v0
  v_lshlrev_b32 v0, 4, v0
  s_waitcnt lgkmcnt(0)
  s_nop 15
L_rec_topa:
  s_waitcnt lgkmcnt(4)
  v_smfmac_f32_16x16x64_bf16 v[92:95], v[72:75], v[128:135], v1
  s_waitcnt lgkmcnt(3)
  s_add_u32 s46, s46, 1
  ds_read_b128 v[128:131], v36 offset:6144
  v_smfmac_f32_16x16x64_bf16 v[92:95], v[76:79], a[0:7], v1
  s_waitcnt lgkmcnt(3)
  s_and_b32 s49, s46, 1
  ds_read_b128 v[132:135], v36 offset:7168
  v_smfmac_f32_16x16x64_bf16 v[92:95], v[80:83], v[136:143], v1
  s_waitcnt lgkmcnt(3)
  s_add_u32 s57, s57, s54
  ds_read_b128 v[136:139], v36 offset:8192
  v_smfmac_f32_16x16x64_bf16 v[92:95], v[84:87], a[8:15], v1
  s_waitcnt lgkmcnt(3)
  s_add_u32 s77, s77, s54
  ds_read_b128 v[140:143], v36 offset:9216
  v_smfmac_f32_16x16x64_bf16 v[92:95], v[88:91], v[144:151], v1
  s_mov_b32 s54, 131072
  ds_read_b128 v[144:147], v36 offset:10240
  v_smfmac_f32_16x16x64_bf16 v[96:99], v[72:75], a[16:23], v1
  s_andn2_b32 s71, 3, s46
  s_cselect_b32 s54, s54, -393216
  ds_read_b128 v[148:151], v36 offset:11264
  v_smfmac_f32_16x16x64_bf16 v[96:99], v[76:79], a[24:31], v1
  s_add_u32 s51, s57, s54
  s_add_u32 s20, s20, s76
  v_add_f32 v92, v92, v94
  v_smfmac_f32_16x16x64_bf16 v[96:99], v[80:83], a[32:39], v1
  s_lshr_b32 s71, s20, 8
  s_and_b32 s71, s71, 0x2000
  v_add_f32 v93, v93, v95
  v_smfmac_f32_16x16x64_bf16 v[96:99], v[84:87], a[40:47], v1
  s_waitcnt lgkmcnt(4)
  s_xor_b32 s58, s20, s71
  v_cvt_pk_bf16_f32 v92, v92, v93
  v_smfmac_f32_16x16x64_bf16 v[96:99], v[88:91], v[128:135], v1
  s_add_u32 s21, s21, s76
  s_lshr_b32 s71, s21, 8
  ds_read_b128 v[128:131], v36 offset:12288
  v_bfi_b32 v92, 1, s49, v92
  v_smfmac_f32_16x16x64_bf16 v[100:103], v[72:75], a[48:55], v1
  s_and_b32 s71, s71, 0x2000
  s_xor_b32 s59, s21, s71
  ds_read_b128 v[132:135], v36 offset:13312
  v_smfmac_f32_16x16x64_bf16 v[100:103], v[76:79], a[56:63], v1
  s_add_u32 s22, s22, s76
  s_lshr_b32 s71, s22, 8
  v_add_f32 v96, v96, v98
  v_smfmac_f32_16x16x64_bf16 v[100:103], v[80:83], a[64:71], v1
  s_and_b32 s71, s71, 0x2000
  s_xor_b32 s60, s22, s71
  v_add_f32 v97, v97, v99
  v_smfmac_f32_16x16x64_bf16 v[100:103], v[84:87], a[72:79], v1
  s_add_u32 s23, s23, s76
  s_lshr_b32 s71, s23, 8
  v_cvt_pk_bf16_f32 v93, v96, v97
  v_smfmac_f32_16x16x64_bf16 v[100:103], v[88:91], a[80:87], v1
  s_waitcnt lgkmcnt(4)
  s_and_b32 s71, s71, 0x2000
  buffer_store_dwordx2 v[92:93], v3, s[4:7], s47 offen offset:0
  v_smfmac_f32_16x16x64_bf16 v[104:107], v[72:75], v[136:143], v1
  s_xor_b32 s61, s23, s71
  s_add_u32 s24, s24, s76
  ds_read_b128 v[136:139], v36 offset:14336
  v_smfmac_f32_16x16x64_bf16 v[104:107], v[76:79], a[88:95], v1
  s_lshr_b32 s71, s24, 8
  s_and_b32 s71, s71, 0x2000
  v_add_f32 v100, v100, v102
  v_smfmac_f32_16x16x64_bf16 v[104:107], v[80:83], a[96:103], v1
  s_xor_b32 s62, s24, s71
  s_add_u32 s25, s25, s76
  v_add_f32 v101, v101, v103
  v_smfmac_f32_16x16x64_bf16 v[104:107], v[84:87], a[104:111], v1
  s_lshr_b32 s71, s25, 8
  s_and_b32 s71, s71, 0x2000
  v_cvt_pk_bf16_f32 v100, v100, v101
  v_smfmac_f32_16x16x64_bf16 v[104:107], v[88:91], a[112:119], v1
  s_xor_b32 s63, s25, s71
  s_add_u32 s26, s26, 1048576
  v_bfi_b32 v100, 1, s49, v100
  v_smfmac_f32_16x16x64_bf16 v[108:111], v[72:75], a[120:127], v1
  s_waitcnt lgkmcnt(3)
  s_lshr_b32 s71, s26, 8
  ds_read_b128 v[140:143], v36 offset:15360
  v_smfmac_f32_16x16x64_bf16 v[108:111], v[76:79], v[144:151], v1
  s_and_b32 s71, s71, 0x2000
  s_xor_b32 s65, s26, s71
  ds_read_b128 v[144:147], v36 offset:16384
  v_add_f32 v104, v104, v106
  v_smfmac_f32_16x16x64_bf16 v[108:111], v[80:83], a[128:135], v1
  s_add_u32 s27, s27, 1048576
  s_lshr_b32 s71, s27, 8
  v_add_f32 v105, v105, v107
  v_smfmac_f32_16x16x64_bf16 v[108:111], v[84:87], a[136:143], v1
  s_and_b32 s71, s71, 0x2000
  s_xor_b32 s66, s27, s71
  v_cvt_pk_bf16_f32 v101, v104, v105
  v_smfmac_f32_16x16x64_bf16 v[108:111], v[88:91], a[144:151], v1
  buffer_store_dwordx2 v[100:101], v3, s[4:7], s47 offen offset:512
  v_smfmac_f32_16x16x64_bf16 v[112:115], v[72:75], a[152:159], v1
  ds_read_b128 v[148:151], v36 offset:17408
  v_smfmac_f32_16x16x64_bf16 v[112:115], v[76:79], a[160:167], v1
  v_add_f32 v108, v108, v110
  v_smfmac_f32_16x16x64_bf16 v[112:115], v[80:83], a[168:175], v1
  s_waitcnt lgkmcnt(4)
  v_add_f32 v109, v109, v111
  v_smfmac_f32_16x16x64_bf16 v[112:115], v[84:87], v[128:135], v1
  s_waitcnt lgkmcnt(2)
  v_cvt_pk_bf16_f32 v108, v108, v109
  v_smfmac_f32_16x16x64_bf16 v[112:115], v[88:91], v[136:143], v1
  ds_read_b128 v[128:131], v36 offset:18432
  v_bfi_b32 v108, 1, s49, v108
  v_smfmac_f32_16x16x64_bf16 v[116:119], v[72:75], a[176:183], v1
  ds_read_b128 v[132:135], v36 offset:19456
  v_smfmac_f32_16x16x64_bf16 v[116:119], v[76:79], a[184:191], v1
  s_waitcnt lgkmcnt(2)
  v_add_f32 v112, v112, v114
  v_add_f32 v113, v113, v115
  v_cvt_pk_bf16_f32 v109, v112, v113
  buffer_store_dwordx2 v[108:109], v3, s[4:7], s47 offen offset:1024
  ds_read_b128 v[136:139], v36 offset:20480
  ds_read_b128 v[140:143], v36 offset:21504
  v_smfmac_f32_16x16x64_bf16 v[116:119], v[80:83], v[144:151], v1
  ds_read_b128 v[144:147], v36 offset:22528
  ds_read_b128 v[148:151], v36 offset:23552
  v_smfmac_f32_16x16x64_bf16 v[116:119], v[84:87], a[192:199], v1
  v_smfmac_f32_16x16x64_bf16 v[116:119], v[88:91], a[200:207], v1
  buffer_load_dwordx2 v[94:95], v3, s[4:7], s48 offen offset:0 sc1
  v_smfmac_f32_16x16x64_bf16 v[120:123], v[72:75], a[208:215], v1
  s_waitcnt lgkmcnt(4)
  buffer_load_dwordx2 v[102:103], v3, s[4:7], s48 offen offset:512 sc1
  v_smfmac_f32_16x16x64_bf16 v[120:123], v[76:79], v[128:135], v1
  s_waitcnt lgkmcnt(2)
  ds_read_b128 v[128:131], v36 offset:24576
  ds_read_b128 v[132:135], v36 offset:25600
  v_add_f32 v116, v116, v118
  v_smfmac_f32_16x16x64_bf16 v[120:123], v[80:83], v[136:143], v1
  s_waitcnt lgkmcnt(2)
  ds_read_b128 v[136:139], v36 offset:26624
  ds_read_b128 v[140:143], v36 offset:27648
  v_add_f32 v117, v117, v119
  v_smfmac_f32_16x16x64_bf16 v[120:123], v[84:87], v[144:151], v1
  ds_read_b128 v[144:147], v36 offset:28672
  ds_read_b128 v[148:151], v36 offset:29696
  v_cvt_pk_bf16_f32 v116, v116, v117
  v_smfmac_f32_16x16x64_bf16 v[120:123], v[88:91], a[216:223], v1
  v_mov_b32 v119, s49
  v_smfmac_f32_16x16x64_bf16 v[124:127], v[72:75], a[224:231], v1
  buffer_load_dwordx2 v[110:111], v3, s[4:7], s48 offen offset:1024 sc1
  v_smfmac_f32_16x16x64_bf16 v[124:127], v[76:79], a[232:239], v1
  s_waitcnt lgkmcnt(4)
  v_add_f32 v120, v120, v122
  v_smfmac_f32_16x16x64_bf16 v[124:127], v[80:83], v[128:135], v1
  s_waitcnt lgkmcnt(2)
  v_add_f32 v121, v121, v123
  v_smfmac_f32_16x16x64_bf16 v[124:127], v[84:87], v[136:143], v1
  s_waitcnt lgkmcnt(0)
  v_cvt_pk_bf16_f32 v117, v120, v121
  v_smfmac_f32_16x16x64_bf16 v[124:127], v[88:91], v[144:151], v1
  s_nop 7
  v_add_f32 v124, v124, v126
  v_add_f32 v125, v125, v127
  v_cvt_pk_bf16_f32 v118, v124, v125
  buffer_store_dwordx4 v[116:119], v2, s[4:7], s47 offen offset:1536
  buffer_load_dwordx2 v[64:65], v3, s[4:7], s48 offen offset:0 sc1
  buffer_load_dwordx2 v[66:67], v3, s[4:7], s48 offen offset:512 sc1
  buffer_load_dwordx2 v[68:69], v3, s[4:7], s48 offen offset:1024 sc1
  s_waitcnt vmcnt(5)
  v_mfma_f32_16x16x32_bf16 v[128:131], v[92:95], v[18:21], 0
  v_bitop3_b32 v37, v94, v102, s49 bitop3:0x7e
  v_mfma_f32_16x16x32_bf16 v[132:135], v[100:103], v[18:21], 0
  s_waitcnt vmcnt(4)
  v_bitop3_b32 v37, v37, v110, s49 bitop3:0xf6
  v_and_b32 v37, 1, v37
  v_mfma_f32_16x16x32_bf16 v[136:139], v[108:111], v[18:21], 0
  v_cmp_ne_u32 vcc, 0, v37
  v_cvt_pk_bf16_f32 v96, v128, v129
  v_cvt_pk_bf16_f32 v97, v130, v131
  s_nop 0
  v_cvt_pk_bf16_f32 v98, v132, v133
  v_cvt_pk_bf16_f32 v99, v134, v135
  s_nop 1
  v_cvt_pk_bf16_f32 v104, v136, v137
  v_cvt_pk_bf16_f32 v105, v138, v139
  s_cbranch_vccnz L_hamiss_391
L_hagot_392:
  v_mfma_f32_16x16x32_bf16 v[100:103], v[40:43], v[96:99], 0
  s_cmp_eq_u32 s46, 63
  s_cbranch_scc1 L_last_393
  v_mfma_f32_16x16x32_bf16 v[108:111], v[44:47], v[96:99], 0
  s_mov_b64 vcc, s[100:101]
  buffer_load_dwordx4 v[52:55], v2, s[4:7], s62 offen offset:0 sc1
  v_mfma_f32_16x16x32_bf16 v[112:115], v[96:99], v[96:99], 0
  buffer_load_dwordx4 v[56:59], v2, s[4:7], s62 offen offset:1024 sc1
  v_mfma_f32_16x16x16_bf16 v[100:103], v[48:49], v[104:105], v[100:103]
  buffer_load_dwordx4 v[60:63], v2, s[4:7], s63 offen offset:0 sc1
  v_mfma_f32_16x16x16_bf16 v[108:111], v[50:51], v[104:105], v[108:111]
  v_mfma_f32_16x16x16_bf16 v[112:115], v[104:105], v[104:105], v[112:115]
  v_mfma_f32_16x16x16_bf16 v[88:91], v[22:23], v[22:23], 0
  v_cndmask_b32_dpp v100, v108, v100, vcc quad_perm:[2,3,2,3] row_mask:0xf bank_mask:0xf
  v_cndmask_b32_dpp v101, v109, v101, vcc quad_perm:[2,3,2,3] row_mask:0xf bank_mask:0xf
  v_cndmask_b32_dpp v102, v110, v102, vcc quad_perm:[2,3,2,3] row_mask:0xf bank_mask:0xf
  v_cndmask_b32_dpp v103, v111, v103, vcc quad_perm:[2,3,2,3] row_mask:0xf bank_mask:0xf
  ds_write_b128 v32, v[100:103] offset:11264
  v_cndmask_b32_dpp v112, v113, v112, vcc quad_perm:[2,3,2,3] row_mask:0xf bank_mask:0xf
  ds_write_b32 v33, v112 offset:12288
  v_mfma_f32_32x32x8_bf16 v[72:87], v[22:23], v[22:23], 0
  buffer_load_dwordx4 v[120:123], v2, s[4:7], s48 offen offset:1536 sc1
  s_waitcnt lgkmcnt(0)
  s_barrier
  ds_read_b128 v[128:131], v2 offset:11264
  ds_read_b128 v[132:135], v2 offset:16896
  ds_read_b128 v[136:139], v2 offset:22528
  ds_read_b128 v[144:147], v2 offset:28160
  ds_read2st64_b32 v[148:149], v35 offset0:48 offset1:70
  ds_read2st64_b32 v[150:151], v35 offset0:92 offset1:114
  buffer_load_dwordx4 v[64:67], v28, s[4:7], s60 offen offset:0 sc1
  buffer_load_dwordx2 v[68:69], v29, s[4:7], s61 offen offset:0 sc1
  s_waitcnt lgkmcnt(4)
  v_pk_add_f32 v[128:129], v[128:129], v[132:133]
  v_pk_add_f32 v[130:131], v[130:131], v[134:135]
  s_waitcnt lgkmcnt(2)
  v_pk_add_f32 v[136:137], v[136:137], v[144:145]
  v_pk_add_f32 v[138:139], v[138:139], v[146:147]
  v_pk_add_f32 v[128:129], v[128:129], v[136:137]
  v_pk_add_f32 v[130:131], v[130:131], v[138:139]
  s_waitcnt lgkmcnt(0)
  v_pk_add_f32 v[148:149], v[148:149], v[150:151]
  v_max3_f32 v37, v128, v129, v130
  v_add_f32 v132, v148, v149
  v_max3_f32 v37, v37, v131, v132
  buffer_store_dword v119, v35, s[4:7], s51 offen offset:0 sc1
  s_nop 0
  v_max_f32_dpp v38, v37, v37 quad_perm:[2,3,0,1] row_mask:0xf bank_mask:0xf
  v_max_f32_dpp v37, v37, v37 quad_perm:[2,3,0,1] row_mask:0xf bank_mask:0xf
  s_nop 1
  v_permlane32_swap_b32 v37, v38
  v_max_f32 v133, v37, v38
  v_max_f32 v37, v37, v38
  v_mov_b32 v38, s46
  buffer_store_dword v38, v0, s[4:7], s67 offen offset:0 sc1
  v_permlane16_swap_b32 v37, v133
  v_max_f32 v37, v37, v133
  v_mul_f32 v37, s69, v37
  v_fma_f32 v128, v128, s69, -v37
  v_fma_f32 v129, v129, s69, -v37
  v_fma_f32 v130, v130, s69, -v37
  v_fma_f32 v131, v131, s69, -v37
  v_fma_f32 v132, v132, s69, -v37
  v_exp_f32 v128, v128
  v_exp_f32 v129, v129
  v_exp_f32 v130, v130
  v_exp_f32 v131, v131
  v_exp_f32 v132, v132
  v_cvt_pk_bf16_f32 v92, v128, v129
  v_cvt_pk_bf16_f32 v93, v130, v131
  v_mov_b32_dpp v133, v132 quad_perm:[0,1,0,1] row_mask:0xf bank_mask:0xf
  v_mov_b32_dpp v94, v92 quad_perm:[0,1,0,1] row_mask:0xf bank_mask:0xf
  v_mov_b32_dpp v95, v93 quad_perm:[0,1,0,1] row_mask:0xf bank_mask:0xf
  v_cvt_pk_bf16_f32 v106, v132, v133
  v_cvt_pk_bf16_f32 v107, v132, v133
  s_waitcnt vmcnt(4)
L_hva_top_385:
  v_mfma_f32_16x16x32_bf16 v[124:127], v[12:15], v[92:95], 0
  v_xor_b32 v37, s49, v123
  v_and_b32 v37, 1, v37
  v_mfma_f32_16x16x32_bf16 v[100:103], v[52:55], v[92:95], 0
  v_cmp_ne_u32 vcc, 0, v37
  v_mfma_f32_16x16x32_bf16 v[108:111], v[56:59], v[92:95], 0
  v_mfma_f32_16x16x32_bf16 v[112:115], v[60:63], v[92:95], 0
  s_cbranch_vccnz L_hva_rt_387
L_hva_ok_386:
  v_swap_b32 v117, v120
  v_mfma_f32_16x16x16_bf16 v[124:127], v[16:17], v[106:107], v[124:127]
  v_mov_b32 v119, v122
  buffer_load_dword v39, v27, s[4:7], s64 offen offset:0 sc1
  v_mfma_f32_16x16x16_bf16 v[100:103], v[116:117], v[106:107], v[100:103]
  v_mfma_f32_16x16x16_bf16 v[108:111], v[120:121], v[106:107], v[108:111]
  v_rcp_f32 v124, v124
  v_mfma_f32_16x16x16_bf16 v[112:115], v[118:119], v[106:107], v[112:115]
  v_mul_f32 v100, v100, v124
  v_mul_f32 v101, v101, v124
  v_mul_f32 v102, v102, v124
  v_mul_f32 v103, v103, v124
  v_cvt_pk_bf16_f32 v100, v100, v101
  v_cvt_pk_bf16_f32 v101, v102, v103
  v_pk_mul_f32 v[108:109], v[108:109], v[124:125] op_sel_hi:[1,0]
  v_pk_mul_f32 v[110:111], v[110:111], v[124:125] op_sel_hi:[1,0]
  v_cvt_pk_bf16_f32 v102, v108, v109
  v_cvt_pk_bf16_f32 v103, v110, v111
  ds_write_b128 v30, v[100:103]
  v_pk_mul_f32 v[112:113], v[112:113], v[124:125] op_sel_hi:[1,0]
  v_pk_mul_f32 v[114:115], v[114:115], v[124:125] op_sel_hi:[1,0]
  v_cvt_pk_bf16_f32 v112, v112, v113
  v_cvt_pk_bf16_f32 v113, v114, v115
  ds_write_b64 v31, v[112:113]
  s_waitcnt lgkmcnt(0)
  s_barrier
  ds_read_b128 v[128:131], v2 offset:5120
  ds_read_b128 v[132:135], v2 offset:6144
  ds_read_b128 v[136:139], v2 offset:7168
  s_waitcnt lgkmcnt(2)
  v_smfmac_f32_16x16x64_bf16 v[72:75], v[128:131], a[240:247], v1
  s_waitcnt lgkmcnt(1)
  v_smfmac_f32_16x16x64_bf16 v[72:75], v[132:135], a[248:255], v1
  s_waitcnt lgkmcnt(0)
  v_smfmac_f32_16x16x64_bf16 v[72:75], v[136:139], v[152:159], v1
  v_smfmac_f32_16x16x64_bf16 v[76:79], v[128:131], v[160:167], v1
  v_smfmac_f32_16x16x64_bf16 v[76:79], v[132:135], v[168:175], v1
  v_add_f32 v72, v72, v74
  v_smfmac_f32_16x16x64_bf16 v[76:79], v[136:139], v[176:183], v1
  v_add_f32 v73, v73, v75
  v_smfmac_f32_16x16x64_bf16 v[80:83], v[128:131], v[184:191], v1
  v_cvt_pk_bf16_f32 v140, v72, v73
  v_smfmac_f32_16x16x64_bf16 v[80:83], v[132:135], v[192:199], v1
  v_bfi_b32 v140, v6, s49, v140
  v_smfmac_f32_16x16x64_bf16 v[80:83], v[136:139], v[200:207], v1
  buffer_store_dword v140, v35, s[4:7], s88 offen offset:0
  v_smfmac_f32_16x16x64_bf16 v[84:87], v[128:131], v[208:215], v1
  v_add_f32 v76, v76, v78
  v_smfmac_f32_16x16x64_bf16 v[84:87], v[132:135], v[216:223], v1
  v_add_f32 v77, v77, v79
  v_smfmac_f32_16x16x64_bf16 v[84:87], v[136:139], v[224:231], v1
  v_cvt_pk_bf16_f32 v141, v76, v77
  v_smfmac_f32_16x16x64_bf16 v[88:91], v[128:131], v[232:239], v1
  v_bfi_b32 v141, v6, s49, v141
  v_smfmac_f32_16x16x64_bf16 v[88:91], v[132:135], v[240:247], v1
  buffer_store_dword v141, v35, s[4:7], s89 offen offset:0
  v_smfmac_f32_16x16x64_bf16 v[88:91], v[136:139], v[248:255], v1
  v_add_f32 v80, v80, v82
  v_add_f32 v81, v81, v83
  v_cvt_pk_bf16_f32 v142, v80, v81
  v_bfi_b32 v142, v6, s49, v142
  buffer_store_dword v142, v35, s[4:7], s90 offen offset:0
  v_add_f32 v84, v84, v86
  v_add_f32 v85, v85, v87
  v_cvt_pk_bf16_f32 v143, v84, v85
  v_bfi_b32 v143, v6, s49, v143
  buffer_store_dword v143, v35, s[4:7], s91 offen offset:0
  v_add_f32 v88, v88, v90
  v_add_f32 v89, v89, v91
  v_cvt_pk_bf16_f32 v144, v88, v89
  v_bfi_b32 v144, v6, s49, v144
  buffer_store_dword v144, v35, s[4:7], s92 offen offset:0
  s_waitcnt vmcnt(8)
  v_mfma_f32_16x16x32_bf16 v[92:95], v[40:43], v[64:67], 0
  v_mfma_f32_16x16x32_bf16 v[108:111], v[44:47], v[64:67], 0
  v_mfma_f32_16x16x32_bf16 v[124:127], v[96:99], v[64:67], 0
  v_mfma_f32_16x16x16_bf16 v[92:95], v[48:49], v[68:69], v[92:95]
  v_mfma_f32_16x16x16_bf16 v[108:111], v[50:51], v[68:69], v[108:111]
  v_mfma_f32_16x16x16_bf16 v[124:127], v[104:105], v[68:69], v[124:127]
  s_cmp_eq_u32 s68, 0
  s_nop 3
  s_cbranch_scc1 L_nored_394
  buffer_load_dwordx4 v[128:131], v2, s[4:7], s52 offen offset:0 sc1
  buffer_load_dwordx4 v[132:135], v2, s[4:7], s52 offen offset:1024 sc1
  buffer_load_dwordx4 v[136:139], v2, s[4:7], s52 offen offset:2048 sc1
  buffer_load_dwordx4 v[140:143], v2, s[4:7], s52 offen offset:3072 sc1
  ds_write_b128 v32, v[92:95] offset:12544
  ds_write_b128 v32, v[108:111] offset:13568
  ds_write_b64 v34, v[124:125] offset:14592
  buffer_load_dwordx4 v[72:75], v2, s[4:7], s52 offen offset:0 sc1
  buffer_load_dwordx4 v[76:79], v2, s[4:7], s52 offen offset:1024 sc1
  buffer_load_dwordx4 v[80:83], v2, s[4:7], s52 offen offset:2048 sc1
  buffer_load_dwordx4 v[84:87], v2, s[4:7], s52 offen offset:3072 sc1
  s_waitcnt lgkmcnt(0)
  s_barrier
L_hb_398:
  s_add_u32 s14, s14, 1
  s_cmp_lt_u32 s14, 100000
  s_cselect_b32 s75, 1, 0
  s_waitcnt vmcnt(6)
  v_mfma_f32_16x16x32_bf16 v[148:151], v[8:11], v[128:131], 0
  v_mfma_f32_16x16x32_bf16 v[148:151], v[8:11], v[132:135], v[148:151]
  v_bitop3_b32 v37, v128, v132, s49 bitop3:0x7e
  s_waitcnt vmcnt(5)
  v_mfma_f32_16x16x32_bf16 v[148:151], v[8:11], v[136:139], v[148:151]
  v_bitop3_b32 v37, v37, v136, s49 bitop3:0xf6
  s_waitcnt vmcnt(4)
  v_mfma_f32_16x16x32_bf16 v[148:151], v[8:11], v[140:143], v[148:151]
  v_bitop3_b32 v37, v37, v140, s49 bitop3:0xf6
  v_and_b32 v37, s75, v37
  v_cmp_ne_u32 vcc, 0, v37
  s_cbranch_vccz L_pub_396
  buffer_load_dwordx4 v[128:131], v2, s[4:7], s52 offen offset:0 sc1
  buffer_load_dwordx4 v[132:135], v2, s[4:7], s52 offen offset:1024 sc1
  buffer_load_dwordx4 v[136:139], v2, s[4:7], s52 offen offset:2048 sc1
  buffer_load_dwordx4 v[140:143], v2, s[4:7], s52 offen offset:3072 sc1
  s_waitcnt vmcnt(6)
  v_mfma_f32_16x16x32_bf16 v[148:151], v[8:11], v[72:75], 0
  v_mfma_f32_16x16x32_bf16 v[148:151], v[8:11], v[76:79], v[148:151]
  v_bitop3_b32 v37, v72, v76, s49 bitop3:0x7e
  s_waitcnt vmcnt(5)
  v_mfma_f32_16x16x32_bf16 v[148:151], v[8:11], v[80:83], v[148:151]
  v_bitop3_b32 v37, v37, v80, s49 bitop3:0xf6
  s_waitcnt vmcnt(4)
  v_mfma_f32_16x16x32_bf16 v[148:151], v[8:11], v[84:87], v[148:151]
  v_bitop3_b32 v37, v37, v84, s49 bitop3:0xf6
  v_and_b32 v37, s75, v37
  v_cmp_ne_u32 vcc, 0, v37
  s_cbranch_vccnz L_hb_397
L_pub_396:
  s_mov_b32 exec_hi, 0
  s_nop 2
  v_cvt_pk_bf16_f32 v148, v148, v149
  v_cvt_pk_bf16_f32 v149, v150, v151
  v_bfi_b32 v148, 1, s49, v148
  buffer_store_dwordx2 v[148:149], v3, s[4:7], s57 offen offset:0 sc1
  buffer_store_dwordx2 v[148:149], v3, s[4:7], s56 offen offset:0
  s_mov_b32 exec_hi, -1
L_join_395:
  s_waitcnt lgkmcnt(0)
  s_barrier
  ds_read_b128 v[92:95], v2 offset:33792
  ds_read2st64_b32 v[106:107], v35 offset0:136 offset1:136
  s_cmp_eq_u32 s46, 63
  s_cbranch_scc1 L_rec_donea
  s_waitcnt lgkmcnt(0)
  v_mfma_f32_16x16x32_bf16 v[124:127], v[12:15], v[92:95], 0
  v_mfma_f32_16x16x32_bf16 v[100:103], v[52:55], v[92:95], 0
  v_mfma_f32_16x16x32_bf16 v[108:111], v[56:59], v[92:95], 0
  v_mfma_f32_16x16x32_bf16 v[112:115], v[60:63], v[92:95], 0
  v_mfma_f32_16x16x16_bf16 v[124:127], v[16:17], v[106:107], v[124:127]
  v_mfma_f32_16x16x16_bf16 v[100:103], v[116:117], v[106:107], v[100:103]
  v_mfma_f32_16x16x16_bf16 v[108:111], v[120:121], v[106:107], v[108:111]
  v_rcp_f32 v124, v124
  v_mfma_f32_16x16x16_bf16 v[112:115], v[118:119], v[106:107], v[112:115]
  buffer_load_dwordx4 v[48:51], v2, s[4:7], s79 offen offset:0 sc1
  buffer_load_dword v52, v35, s[4:7], s79 offen offset:1024 sc1
  v_mul_f32 v100, v100, v124
  v_mul_f32 v101, v101, v124
  v_mul_f32 v102, v102, v124
  v_mul_f32 v103, v103, v124
  v_cvt_pk_bf16_f32 v64, v100, v101
  v_cvt_pk_bf16_f32 v65, v102, v103
  v_pk_mul_f32 v[108:109], v[108:109], v[124:125] op_sel_hi:[1,0]
  v_pk_mul_f32 v[110:111], v[110:111], v[124:125] op_sel_hi:[1,0]
  v_cvt_pk_bf16_f32 v66, v108, v109
  v_cvt_pk_bf16_f32 v67, v110, v111
  v_pk_mul_f32 v[112:113], v[112:113], v[124:125] op_sel_hi:[1,0]
  v_pk_mul_f32 v[114:115], v[114:115], v[124:125] op_sel_hi:[1,0]
  v_cvt_pk_bf16_f32 v68, v112, v113
  v_cvt_pk_bf16_f32 v69, v114, v115
  buffer_load_dwordx4 v[40:43], v2, s[4:7], s77 offen offset:0 sc1
  buffer_load_dword v53, v35, s[4:7], s77 offen offset:1024 sc1
  v_permlane16_swap_b32 v68, v70
  v_permlane16_swap_b32 v69, v71
  v_mfma_f32_32x32x8_bf16 v[92:107], v[22:23], v[22:23], 0
  v_mfma_f32_32x32x8_bf16 v[108:123], v[22:23], v[22:23], 0
  v_mfma_f32_16x16x16_bf16 v[124:127], v[22:23], v[22:23], 0
  buffer_load_dwordx4 v[44:47], v2, s[4:7], s77 offen offset:0 sc1
  buffer_load_dword v55, v35, s[4:7], s77 offen offset:1024 sc1
  s_add_u32 s14, s14, 1
  s_cmp_lt_u32 s14, 100000
  s_cselect_b32 s75, 1, 0
  s_waitcnt vmcnt(4)
L_hl_399:
  v_bitop3_b32 v37, v48, v50, s49 bitop3:0x7e
  v_bitop3_b32 v38, v52, s49, v7 bitop3:0x28
  v_bitop3_b32 v37, v37, v38, s75 bitop3:0xa8
  v_cmp_ne_u32 vcc, 0, v37
  ds_read_b128 v[128:131], v36 offset:0
  ds_read_b128 v[132:135], v36 offset:1024
  ds_read_b128 v[136:139], v36 offset:2048
  s_cbranch_vccnz L_hlmiss_400
  v_mfma_f32_16x16x16_bf16 v[72:75], v[18:19], v[48:49], 0
  v_mov_b32 v54, v52
  ds_read_b128 v[140:143], v36 offset:3072
  v_mfma_f32_16x16x16_bf16 v[76:79], v[18:19], v[50:51], 0
  ds_read_b128 v[144:147], v36 offset:4096
  ds_read_b128 v[148:151], v36 offset:5120
  s_waitcnt vmcnt(3)
  v_mfma_f32_16x16x16_bf16 v[72:75], v[18:19], v[40:41], v[72:75]
  v_bitop3_b32 v37, v40, v42, s49 bitop3:0x7e
  v_mfma_f32_16x16x16_bf16 v[76:79], v[18:19], v[42:43], v[76:79]
  s_waitcnt vmcnt(2)
  v_bitop3_b32 v38, v53, s49, v7 bitop3:0x28
  v_bitop3_b32 v37, v37, v38, s75 bitop3:0xa8
  v_mfma_f32_16x16x16_bf16 v[80:83], v[4:5], v[52:53], 0
  v_cmp_ne_u32 vcc, 0, v37
  s_cbranch_vccnz L_hcmiss_401
L_hcgot_402:
  v_cvt_pk_bf16_f32 v84, v74, v75
  v_cvt_pk_bf16_f32 v85, v72, v73
  v_cvt_pk_bf16_f32 v86, v78, v79
  v_cvt_pk_bf16_f32 v87, v76, v77
  ds_write_b128 v25, v[84:87] offset:0
  s_nop 0
  v_cvt_pk_bf16_f32 v88, v80, v81
  ds_write_b32 v26, v88 offset:1024
  buffer_load_dwordx4 v[40:43], v28, s[4:7], s58 offen offset:0 sc1
  buffer_load_dwordx4 v[44:47], v28, s[4:7], s58 offen offset:256 sc1
  buffer_load_dwordx2 v[48:49], v29, s[4:7], s59 offen offset:0 sc1
  s_waitcnt lgkmcnt(0)
  s_barrier
  ds_read_b128 v[72:75], v24 offset:0
  ds_read_b128 v[76:79], v24 offset:1024
  ds_read_b128 v[80:83], v24 offset:2048
  ds_read_b128 v[84:87], v24 offset:3072
  ds_read_b128 v[88:91], v24 offset:4096
  buffer_load_dwordx2 v[50:51], v29, s[4:7], s59 offen offset:256 sc1
  buffer_store_dwordx4 v[64:67], v28, s[4:7], s65 offen offset:0 sc1
  s_mov_b64 exec, s[98:99]
  buffer_store_dwordx4 v[68:71], v29, s[4:7], s66 offen offset:0 sc1
  s_mov_b64 exec, -1
  s_branch L_rec_topa
L_rec_donea:
  s_waitcnt lgkmcnt(0)
  v_mfma_f32_16x16x32_bf16 v[124:127], v[12:15], v[92:95], 0
  v_mfma_f32_16x16x32_bf16 v[100:103], v[52:55], v[92:95], 0
  v_mfma_f32_16x16x32_bf16 v[108:111], v[56:59], v[92:95], 0
  v_mfma_f32_16x16x32_bf16 v[112:115], v[60:63], v[92:95], 0
  v_mfma_f32_16x16x16_bf16 v[124:127], v[16:17], v[106:107], v[124:127]
  v_mfma_f32_16x16x16_bf16 v[100:103], v[116:117], v[106:107], v[100:103]
  v_mfma_f32_16x16x16_bf16 v[108:111], v[120:121], v[106:107], v[108:111]
  v_rcp_f32 v124, v124
  v_mfma_f32_16x16x16_bf16 v[112:115], v[118:119], v[106:107], v[112:115]
  v_mul_f32 v100, v100, v124
  v_mul_f32 v101, v101, v124
  v_mul_f32 v102, v102, v124
  v_mul_f32 v103, v103, v124
  v_cvt_pk_bf16_f32 v64, v100, v101
  v_cvt_pk_bf16_f32 v65, v102, v103
  v_pk_mul_f32 v[108:109], v[108:109], v[124:125] op_sel_hi:[1,0]
  v_pk_mul_f32 v[110:111], v[110:111], v[124:125] op_sel_hi:[1,0]
  v_cvt_pk_bf16_f32 v66, v108, v109
  v_cvt_pk_bf16_f32 v67, v110, v111
  v_pk_mul_f32 v[112:113], v[112:113], v[124:125] op_sel_hi:[1,0]
  v_pk_mul_f32 v[114:115], v[114:115], v[124:125] op_sel_hi:[1,0]
  v_cvt_pk_bf16_f32 v68, v112, v113
  v_cvt_pk_bf16_f32 v69, v114, v115
  s_nop 0
  v_permlane16_swap_b32 v68, v70
  v_permlane16_swap_b32 v69, v71
  buffer_store_dwordx4 v[64:67], v28, s[4:7], s65 offen offset:0 sc1
  s_mov_b64 exec, s[98:99]
  buffer_store_dwordx4 v[68:71], v29, s[4:7], s66 offen offset:0 sc1
  s_mov_b64 exec, -1
  s_waitcnt vmcnt(0)
  s_barrier
  s_mov_b64 exec, 1
  v_mov_b32 v38, 64
  buffer_store_dword v38, off, s[4:7], s67 sc1
  s_mov_b64 exec, -1
  s_endpgm
L_fq0a_rt_390:
  s_sleep 4
  buffer_load_dword v37, v127, s[4:7], s64 offen offset:0 sc1
  s_add_u32 s14, s14, 1
  s_cmp_lt_u32 s14, 100000
  s_waitcnt vmcnt(0)
  s_cbranch_scc1 L_fq0a_top_388
  s_branch L_fq0a_ok_389
L_hamiss_391:
  buffer_load_dwordx2 v[52:53], v3, s[4:7], s48 offen offset:0 sc1
  buffer_load_dwordx2 v[54:55], v3, s[4:7], s48 offen offset:512 sc1
  buffer_load_dwordx2 v[56:57], v3, s[4:7], s48 offen offset:1024 sc1
  s_add_u32 s14, s14, 1
  s_cmp_lt_u32 s14, 100000
  s_cselect_b32 s75, 1, 0
  v_mfma_f32_16x16x16_bf16 v[128:131], v[92:93], v[18:19], 0
  v_mfma_f32_16x16x16_bf16 v[132:135], v[100:101], v[18:19], 0
  v_mfma_f32_16x16x16_bf16 v[136:139], v[108:109], v[18:19], 0
  s_waitcnt vmcnt(3)
  v_mfma_f32_16x16x16_bf16 v[128:131], v[64:65], v[18:19], v[128:131]
  v_bitop3_b32 v37, v64, v66, s49 bitop3:0x7e
  v_bitop3_b32 v37, v37, v68, s49 bitop3:0xf6
  v_mfma_f32_16x16x16_bf16 v[132:135], v[66:67], v[18:19], v[132:135]
  v_and_b32 v37, s75, v37
  v_cmp_ne_u32 vcc, 0, v37
  v_mfma_f32_16x16x16_bf16 v[136:139], v[68:69], v[18:19], v[136:139]
  v_cvt_pk_bf16_f32 v96, v128, v129
  v_cvt_pk_bf16_f32 v97, v130, v131
  s_nop 1
  v_cvt_pk_bf16_f32 v98, v132, v133
  v_cvt_pk_bf16_f32 v99, v134, v135
  s_nop 1
  v_cvt_pk_bf16_f32 v104, v136, v137
  v_cvt_pk_bf16_f32 v105, v138, v139
  s_cbranch_vccz L_hagot_392
  buffer_load_dwordx2 v[64:65], v3, s[4:7], s48 offen offset:0 sc1
  buffer_load_dwordx2 v[66:67], v3, s[4:7], s48 offen offset:512 sc1
  buffer_load_dwordx2 v[68:69], v3, s[4:7], s48 offen offset:1024 sc1
  v_mfma_f32_16x16x16_bf16 v[128:131], v[92:93], v[18:19], 0
  v_mfma_f32_16x16x16_bf16 v[132:135], v[100:101], v[18:19], 0
  v_mfma_f32_16x16x16_bf16 v[136:139], v[108:109], v[18:19], 0
  s_waitcnt vmcnt(3)
  v_mfma_f32_16x16x16_bf16 v[128:131], v[52:53], v[18:19], v[128:131]
  v_bitop3_b32 v37, v52, v54, s49 bitop3:0x7e
  v_bitop3_b32 v37, v37, v56, s49 bitop3:0xf6
  v_mfma_f32_16x16x16_bf16 v[132:135], v[54:55], v[18:19], v[132:135]
  v_and_b32 v37, 1, v37
  v_cmp_ne_u32 vcc, 0, v37
  v_mfma_f32_16x16x16_bf16 v[136:139], v[56:57], v[18:19], v[136:139]
  v_cvt_pk_bf16_f32 v96, v128, v129
  v_cvt_pk_bf16_f32 v97, v130, v131
  s_nop 1
  v_cvt_pk_bf16_f32 v98, v132, v133
  v_cvt_pk_bf16_f32 v99, v134, v135
  s_nop 1
  v_cvt_pk_bf16_f32 v104, v136, v137
  v_cvt_pk_bf16_f32 v105, v138, v139
  s_cbranch_vccnz L_hamiss_391
  s_branch L_hagot_392
L_hwa_rt_2397:
  buffer_load_dwordx4 v[120:123], v2, s[4:7], s48 offen offset:1536 sc1
  s_add_u32 s14, s14, 1
  s_cmp_lt_u32 s14, 100000
  s_waitcnt vmcnt(0)
  s_cbranch_scc1 L_hwa_top_2395
  s_branch L_hwa_ok_2396
L_last_393:
  buffer_load_dwordx4 v[64:67], v28, s[4:7], s60 offen offset:0 sc1
  buffer_load_dwordx2 v[68:69], v29, s[4:7], s61 offen offset:0 sc1
  buffer_load_dwordx4 v[52:55], v2, s[4:7], s62 offen offset:0 sc1
  buffer_load_dwordx4 v[56:59], v2, s[4:7], s62 offen offset:1024 sc1
  buffer_load_dwordx4 v[60:63], v2, s[4:7], s63 offen offset:0 sc1
  buffer_load_dwordx4 v[120:123], v2, s[4:7], s48 offen offset:1536 sc1
  s_barrier
  v_mov_b32 v38, s46
  buffer_store_dword v38, v0, s[4:7], s67 offen offset:0 sc1
  s_waitcnt vmcnt(5)
  v_mfma_f32_16x16x32_bf16 v[92:95], v[40:43], v[64:67], 0
  v_mfma_f32_16x16x32_bf16 v[108:111], v[44:47], v[64:67], 0
  v_mfma_f32_16x16x32_bf16 v[124:127], v[96:99], v[64:67], 0
  v_mfma_f32_16x16x16_bf16 v[92:95], v[48:49], v[68:69], v[92:95]
  v_mfma_f32_16x16x16_bf16 v[108:111], v[50:51], v[68:69], v[108:111]
  v_mfma_f32_16x16x16_bf16 v[124:127], v[104:105], v[68:69], v[124:127]
  s_waitcnt vmcnt(1)
L_hwa_top_2395:
  v_xor_b32 v37, s49, v123
  v_and_b32 v37, 1, v37
  v_cmp_ne_u32 vcc, 0, v37
  s_cbranch_vccnz L_hwa_rt_2397
L_hwa_ok_2396:
  v_swap_b32 v117, v120
  v_mov_b32 v119, v122
  v_mov_b32 v39, 64
  s_branch L_nored_394
L_hva_rt_387:
  buffer_load_dwordx4 v[120:123], v2, s[4:7], s48 offen offset:1536 sc1
  s_add_u32 s14, s14, 1
  s_cmp_lt_u32 s14, 100000
  s_waitcnt vmcnt(0)
  s_cbranch_scc1 L_hva_top_385
  s_branch L_hva_ok_386
L_hb_397:
  buffer_load_dwordx4 v[72:75], v2, s[4:7], s52 offen offset:0 sc1
  buffer_load_dwordx4 v[76:79], v2, s[4:7], s52 offen offset:1024 sc1
  buffer_load_dwordx4 v[80:83], v2, s[4:7], s52 offen offset:2048 sc1
  buffer_load_dwordx4 v[84:87], v2, s[4:7], s52 offen offset:3072 sc1
  s_branch L_hb_398
L_fqa_rt_384:
  s_sleep 4
  buffer_load_dword v39, v27, s[4:7], s64 offen offset:0 sc1
  s_add_u32 s14, s14, 1
  s_cmp_lt_u32 s14, 100000
  s_waitcnt vmcnt(0)
  s_cbranch_scc1 L_fqa_top_382
  s_branch L_fqa_ok_383
L_nored_394:
  ds_write_b128 v32, v[92:95] offset:12544
  ds_write_b128 v32, v[108:111] offset:13568
  ds_write_b64 v34, v[124:125] offset:14592
  s_waitcnt lgkmcnt(0)
  s_barrier
  s_cmp_lt_u32 s12, 2
  s_cbranch_scc1 L_join_395
  ds_read_b128 v[72:75], v8 offset:12544
  ds_read_b128 v[76:79], v8 offset:18176
  ds_read_b128 v[80:83], v8 offset:23808
  ds_read_b128 v[84:87], v8 offset:29440
  ds_read2st64_b32 v[88:89], v9 offset0:57 offset1:79
  ds_read2st64_b32 v[90:91], v9 offset0:101 offset1:123
  v_mov_b32 v38, s70
  s_waitcnt lgkmcnt(4)
  v_pk_add_f32 v[72:73], v[72:73], v[76:77]
  v_pk_add_f32 v[74:75], v[74:75], v[78:79]
  s_waitcnt lgkmcnt(2)
  v_pk_add_f32 v[80:81], v[80:81], v[84:85]
  v_pk_add_f32 v[82:83], v[82:83], v[86:87]
  v_pk_add_f32 v[72:73], v[72:73], v[80:81]
  v_pk_add_f32 v[74:75], v[74:75], v[82:83]
  s_waitcnt lgkmcnt(0)
  v_pk_add_f32 v[88:89], v[88:89], v[90:91]
  v_cndmask_b32 v72, v38, v72, s[80:81]
  v_cndmask_b32 v73, v38, v73, s[82:83]
  v_cndmask_b32 v74, v38, v74, s[84:85]
  v_cndmask_b32 v75, v38, v75, s[86:87]
  v_add_f32 v76, v88, v89
  v_max3_f32 v37, v72, v73, v74
  v_max3_f32 v37, v37, v75, v76
  s_nop 1
  v_max_f32_dpp v38, v37, v37 row_ror:8 row_mask:0xf bank_mask:0xf
  v_max_f32_dpp v37, v37, v37 row_ror:8 row_mask:0xf bank_mask:0xf
  s_nop 1
  v_permlane32_swap_b32 v37, v38
  v_max_f32 v37, v37, v38
  v_mov_b32 v38, v37
  s_nop 1
  v_permlane16_swap_b32 v37, v38
  v_max_f32 v37, v37, v38
  v_mul_f32 v37, s69, v37
  v_fma_f32 v72, v72, s69, -v37
  v_fma_f32 v73, v73, s69, -v37
  v_fma_f32 v74, v74, s69, -v37
  v_fma_f32 v75, v75, s69, -v37
  v_fma_f32 v76, v76, s69, -v37
  v_exp_f32 v72, v72
  v_exp_f32 v73, v73
  v_exp_f32 v74, v74
  v_exp_f32 v75, v75
  v_exp_f32 v76, v76
  v_cvt_pk_bf16_f32 v72, v72, v73
  v_cvt_pk_bf16_f32 v73, v74, v75
  v_cvt_pk_bf16_f32 v74, v76, v76
  ds_write_b64 v10, v[72:73] offset:33792
  ds_write_b16 v11, v74 offset:34816
  s_cmp_lg_u32 s12, 2
  s_cbranch_scc1 L_join_395
  s_add_u32 s71, s46, 1
  s_min_u32 s71, s71, 63
  s_waitcnt vmcnt(5)
L_fqa_top_382:
  v_cmp_ge_i32 vcc, s71, v39
  s_cbranch_vccnz L_fqa_rt_384
L_fqa_ok_383:
  s_branch L_join_395
L_hlmiss_400:
  buffer_load_dwordx4 v[48:51], v2, s[4:7], s79 offen offset:0 sc1
  buffer_load_dword v52, v35, s[4:7], s79 offen offset:1024 sc1
  buffer_load_dwordx4 v[40:43], v2, s[4:7], s77 offen offset:0 sc1
  buffer_load_dword v53, v35, s[4:7], s77 offen offset:1024 sc1
  buffer_load_dwordx4 v[44:47], v2, s[4:7], s77 offen offset:0 sc1
  buffer_load_dword v55, v35, s[4:7], s77 offen offset:1024 sc1
  s_add_u32 s14, s14, 1
  s_cmp_lt_u32 s14, 100000
  s_cselect_b32 s75, 1, 0
  s_waitcnt vmcnt(4)
  s_branch L_hl_399
L_hcmiss_401:
  buffer_load_dwordx4 v[40:43], v2, s[4:7], s77 offen offset:0 sc1
  buffer_load_dword v53, v35, s[4:7], s77 offen offset:1024 sc1
  v_mfma_f32_16x16x16_bf16 v[72:75], v[18:19], v[48:49], 0
  v_mfma_f32_16x16x16_bf16 v[76:79], v[18:19], v[50:51], 0
  s_waitcnt vmcnt(3)
  v_mfma_f32_16x16x16_bf16 v[72:75], v[18:19], v[44:45], v[72:75]
  v_bitop3_b32 v37, v44, v46, s49 bitop3:0x7e
  v_mfma_f32_16x16x16_bf16 v[76:79], v[18:19], v[46:47], v[76:79]
  s_waitcnt vmcnt(2)
  v_bitop3_b32 v38, v55, s49, v7 bitop3:0x28
  v_bitop3_b32 v37, v37, v38, 1 bitop3:0xa8
  v_mfma_f32_16x16x16_bf16 v[80:83], v[4:5], v[54:55], 0
  v_cmp_ne_u32 vcc, 0, v37
  s_cbranch_vccz L_hcgot_402
  buffer_load_dwordx4 v[44:47], v2, s[4:7], s77 offen offset:0 sc1
  buffer_load_dword v55, v35, s[4:7], s77 offen offset:1024 sc1
  s_add_u32 s14, s14, 1
  s_cmp_lt_u32 s14, 100000
  s_cselect_b32 s75, 1, 0
  v_mfma_f32_16x16x16_bf16 v[72:75], v[18:19], v[48:49], 0
  v_mfma_f32_16x16x16_bf16 v[76:79], v[18:19], v[50:51], 0
  s_waitcnt vmcnt(3)
  v_mfma_f32_16x16x16_bf16 v[72:75], v[18:19], v[40:41], v[72:75]
  v_bitop3_b32 v37, v40, v42, s49 bitop3:0x7e
  v_mfma_f32_16x16x16_bf16 v[76:79], v[18:19], v[42:43], v[76:79]
  s_waitcnt vmcnt(2)
  v_bitop3_b32 v38, v53, s49, v7 bitop3:0x28
  v_bitop3_b32 v37, v37, v38, s75 bitop3:0xa8
  v_mfma_f32_16x16x16_bf16 v[80:83], v[4:5], v[52:53], 0
  v_cmp_ne_u32 vcc, 0, v37
  s_cbranch_vccnz L_hcmiss_401
  s_branch L_hcgot_402
L_rec_mixed:
  s_mov_b32 s8, s18
  s_mov_b32 s9, s19
  s_mov_b32 s10, 10240
  s_mov_b32 s11, 0x20000
  v_bfe_u32 v37, v0, 2, 2
  v_and_b32 v38, 1, v0
  v_lshl_add_u32 v37, v37, 1, v38
  v_mul_u32_u24 v37, 1280, v37
  v_bfe_u32 v38, v0, 1, 1
  v_lshl_add_u32 v37, v38, 4, v37
  v_lshrrev_b32 v38, 4, v0
  v_lshl_add_u32 v37, v38, 5, v37
  s_mul_i32 s71, s44, 640
  buffer_load_dwordx4 v[72:75], v37, s[8:11], s71 offen offset:0
  buffer_load_dwordx4 v[76:79], v37, s[8:11], s71 offen offset:128
  buffer_load_dwordx4 v[80:83], v37, s[8:11], s71 offen offset:256
  buffer_load_dwordx4 v[84:87], v37, s[8:11], s71 offen offset:384
  buffer_load_dwordx4 v[88:91], v37, s[8:11], s71 offen offset:512
  buffer_load_dword v37, v127, s[4:7], s64 offen offset:0 sc1
  s_waitcnt vmcnt(0)
L_fq0b_top_409:
  v_cmp_ge_i32 vcc, 0, v37
  s_cbranch_vccnz L_fq0b_rt_411
L_fq0b_ok_410:
  buffer_load_dwordx4 v[40:43], v28, s[4:7], s58 offen offset:0 sc1
  buffer_load_dwordx4 v[44:47], v28, s[4:7], s58 offen offset:256 sc1
  buffer_load_dwordx2 v[48:49], v29, s[4:7], s59 offen offset:0 sc1
  buffer_load_dwordx2 v[50:51], v29, s[4:7], s59 offen offset:256 sc1
  s_cmp_eq_u32 s12, 2
  s_cselect_b32 s64, s64, 0x20000000
  s_cselect_b64 vcc, -1, 0
  v_cndmask_b32 v27, v35, v127, vcc
  v_mfma_f32_32x32x8_bf16 v[92:107], v[22:23], v[22:23], 0
  v_mfma_f32_32x32x8_bf16 v[108:123], v[22:23], v[22:23], 0
  v_mfma_f32_16x16x16_bf16 v[124:127], v[22:23], v[22:23], 0
  ds_read_b128 v[128:131], v36 offset:0
  ds_read_b128 v[132:135], v36 offset:1024
  ds_read_b128 v[136:139], v36 offset:2048
  ds_read_b128 v[140:143], v36 offset:3072
  ds_read_b128 v[144:147], v36 offset:4096
  ds_read_b128 v[148:151], v36 offset:5120
  v_lshlrev_b32 v0, 24, v0
  v_min_u32 v0, 0x1000000, v0
  v_lshlrev_b32 v0, 4, v0
  s_waitcnt lgkmcnt(0)
  s_nop 15
L_rec_topb:
  s_waitcnt lgkmcnt(4)
  v_smfmac_f32_16x16x64_bf16 v[92:95], v[72:75], v[128:135], v1
  s_waitcnt lgkmcnt(3)
  s_add_u32 s46, s46, 1
  ds_read_b128 v[128:131], v36 offset:6144
  v_smfmac_f32_16x16x64_bf16 v[92:95], v[76:79], a[0:7], v1
  s_waitcnt lgkmcnt(3)
  s_and_b32 s49, s46, 1
  ds_read_b128 v[132:135], v36 offset:7168
  v_smfmac_f32_16x16x64_bf16 v[92:95], v[80:83], v[136:143], v1
  s_waitcnt lgkmcnt(3)
  s_add_u32 s57, s57, s54
  ds_read_b128 v[136:139], v36 offset:8192
  v_smfmac_f32_16x16x64_bf16 v[92:95], v[84:87], a[8:15], v1
  s_waitcnt lgkmcnt(3)
  s_add_u32 s77, s77, s54
  ds_read_b128 v[140:143], v36 offset:9216
  v_smfmac_f32_16x16x64_bf16 v[92:95], v[88:91], v[144:151], v1
  s_mov_b32 s54, 131072
  ds_read_b128 v[144:147], v36 offset:10240
  v_smfmac_f32_16x16x64_bf16 v[96:99], v[72:75], a[16:23], v1
  s_andn2_b32 s71, 3, s46
  s_cselect_b32 s54, s54, -393216
  ds_read_b128 v[148:151], v36 offset:11264
  v_smfmac_f32_16x16x64_bf16 v[96:99], v[76:79], a[24:31], v1
  s_add_u32 s51, s57, s54
  s_add_u32 s20, s20, s76
  v_add_f32 v92, v92, v94
  v_smfmac_f32_16x16x64_bf16 v[96:99], v[80:83], a[32:39], v1
  s_lshr_b32 s71, s20, 8
  s_and_b32 s71, s71, 0x2000
  v_add_f32 v93, v93, v95
  v_smfmac_f32_16x16x64_bf16 v[96:99], v[84:87], a[40:47], v1
  s_waitcnt lgkmcnt(4)
  s_xor_b32 s58, s20, s71
  v_cvt_pk_bf16_f32 v92, v92, v93
  v_smfmac_f32_16x16x64_bf16 v[96:99], v[88:91], v[128:135], v1
  s_add_u32 s21, s21, s76
  s_lshr_b32 s71, s21, 8
  ds_read_b128 v[128:131], v36 offset:12288
  v_bfi_b32 v92, 1, s49, v92
  v_smfmac_f32_16x16x64_bf16 v[100:103], v[72:75], a[48:55], v1
  s_and_b32 s71, s71, 0x2000
  s_xor_b32 s59, s21, s71
  ds_read_b128 v[132:135], v36 offset:13312
  v_smfmac_f32_16x16x64_bf16 v[100:103], v[76:79], a[56:63], v1
  s_add_u32 s22, s22, s76
  s_lshr_b32 s71, s22, 8
  v_add_f32 v96, v96, v98
  v_smfmac_f32_16x16x64_bf16 v[100:103], v[80:83], a[64:71], v1
  s_and_b32 s71, s71, 0x2000
  s_xor_b32 s60, s22, s71
  v_add_f32 v97, v97, v99
  v_smfmac_f32_16x16x64_bf16 v[100:103], v[84:87], a[72:79], v1
  s_add_u32 s23, s23, s76
  s_lshr_b32 s71, s23, 8
  v_cvt_pk_bf16_f32 v93, v96, v97
  v_smfmac_f32_16x16x64_bf16 v[100:103], v[88:91], a[80:87], v1
  s_waitcnt lgkmcnt(4)
  s_and_b32 s71, s71, 0x2000
  buffer_store_dwordx2 v[92:93], v3, s[4:7], s47 offen offset:0 sc1
  v_smfmac_f32_16x16x64_bf16 v[104:107], v[72:75], v[136:143], v1
  s_xor_b32 s61, s23, s71
  s_add_u32 s24, s24, s76
  ds_read_b128 v[136:139], v36 offset:14336
  v_smfmac_f32_16x16x64_bf16 v[104:107], v[76:79], a[88:95], v1
  s_lshr_b32 s71, s24, 8
  s_and_b32 s71, s71, 0x2000
  v_add_f32 v100, v100, v102
  v_smfmac_f32_16x16x64_bf16 v[104:107], v[80:83], a[96:103], v1
  s_xor_b32 s62, s24, s71
  s_add_u32 s25, s25, s76
  v_add_f32 v101, v101, v103
  v_smfmac_f32_16x16x64_bf16 v[104:107], v[84:87], a[104:111], v1
  s_lshr_b32 s71, s25, 8
  s_and_b32 s71, s71, 0x2000
  v_cvt_pk_bf16_f32 v100, v100, v101
  v_smfmac_f32_16x16x64_bf16 v[104:107], v[88:91], a[112:119], v1
  s_xor_b32 s63, s25, s71
  s_add_u32 s26, s26, 1048576
  v_bfi_b32 v100, 1, s49, v100
  v_smfmac_f32_16x16x64_bf16 v[108:111], v[72:75], a[120:127], v1
  s_waitcnt lgkmcnt(3)
  s_lshr_b32 s71, s26, 8
  ds_read_b128 v[140:143], v36 offset:15360
  v_smfmac_f32_16x16x64_bf16 v[108:111], v[76:79], v[144:151], v1
  s_and_b32 s71, s71, 0x2000
  s_xor_b32 s65, s26, s71
  ds_read_b128 v[144:147], v36 offset:16384
  v_add_f32 v104, v104, v106
  v_smfmac_f32_16x16x64_bf16 v[108:111], v[80:83], a[128:135], v1
  s_add_u32 s27, s27, 1048576
  s_lshr_b32 s71, s27, 8
  v_add_f32 v105, v105, v107
  v_smfmac_f32_16x16x64_bf16 v[108:111], v[84:87], a[136:143], v1
  s_and_b32 s71, s71, 0x2000
  s_xor_b32 s66, s27, s71
  v_cvt_pk_bf16_f32 v101, v104, v105
  v_smfmac_f32_16x16x64_bf16 v[108:111], v[88:91], a[144:151], v1
  buffer_store_dwordx2 v[100:101], v3, s[4:7], s47 offen offset:512 sc1
  v_smfmac_f32_16x16x64_bf16 v[112:115], v[72:75], a[152:159], v1
  ds_read_b128 v[148:151], v36 offset:17408
  v_smfmac_f32_16x16x64_bf16 v[112:115], v[76:79], a[160:167], v1
  v_add_f32 v108, v108, v110
  v_smfmac_f32_16x16x64_bf16 v[112:115], v[80:83], a[168:175], v1
  s_waitcnt lgkmcnt(4)
  v_add_f32 v109, v109, v111
  v_smfmac_f32_16x16x64_bf16 v[112:115], v[84:87], v[128:135], v1
  s_waitcnt lgkmcnt(2)
  v_cvt_pk_bf16_f32 v108, v108, v109
  v_smfmac_f32_16x16x64_bf16 v[112:115], v[88:91], v[136:143], v1
  ds_read_b128 v[128:131], v36 offset:18432
  v_bfi_b32 v108, 1, s49, v108
  v_smfmac_f32_16x16x64_bf16 v[116:119], v[72:75], a[176:183], v1
  ds_read_b128 v[132:135], v36 offset:19456
  v_smfmac_f32_16x16x64_bf16 v[116:119], v[76:79], a[184:191], v1
  s_waitcnt lgkmcnt(2)
  v_add_f32 v112, v112, v114
  v_add_f32 v113, v113, v115
  v_cvt_pk_bf16_f32 v109, v112, v113
  buffer_store_dwordx2 v[108:109], v3, s[4:7], s47 offen offset:1024 sc1
  ds_read_b128 v[136:139], v36 offset:20480
  ds_read_b128 v[140:143], v36 offset:21504
  v_smfmac_f32_16x16x64_bf16 v[116:119], v[80:83], v[144:151], v1
  ds_read_b128 v[144:147], v36 offset:22528
  ds_read_b128 v[148:151], v36 offset:23552
  v_smfmac_f32_16x16x64_bf16 v[116:119], v[84:87], a[192:199], v1
  v_smfmac_f32_16x16x64_bf16 v[116:119], v[88:91], a[200:207], v1
  buffer_load_dwordx2 v[94:95], v3, s[4:7], s48 offen offset:0 sc1
  v_smfmac_f32_16x16x64_bf16 v[120:123], v[72:75], a[208:215], v1
  s_waitcnt lgkmcnt(4)
  buffer_load_dwordx2 v[102:103], v3, s[4:7], s48 offen offset:512 sc1
  v_smfmac_f32_16x16x64_bf16 v[120:123], v[76:79], v[128:135], v1
  s_waitcnt lgkmcnt(2)
  ds_read_b128 v[128:131], v36 offset:24576
  ds_read_b128 v[132:135], v36 offset:25600
  v_add_f32 v116, v116, v118
  v_smfmac_f32_16x16x64_bf16 v[120:123], v[80:83], v[136:143], v1
  s_waitcnt lgkmcnt(2)
  ds_read_b128 v[136:139], v36 offset:26624
  ds_read_b128 v[140:143], v36 offset:27648
  v_add_f32 v117, v117, v119
  v_smfmac_f32_16x16x64_bf16 v[120:123], v[84:87], v[144:151], v1
  ds_read_b128 v[144:147], v36 offset:28672
  ds_read_b128 v[148:151], v36 offset:29696
  v_cvt_pk_bf16_f32 v116, v116, v117
  v_smfmac_f32_16x16x64_bf16 v[120:123], v[88:91], a[216:223], v1
  v_mov_b32 v119, s49
  v_smfmac_f32_16x16x64_bf16 v[124:127], v[72:75], a[224:231], v1
  buffer_load_dwordx2 v[110:111], v3, s[4:7], s48 offen offset:1024 sc1
  v_smfmac_f32_16x16x64_bf16 v[124:127], v[76:79], a[232:239], v1
  s_waitcnt lgkmcnt(4)
  v_add_f32 v120, v120, v122
  v_smfmac_f32_16x16x64_bf16 v[124:127], v[80:83], v[128:135], v1
  s_waitcnt lgkmcnt(2)
  v_add_f32 v121, v121, v123
  v_smfmac_f32_16x16x64_bf16 v[124:127], v[84:87], v[136:143], v1
  s_waitcnt lgkmcnt(0)
  v_cvt_pk_bf16_f32 v117, v120, v121
  v_smfmac_f32_16x16x64_bf16 v[124:127], v[88:91], v[144:151], v1
  s_nop 7
  v_add_f32 v124, v124, v126
  v_add_f32 v125, v125, v127
  v_cvt_pk_bf16_f32 v118, v124, v125
  buffer_store_dwordx4 v[116:119], v2, s[4:7], s47 offen offset:1536 sc1
  buffer_load_dwordx2 v[64:65], v3, s[4:7], s48 offen offset:0 sc1
  buffer_load_dwordx2 v[66:67], v3, s[4:7], s48 offen offset:512 sc1
  buffer_load_dwordx2 v[68:69], v3, s[4:7], s48 offen offset:1024 sc1
  s_waitcnt vmcnt(5)
  v_mfma_f32_16x16x32_bf16 v[128:131], v[92:95], v[18:21], 0
  v_bitop3_b32 v37, v94, v102, s49 bitop3:0x7e
  v_mfma_f32_16x16x32_bf16 v[132:135], v[100:103], v[18:21], 0
  s_waitcnt vmcnt(4)
  v_bitop3_b32 v37, v37, v110, s49 bitop3:0xf6
  v_and_b32 v37, 1, v37
  v_mfma_f32_16x16x32_bf16 v[136:139], v[108:111], v[18:21], 0
  v_cmp_ne_u32 vcc, 0, v37
  v_cvt_pk_bf16_f32 v96, v128, v129
  v_cvt_pk_bf16_f32 v97, v130, v131
  s_nop 0
  v_cvt_pk_bf16_f32 v98, v132, v133
  v_cvt_pk_bf16_f32 v99, v134, v135
  s_nop 1
  v_cvt_pk_bf16_f32 v104, v136, v137
  v_cvt_pk_bf16_f32 v105, v138, v139
  s_cbranch_vccnz L_hamiss_412
L_hagot_413:
  v_mfma_f32_16x16x32_bf16 v[100:103], v[40:43], v[96:99], 0
  s_cmp_eq_u32 s46, 63
  s_cbranch_scc1 L_last_414
  v_mfma_f32_16x16x32_bf16 v[108:111], v[44:47], v[96:99], 0
  s_mov_b64 vcc, s[100:101]
  buffer_load_dwordx4 v[52:55], v2, s[4:7], s62 offen offset:0 sc1
  v_mfma_f32_16x16x32_bf16 v[112:115], v[96:99], v[96:99], 0
  buffer_load_dwordx4 v[56:59], v2, s[4:7], s62 offen offset:1024 sc1
  v_mfma_f32_16x16x16_bf16 v[100:103], v[48:49], v[104:105], v[100:103]
  buffer_load_dwordx4 v[60:63], v2, s[4:7], s63 offen offset:0 sc1
  v_mfma_f32_16x16x16_bf16 v[108:111], v[50:51], v[104:105], v[108:111]
  v_mfma_f32_16x16x16_bf16 v[112:115], v[104:105], v[104:105], v[112:115]
  v_mfma_f32_16x16x16_bf16 v[88:91], v[22:23], v[22:23], 0
  v_cndmask_b32_dpp v100, v108, v100, vcc quad_perm:[2,3,2,3] row_mask:0xf bank_mask:0xf
  v_cndmask_b32_dpp v101, v109, v101, vcc quad_perm:[2,3,2,3] row_mask:0xf bank_mask:0xf
  v_cndmask_b32_dpp v102, v110, v102, vcc quad_perm:[2,3,2,3] row_mask:0xf bank_mask:0xf
  v_cndmask_b32_dpp v103, v111, v103, vcc quad_perm:[2,3,2,3] row_mask:0xf bank_mask:0xf
  ds_write_b128 v32, v[100:103] offset:11264
  v_cndmask_b32_dpp v112, v113, v112, vcc quad_perm:[2,3,2,3] row_mask:0xf bank_mask:0xf
  ds_write_b32 v33, v112 offset:12288
  v_mfma_f32_32x32x8_bf16 v[72:87], v[22:23], v[22:23], 0
  buffer_load_dwordx4 v[120:123], v2, s[4:7], s48 offen offset:1536 sc1
  s_waitcnt lgkmcnt(0)
  s_barrier
  ds_read_b128 v[128:131], v2 offset:11264
  ds_read_b128 v[132:135], v2 offset:16896
  ds_read_b128 v[136:139], v2 offset:22528
  ds_read_b128 v[144:147], v2 offset:28160
  ds_read2st64_b32 v[148:149], v35 offset0:48 offset1:70
  ds_read2st64_b32 v[150:151], v35 offset0:92 offset1:114
  buffer_load_dwordx4 v[64:67], v28, s[4:7], s60 offen offset:0 sc1
  buffer_load_dwordx2 v[68:69], v29, s[4:7], s61 offen offset:0 sc1
  s_waitcnt lgkmcnt(4)
  v_pk_add_f32 v[128:129], v[128:129], v[132:133]
  v_pk_add_f32 v[130:131], v[130:131], v[134:135]
  s_waitcnt lgkmcnt(2)
  v_pk_add_f32 v[136:137], v[136:137], v[144:145]
  v_pk_add_f32 v[138:139], v[138:139], v[146:147]
  v_pk_add_f32 v[128:129], v[128:129], v[136:137]
  v_pk_add_f32 v[130:131], v[130:131], v[138:139]
  s_waitcnt lgkmcnt(0)
  v_pk_add_f32 v[148:149], v[148:149], v[150:151]
  v_max3_f32 v37, v128, v129, v130
  v_add_f32 v132, v148, v149
  v_max3_f32 v37, v37, v131, v132
  buffer_store_dword v119, v35, s[4:7], s51 offen offset:0 sc1
  s_nop 0
  v_max_f32_dpp v38, v37, v37 quad_perm:[2,3,0,1] row_mask:0xf bank_mask:0xf
  v_max_f32_dpp v37, v37, v37 quad_perm:[2,3,0,1] row_mask:0xf bank_mask:0xf
  s_nop 1
  v_permlane32_swap_b32 v37, v38
  v_max_f32 v133, v37, v38
  v_max_f32 v37, v37, v38
  v_mov_b32 v38, s46
  buffer_store_dword v38, v0, s[4:7], s67 offen offset:0 sc1
  v_permlane16_swap_b32 v37, v133
  v_max_f32 v37, v37, v133
  v_mul_f32 v37, s69, v37
  v_fma_f32 v128, v128, s69, -v37
  v_fma_f32 v129, v129, s69, -v37
  v_fma_f32 v130, v130, s69, -v37
  v_fma_f32 v131, v131, s69, -v37
  v_fma_f32 v132, v132, s69, -v37
  v_exp_f32 v128, v128
  v_exp_f32 v129, v129
  v_exp_f32 v130, v130
  v_exp_f32 v131, v131
  v_exp_f32 v132, v132
  v_cvt_pk_bf16_f32 v92, v128, v129
  v_cvt_pk_bf16_f32 v93, v130, v131
  v_mov_b32_dpp v133, v132 quad_perm:[0,1,0,1] row_mask:0xf bank_mask:0xf
  v_mov_b32_dpp v94, v92 quad_perm:[0,1,0,1] row_mask:0xf bank_mask:0xf
  v_mov_b32_dpp v95, v93 quad_perm:[0,1,0,1] row_mask:0xf bank_mask:0xf
  v_cvt_pk_bf16_f32 v106, v132, v133
  v_cvt_pk_bf16_f32 v107, v132, v133
  s_waitcnt vmcnt(4)
L_hvb_top_406:
  v_mfma_f32_16x16x32_bf16 v[124:127], v[12:15], v[92:95], 0
  v_xor_b32 v37, s49, v123
  v_and_b32 v37, 1, v37
  v_mfma_f32_16x16x32_bf16 v[100:103], v[52:55], v[92:95], 0
  v_cmp_ne_u32 vcc, 0, v37
  v_mfma_f32_16x16x32_bf16 v[108:111], v[56:59], v[92:95], 0
  v_mfma_f32_16x16x32_bf16 v[112:115], v[60:63], v[92:95], 0
  s_cbranch_vccnz L_hvb_rt_408
L_hvb_ok_407:
  v_swap_b32 v117, v120
  v_mfma_f32_16x16x16_bf16 v[124:127], v[16:17], v[106:107], v[124:127]
  v_mov_b32 v119, v122
  buffer_load_dword v39, v27, s[4:7], s64 offen offset:0 sc1
  v_mfma_f32_16x16x16_bf16 v[100:103], v[116:117], v[106:107], v[100:103]
  v_mfma_f32_16x16x16_bf16 v[108:111], v[120:121], v[106:107], v[108:111]
  v_rcp_f32 v124, v124
  v_mfma_f32_16x16x16_bf16 v[112:115], v[118:119], v[106:107], v[112:115]
  v_mul_f32 v100, v100, v124
  v_mul_f32 v101, v101, v124
  v_mul_f32 v102, v102, v124
  v_mul_f32 v103, v103, v124
  v_cvt_pk_bf16_f32 v100, v100, v101
  v_cvt_pk_bf16_f32 v101, v102, v103
  v_pk_mul_f32 v[108:109], v[108:109], v[124:125] op_sel_hi:[1,0]
  v_pk_mul_f32 v[110:111], v[110:111], v[124:125] op_sel_hi:[1,0]
  v_cvt_pk_bf16_f32 v102, v108, v109
  v_cvt_pk_bf16_f32 v103, v110, v111
  ds_write_b128 v30, v[100:103]
  v_pk_mul_f32 v[112:113], v[112:113], v[124:125] op_sel_hi:[1,0]
  v_pk_mul_f32 v[114:115], v[114:115], v[124:125] op_sel_hi:[1,0]
  v_cvt_pk_bf16_f32 v112, v112, v113
  v_cvt_pk_bf16_f32 v113, v114, v115
  ds_write_b64 v31, v[112:113]
  s_waitcnt lgkmcnt(0)
  s_barrier
  ds_read_b128 v[128:131], v2 offset:5120
  ds_read_b128 v[132:135], v2 offset:6144
  ds_read_b128 v[136:139], v2 offset:7168
  s_waitcnt lgkmcnt(2)
  v_smfmac_f32_16x16x64_bf16 v[72:75], v[128:131], a[240:247], v1
  s_waitcnt lgkmcnt(1)
  v_smfmac_f32_16x16x64_bf16 v[72:75], v[132:135], a[248:255], v1
  s_waitcnt lgkmcnt(0)
  v_smfmac_f32_16x16x64_bf16 v[72:75], v[136:139], v[152:159], v1
  v_smfmac_f32_16x16x64_bf16 v[76:79], v[128:131], v[160:167], v1
  v_smfmac_f32_16x16x64_bf16 v[76:79], v[132:135], v[168:175], v1
  v_add_f32 v72, v72, v74
  v_smfmac_f32_16x16x64_bf16 v[76:79], v[136:139], v[176:183], v1
  v_add_f32 v73, v73, v75
  v_smfmac_f32_16x16x64_bf16 v[80:83], v[128:131], v[184:191], v1
  v_cvt_pk_bf16_f32 v140, v72, v73
  v_smfmac_f32_16x16x64_bf16 v[80:83], v[132:135], v[192:199], v1
  v_bfi_b32 v140, v6, s49, v140
  v_smfmac_f32_16x16x64_bf16 v[80:83], v[136:139], v[200:207], v1
  buffer_store_dword v140, v35, s[4:7], s88 offen offset:0 sc1
  v_smfmac_f32_16x16x64_bf16 v[84:87], v[128:131], v[208:215], v1
  v_add_f32 v76, v76, v78
  v_smfmac_f32_16x16x64_bf16 v[84:87], v[132:135], v[216:223], v1
  v_add_f32 v77, v77, v79
  v_smfmac_f32_16x16x64_bf16 v[84:87], v[136:139], v[224:231], v1
  v_cvt_pk_bf16_f32 v141, v76, v77
  v_smfmac_f32_16x16x64_bf16 v[88:91], v[128:131], v[232:239], v1
  v_bfi_b32 v141, v6, s49, v141
  v_smfmac_f32_16x16x64_bf16 v[88:91], v[132:135], v[240:247], v1
  buffer_store_dword v141, v35, s[4:7], s89 offen offset:0 sc1
  v_smfmac_f32_16x16x64_bf16 v[88:91], v[136:139], v[248:255], v1
  v_add_f32 v80, v80, v82
  v_add_f32 v81, v81, v83
  v_cvt_pk_bf16_f32 v142, v80, v81
  v_bfi_b32 v142, v6, s49, v142
  buffer_store_dword v142, v35, s[4:7], s90 offen offset:0 sc1
  v_add_f32 v84, v84, v86
  v_add_f32 v85, v85, v87
  v_cvt_pk_bf16_f32 v143, v84, v85
  v_bfi_b32 v143, v6, s49, v143
  buffer_store_dword v143, v35, s[4:7], s91 offen offset:0 sc1
  v_add_f32 v88, v88, v90
  v_add_f32 v89, v89, v91
  v_cvt_pk_bf16_f32 v144, v88, v89
  v_bfi_b32 v144, v6, s49, v144
  buffer_store_dword v144, v35, s[4:7], s92 offen offset:0 sc1
  s_waitcnt vmcnt(8)
  v_mfma_f32_16x16x32_bf16 v[92:95], v[40:43], v[64:67], 0
  v_mfma_f32_16x16x32_bf16 v[108:111], v[44:47], v[64:67], 0
  v_mfma_f32_16x16x32_bf16 v[124:127], v[96:99], v[64:67], 0
  v_mfma_f32_16x16x16_bf16 v[92:95], v[48:49], v[68:69], v[92:95]
  v_mfma_f32_16x16x16_bf16 v[108:111], v[50:51], v[68:69], v[108:111]
  v_mfma_f32_16x16x16_bf16 v[124:127], v[104:105], v[68:69], v[124:127]
  s_cmp_eq_u32 s68, 0
  s_nop 3
  s_cbranch_scc1 L_nored_415
  buffer_load_dwordx4 v[128:131], v2, s[4:7], s52 offen offset:0 sc1
  buffer_load_dwordx4 v[132:135], v2, s[4:7], s52 offen offset:1024 sc1
  buffer_load_dwordx4 v[136:139], v2, s[4:7], s52 offen offset:2048 sc1
  buffer_load_dwordx4 v[140:143], v2, s[4:7], s52 offen offset:3072 sc1
  ds_write_b128 v32, v[92:95] offset:12544
  ds_write_b128 v32, v[108:111] offset:13568
  ds_write_b64 v34, v[124:125] offset:14592
  buffer_load_dwordx4 v[72:75], v2, s[4:7], s52 offen offset:0 sc1
  buffer_load_dwordx4 v[76:79], v2, s[4:7], s52 offen offset:1024 sc1
  buffer_load_dwordx4 v[80:83], v2, s[4:7], s52 offen offset:2048 sc1
  buffer_load_dwordx4 v[84:87], v2, s[4:7], s52 offen offset:3072 sc1
  s_waitcnt lgkmcnt(0)
  s_barrier
L_hb_419:
  s_add_u32 s14, s14, 1
  s_cmp_lt_u32 s14, 100000
  s_cselect_b32 s75, 1, 0
  s_waitcnt vmcnt(6)
  v_mfma_f32_16x16x32_bf16 v[148:151], v[8:11], v[128:131], 0
  v_mfma_f32_16x16x32_bf16 v[148:151], v[8:11], v[132:135], v[148:151]
  v_bitop3_b32 v37, v128, v132, s49 bitop3:0x7e
  s_waitcnt vmcnt(5)
  v_mfma_f32_16x16x32_bf16 v[148:151], v[8:11], v[136:139], v[148:151]
  v_bitop3_b32 v37, v37, v136, s49 bitop3:0xf6
  s_waitcnt vmcnt(4)
  v_mfma_f32_16x16x32_bf16 v[148:151], v[8:11], v[140:143], v[148:151]
  v_bitop3_b32 v37, v37, v140, s49 bitop3:0xf6
  v_and_b32 v37, s75, v37
  v_cmp_ne_u32 vcc, 0, v37
  s_cbranch_vccz L_pub_417
  buffer_load_dwordx4 v[128:131], v2, s[4:7], s52 offen offset:0 sc1
  buffer_load_dwordx4 v[132:135], v2, s[4:7], s52 offen offset:1024 sc1
  buffer_load_dwordx4 v[136:139], v2, s[4:7], s52 offen offset:2048 sc1
  buffer_load_dwordx4 v[140:143], v2, s[4:7], s52 offen offset:3072 sc1
  s_waitcnt vmcnt(6)
  v_mfma_f32_16x16x32_bf16 v[148:151], v[8:11], v[72:75], 0
  v_mfma_f32_16x16x32_bf16 v[148:151], v[8:11], v[76:79], v[148:151]
  v_bitop3_b32 v37, v72, v76, s49 bitop3:0x7e
  s_waitcnt vmcnt(5)
  v_mfma_f32_16x16x32_bf16 v[148:151], v[8:11], v[80:83], v[148:151]
  v_bitop3_b32 v37, v37, v80, s49 bitop3:0xf6
  s_waitcnt vmcnt(4)
  v_mfma_f32_16x16x32_bf16 v[148:151], v[8:11], v[84:87], v[148:151]
  v_bitop3_b32 v37, v37, v84, s49 bitop3:0xf6
  v_and_b32 v37, s75, v37
  v_cmp_ne_u32 vcc, 0, v37
  s_cbranch_vccnz L_hb_418
L_pub_417:
  s_mov_b32 exec_hi, 0
  s_nop 2
  v_cvt_pk_bf16_f32 v148, v148, v149
  v_cvt_pk_bf16_f32 v149, v150, v151
  v_bfi_b32 v148, 1, s49, v148
  buffer_store_dwordx2 v[148:149], v3, s[4:7], s57 offen offset:0 sc1
  buffer_store_dwordx2 v[148:149], v3, s[4:7], s56 offen offset:0 sc1
  s_mov_b32 exec_hi, -1
L_join_416:
  s_waitcnt lgkmcnt(0)
  s_barrier
  ds_read_b128 v[92:95], v2 offset:33792
  ds_read2st64_b32 v[106:107], v35 offset0:136 offset1:136
  s_cmp_eq_u32 s46, 63
  s_cbranch_scc1 L_rec_doneb
  s_waitcnt lgkmcnt(0)
  v_mfma_f32_16x16x32_bf16 v[124:127], v[12:15], v[92:95], 0
  v_mfma_f32_16x16x32_bf16 v[100:103], v[52:55], v[92:95], 0
  v_mfma_f32_16x16x32_bf16 v[108:111], v[56:59], v[92:95], 0
  v_mfma_f32_16x16x32_bf16 v[112:115], v[60:63], v[92:95], 0
  v_mfma_f32_16x16x16_bf16 v[124:127], v[16:17], v[106:107], v[124:127]
  v_mfma_f32_16x16x16_bf16 v[100:103], v[116:117], v[106:107], v[100:103]
  v_mfma_f32_16x16x16_bf16 v[108:111], v[120:121], v[106:107], v[108:111]
  v_rcp_f32 v124, v124
  v_mfma_f32_16x16x16_bf16 v[112:115], v[118:119], v[106:107], v[112:115]
  buffer_load_dwordx4 v[48:51], v2, s[4:7], s79 offen offset:0 sc1
  buffer_load_dword v52, v35, s[4:7], s79 offen offset:1024 sc1
  v_mul_f32 v100, v100, v124
  v_mul_f32 v101, v101, v124
  v_mul_f32 v102, v102, v124
  v_mul_f32 v103, v103, v124
  v_cvt_pk_bf16_f32 v64, v100, v101
  v_cvt_pk_bf16_f32 v65, v102, v103
  v_pk_mul_f32 v[108:109], v[108:109], v[124:125] op_sel_hi:[1,0]
  v_pk_mul_f32 v[110:111], v[110:111], v[124:125] op_sel_hi:[1,0]
  v_cvt_pk_bf16_f32 v66, v108, v109
  v_cvt_pk_bf16_f32 v67, v110, v111
  v_pk_mul_f32 v[112:113], v[112:113], v[124:125] op_sel_hi:[1,0]
  v_pk_mul_f32 v[114:115], v[114:115], v[124:125] op_sel_hi:[1,0]
  v_cvt_pk_bf16_f32 v68, v112, v113
  v_cvt_pk_bf16_f32 v69, v114, v115
  buffer_load_dwordx4 v[40:43], v2, s[4:7], s77 offen offset:0 sc1
  buffer_load_dword v53, v35, s[4:7], s77 offen offset:1024 sc1
  v_permlane16_swap_b32 v68, v70
  v_permlane16_swap_b32 v69, v71
  v_mfma_f32_32x32x8_bf16 v[92:107], v[22:23], v[22:23], 0
  v_mfma_f32_32x32x8_bf16 v[108:123], v[22:23], v[22:23], 0
  v_mfma_f32_16x16x16_bf16 v[124:127], v[22:23], v[22:23], 0
  buffer_load_dwordx4 v[44:47], v2, s[4:7], s77 offen offset:0 sc1
  buffer_load_dword v55, v35, s[4:7], s77 offen offset:1024 sc1
  s_add_u32 s14, s14, 1
  s_cmp_lt_u32 s14, 100000
  s_cselect_b32 s75, 1, 0
  s_waitcnt vmcnt(4)
L_hl_420:
  v_bitop3_b32 v37, v48, v50, s49 bitop3:0x7e
  v_bitop3_b32 v38, v52, s49, v7 bitop3:0x28
  v_bitop3_b32 v37, v37, v38, s75 bitop3:0xa8
  v_cmp_ne_u32 vcc, 0, v37
  ds_read_b128 v[128:131], v36 offset:0
  ds_read_b128 v[132:135], v36 offset:1024
  ds_read_b128 v[136:139], v36 offset:2048
  s_cbranch_vccnz L_hlmiss_421
  v_mfma_f32_16x16x16_bf16 v[72:75], v[18:19], v[48:49], 0
  v_mov_b32 v54, v52
  ds_read_b128 v[140:143], v36 offset:3072
  v_mfma_f32_16x16x16_bf16 v[76:79], v[18:19], v[50:51], 0
  ds_read_b128 v[144:147], v36 offset:4096
  ds_read_b128 v[148:151], v36 offset:5120
  s_waitcnt vmcnt(3)
  v_mfma_f32_16x16x16_bf16 v[72:75], v[18:19], v[40:41], v[72:75]
  v_bitop3_b32 v37, v40, v42, s49 bitop3:0x7e
  v_mfma_f32_16x16x16_bf16 v[76:79], v[18:19], v[42:43], v[76:79]
  s_waitcnt vmcnt(2)
  v_bitop3_b32 v38, v53, s49, v7 bitop3:0x28
  v_bitop3_b32 v37, v37, v38, s75 bitop3:0xa8
  v_mfma_f32_16x16x16_bf16 v[80:83], v[4:5], v[52:53], 0
  v_cmp_ne_u32 vcc, 0, v37
  s_cbranch_vccnz L_hcmiss_422
L_hcgot_423:
  v_cvt_pk_bf16_f32 v84, v74, v75
  v_cvt_pk_bf16_f32 v85, v72, v73
  v_cvt_pk_bf16_f32 v86, v78, v79
  v_cvt_pk_bf16_f32 v87, v76, v77
  ds_write_b128 v25, v[84:87] offset:0
  s_nop 0
  v_cvt_pk_bf16_f32 v88, v80, v81
  ds_write_b32 v26, v88 offset:1024
  buffer_load_dwordx4 v[40:43], v28, s[4:7], s58 offen offset:0 sc1
  buffer_load_dwordx4 v[44:47], v28, s[4:7], s58 offen offset:256 sc1
  buffer_load_dwordx2 v[48:49], v29, s[4:7], s59 offen offset:0 sc1
  s_waitcnt lgkmcnt(0)
  s_barrier
  ds_read_b128 v[72:75], v24 offset:0
  ds_read_b128 v[76:79], v24 offset:1024
  ds_read_b128 v[80:83], v24 offset:2048
  ds_read_b128 v[84:87], v24 offset:3072
  ds_read_b128 v[88:91], v24 offset:4096
  buffer_load_dwordx2 v[50:51], v29, s[4:7], s59 offen offset:256 sc1
  buffer_store_dwordx4 v[64:67], v28, s[4:7], s65 offen offset:0 sc1
  s_mov_b64 exec, s[98:99]
  buffer_store_dwordx4 v[68:71], v29, s[4:7], s66 offen offset:0 sc1
  s_mov_b64 exec, -1
  s_branch L_rec_topb
L_rec_doneb:
  s_waitcnt lgkmcnt(0)
  v_mfma_f32_16x16x32_bf16 v[124:127], v[12:15], v[92:95], 0
  v_mfma_f32_16x16x32_bf16 v[100:103], v[52:55], v[92:95], 0
  v_mfma_f32_16x16x32_bf16 v[108:111], v[56:59], v[92:95], 0
  v_mfma_f32_16x16x32_bf16 v[112:115], v[60:63], v[92:95], 0
  v_mfma_f32_16x16x16_bf16 v[124:127], v[16:17], v[106:107], v[124:127]
  v_mfma_f32_16x16x16_bf16 v[100:103], v[116:117], v[106:107], v[100:103]
  v_mfma_f32_16x16x16_bf16 v[108:111], v[120:121], v[106:107], v[108:111]
  v_rcp_f32 v124, v124
  v_mfma_f32_16x16x16_bf16 v[112:115], v[118:119], v[106:107], v[112:115]
  v_mul_f32 v100, v100, v124
  v_mul_f32 v101, v101, v124
  v_mul_f32 v102, v102, v124
  v_mul_f32 v103, v103, v124
  v_cvt_pk_bf16_f32 v64, v100, v101
  v_cvt_pk_bf16_f32 v65, v102, v103
  v_pk_mul_f32 v[108:109], v[108:109], v[124:125] op_sel_hi:[1,0]
  v_pk_mul_f32 v[110:111], v[110:111], v[124:125] op_sel_hi:[1,0]
  v_cvt_pk_bf16_f32 v66, v108, v109
  v_cvt_pk_bf16_f32 v67, v110, v111
  v_pk_mul_f32 v[112:113], v[112:113], v[124:125] op_sel_hi:[1,0]
  v_pk_mul_f32 v[114:115], v[114:115], v[124:125] op_sel_hi:[1,0]
  v_cvt_pk_bf16_f32 v68, v112, v113
  v_cvt_pk_bf16_f32 v69, v114, v115
  s_nop 0
  v_permlane16_swap_b32 v68, v70
  v_permlane16_swap_b32 v69, v71
  buffer_store_dwordx4 v[64:67], v28, s[4:7], s65 offen offset:0 sc1
  s_mov_b64 exec, s[98:99]
  buffer_store_dwordx4 v[68:71], v29, s[4:7], s66 offen offset:0 sc1
  s_mov_b64 exec, -1
  s_waitcnt vmcnt(0)
  s_barrier
  s_mov_b64 exec, 1
  v_mov_b32 v38, 64
  buffer_store_dword v38, off, s[4:7], s67 sc1
  s_mov_b64 exec, -1
  s_endpgm
L_fq0b_rt_411:
  s_sleep 4
  buffer_load_dword v37, v127, s[4:7], s64 offen offset:0 sc1
  s_add_u32 s14, s14, 1
  s_cmp_lt_u32 s14, 100000
  s_waitcnt vmcnt(0)
  s_cbranch_scc1 L_fq0b_top_409
  s_branch L_fq0b_ok_410
L_hamiss_412:
  buffer_load_dwordx2 v[52:53], v3, s[4:7], s48 offen offset:0 sc1
  buffer_load_dwordx2 v[54:55], v3, s[4:7], s48 offen offset:512 sc1
  buffer_load_dwordx2 v[56:57], v3, s[4:7], s48 offen offset:1024 sc1
  s_add_u32 s14, s14, 1
  s_cmp_lt_u32 s14, 100000
  s_cselect_b32 s75, 1, 0
  v_mfma_f32_16x16x16_bf16 v[128:131], v[92:93], v[18:19], 0
  v_mfma_f32_16x16x16_bf16 v[132:135], v[100:101], v[18:19], 0
  v_mfma_f32_16x16x16_bf16 v[136:139], v[108:109], v[18:19], 0
  s_waitcnt vmcnt(3)
  v_mfma_f32_16x16x16_bf16 v[128:131], v[64:65], v[18:19], v[128:131]
  v_bitop3_b32 v37, v64, v66, s49 bitop3:0x7e
  v_bitop3_b32 v37, v37, v68, s49 bitop3:0xf6
  v_mfma_f32_16x16x16_bf16 v[132:135], v[66:67], v[18:19], v[132:135]
  v_and_b32 v37, s75, v37
  v_cmp_ne_u32 vcc, 0, v37
  v_mfma_f32_16x16x16_bf16 v[136:139], v[68:69], v[18:19], v[136:139]
  v_cvt_pk_bf16_f32 v96, v128, v129
  v_cvt_pk_bf16_f32 v97, v130, v131
  s_nop 1
  v_cvt_pk_bf16_f32 v98, v132, v133
  v_cvt_pk_bf16_f32 v99, v134, v135
  s_nop 1
  v_cvt_pk_bf16_f32 v104, v136, v137
  v_cvt_pk_bf16_f32 v105, v138, v139
  s_cbranch_vccz L_hagot_413
  buffer_load_dwordx2 v[64:65], v3, s[4:7], s48 offen offset:0 sc1
  buffer_load_dwordx2 v[66:67], v3, s[4:7], s48 offen offset:512 sc1
  buffer_load_dwordx2 v[68:69], v3, s[4:7], s48 offen offset:1024 sc1
  v_mfma_f32_16x16x16_bf16 v[128:131], v[92:93], v[18:19], 0
  v_mfma_f32_16x16x16_bf16 v[132:135], v[100:101], v[18:19], 0
  v_mfma_f32_16x16x16_bf16 v[136:139], v[108:109], v[18:19], 0
  s_waitcnt vmcnt(3)
  v_mfma_f32_16x16x16_bf16 v[128:131], v[52:53], v[18:19], v[128:131]
  v_bitop3_b32 v37, v52, v54, s49 bitop3:0x7e
  v_bitop3_b32 v37, v37, v56, s49 bitop3:0xf6
  v_mfma_f32_16x16x16_bf16 v[132:135], v[54:55], v[18:19], v[132:135]
  v_and_b32 v37, 1, v37
  v_cmp_ne_u32 vcc, 0, v37
  v_mfma_f32_16x16x16_bf16 v[136:139], v[56:57], v[18:19], v[136:139]
  v_cvt_pk_bf16_f32 v96, v128, v129
  v_cvt_pk_bf16_f32 v97, v130, v131
  s_nop 1
  v_cvt_pk_bf16_f32 v98, v132, v133
  v_cvt_pk_bf16_f32 v99, v134, v135
  s_nop 1
  v_cvt_pk_bf16_f32 v104, v136, v137
  v_cvt_pk_bf16_f32 v105, v138, v139
  s_cbranch_vccnz L_hamiss_412
  s_branch L_hagot_413
L_hwb_rt_2418:
  buffer_load_dwordx4 v[120:123], v2, s[4:7], s48 offen offset:1536 sc1
  s_add_u32 s14, s14, 1
  s_cmp_lt_u32 s14, 100000
  s_waitcnt vmcnt(0)
  s_cbranch_scc1 L_hwb_top_2416
  s_branch L_hwb_ok_2417
L_last_414:
  buffer_load_dwordx4 v[64:67], v28, s[4:7], s60 offen offset:0 sc1
  buffer_load_dwordx2 v[68:69], v29, s[4:7], s61 offen offset:0 sc1
  buffer_load_dwordx4 v[52:55], v2, s[4:7], s62 offen offset:0 sc1
  buffer_load_dwordx4 v[56:59], v2, s[4:7], s62 offen offset:1024 sc1
  buffer_load_dwordx4 v[60:63], v2, s[4:7], s63 offen offset:0 sc1
  buffer_load_dwordx4 v[120:123], v2, s[4:7], s48 offen offset:1536 sc1
  s_barrier
  v_mov_b32 v38, s46
  buffer_store_dword v38, v0, s[4:7], s67 offen offset:0 sc1
  s_waitcnt vmcnt(5)
  v_mfma_f32_16x16x32_bf16 v[92:95], v[40:43], v[64:67], 0
  v_mfma_f32_16x16x32_bf16 v[108:111], v[44:47], v[64:67], 0
  v_mfma_f32_16x16x32_bf16 v[124:127], v[96:99], v[64:67], 0
  v_mfma_f32_16x16x16_bf16 v[92:95], v[48:49], v[68:69], v[92:95]
  v_mfma_f32_16x16x16_bf16 v[108:111], v[50:51], v[68:69], v[108:111]
  v_mfma_f32_16x16x16_bf16 v[124:127], v[104:105], v[68:69], v[124:127]
  s_waitcnt vmcnt(1)
L_hwb_top_2416:
  v_xor_b32 v37, s49, v123
  v_and_b32 v37, 1, v37
  v_cmp_ne_u32 vcc, 0, v37
  s_cbranch_vccnz L_hwb_rt_2418
L_hwb_ok_2417:
  v_swap_b32 v117, v120
  v_mov_b32 v119, v122
  v_mov_b32 v39, 64
  s_branch L_nored_415
L_hvb_rt_408:
  buffer_load_dwordx4 v[120:123], v2, s[4:7], s48 offen offset:1536 sc1
  s_add_u32 s14, s14, 1
  s_cmp_lt_u32 s14, 100000
  s_waitcnt vmcnt(0)
  s_cbranch_scc1 L_hvb_top_406
  s_branch L_hvb_ok_407
L_hb_418:
  buffer_load_dwordx4 v[72:75], v2, s[4:7], s52 offen offset:0 sc1
  buffer_load_dwordx4 v[76:79], v2, s[4:7], s52 offen offset:1024 sc1
  buffer_load_dwordx4 v[80:83], v2, s[4:7], s52 offen offset:2048 sc1
  buffer_load_dwordx4 v[84:87], v2, s[4:7], s52 offen offset:3072 sc1
  s_branch L_hb_419
L_fqb_rt_405:
  s_sleep 4
  buffer_load_dword v39, v27, s[4:7], s64 offen offset:0 sc1
  s_add_u32 s14, s14, 1
  s_cmp_lt_u32 s14, 100000
  s_waitcnt vmcnt(0)
  s_cbranch_scc1 L_fqb_top_403
  s_branch L_fqb_ok_404
L_nored_415:
  ds_write_b128 v32, v[92:95] offset:12544
  ds_write_b128 v32, v[108:111] offset:13568
  ds_write_b64 v34, v[124:125] offset:14592
  s_waitcnt lgkmcnt(0)
  s_barrier
  s_cmp_lt_u32 s12, 2
  s_cbranch_scc1 L_join_416
  ds_read_b128 v[72:75], v8 offset:12544
  ds_read_b128 v[76:79], v8 offset:18176
  ds_read_b128 v[80:83], v8 offset:23808
  ds_read_b128 v[84:87], v8 offset:29440
  ds_read2st64_b32 v[88:89], v9 offset0:57 offset1:79
  ds_read2st64_b32 v[90:91], v9 offset0:101 offset1:123
  v_mov_b32 v38, s70
  s_waitcnt lgkmcnt(4)
  v_pk_add_f32 v[72:73], v[72:73], v[76:77]
  v_pk_add_f32 v[74:75], v[74:75], v[78:79]
  s_waitcnt lgkmcnt(2)
  v_pk_add_f32 v[80:81], v[80:81], v[84:85]
  v_pk_add_f32 v[82:83], v[82:83], v[86:87]
  v_pk_add_f32 v[72:73], v[72:73], v[80:81]
  v_pk_add_f32 v[74:75], v[74:75], v[82:83]
  s_waitcnt lgkmcnt(0)
  v_pk_add_f32 v[88:89], v[88:89], v[90:91]
  v_cndmask_b32 v72, v38, v72, s[80:81]
  v_cndmask_b32 v73, v38, v73, s[82:83]
  v_cndmask_b32 v74, v38, v74, s[84:85]
  v_cndmask_b32 v75, v38, v75, s[86:87]
  v_add_f32 v76, v88, v89
  v_max3_f32 v37, v72, v73, v74
  v_max3_f32 v37, v37, v75, v76
  s_nop 1
  v_max_f32_dpp v38, v37, v37 row_ror:8 row_mask:0xf bank_mask:0xf
  v_max_f32_dpp v37, v37, v37 row_ror:8 row_mask:0xf bank_mask:0xf
  s_nop 1
  v_permlane32_swap_b32 v37, v38
  v_max_f32 v37, v37, v38
  v_mov_b32 v38, v37
  s_nop 1
  v_permlane16_swap_b32 v37, v38
  v_max_f32 v37, v37, v38
  v_mul_f32 v37, s69, v37
  v_fma_f32 v72, v72, s69, -v37
  v_fma_f32 v73, v73, s69, -v37
  v_fma_f32 v74, v74, s69, -v37
  v_fma_f32 v75, v75, s69, -v37
  v_fma_f32 v76, v76, s69, -v37
  v_exp_f32 v72, v72
  v_exp_f32 v73, v73
  v_exp_f32 v74, v74
  v_exp_f32 v75, v75
  v_exp_f32 v76, v76
  v_cvt_pk_bf16_f32 v72, v72, v73
  v_cvt_pk_bf16_f32 v73, v74, v75
  v_cvt_pk_bf16_f32 v74, v76, v76
  ds_write_b64 v10, v[72:73] offset:33792
  ds_write_b16 v11, v74 offset:34816
  s_cmp_lg_u32 s12, 2
  s_cbranch_scc1 L_join_416
  s_add_u32 s71, s46, 1
  s_min_u32 s71, s71, 63
  s_waitcnt vmcnt(5)
L_fqb_top_403:
  v_cmp_ge_i32 vcc, s71, v39
  s_cbranch_vccnz L_fqb_rt_405
L_fqb_ok_404:
  s_branch L_join_416
L_hlmiss_421:
  buffer_load_dwordx4 v[48:51], v2, s[4:7], s79 offen offset:0 sc1
  buffer_load_dword v52, v35, s[4:7], s79 offen offset:1024 sc1
  buffer_load_dwordx4 v[40:43], v2, s[4:7], s77 offen offset:0 sc1
  buffer_load_dword v53, v35, s[4:7], s77 offen offset:1024 sc1
  buffer_load_dwordx4 v[44:47], v2, s[4:7], s77 offen offset:0 sc1
  buffer_load_dword v55, v35, s[4:7], s77 offen offset:1024 sc1
  s_add_u32 s14, s14, 1
  s_cmp_lt_u32 s14, 100000
  s_cselect_b32 s75, 1, 0
  s_waitcnt vmcnt(4)
  s_branch L_hl_420
L_hcmiss_422:
  buffer_load_dwordx4 v[40:43], v2, s[4:7], s77 offen offset:0 sc1
  buffer_load_dword v53, v35, s[4:7], s77 offen offset:1024 sc1
  v_mfma_f32_16x16x16_bf16 v[72:75], v[18:19], v[48:49], 0
  v_mfma_f32_16x16x16_bf16 v[76:79], v[18:19], v[50:51], 0
  s_waitcnt vmcnt(3)
  v_mfma_f32_16x16x16_bf16 v[72:75], v[18:19], v[44:45], v[72:75]
  v_bitop3_b32 v37, v44, v46, s49 bitop3:0x7e
  v_mfma_f32_16x16x16_bf16 v[76:79], v[18:19], v[46:47], v[76:79]
  s_waitcnt vmcnt(2)
  v_bitop3_b32 v38, v55, s49, v7 bitop3:0x28
  v_bitop3_b32 v37, v37, v38, 1 bitop3:0xa8
  v_mfma_f32_16x16x16_bf16 v[80:83], v[4:5], v[54:55], 0
  v_cmp_ne_u32 vcc, 0, v37
  s_cbranch_vccz L_hcgot_423
  buffer_load_dwordx4 v[44:47], v2, s[4:7], s77 offen offset:0 sc1
  buffer_load_dword v55, v35, s[4:7], s77 offen offset:1024 sc1
  s_add_u32 s14, s14, 1
  s_cmp_lt_u32 s14, 100000
  s_cselect_b32 s75, 1, 0
  v_mfma_f32_16x16x16_bf16 v[72:75], v[18:19], v[48:49], 0
  v_mfma_f32_16x16x16_bf16 v[76:79], v[18:19], v[50:51], 0
  s_waitcnt vmcnt(3)
  v_mfma_f32_16x16x16_bf16 v[72:75], v[18:19], v[40:41], v[72:75]
  v_bitop3_b32 v37, v40, v42, s49 bitop3:0x7e
  v_mfma_f32_16x16x16_bf16 v[76:79], v[18:19], v[42:43], v[76:79]
  s_waitcnt vmcnt(2)
  v_bitop3_b32 v38, v53, s49, v7 bitop3:0x28
  v_bitop3_b32 v37, v37, v38, s75 bitop3:0xa8
  v_mfma_f32_16x16x16_bf16 v[80:83], v[4:5], v[52:53], 0
  v_cmp_ne_u32 vcc, 0, v37
  s_cbranch_vccnz L_hcmiss_422
  s_branch L_hcgot_423
.section .rodata,"a"
.p2align 6
.amdhsa_kernel interleave_layers__memory_aug_recurrent_mem_tr__sliding_local_dilated__prompt_kernel
  .amdhsa_next_free_vgpr 512
  .amdhsa_next_free_sgpr 102
  .amdhsa_accum_offset 256
  .amdhsa_group_segment_fixed_size 0
  .amdhsa_kernarg_size 104
  .amdhsa_user_sgpr_count 2
  .amdhsa_user_sgpr_kernarg_segment_ptr 1
  .amdhsa_system_sgpr_workgroup_id_x 1
  .amdhsa_float_denorm_mode_32 3
.end_amdhsa_kernel
```
